```python
import torch

def _softmax(x, axis=-1):
    return torch.softmax(x, dim=axis)

def _gelu(x):
    return torch.nn.functional.gelu(x, approximate='tanh')

def _silu(x):
    return torch.nn.functional.silu(x)

def _sigmoid(x):
    return torch.sigmoid(x)

def _layernorm(x, axis=-1, eps=1e-05):
    m = x.mean(dim=axis, keepdim=True)
    v = x.var(dim=axis, keepdim=True, unbiased=False)
    return (x - m) / torch.sqrt(v + eps)

def _scatter_add(tgt, idx, src, axis=0):
    return tgt.clone().index_add_(axis, idx, src)

def _segment_sum(src, seg, n):
    out = torch.zeros((n,) + src.shape[1:], dtype=src.dtype)
    return out.index_add_(0, seg, src)

def _pad(x, pw):
    flat = tuple((v for pair in reversed(pw) for v in pair))
    return torch.nn.functional.pad(x, flat)
kernel_name = 'sequential_preLN__linear_kernel_hedgehog__mixer_gmlp__prompt'

def setup_inputs():

    _w = lambda a: (lambda t: t.to(torch.bfloat16) if t.is_floating_point() else t)(torch.as_tensor(a))

    def _A_setup():
        B, S, D, H = (1, 2048, 1024, 32)
        Dh = D // H
        return {'x': _w((lambda *s: torch.randn(*s, dtype=torch.bfloat16) * 0.05)(B, S, D)), 'wqkv': _w((lambda *s: torch.randn(*s, dtype=torch.bfloat16) * 0.2)(D, 3 * D)), 'w_phi': _w((lambda *s: torch.randn(*s, dtype=torch.bfloat16) * 0.2)(H, Dh, Dh) * Dh ** (-0.5)), 'wo': _w((lambda *s: torch.randn(*s, dtype=torch.bfloat16) * 0.05)(D, D))}
    _A_in = _A_setup()

    def _B_setup():
        B, S, D, F = (1, 2048, 1024, 3584)
        Fh = F // 2
        return {'x': _w((lambda *s: torch.randn(*s, dtype=torch.bfloat16) * 0.05)(B, S, D)), 'w_in': _w((lambda *s: torch.randn(*s, dtype=torch.bfloat16) * 0.2)(D, 2 * Fh)), 'w_sp': _w(0.01 * (lambda *s: torch.randn(*s, dtype=torch.bfloat16) * 0.2)(S, S)), 'b_sp': _w(1.0 + 0.01 * (lambda *s: torch.randn(*s, dtype=torch.bfloat16) * 0.05)(S)), 'w_out': _w((lambda *s: torch.randn(*s, dtype=torch.bfloat16) * 0.05)(Fh, D))}
    _B_in = _B_setup()
    return {'A_x': _A_in['x'], 'A_wqkv': _A_in['wqkv'], 'A_w_phi': _A_in['w_phi'], 'A_wo': _A_in['wo'], 'B_x': _B_in['x'], 'B_w_in': _B_in['w_in'], 'B_w_sp': _B_in['w_sp'], 'B_b_sp': _B_in['b_sp'], 'B_w_out': _B_in['w_out']}

def reference(A_x, A_wqkv, A_w_phi, A_wo, B_x, B_w_in, B_w_sp, B_b_sp, B_w_out):

    def _A_ref(x, wqkv, w_phi, wo):
        B, S, D = x.shape
        H = 32
        Dh = D // H
        qkv = (lambda x, *d: x.permute(*d))((x @ wqkv).reshape(B, S, 3, H, Dh), 2, 0, 3, 1, 4)
        q, k, v = (qkv[0], qkv[1], qkv[2])
        pq = torch.einsum('bhsd,hdf->bhsf', q, w_phi)
        pk = torch.einsum('bhsd,hdf->bhsf', k, w_phi)
        phi_q = torch.concatenate([_softmax(pq, axis=-1), _softmax(-pq, axis=-1)], axis=-1)
        phi_k = torch.concatenate([_softmax(pk, axis=-1), _softmax(-pk, axis=-1)], axis=-1)
        kv = torch.einsum('bhsf,bhsd->bhfd', phi_k, v)
        z = torch.einsum('bhsf->bhf', phi_k)
        num = torch.einsum('bhqf,bhfd->bhqd', phi_q, kv)
        den = torch.einsum('bhqf,bhf->bhq', phi_q, z)[..., None] + 1e-06
        o = num / den
        return (lambda x, *d: x.permute(*d))(o, 0, 2, 1, 3).reshape(B, S, D) @ wo

    def _B_ref(x, w_in, w_sp, b_sp, w_out):
        B, S, D = x.shape
        F = w_in.shape[-1]
        Fh = F // 2
        z = _gelu(torch.einsum('bsd,df->bsf', x, w_in))
        z1 = z[..., :Fh].clone()
        z2 = _layernorm(z[..., Fh:], axis=-1)
        g = torch.einsum('ts,bsf->btf', w_sp, z2) + b_sp[None, :, None]
        return torch.einsum('bsf,fd->bsd', z1 * g, w_out)
    x = A_x
    h = x + _A_ref(_layernorm(x, axis=-1), A_wqkv, A_w_phi, A_wo)
    h2 = h + _B_ref(_layernorm(h, axis=-1), B_w_in, B_w_sp, B_b_sp, B_w_out)
    return h2
```

```asm
; @launch grid=(256,1,1) block=(512,1,1) lds=163840
.amdgcn_target "amdgcn-amd-amdhsa--gfx950"
.text
.globl sequential_preLN__linear_kernel_hedgehog__mixer_gmlp__prompt_kernel
.p2align 8
.type sequential_preLN__linear_kernel_hedgehog__mixer_gmlp__prompt_kernel,@function
sequential_preLN__linear_kernel_hedgehog__mixer_gmlp__prompt_kernel:
    s_cmp_ge_u32 s2, 256
    s_cbranch_scc1 L_end
    s_load_dwordx16 s[32:47], s[0:1], 0
    s_load_dwordx8 s[48:55], s[0:1], 64
    v_lshrrev_b32 v2, 6, v0
    v_and_b32 v1, 63, v0
    v_readfirstlane_b32 s3, v2
    s_and_b32 s56, s2, 7
    s_lshr_b32 s57, s2, 3
    s_and_b32 s58, s57, 7
    s_lshr_b32 s59, s57, 3
    s_lshr_b32 s4, s56, 2
    s_mul_i32 s4, s4, 8
    s_add_u32 s4, s4, s58
    s_and_b32 s5, s56, 3
    s_mul_i32 s5, s5, 4
    s_add_u32 s5, s5, s59
    s_add_u32 s6, s58, s59
    s_cmp_ge_u32 s2, 192
    s_cselect_b32 s101, 1, s2
    s_cmp_lt_u32 s3, 4
    s_cbranch_scc1 L_cons
    s_and_b32 s93, s4, 7
    s_mul_i32 s93, s93, 5
    s_lshr_b32 s93, s93, 3
    s_add_u32 s93, s93, 1
    s_and_b32 s74, s3, 1
    s_sub_u32 s92, s3, 4
    s_cmp_ge_u32 s3, 6
    s_cbranch_scc1 L_aux
    s_setprio 2
    s_lshl_b32 s86, s74, 10
    s_sub_u32 s56, s4, s6
    s_and_b32 s56, s56, 3
    s_lshl_b32 s56, s56, 2
    s_lshr_b32 s56, 39302, s56
    s_and_b32 s56, s56, 15
    s_add_u32 s56, s56, s4
    s_sub_u32 s56, s56, 8
    s_and_b32 s75, s56, 15
    s_lshl_b32 s7, s5, 7
    v_lshrrev_b32 v2, 3, v1
    v_and_b32 v4, 7, v1
    s_lshl_b32 s62, s74, 3
    v_lshrrev_b32 v3, 4, v1
    s_lshl_b32 s61, s74, 2
    v_add_u32 v3, s61, v3
    v_xor_b32 v3, v3, v4
    v_lshlrev_b32 v3, 4, v3
    s_mul_i32 s61, s4, 128
    s_add_u32 s61, s61, s62
    v_add_u32 v5, s61, v2
    s_mov_b32 s63, 2048
    v_mul_lo_u32 v5, v5, s63
    v_add_u32 v16, v5, v3
    v_add_u32 v17, 32768, v16
    v_add_u32 v18, 65536, v16
    v_add_u32 v19, 98304, v16
    v_add_u32 v20, 131072, v16
    v_add_u32 v21, 163840, v16
    v_add_u32 v22, 196608, v16
    v_add_u32 v23, 229376, v16
    v_lshrrev_b32 v2, 3, v1
    v_and_b32 v4, 7, v1
    s_lshl_b32 s62, s74, 3
    v_lshrrev_b32 v3, 2, v1
    v_and_b32 v3, 4, v3
    v_xor_b32 v3, v3, v4
    s_lshl_b32 s61, s74, 1
    v_xor_b32 v3, s61, v3
    v_lshlrev_b32 v3, 4, v3
    v_add_u32 v5, s62, v2
    s_mov_b32 s63, 6144
    v_mul_lo_u32 v5, v5, s63
    v_add3_u32 v5, v5, v3, s7
    v_add_u32 v24, 0, v5
    v_add_u32 v25, 98304, v5
    v_add_u32 v26, 196608, v5
    v_add_u32 v27, 294912, v5
    v_add_u32 v28, 2048, v5
    v_add_u32 v29, 100352, v5
    v_add_u32 v30, 198656, v5
    v_add_u32 v31, 296960, v5
    v_add_u32 v32, 4096, v5
    v_add_u32 v33, 102400, v5
    v_add_u32 v34, 200704, v5
    v_add_u32 v35, 299008, v5
    s_mov_b32 s87, 0
    s_mov_b32 s81, 0
    s_cmp_gt_u32 s87, s93
    s_subb_u32 s65, s87, 0
    s_cmp_ge_u32 s65, s75
    s_addc_u32 s65, s65, 0
    s_cmp_eq_u32 s87, s93
    s_cselect_b32 s65, s75, s65
    s_sub_u32 s64, s65, s6
    s_and_b32 s64, s64, 3
    s_lshl_b32 s64, s64, 2
    s_lshr_b32 s64, 31367, s64
    s_and_b32 s64, s64, 15
    s_add_u32 s64, s64, s65
    s_sub_u32 s64, s64, 8
    s_and_b32 s64, s64, 15
    s_lshl_b32 s60, s64, 7
    s_mul_i32 s61, s64, 393216
    s_mul_i32 s62, s81, 16384
    s_add_u32 s62, s62, s86
    s_mul_i32 s63, s81, 24576
    s_add_u32 s63, s63, s86
    s_add_u32 s87, s87, 1
    s_add_u32 s81, s81, 1
    s_cmp_eq_u32 s81, 3
    s_cselect_b32 s81, 0, s81
    s_waitcnt lgkmcnt(0)
    s_mov_b32 s8, s32
    s_mov_b32 s9, s33
    s_mov_b32 s10, 4194304
    s_mov_b32 s11, 0x20000
    s_mov_b32 s12, s34
    s_mov_b32 s13, s35
    s_mov_b32 s14, 6291456
    s_mov_b32 s15, 0x20000
    s_add_u32 m0, s62, 0
    s_nop 0
    buffer_load_dwordx4 v16, s[8:11], s60 offen  lds
    s_add_u32 m0, s62, 2048
    s_cmp_gt_u32 s87, s93
    s_subb_u32 s65, s87, 0
    s_cmp_ge_u32 s65, s75
    s_addc_u32 s65, s65, 0
    buffer_load_dwordx4 v17, s[8:11], s60 offen  lds
    s_add_u32 m0, s62, 4096
    s_cmp_eq_u32 s87, s93
    s_cselect_b32 s65, s75, s65
    buffer_load_dwordx4 v18, s[8:11], s60 offen  lds
    s_add_u32 m0, s62, 6144
    s_sub_u32 s64, s65, s6
    buffer_load_dwordx4 v19, s[8:11], s60 offen  lds
    s_add_u32 m0, s62, 8192
    s_and_b32 s64, s64, 3
    buffer_load_dwordx4 v20, s[8:11], s60 offen  lds
    s_add_u32 m0, s62, 10240
    s_lshl_b32 s64, s64, 2
    buffer_load_dwordx4 v21, s[8:11], s60 offen  lds
    s_add_u32 m0, s62, 12288
    s_lshr_b32 s64, 31367, s64
    buffer_load_dwordx4 v22, s[8:11], s60 offen  lds
    s_add_u32 m0, s62, 14336
    s_and_b32 s64, s64, 15
    buffer_load_dwordx4 v23, s[8:11], s60 offen  lds
    s_add_u32 m0, s63, 49152
    s_add_u32 s64, s64, s65
    buffer_load_dwordx4 v24, s[12:15], s61 offen  lds
    s_add_u32 m0, s63, 51200
    s_sub_u32 s64, s64, 8
    buffer_load_dwordx4 v25, s[12:15], s61 offen  lds
    s_add_u32 m0, s63, 53248
    s_and_b32 s64, s64, 15
    buffer_load_dwordx4 v26, s[12:15], s61 offen  lds
    s_add_u32 m0, s63, 55296
    s_lshl_b32 s68, s64, 7
    buffer_load_dwordx4 v27, s[12:15], s61 offen  lds
    s_add_u32 m0, s63, 57344
    s_mul_i32 s69, s64, 393216
    buffer_load_dwordx4 v28, s[12:15], s61 offen  lds
    s_add_u32 m0, s63, 59392
    s_mul_i32 s70, s81, 16384
    buffer_load_dwordx4 v29, s[12:15], s61 offen  lds
    s_add_u32 m0, s63, 61440
    s_add_u32 s70, s70, s86
    buffer_load_dwordx4 v30, s[12:15], s61 offen  lds
    s_add_u32 m0, s63, 63488
    s_mul_i32 s71, s81, 24576
    buffer_load_dwordx4 v31, s[12:15], s61 offen  lds
    s_add_u32 m0, s63, 65536
    s_add_u32 s71, s71, s86
    buffer_load_dwordx4 v32, s[12:15], s61 offen  lds
    s_add_u32 m0, s63, 67584
    s_add_u32 s87, s87, 1
    buffer_load_dwordx4 v33, s[12:15], s61 offen  lds
    s_add_u32 m0, s63, 69632
    s_add_u32 s81, s81, 1
    buffer_load_dwordx4 v34, s[12:15], s61 offen  lds
    s_add_u32 m0, s63, 71680
    s_cmp_eq_u32 s81, 3
    s_cselect_b32 s81, 0, s81
    buffer_load_dwordx4 v35, s[12:15], s61 offen  lds
    s_add_u32 m0, s70, 0
    s_nop 0
    buffer_load_dwordx4 v16, s[8:11], s68 offen  lds
    s_add_u32 m0, s70, 2048
    s_cmp_gt_u32 s87, s93
    s_subb_u32 s65, s87, 0
    s_cmp_ge_u32 s65, s75
    s_addc_u32 s65, s65, 0
    buffer_load_dwordx4 v17, s[8:11], s68 offen  lds
    s_add_u32 m0, s70, 4096
    s_cmp_eq_u32 s87, s93
    s_cselect_b32 s65, s75, s65
    buffer_load_dwordx4 v18, s[8:11], s68 offen  lds
    s_add_u32 m0, s70, 6144
    s_sub_u32 s64, s65, s6
    buffer_load_dwordx4 v19, s[8:11], s68 offen  lds
    s_add_u32 m0, s70, 8192
    s_and_b32 s64, s64, 3
    buffer_load_dwordx4 v20, s[8:11], s68 offen  lds
    s_add_u32 m0, s70, 10240
    s_lshl_b32 s64, s64, 2
    buffer_load_dwordx4 v21, s[8:11], s68 offen  lds
    s_add_u32 m0, s70, 12288
    s_lshr_b32 s64, 31367, s64
    buffer_load_dwordx4 v22, s[8:11], s68 offen  lds
    s_add_u32 m0, s70, 14336
    s_and_b32 s64, s64, 15
    buffer_load_dwordx4 v23, s[8:11], s68 offen  lds
    s_add_u32 m0, s71, 49152
    s_add_u32 s64, s64, s65
    buffer_load_dwordx4 v24, s[12:15], s69 offen  lds
    s_add_u32 m0, s71, 51200
    s_sub_u32 s64, s64, 8
    buffer_load_dwordx4 v25, s[12:15], s69 offen  lds
    s_add_u32 m0, s71, 53248
    s_and_b32 s64, s64, 15
    buffer_load_dwordx4 v26, s[12:15], s69 offen  lds
    s_add_u32 m0, s71, 55296
    s_lshl_b32 s60, s64, 7
    buffer_load_dwordx4 v27, s[12:15], s69 offen  lds
    s_add_u32 m0, s71, 57344
    s_mul_i32 s61, s64, 393216
    buffer_load_dwordx4 v28, s[12:15], s69 offen  lds
    s_add_u32 m0, s71, 59392
    s_mul_i32 s62, s81, 16384
    buffer_load_dwordx4 v29, s[12:15], s69 offen  lds
    s_add_u32 m0, s71, 61440
    s_add_u32 s62, s62, s86
    buffer_load_dwordx4 v30, s[12:15], s69 offen  lds
    s_add_u32 m0, s71, 63488
    s_mul_i32 s63, s81, 24576
    buffer_load_dwordx4 v31, s[12:15], s69 offen  lds
    s_add_u32 m0, s71, 65536
    s_add_u32 s63, s63, s86
    buffer_load_dwordx4 v32, s[12:15], s69 offen  lds
    s_add_u32 m0, s71, 67584
    s_add_u32 s87, s87, 1
    buffer_load_dwordx4 v33, s[12:15], s69 offen  lds
    s_add_u32 m0, s71, 69632
    s_add_u32 s81, s81, 1
    buffer_load_dwordx4 v34, s[12:15], s69 offen  lds
    s_add_u32 m0, s71, 71680
    s_cmp_eq_u32 s81, 3
    s_cselect_b32 s81, 0, s81
    buffer_load_dwordx4 v35, s[12:15], s69 offen  lds
    s_add_u32 m0, s62, 0
    s_waitcnt vmcnt(20)
    s_barrier
    buffer_load_dwordx4 v16, s[8:11], s60 offen  lds
    s_add_u32 m0, s62, 2048
    s_cmp_gt_u32 s87, s93
    s_subb_u32 s65, s87, 0
    s_cmp_ge_u32 s65, s75
    s_addc_u32 s65, s65, 0
    buffer_load_dwordx4 v17, s[8:11], s60 offen  lds
    s_add_u32 m0, s62, 4096
    s_cmp_eq_u32 s87, s93
    s_cselect_b32 s65, s75, s65
    buffer_load_dwordx4 v18, s[8:11], s60 offen  lds
    s_add_u32 m0, s62, 6144
    s_sub_u32 s64, s65, s6
    buffer_load_dwordx4 v19, s[8:11], s60 offen  lds
    s_add_u32 m0, s62, 8192
    s_and_b32 s64, s64, 3
    buffer_load_dwordx4 v20, s[8:11], s60 offen  lds
    s_add_u32 m0, s62, 10240
    s_lshl_b32 s64, s64, 2
    buffer_load_dwordx4 v21, s[8:11], s60 offen  lds
    s_add_u32 m0, s62, 12288
    s_lshr_b32 s64, 31367, s64
    buffer_load_dwordx4 v22, s[8:11], s60 offen  lds
    s_add_u32 m0, s62, 14336
    s_and_b32 s64, s64, 15
    buffer_load_dwordx4 v23, s[8:11], s60 offen  lds
    s_add_u32 m0, s63, 49152
    s_add_u32 s64, s64, s65
    buffer_load_dwordx4 v24, s[12:15], s61 offen  lds
    s_add_u32 m0, s63, 51200
    s_sub_u32 s64, s64, 8
    buffer_load_dwordx4 v25, s[12:15], s61 offen  lds
    s_add_u32 m0, s63, 53248
    s_and_b32 s64, s64, 15
    buffer_load_dwordx4 v26, s[12:15], s61 offen  lds
    s_add_u32 m0, s63, 55296
    s_lshl_b32 s68, s64, 7
    buffer_load_dwordx4 v27, s[12:15], s61 offen  lds
    s_add_u32 m0, s63, 57344
    s_mul_i32 s69, s64, 393216
    buffer_load_dwordx4 v28, s[12:15], s61 offen  lds
    s_add_u32 m0, s63, 59392
    s_mul_i32 s70, s81, 16384
    buffer_load_dwordx4 v29, s[12:15], s61 offen  lds
    s_add_u32 m0, s63, 61440
    s_add_u32 s70, s70, s86
    buffer_load_dwordx4 v30, s[12:15], s61 offen  lds
    s_add_u32 m0, s63, 63488
    s_mul_i32 s71, s81, 24576
    buffer_load_dwordx4 v31, s[12:15], s61 offen  lds
    s_add_u32 m0, s63, 65536
    s_add_u32 s71, s71, s86
    buffer_load_dwordx4 v32, s[12:15], s61 offen  lds
    s_add_u32 m0, s63, 67584
    s_add_u32 s87, s87, 1
    buffer_load_dwordx4 v33, s[12:15], s61 offen  lds
    s_add_u32 m0, s63, 69632
    s_add_u32 s81, s81, 1
    buffer_load_dwordx4 v34, s[12:15], s61 offen  lds
    s_add_u32 m0, s63, 71680
    s_cmp_eq_u32 s81, 3
    s_cselect_b32 s81, 0, s81
    buffer_load_dwordx4 v35, s[12:15], s61 offen  lds
    s_mov_b32 s24, s54
    s_mov_b32 s25, s55
    s_mov_b32 s26, 45088768
    s_mov_b32 s27, 0x20000
    s_mov_b32 s16, s32
    s_mov_b32 s17, s33
    s_mov_b32 s18, 0
    s_mov_b32 s19, 0x20000
    s_mov_b32 s20, s32
    s_mov_b32 s21, s33
    s_mov_b32 s22, 0
    s_mov_b32 s23, 0x20000
    s_mov_b32 s28, s32
    s_mov_b32 s29, s33
    s_mov_b32 s30, 0
    s_mov_b32 s31, 0x20000
    s_mov_b32 s80, 6
L_p_lp_1:
    s_add_u32 m0, s70, 0
    s_waitcnt vmcnt(20)
    s_barrier
    buffer_load_dwordx4 v16, s[8:11], s68 offen  lds
    s_add_u32 m0, s70, 2048
    s_sub_u32 s80, s80, 1
    s_cmp_gt_u32 s87, s93
    s_subb_u32 s65, s87, 0
    buffer_load_dwordx4 v17, s[8:11], s68 offen  lds
    s_add_u32 m0, s70, 4096
    s_cmp_ge_u32 s65, s75
    s_addc_u32 s65, s65, 0
    buffer_load_dwordx4 v18, s[8:11], s68 offen  lds
    s_add_u32 m0, s70, 6144
    s_cmp_eq_u32 s87, s93
    s_cselect_b32 s65, s75, s65
    buffer_load_dwordx4 v19, s[8:11], s68 offen  lds
    s_add_u32 m0, s70, 8192
    s_sub_u32 s64, s65, s6
    buffer_load_dwordx4 v20, s[8:11], s68 offen  lds
    s_add_u32 m0, s70, 10240
    s_and_b32 s64, s64, 3
    buffer_load_dwordx4 v21, s[8:11], s68 offen  lds
    s_add_u32 m0, s70, 12288
    s_lshl_b32 s64, s64, 2
    buffer_load_dwordx4 v22, s[8:11], s68 offen  lds
    s_add_u32 m0, s70, 14336
    s_lshr_b32 s64, 31367, s64
    buffer_load_dwordx4 v23, s[8:11], s68 offen  lds
    s_add_u32 m0, s71, 49152
    s_and_b32 s64, s64, 15
    buffer_load_dwordx4 v24, s[12:15], s69 offen  lds
    s_add_u32 m0, s71, 51200
    s_add_u32 s64, s64, s65
    buffer_load_dwordx4 v25, s[12:15], s69 offen  lds
    s_add_u32 m0, s71, 53248
    s_sub_u32 s64, s64, 8
    s_and_b32 s64, s64, 15
    buffer_load_dwordx4 v26, s[12:15], s69 offen  lds
    s_add_u32 m0, s71, 55296
    s_lshl_b32 s60, s64, 7
    buffer_load_dwordx4 v27, s[12:15], s69 offen  lds
    s_add_u32 m0, s71, 57344
    s_mul_i32 s61, s64, 393216
    buffer_load_dwordx4 v28, s[12:15], s69 offen  lds
    s_add_u32 m0, s71, 59392
    s_mul_i32 s62, s81, 16384
    buffer_load_dwordx4 v29, s[12:15], s69 offen  lds
    s_add_u32 m0, s71, 61440
    s_add_u32 s62, s62, s86
    buffer_load_dwordx4 v30, s[12:15], s69 offen  lds
    s_add_u32 m0, s71, 63488
    s_mul_i32 s63, s81, 24576
    buffer_load_dwordx4 v31, s[12:15], s69 offen  lds
    s_add_u32 m0, s71, 65536
    s_add_u32 s63, s63, s86
    buffer_load_dwordx4 v32, s[12:15], s69 offen  lds
    s_add_u32 m0, s71, 67584
    s_add_u32 s87, s87, 1
    buffer_load_dwordx4 v33, s[12:15], s69 offen  lds
    s_add_u32 m0, s71, 69632
    s_add_u32 s81, s81, 1
    buffer_load_dwordx4 v34, s[12:15], s69 offen  lds
    s_add_u32 m0, s71, 71680
    s_cmp_eq_u32 s81, 3
    s_cselect_b32 s81, 0, s81
    buffer_load_dwordx4 v35, s[12:15], s69 offen  lds
    s_add_u32 m0, s62, 0
    s_waitcnt vmcnt(20)
    s_barrier
    buffer_load_dwordx4 v16, s[8:11], s60 offen  lds
    s_add_u32 m0, s62, 2048
    s_cmp_gt_u32 s87, s93
    s_subb_u32 s65, s87, 0
    s_cmp_ge_u32 s65, s75
    s_addc_u32 s65, s65, 0
    buffer_load_dwordx4 v17, s[8:11], s60 offen  lds
    s_add_u32 m0, s62, 4096
    s_cmp_eq_u32 s87, s93
    s_cselect_b32 s65, s75, s65
    buffer_load_dwordx4 v18, s[8:11], s60 offen  lds
    s_add_u32 m0, s62, 6144
    s_sub_u32 s64, s65, s6
    buffer_load_dwordx4 v19, s[8:11], s60 offen  lds
    s_add_u32 m0, s62, 8192
    s_and_b32 s64, s64, 3
    buffer_load_dwordx4 v20, s[8:11], s60 offen  lds
    s_add_u32 m0, s62, 10240
    s_lshl_b32 s64, s64, 2
    buffer_load_dwordx4 v21, s[8:11], s60 offen  lds
    s_add_u32 m0, s62, 12288
    s_lshr_b32 s64, 31367, s64
    buffer_load_dwordx4 v22, s[8:11], s60 offen  lds
    s_add_u32 m0, s62, 14336
    s_and_b32 s64, s64, 15
    buffer_load_dwordx4 v23, s[8:11], s60 offen  lds
    s_add_u32 m0, s63, 49152
    s_add_u32 s64, s64, s65
    buffer_load_dwordx4 v24, s[12:15], s61 offen  lds
    s_add_u32 m0, s63, 51200
    s_sub_u32 s64, s64, 8
    buffer_load_dwordx4 v25, s[12:15], s61 offen  lds
    s_add_u32 m0, s63, 53248
    s_and_b32 s64, s64, 15
    buffer_load_dwordx4 v26, s[12:15], s61 offen  lds
    s_add_u32 m0, s63, 55296
    s_lshl_b32 s68, s64, 7
    buffer_load_dwordx4 v27, s[12:15], s61 offen  lds
    s_add_u32 m0, s63, 57344
    s_mul_i32 s69, s64, 393216
    buffer_load_dwordx4 v28, s[12:15], s61 offen  lds
    s_add_u32 m0, s63, 59392
    s_mul_i32 s70, s81, 16384
    buffer_load_dwordx4 v29, s[12:15], s61 offen  lds
    s_add_u32 m0, s63, 61440
    s_add_u32 s70, s70, s86
    buffer_load_dwordx4 v30, s[12:15], s61 offen  lds
    s_add_u32 m0, s63, 63488
    s_mul_i32 s71, s81, 24576
    buffer_load_dwordx4 v31, s[12:15], s61 offen  lds
    s_add_u32 m0, s63, 65536
    s_add_u32 s71, s71, s86
    buffer_load_dwordx4 v32, s[12:15], s61 offen  lds
    s_add_u32 m0, s63, 67584
    s_add_u32 s87, s87, 1
    buffer_load_dwordx4 v33, s[12:15], s61 offen  lds
    s_add_u32 m0, s63, 69632
    s_add_u32 s81, s81, 1
    buffer_load_dwordx4 v34, s[12:15], s61 offen  lds
    s_add_u32 m0, s63, 71680
    s_cmp_eq_u32 s81, 3
    s_cselect_b32 s81, 0, s81
    buffer_load_dwordx4 v35, s[12:15], s61 offen  lds
    s_cmp_lg_u32 s80, 0
    s_cbranch_scc1 L_p_lp_1
    s_add_u32 m0, s70, 0
    s_waitcnt vmcnt(20)
    s_barrier
    buffer_load_dwordx4 v16, s[8:11], s68 offen  lds
    s_add_u32 m0, s70, 2048
    s_nop 0
    buffer_load_dwordx4 v17, s[8:11], s68 offen  lds
    s_add_u32 m0, s70, 4096
    s_nop 0
    buffer_load_dwordx4 v18, s[8:11], s68 offen  lds
    s_add_u32 m0, s70, 6144
    s_nop 0
    buffer_load_dwordx4 v19, s[8:11], s68 offen  lds
    s_add_u32 m0, s70, 8192
    s_nop 0
    buffer_load_dwordx4 v20, s[8:11], s68 offen  lds
    s_add_u32 m0, s70, 10240
    s_nop 0
    buffer_load_dwordx4 v21, s[8:11], s68 offen  lds
    s_add_u32 m0, s70, 12288
    s_nop 0
    buffer_load_dwordx4 v22, s[8:11], s68 offen  lds
    s_add_u32 m0, s70, 14336
    s_nop 0
    buffer_load_dwordx4 v23, s[8:11], s68 offen  lds
    s_add_u32 m0, s71, 49152
    s_nop 0
    buffer_load_dwordx4 v24, s[12:15], s69 offen  lds
    s_add_u32 m0, s71, 51200
    s_nop 0
    buffer_load_dwordx4 v25, s[12:15], s69 offen  lds
    s_add_u32 m0, s71, 53248
    s_nop 0
    buffer_load_dwordx4 v26, s[12:15], s69 offen  lds
    s_add_u32 m0, s71, 55296
    s_nop 0
    buffer_load_dwordx4 v27, s[12:15], s69 offen  lds
    s_add_u32 m0, s71, 57344
    s_nop 0
    buffer_load_dwordx4 v28, s[12:15], s69 offen  lds
    s_add_u32 m0, s71, 59392
    s_nop 0
    buffer_load_dwordx4 v29, s[12:15], s69 offen  lds
    s_add_u32 m0, s71, 61440
    s_nop 0
    buffer_load_dwordx4 v30, s[12:15], s69 offen  lds
    s_add_u32 m0, s71, 63488
    s_nop 0
    buffer_load_dwordx4 v31, s[12:15], s69 offen  lds
    s_add_u32 m0, s71, 65536
    s_nop 0
    buffer_load_dwordx4 v32, s[12:15], s69 offen  lds
    s_add_u32 m0, s71, 67584
    s_nop 0
    buffer_load_dwordx4 v33, s[12:15], s69 offen  lds
    s_add_u32 m0, s71, 69632
    s_nop 0
    buffer_load_dwordx4 v34, s[12:15], s69 offen  lds
    s_add_u32 m0, s71, 71680
    s_nop 0
    buffer_load_dwordx4 v35, s[12:15], s69 offen  lds
    s_branch L_ld
    .p2align 12
L_ld:
L_pad0:
    s_cbranch_execz L_padr0
    s_waitcnt vmcnt(20)
    s_barrier
    s_mov_b32 s16, s38
    s_mov_b32 s17, s39
    s_mov_b32 s18, 2097152
    s_mov_b32 s19, 0x20000
    s_mov_b32 s20, s42
    s_mov_b32 s21, s43
    s_mov_b32 s22, 7340032
    s_mov_b32 s23, 0x20000
    s_lshr_b32 s56, s2, 3
    s_lshl_b32 s58, s56, 2
    s_add_u32 s58, s58, s92
    s_and_b32 s59, s2, 1
    s_lshl_b32 s57, s2, 2
    s_add_u32 s57, s57, s92
    s_lshl_b32 s57, s57, 11
    v_lshlrev_b32 v3, 7, v1
    s_mov_b64 exec, 0xffff
    buffer_load_dword v250, v3, s[16:19], s57 offen
    s_mov_b64 exec, -1
    s_lshr_b32 s60, s56, 1
    s_cmp_ge_u32 s60, 7
    s_cselect_b32 s61, 7, 0
    s_add_u32 s60, s60, s61
    s_mul_i32 s61, s59, 7
    s_add_u32 s90, s60, s61
    s_and_b32 s61, s2, 6
    s_and_b32 s62, s56, 1
    s_add_u32 s91, s61, s62
    s_lshl_b32 s61, s91, 2
    s_add_u32 s61, s61, s92
    s_mul_i32 s61, s61, 229376
    s_lshl_b32 s60, s90, 8
    s_add_u32 s61, s61, s60
    s_cmp_ge_u32 s2, 224
    s_cselect_b32 s61, 7340032, s61
    v_lshrrev_b32 v3, 4, v1
    v_mul_u32_u24 v3, 7168, v3
    v_and_b32 v4, 15, v1
    v_lshl_add_u32 v5, v4, 4, v3
    buffer_load_dwordx4 v[192:195], v5, s[20:23], s61 offen
    s_add_u32 s61, s61, 28672
    buffer_load_dwordx4 v[196:199], v5, s[20:23], s61 offen
    s_add_u32 s61, s61, 28672
    buffer_load_dwordx4 v[200:203], v5, s[20:23], s61 offen
    s_add_u32 s61, s61, 28672
    buffer_load_dwordx4 v[204:207], v5, s[20:23], s61 offen
    s_add_u32 s61, s61, 28672
    buffer_load_dwordx4 v[208:211], v5, s[20:23], s61 offen
    s_add_u32 s61, s61, 28672
    buffer_load_dwordx4 v[212:215], v5, s[20:23], s61 offen
    s_add_u32 s61, s61, 28672
    buffer_load_dwordx4 v[216:219], v5, s[20:23], s61 offen
    s_add_u32 s61, s61, 28672
    buffer_load_dwordx4 v[220:223], v5, s[20:23], s61 offen
    s_add_u32 s61, s61, 28672
    s_waitcnt vmcnt(9)
    s_barrier
    s_lshl_b32 s68, s5, 4
    s_add_u32 s68, s68, s4
    s_lshl_b32 s70, s68, 4
    s_add_u32 s70, s70, 40108032
    s_lshl_b32 s68, s68, 8
    s_add_u32 s68, s68, 39845888
    v_and_b32 v13, 15, v1
    v_lshlrev_b32 v13, 4, v13
    s_and_b32 s56, s2, 7
    s_lshr_b32 s57, s2, 3
    s_and_b32 s58, s57, 3
    s_lshr_b32 s59, s57, 2
    s_lshr_b32 s4, s56, 1
    s_mul_i32 s4, s4, 4
    s_add_u32 s4, s4, s58
    s_and_b32 s5, s56, 1
    s_mul_i32 s5, s5, 8
    s_add_u32 s5, s5, s59
    s_add_u32 s6, s58, s59
    s_mov_b32 s88, 0xb3a98210
    s_mov_b32 s89, 0xfedc7654
    s_add_u32 s8, s54, 4194304
    s_addc_u32 s9, s55, 0
    s_mov_b32 s10, 4194304
    s_mov_b32 s11, 0x20000
    s_mov_b32 s12, s38
    s_mov_b32 s13, s39
    s_mov_b32 s14, 2097152
    s_mov_b32 s15, 0x20000
    s_lshl_b32 s7, s5, 7
    s_mul_i32 s61, s4, 262144
    s_add_u32 s61, s61, s86
    v_lshlrev_b32 v3, 4, v1
    v_add_u32 v16, s61, v3
    v_add_u32 v17, 2048, v16
    v_add_u32 v18, 65536, v16
    v_add_u32 v19, 67584, v16
    v_add_u32 v20, 131072, v16
    v_add_u32 v21, 133120, v16
    v_add_u32 v22, 196608, v16
    v_add_u32 v23, 198656, v16
    v_lshrrev_b32 v2, 3, v1
    v_and_b32 v4, 7, v1
    s_lshl_b32 s62, s74, 3
    v_lshrrev_b32 v3, 2, v1
    v_and_b32 v3, 4, v3
    v_xor_b32 v3, v3, v4
    s_lshl_b32 s61, s74, 1
    v_xor_b32 v3, s61, v3
    v_lshlrev_b32 v3, 4, v3
    v_add_u32 v5, s62, v2
    s_mov_b32 s63, 2048
    v_mul_lo_u32 v5, v5, s63
    v_add3_u32 v5, v5, v3, s7
    v_add_u32 v24, 0, v5
    v_add_u32 v25, 32768, v5
    v_add_u32 v26, 65536, v5
    v_add_u32 v27, 98304, v5
    s_barrier
    s_barrier
    s_mov_b32 s87, 0
    s_mov_b32 s81, 0
L_p_if_2:
    s_sub_u32 s64, s87, s6
    s_and_b32 s64, s64, 3
    s_lshl_b32 s64, s64, 2
    s_lshr_b32 s64, 31367, s64
    s_and_b32 s64, s64, 15
    s_add_u32 s64, s64, s87
    s_sub_u32 s64, s64, 8
    s_sub_u32 s65, s6, s87
    s_and_b32 s65, s65, 3
    s_add_u32 s65, s65, s87
    s_lshr_b32 s65, 0xff3c, s65
    s_and_b32 s65, s65, 1
    s_cselect_b32 s64, s64, s87
    s_lshl_b32 s64, s64, 2
    s_lshr_b64 s[66:67], s[88:89], s64
    s_and_b32 s64, s66, 15
    s_mul_i32 s85, s64, 131072
    s_mul_i32 s65, s81, 8192
    s_add_u32 s65, s65, s86
    s_add_u32 m0, s65, 65536
    s_nop 0
    buffer_load_dwordx4 v24, s[12:15], s85 offen  lds
    s_add_u32 m0, m0, 2048
    s_nop 0
    buffer_load_dwordx4 v25, s[12:15], s85 offen  lds
    s_add_u32 m0, m0, 2048
    s_nop 0
    buffer_load_dwordx4 v26, s[12:15], s85 offen  lds
    s_add_u32 m0, m0, 2048
    s_nop 0
    buffer_load_dwordx4 v27, s[12:15], s85 offen  lds
    s_add_u32 s87, s87, 1
    s_add_u32 s81, s81, 1
    s_cmp_eq_u32 s81, 4
    s_cselect_b32 s81, 0, s81
    s_cmp_lt_u32 s87, 4
    s_cbranch_scc1 L_p_if_2
    s_barrier
    s_mul_i32 s61, s4, 458752
    s_add_u32 s61, s61, s86
    v_lshlrev_b32 v3, 4, v1
    v_add_u32 v52, s61, v3
    v_add_u32 v53, 2048, v52
    v_add_u32 v54, 114688, v52
    v_add_u32 v55, 116736, v52
    v_add_u32 v56, 229376, v52
    v_add_u32 v57, 231424, v52
    v_add_u32 v58, 344064, v52
    v_add_u32 v59, 346112, v52
    v_lshrrev_b32 v2, 3, v1
    v_and_b32 v4, 7, v1
    s_lshl_b32 s62, s74, 3
    v_lshrrev_b32 v3, 2, v1
    v_and_b32 v3, 4, v3
    v_xor_b32 v3, v3, v4
    s_lshl_b32 s61, s74, 1
    v_xor_b32 v3, s61, v3
    v_lshlrev_b32 v3, 4, v3
    v_add_u32 v5, s62, v2
    s_mov_b32 s63, 2048
    v_mul_lo_u32 v5, v5, s63
    v_add3_u32 v5, v5, v3, s7
    v_add_u32 v60, 0, v5
    v_add_u32 v61, 32768, v5
    v_add_u32 v62, 65536, v5
    v_add_u32 v63, 98304, v5
    v_add_u32 v64, 0, v5
    v_add_u32 v65, 32768, v5
    v_add_u32 v66, 65536, v5
    v_add_u32 v67, 98304, v5
    s_and_b32 s56, s2, 1
    s_mul_i32 s57, s56, 28672
    s_mul_i32 s58, s56, 917504
    v_add_u32 v52, s57, v52
    v_add_u32 v53, s57, v53
    v_add_u32 v54, s57, v54
    v_add_u32 v55, s57, v55
    v_add_u32 v56, s57, v56
    v_add_u32 v57, s57, v57
    v_add_u32 v58, s57, v58
    v_add_u32 v59, s57, v59
    v_xor_b32 v60, 1024, v60
    v_add_u32 v60, s58, v60
    v_xor_b32 v61, 1024, v61
    v_add_u32 v61, s58, v61
    v_xor_b32 v62, 1024, v62
    v_add_u32 v62, s58, v62
    v_xor_b32 v63, 1024, v63
    v_add_u32 v63, s58, v63
    v_add_u32 v64, s58, v64
    v_add_u32 v65, s58, v65
    v_add_u32 v66, s58, v66
    v_add_u32 v67, s58, v67
    s_sub_u32 s7, s5, s56
    s_lshl_b32 s7, s7, 8
    s_mov_b32 s96, 3584
    v_lshrrev_b32 v2, 3, v1
    v_and_b32 v4, 7, v1
    s_lshl_b32 s62, s74, 3
    v_lshrrev_b32 v3, 2, v1
    v_and_b32 v3, 4, v3
    v_xor_b32 v3, v3, v4
    s_lshl_b32 s61, s74, 1
    v_xor_b32 v3, s61, v3
    v_lshlrev_b32 v3, 4, v3
    v_add_u32 v5, s62, v2
    s_mov_b32 s63, 7168
    v_mul_lo_u32 v5, v5, s63
    v_add3_u32 v5, v5, v3, s7
    v_add_u32 v68, 0, v5
    v_add_u32 v69, 114688, v5
    v_add_u32 v70, 229376, v5
    v_add_u32 v71, 344064, v5
    v_add_u32 v72, 128, v5
    v_add_u32 v73, 114816, v5
    v_add_u32 v74, 229504, v5
    v_add_u32 v75, 344192, v5
    s_cmp_eq_u32 s74, 0
    s_cbranch_scc1 L_l_noz
    s_sleep 12
    s_mov_b32 s66, 0x40000
L_p_vsp_4:
    buffer_load_dwordx4 v[128:131], v13, s[24:27], s68 offen sc1
    s_waitcnt vmcnt(0)
    v_max_u32 v3, v128, v129
    v_max3_u32 v3, v3, v130, v131
    v_cmp_eq_u32 vcc, -1, v3
    s_cmp_eq_u64 vcc, 0
    s_cbranch_scc1 L_p_vok_5
    s_sleep 2
    s_sub_u32 s66, s66, 1
    s_cmp_lg_u32 s66, 0
    s_cbranch_scc1 L_p_vsp_4
L_p_vok_5:
    v_lshlrev_b32 v136, 16, v128
    v_and_b32 v137, 0xffff0000, v128
    v_lshlrev_b32 v138, 16, v129
    v_and_b32 v139, 0xffff0000, v129
    v_lshlrev_b32 v140, 16, v130
    v_and_b32 v141, 0xffff0000, v130
    v_lshlrev_b32 v142, 16, v131
    v_and_b32 v143, 0xffff0000, v131
    s_nop 1
    v_add_f32_dpp v136, v136, v136 row_ror:8 row_mask:0xf bank_mask:0xf
    v_add_f32_dpp v137, v137, v137 row_ror:8 row_mask:0xf bank_mask:0xf
    v_add_f32_dpp v138, v138, v138 row_ror:8 row_mask:0xf bank_mask:0xf
    v_add_f32_dpp v139, v139, v139 row_ror:8 row_mask:0xf bank_mask:0xf
    v_add_f32_dpp v140, v140, v140 row_ror:8 row_mask:0xf bank_mask:0xf
    v_add_f32_dpp v141, v141, v141 row_ror:8 row_mask:0xf bank_mask:0xf
    v_add_f32_dpp v142, v142, v142 row_ror:8 row_mask:0xf bank_mask:0xf
    v_add_f32_dpp v143, v143, v143 row_ror:8 row_mask:0xf bank_mask:0xf
    s_nop 1
    v_add_f32_dpp v136, v136, v136 row_ror:4 row_mask:0xf bank_mask:0xf
    v_add_f32_dpp v137, v137, v137 row_ror:4 row_mask:0xf bank_mask:0xf
    v_add_f32_dpp v138, v138, v138 row_ror:4 row_mask:0xf bank_mask:0xf
    v_add_f32_dpp v139, v139, v139 row_ror:4 row_mask:0xf bank_mask:0xf
    v_add_f32_dpp v140, v140, v140 row_ror:4 row_mask:0xf bank_mask:0xf
    v_add_f32_dpp v141, v141, v141 row_ror:4 row_mask:0xf bank_mask:0xf
    v_add_f32_dpp v142, v142, v142 row_ror:4 row_mask:0xf bank_mask:0xf
    v_add_f32_dpp v143, v143, v143 row_ror:4 row_mask:0xf bank_mask:0xf
    s_nop 1
    v_add_f32_dpp v136, v136, v136 row_ror:2 row_mask:0xf bank_mask:0xf
    v_add_f32_dpp v137, v137, v137 row_ror:2 row_mask:0xf bank_mask:0xf
    v_add_f32_dpp v138, v138, v138 row_ror:2 row_mask:0xf bank_mask:0xf
    v_add_f32_dpp v139, v139, v139 row_ror:2 row_mask:0xf bank_mask:0xf
    v_add_f32_dpp v140, v140, v140 row_ror:2 row_mask:0xf bank_mask:0xf
    v_add_f32_dpp v141, v141, v141 row_ror:2 row_mask:0xf bank_mask:0xf
    v_add_f32_dpp v142, v142, v142 row_ror:2 row_mask:0xf bank_mask:0xf
    v_add_f32_dpp v143, v143, v143 row_ror:2 row_mask:0xf bank_mask:0xf
    s_nop 1
    v_add_f32_dpp v136, v136, v136 row_ror:1 row_mask:0xf bank_mask:0xf
    v_add_f32_dpp v137, v137, v137 row_ror:1 row_mask:0xf bank_mask:0xf
    v_add_f32_dpp v138, v138, v138 row_ror:1 row_mask:0xf bank_mask:0xf
    v_add_f32_dpp v139, v139, v139 row_ror:1 row_mask:0xf bank_mask:0xf
    v_add_f32_dpp v140, v140, v140 row_ror:1 row_mask:0xf bank_mask:0xf
    v_add_f32_dpp v141, v141, v141 row_ror:1 row_mask:0xf bank_mask:0xf
    v_add_f32_dpp v142, v142, v142 row_ror:1 row_mask:0xf bank_mask:0xf
    v_add_f32_dpp v143, v143, v143 row_ror:1 row_mask:0xf bank_mask:0xf
    v_cvt_pk_bf16_f32 v132, v136, v137
    v_cvt_pk_bf16_f32 v133, v138, v139
    v_cvt_pk_bf16_f32 v134, v140, v141
    v_cvt_pk_bf16_f32 v135, v142, v143
    s_mov_b64 exec, 1
    buffer_store_dwordx4 v[132:135], v13, s[24:27], s70 offen sc1
    s_mov_b64 exec, -1
L_l_noz:
    s_waitcnt vmcnt(16)
    v_lshlrev_b32 v224, 16, v192
    v_and_b32 v225, 0xffff0000, v192
    v_lshlrev_b32 v226, 16, v193
    v_and_b32 v227, 0xffff0000, v193
    v_lshlrev_b32 v228, 16, v194
    v_and_b32 v229, 0xffff0000, v194
    v_lshlrev_b32 v230, 16, v195
    v_and_b32 v231, 0xffff0000, v195
    v_lshlrev_b32 v232, 16, v196
    v_and_b32 v233, 0xffff0000, v196
    v_pk_add_f32 v[224:225], v[224:225], v[232:233]
    v_lshlrev_b32 v234, 16, v197
    v_and_b32 v235, 0xffff0000, v197
    v_pk_add_f32 v[226:227], v[226:227], v[234:235]
    v_lshlrev_b32 v232, 16, v198
    v_and_b32 v233, 0xffff0000, v198
    v_pk_add_f32 v[228:229], v[228:229], v[232:233]
    v_lshlrev_b32 v234, 16, v199
    v_and_b32 v235, 0xffff0000, v199
    v_pk_add_f32 v[230:231], v[230:231], v[234:235]
    v_lshlrev_b32 v232, 16, v200
    v_and_b32 v233, 0xffff0000, v200
    v_pk_add_f32 v[224:225], v[224:225], v[232:233]
    v_lshlrev_b32 v234, 16, v201
    v_and_b32 v235, 0xffff0000, v201
    v_pk_add_f32 v[226:227], v[226:227], v[234:235]
    v_lshlrev_b32 v232, 16, v202
    v_and_b32 v233, 0xffff0000, v202
    v_pk_add_f32 v[228:229], v[228:229], v[232:233]
    v_lshlrev_b32 v234, 16, v203
    v_and_b32 v235, 0xffff0000, v203
    v_pk_add_f32 v[230:231], v[230:231], v[234:235]
    v_lshlrev_b32 v232, 16, v204
    v_and_b32 v233, 0xffff0000, v204
    v_pk_add_f32 v[224:225], v[224:225], v[232:233]
    v_lshlrev_b32 v234, 16, v205
    v_and_b32 v235, 0xffff0000, v205
    v_pk_add_f32 v[226:227], v[226:227], v[234:235]
    v_lshlrev_b32 v232, 16, v206
    v_and_b32 v233, 0xffff0000, v206
    v_pk_add_f32 v[228:229], v[228:229], v[232:233]
    v_lshlrev_b32 v234, 16, v207
    v_and_b32 v235, 0xffff0000, v207
    v_pk_add_f32 v[230:231], v[230:231], v[234:235]
    v_lshlrev_b32 v232, 16, v208
    v_and_b32 v233, 0xffff0000, v208
    v_pk_add_f32 v[224:225], v[224:225], v[232:233]
    v_lshlrev_b32 v234, 16, v209
    v_and_b32 v235, 0xffff0000, v209
    v_pk_add_f32 v[226:227], v[226:227], v[234:235]
    v_lshlrev_b32 v232, 16, v210
    v_and_b32 v233, 0xffff0000, v210
    v_pk_add_f32 v[228:229], v[228:229], v[232:233]
    v_lshlrev_b32 v234, 16, v211
    v_and_b32 v235, 0xffff0000, v211
    v_pk_add_f32 v[230:231], v[230:231], v[234:235]
    v_lshlrev_b32 v232, 16, v212
    v_and_b32 v233, 0xffff0000, v212
    v_pk_add_f32 v[224:225], v[224:225], v[232:233]
    v_lshlrev_b32 v234, 16, v213
    v_and_b32 v235, 0xffff0000, v213
    v_pk_add_f32 v[226:227], v[226:227], v[234:235]
    v_lshlrev_b32 v232, 16, v214
    v_and_b32 v233, 0xffff0000, v214
    v_pk_add_f32 v[228:229], v[228:229], v[232:233]
    v_lshlrev_b32 v234, 16, v215
    v_and_b32 v235, 0xffff0000, v215
    v_pk_add_f32 v[230:231], v[230:231], v[234:235]
    v_lshlrev_b32 v232, 16, v216
    v_and_b32 v233, 0xffff0000, v216
    v_pk_add_f32 v[224:225], v[224:225], v[232:233]
    v_lshlrev_b32 v234, 16, v217
    v_and_b32 v235, 0xffff0000, v217
    v_pk_add_f32 v[226:227], v[226:227], v[234:235]
    v_lshlrev_b32 v232, 16, v218
    v_and_b32 v233, 0xffff0000, v218
    v_pk_add_f32 v[228:229], v[228:229], v[232:233]
    v_lshlrev_b32 v234, 16, v219
    v_and_b32 v235, 0xffff0000, v219
    v_pk_add_f32 v[230:231], v[230:231], v[234:235]
    v_lshlrev_b32 v232, 16, v220
    v_and_b32 v233, 0xffff0000, v220
    v_pk_add_f32 v[224:225], v[224:225], v[232:233]
    v_lshlrev_b32 v234, 16, v221
    v_and_b32 v235, 0xffff0000, v221
    v_pk_add_f32 v[226:227], v[226:227], v[234:235]
    v_lshlrev_b32 v232, 16, v222
    v_and_b32 v233, 0xffff0000, v222
    v_pk_add_f32 v[228:229], v[228:229], v[232:233]
    v_lshlrev_b32 v234, 16, v223
    v_and_b32 v235, 0xffff0000, v223
    v_pk_add_f32 v[230:231], v[230:231], v[234:235]
    v_mov_b32 v232, v224
    v_mov_b32 v233, v225
    v_mov_b32 v234, v226
    v_mov_b32 v235, v227
    v_mov_b32 v236, v228
    v_mov_b32 v237, v229
    v_mov_b32 v238, v230
    v_mov_b32 v239, v231
    s_nop 1
    v_permlane32_swap_b32 v224, v232
    v_permlane32_swap_b32 v225, v233
    v_permlane32_swap_b32 v226, v234
    v_permlane32_swap_b32 v227, v235
    v_permlane32_swap_b32 v228, v236
    v_permlane32_swap_b32 v229, v237
    v_permlane32_swap_b32 v230, v238
    v_permlane32_swap_b32 v231, v239
    v_add_f32 v224, v224, v232
    v_add_f32 v225, v225, v233
    v_add_f32 v226, v226, v234
    v_add_f32 v227, v227, v235
    v_add_f32 v228, v228, v236
    v_add_f32 v229, v229, v237
    v_add_f32 v230, v230, v238
    v_add_f32 v231, v231, v239
    s_lshl_b32 s56, s92, 10
    s_add_u32 s56, s56, 131072
    v_and_b32 v4, 31, v1
    v_lshl_add_u32 v4, v4, 5, s56
    ds_write_b128 v4, v[224:227]
    ds_write_b128 v4, v[228:231] offset:16
    s_waitcnt lgkmcnt(0)
    s_mov_b32 s87, 0
    s_mov_b32 s81, 0
    s_sub_u32 s64, s87, s6
    s_and_b32 s64, s64, 3
    s_lshl_b32 s64, s64, 2
    s_lshr_b32 s64, 31367, s64
    s_and_b32 s64, s64, 15
    s_add_u32 s64, s64, s87
    s_sub_u32 s64, s64, 8
    s_sub_u32 s65, s6, s87
    s_and_b32 s65, s65, 3
    s_add_u32 s65, s65, s87
    s_lshr_b32 s65, 0xff3c, s65
    s_and_b32 s65, s65, 1
    s_cselect_b32 s64, s64, s87
    s_lshl_b32 s64, s64, 2
    s_lshr_b64 s[66:67], s[88:89], s64
    s_and_b32 s64, s66, 15
    s_lshl_b32 s60, s64, 12
    s_mul_i32 s61, s64, 131072
    s_mul_i32 s62, s81, 16384
    s_add_u32 s62, s62, s86
    s_mul_i32 s63, s81, 8192
    s_add_u32 s63, s63, s86
    s_add_u32 s87, s87, 1
    s_add_u32 s81, s81, 1
    s_cmp_eq_u32 s81, 4
    s_cselect_b32 s81, 0, s81
    s_barrier
    s_bitcmp1_b32 s101, 0
    s_cbranch_scc1 L_p_par_6
    s_barrier
L_p_par_6:
    s_add_u32 m0, s62, 0
    s_barrier
    buffer_load_dwordx4 v16, s[8:11], s60 offen sc1 lds
    s_add_u32 m0, s62, 2048
    s_sub_u32 s64, s87, s6
    s_and_b32 s64, s64, 3
    s_lshl_b32 s64, s64, 2
    s_lshr_b32 s64, 31367, s64
    buffer_load_dwordx4 v17, s[8:11], s60 offen sc1 lds
    s_add_u32 m0, s62, 4096
    s_and_b32 s64, s64, 15
    s_add_u32 s64, s64, s87
    s_sub_u32 s64, s64, 8
    buffer_load_dwordx4 v18, s[8:11], s60 offen sc1 lds
    s_add_u32 m0, s62, 6144
    s_sub_u32 s65, s6, s87
    s_and_b32 s65, s65, 3
    s_add_u32 s65, s65, s87
    s_lshr_b32 s65, 0xff3c, s65
    buffer_load_dwordx4 v19, s[8:11], s60 offen sc1 lds
    s_add_u32 m0, s62, 8192
    s_and_b32 s65, s65, 1
    s_cselect_b32 s64, s64, s87
    s_lshl_b32 s64, s64, 2
    s_lshr_b64 s[66:67], s[88:89], s64
    buffer_load_dwordx4 v20, s[8:11], s60 offen sc1 lds
    s_add_u32 m0, s62, 10240
    s_and_b32 s64, s66, 15
    s_lshl_b32 s68, s64, 12
    s_mul_i32 s69, s64, 131072
    s_mul_i32 s70, s81, 16384
    buffer_load_dwordx4 v21, s[8:11], s60 offen sc1 lds
    s_add_u32 m0, s62, 12288
    s_add_u32 s70, s70, s86
    s_mul_i32 s71, s81, 8192
    s_add_u32 s71, s71, s86
    buffer_load_dwordx4 v22, s[8:11], s60 offen sc1 lds
    s_add_u32 m0, s62, 14336
    s_add_u32 s87, s87, 1
    s_add_u32 s81, s81, 1
    s_cmp_eq_u32 s81, 4
    s_cselect_b32 s81, 0, s81
    buffer_load_dwordx4 v23, s[8:11], s60 offen sc1 lds
    s_add_u32 m0, s70, 0
    s_nop 0
    buffer_load_dwordx4 v16, s[8:11], s68 offen sc1 lds
    s_add_u32 m0, s70, 2048
    s_sub_u32 s64, s87, s6
    s_and_b32 s64, s64, 3
    s_lshl_b32 s64, s64, 2
    s_lshr_b32 s64, 31367, s64
    buffer_load_dwordx4 v17, s[8:11], s68 offen sc1 lds
    s_add_u32 m0, s70, 4096
    s_and_b32 s64, s64, 15
    s_add_u32 s64, s64, s87
    s_sub_u32 s64, s64, 8
    buffer_load_dwordx4 v18, s[8:11], s68 offen sc1 lds
    s_add_u32 m0, s70, 6144
    s_sub_u32 s65, s6, s87
    s_and_b32 s65, s65, 3
    s_add_u32 s65, s65, s87
    s_lshr_b32 s65, 0xff3c, s65
    buffer_load_dwordx4 v19, s[8:11], s68 offen sc1 lds
    s_add_u32 m0, s70, 8192
    s_and_b32 s65, s65, 1
    s_cselect_b32 s64, s64, s87
    s_lshl_b32 s64, s64, 2
    s_lshr_b64 s[66:67], s[88:89], s64
    buffer_load_dwordx4 v20, s[8:11], s68 offen sc1 lds
    s_add_u32 m0, s70, 10240
    s_and_b32 s64, s66, 15
    s_lshl_b32 s60, s64, 12
    s_mul_i32 s61, s64, 131072
    s_mul_i32 s62, s81, 16384
    buffer_load_dwordx4 v21, s[8:11], s68 offen sc1 lds
    s_add_u32 m0, s70, 12288
    s_add_u32 s62, s62, s86
    s_mul_i32 s63, s81, 8192
    s_add_u32 s63, s63, s86
    buffer_load_dwordx4 v22, s[8:11], s68 offen sc1 lds
    s_add_u32 m0, s70, 14336
    s_add_u32 s87, s87, 1
    s_add_u32 s81, s81, 1
    s_cmp_eq_u32 s81, 4
    s_cselect_b32 s81, 0, s81
    buffer_load_dwordx4 v23, s[8:11], s68 offen sc1 lds
    s_bitcmp1_b32 s101, 0
    s_cbranch_scc0 L_p_par_7
    s_barrier
L_p_par_7:
    s_add_u32 m0, s62, 0
    s_waitcnt vmcnt(8)
    s_barrier
    buffer_load_dwordx4 v16, s[8:11], s60 offen sc1 lds
    s_add_u32 m0, s62, 2048
    s_sub_u32 s64, s87, s6
    s_and_b32 s64, s64, 3
    s_lshl_b32 s64, s64, 2
    s_lshr_b32 s64, 31367, s64
    buffer_load_dwordx4 v17, s[8:11], s60 offen sc1 lds
    s_add_u32 m0, s62, 4096
    s_and_b32 s64, s64, 15
    s_add_u32 s64, s64, s87
    s_sub_u32 s64, s64, 8
    buffer_load_dwordx4 v18, s[8:11], s60 offen sc1 lds
    s_add_u32 m0, s62, 6144
    s_sub_u32 s65, s6, s87
    s_and_b32 s65, s65, 3
    s_add_u32 s65, s65, s87
    s_lshr_b32 s65, 0xff3c, s65
    buffer_load_dwordx4 v19, s[8:11], s60 offen sc1 lds
    s_add_u32 m0, s62, 8192
    s_and_b32 s65, s65, 1
    s_cselect_b32 s64, s64, s87
    s_lshl_b32 s64, s64, 2
    s_lshr_b64 s[66:67], s[88:89], s64
    buffer_load_dwordx4 v20, s[8:11], s60 offen sc1 lds
    s_add_u32 m0, s62, 10240
    s_and_b32 s64, s66, 15
    s_lshl_b32 s68, s64, 12
    s_mul_i32 s69, s64, 131072
    s_mul_i32 s70, s81, 16384
    buffer_load_dwordx4 v21, s[8:11], s60 offen sc1 lds
    s_add_u32 m0, s62, 12288
    s_add_u32 s70, s70, s86
    s_mul_i32 s71, s81, 8192
    s_add_u32 s71, s71, s86
    buffer_load_dwordx4 v22, s[8:11], s60 offen sc1 lds
    s_add_u32 m0, s62, 14336
    s_add_u32 s87, s87, 1
    s_add_u32 s81, s81, 1
    s_cmp_eq_u32 s81, 4
    s_cselect_b32 s81, 0, s81
    buffer_load_dwordx4 v23, s[8:11], s60 offen sc1 lds
    s_add_u32 m0, s70, 0
    s_nop 0
    buffer_load_dwordx4 v16, s[8:11], s68 offen sc1 lds
    s_add_u32 m0, s70, 2048
    s_sub_u32 s64, s87, s6
    s_and_b32 s64, s64, 3
    s_lshl_b32 s64, s64, 2
    s_lshr_b32 s64, 31367, s64
    buffer_load_dwordx4 v17, s[8:11], s68 offen sc1 lds
    s_add_u32 m0, s70, 4096
    s_and_b32 s64, s64, 15
    s_add_u32 s64, s64, s87
    s_sub_u32 s64, s64, 8
    buffer_load_dwordx4 v18, s[8:11], s68 offen sc1 lds
    s_add_u32 m0, s70, 6144
    s_sub_u32 s65, s6, s87
    s_and_b32 s65, s65, 3
    s_add_u32 s65, s65, s87
    s_lshr_b32 s65, 0xff3c, s65
    buffer_load_dwordx4 v19, s[8:11], s68 offen sc1 lds
    s_add_u32 m0, s70, 8192
    s_and_b32 s65, s65, 1
    s_cselect_b32 s64, s64, s87
    s_lshl_b32 s64, s64, 2
    s_lshr_b64 s[66:67], s[88:89], s64
    buffer_load_dwordx4 v20, s[8:11], s68 offen sc1 lds
    s_add_u32 m0, s70, 10240
    s_and_b32 s64, s66, 15
    s_lshl_b32 s60, s64, 12
    s_mul_i32 s61, s64, 131072
    s_mul_i32 s62, s81, 16384
    buffer_load_dwordx4 v21, s[8:11], s68 offen sc1 lds
    s_add_u32 m0, s70, 12288
    s_add_u32 s62, s62, s86
    s_mul_i32 s63, s81, 8192
    s_add_u32 s63, s63, s86
    buffer_load_dwordx4 v22, s[8:11], s68 offen sc1 lds
    s_add_u32 m0, s70, 14336
    s_add_u32 s87, s87, 1
    s_add_u32 s81, s81, 1
    s_cmp_eq_u32 s81, 4
    s_cselect_b32 s81, 0, s81
    buffer_load_dwordx4 v23, s[8:11], s68 offen sc1 lds
    s_add_u32 m0, s62, 0
    s_waitcnt vmcnt(16)
    s_barrier
    buffer_load_dwordx4 v16, s[8:11], s60 offen sc1 lds
    s_add_u32 m0, s62, 2048
    s_sub_u32 s64, s87, s6
    s_and_b32 s64, s64, 3
    s_lshl_b32 s64, s64, 2
    buffer_load_dwordx4 v17, s[8:11], s60 offen sc1 lds
    s_add_u32 m0, s62, 4096
    s_lshr_b32 s64, 31367, s64
    s_and_b32 s64, s64, 15
    buffer_load_dwordx4 v18, s[8:11], s60 offen sc1 lds
    s_add_u32 m0, s62, 6144
    s_add_u32 s64, s64, s87
    s_sub_u32 s64, s64, 8
    buffer_load_dwordx4 v19, s[8:11], s60 offen sc1 lds
    s_add_u32 m0, s62, 8192
    s_sub_u32 s65, s6, s87
    s_and_b32 s65, s65, 3
    buffer_load_dwordx4 v20, s[8:11], s60 offen sc1 lds
    s_add_u32 m0, s62, 10240
    s_add_u32 s65, s65, s87
    s_lshr_b32 s65, 0xff3c, s65
    buffer_load_dwordx4 v21, s[8:11], s60 offen sc1 lds
    s_add_u32 m0, s62, 12288
    s_and_b32 s65, s65, 1
    s_cselect_b32 s64, s64, s87
    s_lshl_b32 s64, s64, 2
    s_lshr_b64 s[66:67], s[88:89], s64
    buffer_load_dwordx4 v22, s[8:11], s60 offen sc1 lds
    s_add_u32 m0, s62, 14336
    s_and_b32 s64, s66, 15
    s_lshl_b32 s68, s64, 12
    buffer_load_dwordx4 v23, s[8:11], s60 offen sc1 lds
    s_add_u32 m0, s63, 65536
    s_mul_i32 s69, s64, 131072
    s_mul_i32 s70, s81, 16384
    buffer_load_dwordx4 v24, s[12:15], s61 offen  lds
    s_add_u32 m0, s63, 67584
    s_add_u32 s70, s70, s86
    s_mul_i32 s71, s81, 8192
    buffer_load_dwordx4 v25, s[12:15], s61 offen  lds
    s_add_u32 m0, s63, 69632
    s_add_u32 s71, s71, s86
    s_add_u32 s87, s87, 1
    buffer_load_dwordx4 v26, s[12:15], s61 offen  lds
    s_add_u32 m0, s63, 71680
    s_add_u32 s81, s81, 1
    s_cmp_eq_u32 s81, 4
    s_cselect_b32 s81, 0, s81
    buffer_load_dwordx4 v27, s[12:15], s61 offen  lds
    s_add_u32 m0, s70, 0
    s_waitcnt vmcnt(20)
    s_barrier
    buffer_load_dwordx4 v16, s[8:11], s68 offen sc1 lds
    s_add_u32 m0, s70, 2048
    s_sub_u32 s64, s87, s6
    s_and_b32 s64, s64, 3
    s_lshl_b32 s64, s64, 2
    buffer_load_dwordx4 v17, s[8:11], s68 offen sc1 lds
    s_add_u32 m0, s70, 4096
    s_lshr_b32 s64, 31367, s64
    s_and_b32 s64, s64, 15
L_pad1:
    s_cbranch_execz L_padr1
    buffer_load_dwordx4 v18, s[8:11], s68 offen sc1 lds
    s_add_u32 m0, s70, 6144
    s_add_u32 s64, s64, s87
    s_sub_u32 s64, s64, 8
    buffer_load_dwordx4 v19, s[8:11], s68 offen sc1 lds
    s_add_u32 m0, s70, 8192
    s_sub_u32 s65, s6, s87
    s_and_b32 s65, s65, 3
    buffer_load_dwordx4 v20, s[8:11], s68 offen sc1 lds
    s_add_u32 m0, s70, 10240
    s_add_u32 s65, s65, s87
    s_lshr_b32 s65, 0xff3c, s65
    buffer_load_dwordx4 v21, s[8:11], s68 offen sc1 lds
    s_add_u32 m0, s70, 12288
    s_and_b32 s65, s65, 1
    s_cselect_b32 s64, s64, s87
    s_lshl_b32 s64, s64, 2
    s_lshr_b64 s[66:67], s[88:89], s64
    buffer_load_dwordx4 v22, s[8:11], s68 offen sc1 lds
    s_add_u32 m0, s70, 14336
    s_and_b32 s64, s66, 15
    s_lshl_b32 s60, s64, 12
    buffer_load_dwordx4 v23, s[8:11], s68 offen sc1 lds
    s_add_u32 m0, s71, 65536
    s_mul_i32 s61, s64, 131072
    s_mul_i32 s62, s81, 16384
    buffer_load_dwordx4 v24, s[12:15], s69 offen  lds
    s_add_u32 m0, s71, 67584
    s_add_u32 s62, s62, s86
    s_mul_i32 s63, s81, 8192
    buffer_load_dwordx4 v25, s[12:15], s69 offen  lds
    s_add_u32 m0, s71, 69632
    s_add_u32 s63, s63, s86
    s_add_u32 s87, s87, 1
    buffer_load_dwordx4 v26, s[12:15], s69 offen  lds
    s_add_u32 m0, s71, 71680
    s_add_u32 s81, s81, 1
    s_cmp_eq_u32 s81, 4
    s_cselect_b32 s81, 0, s81
    buffer_load_dwordx4 v27, s[12:15], s69 offen  lds
    s_add_u32 m0, s62, 0
    s_waitcnt vmcnt(24)
    s_barrier
    buffer_load_dwordx4 v16, s[8:11], s60 offen sc1 lds
    s_add_u32 m0, s62, 2048
    s_sub_u32 s64, s87, s6
    s_and_b32 s64, s64, 3
    s_lshl_b32 s64, s64, 2
    buffer_load_dwordx4 v17, s[8:11], s60 offen sc1 lds
    s_add_u32 m0, s62, 4096
    s_lshr_b32 s64, 31367, s64
    s_and_b32 s64, s64, 15
    buffer_load_dwordx4 v18, s[8:11], s60 offen sc1 lds
    s_add_u32 m0, s62, 6144
    s_add_u32 s64, s64, s87
    s_sub_u32 s64, s64, 8
    buffer_load_dwordx4 v19, s[8:11], s60 offen sc1 lds
    s_add_u32 m0, s62, 8192
    s_sub_u32 s65, s6, s87
    s_and_b32 s65, s65, 3
    buffer_load_dwordx4 v20, s[8:11], s60 offen sc1 lds
    s_add_u32 m0, s62, 10240
    s_add_u32 s65, s65, s87
    s_lshr_b32 s65, 0xff3c, s65
    buffer_load_dwordx4 v21, s[8:11], s60 offen sc1 lds
    s_add_u32 m0, s62, 12288
    s_and_b32 s65, s65, 1
    s_cselect_b32 s64, s64, s87
    s_lshl_b32 s64, s64, 2
    s_lshr_b64 s[66:67], s[88:89], s64
    buffer_load_dwordx4 v22, s[8:11], s60 offen sc1 lds
    s_add_u32 m0, s62, 14336
    s_and_b32 s64, s66, 15
    s_lshl_b32 s68, s64, 12
    buffer_load_dwordx4 v23, s[8:11], s60 offen sc1 lds
    s_add_u32 m0, s63, 65536
    s_mul_i32 s69, s64, 131072
    s_mul_i32 s70, s81, 16384
    buffer_load_dwordx4 v24, s[12:15], s61 offen  lds
    s_add_u32 m0, s63, 67584
    s_add_u32 s70, s70, s86
    s_mul_i32 s71, s81, 8192
    buffer_load_dwordx4 v25, s[12:15], s61 offen  lds
    s_add_u32 m0, s63, 69632
    s_add_u32 s71, s71, s86
    s_add_u32 s87, s87, 1
    buffer_load_dwordx4 v26, s[12:15], s61 offen  lds
    s_add_u32 m0, s63, 71680
    s_add_u32 s81, s81, 1
    s_cmp_eq_u32 s81, 4
    s_cselect_b32 s81, 0, s81
    buffer_load_dwordx4 v27, s[12:15], s61 offen  lds
    s_mov_b32 s80, 4
L_p_lp_8:
    s_add_u32 m0, s70, 0
    s_waitcnt vmcnt(24)
    s_barrier
    buffer_load_dwordx4 v16, s[8:11], s68 offen sc1 lds
    s_add_u32 m0, s70, 2048
    s_sub_u32 s80, s80, 1
    s_sub_u32 s64, s87, s6
    s_and_b32 s64, s64, 3
    buffer_load_dwordx4 v17, s[8:11], s68 offen sc1 lds
    s_add_u32 m0, s70, 4096
    s_lshl_b32 s64, s64, 2
    s_lshr_b32 s64, 31367, s64
    buffer_load_dwordx4 v18, s[8:11], s68 offen sc1 lds
    s_add_u32 m0, s70, 6144
    s_and_b32 s64, s64, 15
    s_add_u32 s64, s64, s87
    buffer_load_dwordx4 v19, s[8:11], s68 offen sc1 lds
    s_add_u32 m0, s70, 8192
    s_sub_u32 s64, s64, 8
    s_sub_u32 s65, s6, s87
    s_and_b32 s65, s65, 3
    buffer_load_dwordx4 v20, s[8:11], s68 offen sc1 lds
    s_add_u32 m0, s70, 10240
    s_add_u32 s65, s65, s87
    s_lshr_b32 s65, 0xff3c, s65
    buffer_load_dwordx4 v21, s[8:11], s68 offen sc1 lds
    s_add_u32 m0, s70, 12288
    s_and_b32 s65, s65, 1
    s_cselect_b32 s64, s64, s87
    s_lshl_b32 s64, s64, 2
    buffer_load_dwordx4 v22, s[8:11], s68 offen sc1 lds
    s_add_u32 m0, s70, 14336
    s_lshr_b64 s[66:67], s[88:89], s64
    s_and_b32 s64, s66, 15
    buffer_load_dwordx4 v23, s[8:11], s68 offen sc1 lds
    s_add_u32 m0, s71, 65536
    s_lshl_b32 s60, s64, 12
    s_mul_i32 s61, s64, 131072
    s_mul_i32 s62, s81, 16384
    buffer_load_dwordx4 v24, s[12:15], s69 offen  lds
    s_add_u32 m0, s71, 67584
    s_add_u32 s62, s62, s86
    s_mul_i32 s63, s81, 8192
    buffer_load_dwordx4 v25, s[12:15], s69 offen  lds
    s_add_u32 m0, s71, 69632
    s_add_u32 s63, s63, s86
    s_add_u32 s87, s87, 1
    buffer_load_dwordx4 v26, s[12:15], s69 offen  lds
    s_add_u32 m0, s71, 71680
    s_add_u32 s81, s81, 1
    s_cmp_eq_u32 s81, 4
    s_cselect_b32 s81, 0, s81
    buffer_load_dwordx4 v27, s[12:15], s69 offen  lds
    s_add_u32 m0, s62, 0
    s_waitcnt vmcnt(24)
    s_barrier
    buffer_load_dwordx4 v16, s[8:11], s60 offen sc1 lds
    s_add_u32 m0, s62, 2048
    s_sub_u32 s64, s87, s6
    s_and_b32 s64, s64, 3
    s_lshl_b32 s64, s64, 2
    buffer_load_dwordx4 v17, s[8:11], s60 offen sc1 lds
    s_add_u32 m0, s62, 4096
    s_lshr_b32 s64, 31367, s64
    s_and_b32 s64, s64, 15
    buffer_load_dwordx4 v18, s[8:11], s60 offen sc1 lds
    s_add_u32 m0, s62, 6144
    s_add_u32 s64, s64, s87
    s_sub_u32 s64, s64, 8
    buffer_load_dwordx4 v19, s[8:11], s60 offen sc1 lds
    s_add_u32 m0, s62, 8192
    s_sub_u32 s65, s6, s87
    s_and_b32 s65, s65, 3
    buffer_load_dwordx4 v20, s[8:11], s60 offen sc1 lds
    s_add_u32 m0, s62, 10240
    s_add_u32 s65, s65, s87
    s_lshr_b32 s65, 0xff3c, s65
    buffer_load_dwordx4 v21, s[8:11], s60 offen sc1 lds
    s_add_u32 m0, s62, 12288
    s_and_b32 s65, s65, 1
    s_cselect_b32 s64, s64, s87
    s_lshl_b32 s64, s64, 2
    s_lshr_b64 s[66:67], s[88:89], s64
    buffer_load_dwordx4 v22, s[8:11], s60 offen sc1 lds
    s_add_u32 m0, s62, 14336
    s_and_b32 s64, s66, 15
    s_lshl_b32 s68, s64, 12
    buffer_load_dwordx4 v23, s[8:11], s60 offen sc1 lds
    s_add_u32 m0, s63, 65536
    s_mul_i32 s69, s64, 131072
    s_mul_i32 s70, s81, 16384
    buffer_load_dwordx4 v24, s[12:15], s61 offen  lds
    s_add_u32 m0, s63, 67584
    s_add_u32 s70, s70, s86
    s_mul_i32 s71, s81, 8192
    buffer_load_dwordx4 v25, s[12:15], s61 offen  lds
    s_add_u32 m0, s63, 69632
    s_add_u32 s71, s71, s86
    s_add_u32 s87, s87, 1
    buffer_load_dwordx4 v26, s[12:15], s61 offen  lds
    s_add_u32 m0, s63, 71680
    s_add_u32 s81, s81, 1
    s_cmp_eq_u32 s81, 4
    s_cselect_b32 s81, 0, s81
    buffer_load_dwordx4 v27, s[12:15], s61 offen  lds
    s_cmp_lg_u32 s80, 0
    s_cbranch_scc1 L_p_lp_8
    s_add_u32 m0, s70, 0
    s_waitcnt vmcnt(24)
    s_barrier
    buffer_load_dwordx4 v16, s[8:11], s68 offen sc1 lds
    s_add_u32 m0, s70, 2048
    s_mov_b32 s87, 0
    s_mov_b32 s81, 2
    s_sub_u32 s64, s87, s6
    buffer_load_dwordx4 v17, s[8:11], s68 offen sc1 lds
    s_add_u32 m0, s70, 4096
    s_and_b32 s64, s64, 3
    s_lshl_b32 s64, s64, 2
    buffer_load_dwordx4 v18, s[8:11], s68 offen sc1 lds
    s_add_u32 m0, s70, 6144
    s_lshr_b32 s64, 31367, s64
    s_and_b32 s64, s64, 15
    buffer_load_dwordx4 v19, s[8:11], s68 offen sc1 lds
    s_add_u32 m0, s70, 8192
    s_add_u32 s64, s64, s87
    s_sub_u32 s64, s64, 8
    buffer_load_dwordx4 v20, s[8:11], s68 offen sc1 lds
    s_add_u32 m0, s70, 10240
    s_sub_u32 s65, s6, s87
    s_and_b32 s65, s65, 3
    buffer_load_dwordx4 v21, s[8:11], s68 offen sc1 lds
    s_add_u32 m0, s70, 12288
    s_add_u32 s65, s65, s87
    s_sub_u32 s65, s65, 2
    s_cmp_ge_u32 s65, 14
    s_cselect_b32 s64, s87, s64
    buffer_load_dwordx4 v22, s[8:11], s68 offen sc1 lds
    s_add_u32 m0, s70, 14336
    s_lshl_b32 s60, s64, 12
    s_mul_i32 s61, s64, 458752
    buffer_load_dwordx4 v23, s[8:11], s68 offen sc1 lds
    s_add_u32 m0, s71, 65536
    s_add_u32 s61, s61, s96
    s_mul_i32 s62, s81, 16384
    buffer_load_dwordx4 v24, s[12:15], s69 offen  lds
    s_add_u32 m0, s71, 67584
    s_add_u32 s62, s62, s86
    s_mul_i32 s63, s81, 16384
    buffer_load_dwordx4 v25, s[12:15], s69 offen  lds
    s_add_u32 m0, s71, 69632
    s_add_u32 s63, s63, s86
    s_add_u32 s87, s87, 1
    buffer_load_dwordx4 v26, s[12:15], s69 offen  lds
    s_add_u32 m0, s71, 71680
    s_add_u32 s81, s81, 1
    s_cmp_eq_u32 s81, 4
    s_cselect_b32 s81, 0, s81
    buffer_load_dwordx4 v27, s[12:15], s69 offen  lds
    s_cmp_ge_u32 s2, 224
    s_cbranch_scc1 L_ld_helper
    s_add_u32 m0, s63, 65536
    s_waitcnt vmcnt(24)
    s_barrier
    buffer_load_dwordx4 v68, s[20:23], s61 offen  lds
    s_add_u32 m0, s63, 67584
    s_sub_u32 s64, s87, s6
    s_and_b32 s64, s64, 3
    s_lshl_b32 s64, s64, 2
    s_lshr_b32 s64, 31367, s64
    buffer_load_dwordx4 v69, s[20:23], s61 offen  lds
    s_add_u32 m0, s63, 69632
    s_and_b32 s64, s64, 15
    s_add_u32 s64, s64, s87
    s_sub_u32 s64, s64, 8
    buffer_load_dwordx4 v70, s[20:23], s61 offen  lds
    s_add_u32 m0, s63, 71680
    s_sub_u32 s65, s6, s87
    s_and_b32 s65, s65, 3
    s_add_u32 s65, s65, s87
    buffer_load_dwordx4 v71, s[20:23], s61 offen  lds
    s_add_u32 m0, s63, 73728
    s_sub_u32 s65, s65, 2
    s_cmp_ge_u32 s65, 14
    s_cselect_b32 s64, s87, s64
    s_lshl_b32 s68, s64, 12
    buffer_load_dwordx4 v72, s[20:23], s61 offen  lds
    s_add_u32 m0, s63, 75776
    s_mul_i32 s69, s64, 458752
    s_add_u32 s69, s69, s96
    s_mul_i32 s70, s81, 16384
    buffer_load_dwordx4 v73, s[20:23], s61 offen  lds
    s_add_u32 m0, s63, 77824
    s_add_u32 s70, s70, s86
    s_mul_i32 s71, s81, 16384
    s_add_u32 s71, s71, s86
    buffer_load_dwordx4 v74, s[20:23], s61 offen  lds
    s_add_u32 m0, s63, 79872
    s_add_u32 s87, s87, 1
    s_add_u32 s81, s81, 1
    s_cmp_eq_u32 s81, 4
    s_cselect_b32 s81, 0, s81
    buffer_load_dwordx4 v75, s[20:23], s61 offen  lds
    s_add_u32 m0, s71, 65536
    s_waitcnt vmcnt(20)
    s_barrier
    buffer_load_dwordx4 v68, s[20:23], s69 offen  lds
    s_add_u32 m0, s71, 67584
    s_nop 0
    buffer_load_dwordx4 v69, s[20:23], s69 offen  lds
    s_add_u32 m0, s71, 69632
    s_nop 0
    buffer_load_dwordx4 v70, s[20:23], s69 offen  lds
    s_add_u32 m0, s71, 71680
    s_nop 0
    buffer_load_dwordx4 v71, s[20:23], s69 offen  lds
    s_add_u32 m0, s71, 73728
    s_nop 0
    buffer_load_dwordx4 v72, s[20:23], s69 offen  lds
    s_add_u32 m0, s71, 75776
    s_nop 0
    buffer_load_dwordx4 v73, s[20:23], s69 offen  lds
    s_add_u32 m0, s71, 77824
    s_nop 0
    buffer_load_dwordx4 v74, s[20:23], s69 offen  lds
    s_add_u32 m0, s71, 79872
    s_nop 0
    buffer_load_dwordx4 v75, s[20:23], s69 offen  lds
    s_waitcnt vmcnt(16)
    s_barrier
    s_barrier
    s_and_b32 s56, s2, 7
    s_lshr_b32 s57, s2, 3
    s_and_b32 s58, s57, 3
    s_lshr_b32 s59, s57, 2
    s_lshr_b32 s4, s56, 1
    s_mul_i32 s4, s4, 4
    s_add_u32 s4, s4, s58
    s_and_b32 s5, s56, 1
    s_mul_i32 s5, s5, 7
    s_add_u32 s5, s5, s59
    s_add_u32 s6, s58, s59
    s_add_u32 s8, s54, 8388608
    s_addc_u32 s9, s55, 0
    s_mov_b32 s10, 4194304
    s_mov_b32 s11, 0x20000
    s_mov_b32 s16, s44
    s_mov_b32 s17, s45
    s_mov_b32 s18, 8388608
    s_mov_b32 s19, 0x20000
    s_add_u32 s28, s54, 20971520
    s_addc_u32 s29, s55, 0
    s_mov_b32 s30, 7340032
    s_mov_b32 s31, 0x20000
    s_mul_i32 s61, s4, 262144
    s_add_u32 s61, s61, s86
    v_lshlrev_b32 v3, 4, v1
    v_add_u32 v16, s61, v3
    v_add_u32 v17, 2048, v16
    v_add_u32 v18, 65536, v16
    v_add_u32 v19, 67584, v16
    v_add_u32 v20, 131072, v16
    v_add_u32 v21, 133120, v16
    v_add_u32 v22, 196608, v16
    v_add_u32 v23, 198656, v16
    v_lshrrev_b32 v2, 3, v1
    v_and_b32 v4, 7, v1
    s_lshl_b32 s62, s74, 3
    v_lshrrev_b32 v3, 4, v1
    s_lshl_b32 s61, s74, 2
    v_add_u32 v3, s61, v3
    v_xor_b32 v3, v3, v4
    v_lshlrev_b32 v3, 4, v3
    s_mul_i32 s61, s4, 128
    s_add_u32 s61, s61, s62
    v_add_u32 v5, s61, v2
    s_mov_b32 s63, 4096
    v_mul_lo_u32 v5, v5, s63
    v_add_u32 v36, v5, v3
    v_add_u32 v37, 65536, v36
    v_add_u32 v38, 131072, v36
    v_add_u32 v39, 196608, v36
    v_add_u32 v40, 262144, v36
    v_add_u32 v41, 327680, v36
    v_add_u32 v42, 393216, v36
    v_add_u32 v43, 458752, v36
    s_mul_i32 s61, s5, 524288
    s_add_u32 s61, s61, s86
    v_lshlrev_b32 v3, 4, v1
    v_add_u32 v44, s61, v3
    v_add_u32 v45, 2048, v44
    v_add_u32 v46, 4096, v44
    v_add_u32 v47, 6144, v44
    v_add_u32 v48, 8192, v44
    v_add_u32 v49, 10240, v44
    v_add_u32 v50, 12288, v44
    v_add_u32 v51, 14336, v44
    s_and_b32 s75, s4, 3
    s_lshl_b32 s75, s75, 1
    s_lshr_b32 s93, s4, 2
    s_lshl_b32 s93, s93, 3
    s_mov_b32 s87, 0
    s_mov_b32 s81, 2
    s_sub_u32 s64, s87, s6
    s_and_b32 s64, s64, 3
    s_lshl_b32 s64, s64, 2
    s_lshr_b32 s64, 31367, s64
    s_and_b32 s64, s64, 15
    s_add_u32 s64, s64, s87
    s_sub_u32 s64, s64, 8
    s_sub_u32 s65, s6, s87
    s_and_b32 s65, s65, 3
    s_add_u32 s65, s65, s87
    s_sub_u32 s65, s65, 2
    s_cmp_ge_u32 s65, 14
    s_cselect_b32 s64, s87, s64
    s_lshl_b32 s60, s64, 12
    s_mul_i32 s61, s64, 458752
    s_add_u32 s61, s61, s96
    s_mul_i32 s62, s81, 16384
    s_add_u32 s62, s62, s86
    s_mul_i32 s63, s81, 16384
    s_add_u32 s63, s63, s86
    s_add_u32 s87, s87, 1
    s_add_u32 s81, s81, 1
    s_cmp_eq_u32 s81, 4
    s_cselect_b32 s81, 0, s81
    s_bitcmp1_b32 s2, 0
    s_cbranch_scc1 L_p_par_9
    s_barrier
L_p_par_9:
    s_add_u32 m0, s62, 0
    s_barrier
    buffer_load_dwordx4 v16, s[8:11], s60 offen sc1 lds
    s_add_u32 m0, s62, 2048
    s_sub_u32 s64, s87, s6
    s_and_b32 s64, s64, 3
    s_lshl_b32 s64, s64, 2
    s_lshr_b32 s64, 31367, s64
    buffer_load_dwordx4 v17, s[8:11], s60 offen sc1 lds
    s_add_u32 m0, s62, 4096
    s_and_b32 s64, s64, 15
    s_add_u32 s64, s64, s87
    s_sub_u32 s64, s64, 8
    buffer_load_dwordx4 v18, s[8:11], s60 offen sc1 lds
    s_add_u32 m0, s62, 6144
    s_sub_u32 s65, s6, s87
    s_and_b32 s65, s65, 3
    s_add_u32 s65, s65, s87
    buffer_load_dwordx4 v19, s[8:11], s60 offen sc1 lds
    s_add_u32 m0, s62, 8192
    s_sub_u32 s65, s65, 2
    s_cmp_ge_u32 s65, 14
    s_cselect_b32 s64, s87, s64
    s_lshl_b32 s68, s64, 12
    buffer_load_dwordx4 v20, s[8:11], s60 offen sc1 lds
    s_add_u32 m0, s62, 10240
    s_mul_i32 s69, s64, 458752
    s_add_u32 s69, s69, s96
    s_mul_i32 s70, s81, 16384
    buffer_load_dwordx4 v21, s[8:11], s60 offen sc1 lds
    s_add_u32 m0, s62, 12288
    s_add_u32 s70, s70, s86
    s_mul_i32 s71, s81, 16384
    s_add_u32 s71, s71, s86
    buffer_load_dwordx4 v22, s[8:11], s60 offen sc1 lds
    s_add_u32 m0, s62, 14336
    s_add_u32 s87, s87, 1
    s_add_u32 s81, s81, 1
    s_cmp_eq_u32 s81, 4
    s_cselect_b32 s81, 0, s81
    buffer_load_dwordx4 v23, s[8:11], s60 offen sc1 lds
    s_add_u32 m0, s70, 0
    s_nop 0
    buffer_load_dwordx4 v16, s[8:11], s68 offen sc1 lds
    s_add_u32 m0, s70, 2048
    s_sub_u32 s64, s87, s6
    s_and_b32 s64, s64, 3
    s_lshl_b32 s64, s64, 2
    s_lshr_b32 s64, 31367, s64
    buffer_load_dwordx4 v17, s[8:11], s68 offen sc1 lds
    s_add_u32 m0, s70, 4096
    s_and_b32 s64, s64, 15
    s_add_u32 s64, s64, s87
    s_sub_u32 s64, s64, 8
    buffer_load_dwordx4 v18, s[8:11], s68 offen sc1 lds
    s_add_u32 m0, s70, 6144
    s_sub_u32 s65, s6, s87
    s_and_b32 s65, s65, 3
    s_add_u32 s65, s65, s87
    buffer_load_dwordx4 v19, s[8:11], s68 offen sc1 lds
    s_add_u32 m0, s70, 8192
    s_sub_u32 s65, s65, 2
    s_cmp_ge_u32 s65, 14
    s_cselect_b32 s64, s87, s64
    s_lshl_b32 s60, s64, 12
    buffer_load_dwordx4 v20, s[8:11], s68 offen sc1 lds
    s_add_u32 m0, s70, 10240
    s_mul_i32 s61, s64, 458752
    s_add_u32 s61, s61, s96
    s_mul_i32 s62, s81, 16384
    buffer_load_dwordx4 v21, s[8:11], s68 offen sc1 lds
    s_add_u32 m0, s70, 12288
    s_add_u32 s62, s62, s86
    s_mul_i32 s63, s81, 16384
    s_add_u32 s63, s63, s86
    buffer_load_dwordx4 v22, s[8:11], s68 offen sc1 lds
    s_add_u32 m0, s70, 14336
    s_add_u32 s87, s87, 1
    s_add_u32 s81, s81, 1
    s_cmp_eq_u32 s81, 4
    s_cselect_b32 s81, 0, s81
    buffer_load_dwordx4 v23, s[8:11], s68 offen sc1 lds
    s_bitcmp1_b32 s2, 0
    s_cbranch_scc0 L_p_par_10
    s_barrier
L_p_par_10:
    s_add_u32 m0, s62, 0
    s_waitcnt vmcnt(8)
    s_barrier
    buffer_load_dwordx4 v16, s[8:11], s60 offen sc1 lds
    s_add_u32 m0, s62, 2048
    s_sub_u32 s64, s87, s6
    s_and_b32 s64, s64, 3
    buffer_load_dwordx4 v17, s[8:11], s60 offen sc1 lds
    s_add_u32 m0, s62, 4096
    s_lshl_b32 s64, s64, 2
    buffer_load_dwordx4 v18, s[8:11], s60 offen sc1 lds
    s_add_u32 m0, s62, 6144
    s_lshr_b32 s64, 31367, s64
    s_and_b32 s64, s64, 15
    buffer_load_dwordx4 v19, s[8:11], s60 offen sc1 lds
    s_add_u32 m0, s62, 8192
    s_add_u32 s64, s64, s87
    buffer_load_dwordx4 v20, s[8:11], s60 offen sc1 lds
    s_add_u32 m0, s62, 10240
    s_sub_u32 s64, s64, 8
    s_sub_u32 s65, s6, s87
    buffer_load_dwordx4 v21, s[8:11], s60 offen sc1 lds
    s_add_u32 m0, s62, 12288
    s_and_b32 s65, s65, 3
    buffer_load_dwordx4 v22, s[8:11], s60 offen sc1 lds
    s_add_u32 m0, s62, 14336
    s_add_u32 s65, s65, s87
    s_sub_u32 s65, s65, 2
    buffer_load_dwordx4 v23, s[8:11], s60 offen sc1 lds
    s_add_u32 m0, s63, 65536
    s_cmp_ge_u32 s65, 14
    s_cselect_b32 s64, s87, s64
    buffer_load_dwordx4 v68, s[20:23], s61 offen  lds
    s_add_u32 m0, s63, 67584
    s_lshl_b32 s68, s64, 12
    s_mul_i32 s69, s64, 458752
    buffer_load_dwordx4 v69, s[20:23], s61 offen  lds
    s_add_u32 m0, s63, 69632
    s_add_u32 s69, s69, s96
    buffer_load_dwordx4 v70, s[20:23], s61 offen  lds
    s_add_u32 m0, s63, 71680
    s_mul_i32 s70, s81, 16384
    s_add_u32 s70, s70, s86
    buffer_load_dwordx4 v71, s[20:23], s61 offen  lds
    s_add_u32 m0, s63, 73728
    s_mul_i32 s71, s81, 16384
    buffer_load_dwordx4 v72, s[20:23], s61 offen  lds
    s_add_u32 m0, s63, 75776
    s_add_u32 s71, s71, s86
    s_add_u32 s87, s87, 1
    buffer_load_dwordx4 v73, s[20:23], s61 offen  lds
    s_add_u32 m0, s63, 77824
    s_add_u32 s81, s81, 1
    buffer_load_dwordx4 v74, s[20:23], s61 offen  lds
    s_add_u32 m0, s63, 79872
    s_cmp_eq_u32 s81, 4
    s_cselect_b32 s81, 0, s81
    buffer_load_dwordx4 v75, s[20:23], s61 offen  lds
    s_mov_b32 s80, 6
L_p_lp_11:
    s_add_u32 m0, s70, 0
    s_waitcnt vmcnt(16)
    s_barrier
    buffer_load_dwordx4 v16, s[8:11], s68 offen sc1 lds
    s_add_u32 m0, s70, 2048
    s_sub_u32 s80, s80, 1
    s_sub_u32 s64, s87, s6
    buffer_load_dwordx4 v17, s[8:11], s68 offen sc1 lds
    s_add_u32 m0, s70, 4096
    s_and_b32 s64, s64, 3
    s_lshl_b32 s64, s64, 2
    buffer_load_dwordx4 v18, s[8:11], s68 offen sc1 lds
    s_add_u32 m0, s70, 6144
    s_lshr_b32 s64, 31367, s64
    buffer_load_dwordx4 v19, s[8:11], s68 offen sc1 lds
    s_add_u32 m0, s70, 8192
    s_and_b32 s64, s64, 15
    s_add_u32 s64, s64, s87
    buffer_load_dwordx4 v20, s[8:11], s68 offen sc1 lds
    s_add_u32 m0, s70, 10240
    s_sub_u32 s64, s64, 8
    buffer_load_dwordx4 v21, s[8:11], s68 offen sc1 lds
    s_add_u32 m0, s70, 12288
    s_sub_u32 s65, s6, s87
    s_and_b32 s65, s65, 3
    buffer_load_dwordx4 v22, s[8:11], s68 offen sc1 lds
    s_add_u32 m0, s70, 14336
    s_add_u32 s65, s65, s87
    buffer_load_dwordx4 v23, s[8:11], s68 offen sc1 lds
    s_add_u32 m0, s71, 65536
    s_sub_u32 s65, s65, 2
    s_cmp_ge_u32 s65, 14
    s_cselect_b32 s64, s87, s64
    buffer_load_dwordx4 v68, s[20:23], s69 offen  lds
    s_add_u32 m0, s71, 67584
    s_lshl_b32 s60, s64, 12
    buffer_load_dwordx4 v69, s[20:23], s69 offen  lds
    s_add_u32 m0, s71, 69632
    s_mul_i32 s61, s64, 458752
    s_add_u32 s61, s61, s96
    buffer_load_dwordx4 v70, s[20:23], s69 offen  lds
    s_add_u32 m0, s71, 71680
    s_mul_i32 s62, s81, 16384
    buffer_load_dwordx4 v71, s[20:23], s69 offen  lds
    s_add_u32 m0, s71, 73728
    s_add_u32 s62, s62, s86
    s_mul_i32 s63, s81, 16384
    buffer_load_dwordx4 v72, s[20:23], s69 offen  lds
    s_add_u32 m0, s71, 75776
    s_add_u32 s63, s63, s86
    buffer_load_dwordx4 v73, s[20:23], s69 offen  lds
    s_add_u32 m0, s71, 77824
    s_add_u32 s87, s87, 1
    s_add_u32 s81, s81, 1
    buffer_load_dwordx4 v74, s[20:23], s69 offen  lds
    s_add_u32 m0, s71, 79872
    s_cmp_eq_u32 s81, 4
    s_cselect_b32 s81, 0, s81
    buffer_load_dwordx4 v75, s[20:23], s69 offen  lds
    s_add_u32 m0, s62, 0
    s_waitcnt vmcnt(16)
    s_barrier
    buffer_load_dwordx4 v16, s[8:11], s60 offen sc1 lds
    s_add_u32 m0, s62, 2048
    s_sub_u32 s64, s87, s6
    s_and_b32 s64, s64, 3
    buffer_load_dwordx4 v17, s[8:11], s60 offen sc1 lds
    s_add_u32 m0, s62, 4096
    s_lshl_b32 s64, s64, 2
    buffer_load_dwordx4 v18, s[8:11], s60 offen sc1 lds
    s_add_u32 m0, s62, 6144
    s_lshr_b32 s64, 31367, s64
    s_and_b32 s64, s64, 15
    buffer_load_dwordx4 v19, s[8:11], s60 offen sc1 lds
    s_add_u32 m0, s62, 8192
    s_add_u32 s64, s64, s87
    buffer_load_dwordx4 v20, s[8:11], s60 offen sc1 lds
    s_add_u32 m0, s62, 10240
    s_sub_u32 s64, s64, 8
    s_sub_u32 s65, s6, s87
    buffer_load_dwordx4 v21, s[8:11], s60 offen sc1 lds
    s_add_u32 m0, s62, 12288
    s_and_b32 s65, s65, 3
    buffer_load_dwordx4 v22, s[8:11], s60 offen sc1 lds
    s_add_u32 m0, s62, 14336
    s_add_u32 s65, s65, s87
    s_sub_u32 s65, s65, 2
    buffer_load_dwordx4 v23, s[8:11], s60 offen sc1 lds
    s_add_u32 m0, s63, 65536
    s_cmp_ge_u32 s65, 14
    s_cselect_b32 s64, s87, s64
    buffer_load_dwordx4 v68, s[20:23], s61 offen  lds
    s_add_u32 m0, s63, 67584
    s_lshl_b32 s68, s64, 12
    s_mul_i32 s69, s64, 458752
    buffer_load_dwordx4 v69, s[20:23], s61 offen  lds
    s_add_u32 m0, s63, 69632
    s_add_u32 s69, s69, s96
    buffer_load_dwordx4 v70, s[20:23], s61 offen  lds
    s_add_u32 m0, s63, 71680
    s_mul_i32 s70, s81, 16384
    s_add_u32 s70, s70, s86
    buffer_load_dwordx4 v71, s[20:23], s61 offen  lds
    s_add_u32 m0, s63, 73728
    s_mul_i32 s71, s81, 16384
    buffer_load_dwordx4 v72, s[20:23], s61 offen  lds
    s_add_u32 m0, s63, 75776
    s_add_u32 s71, s71, s86
    s_add_u32 s87, s87, 1
L_pad2:
    s_cbranch_execz L_padr2
    buffer_load_dwordx4 v73, s[20:23], s61 offen  lds
    s_add_u32 m0, s63, 77824
    s_add_u32 s81, s81, 1
    buffer_load_dwordx4 v74, s[20:23], s61 offen  lds
    s_add_u32 m0, s63, 79872
    s_cmp_eq_u32 s81, 4
    s_cselect_b32 s81, 0, s81
    buffer_load_dwordx4 v75, s[20:23], s61 offen  lds
    s_cmp_lg_u32 s80, 0
    s_cbranch_scc1 L_p_lp_11
    s_add_u32 m0, s70, 0
    s_waitcnt vmcnt(16)
    s_barrier
    buffer_load_dwordx4 v16, s[8:11], s68 offen sc1 lds
    s_add_u32 m0, s70, 2048
    s_mov_b32 s87, 0
    s_mov_b32 s96, 0
    buffer_load_dwordx4 v17, s[8:11], s68 offen sc1 lds
    s_add_u32 m0, s70, 4096
    s_sub_u32 s64, s87, s6
    s_and_b32 s64, s64, 3
    buffer_load_dwordx4 v18, s[8:11], s68 offen sc1 lds
    s_add_u32 m0, s70, 6144
    s_lshl_b32 s64, s64, 2
    buffer_load_dwordx4 v19, s[8:11], s68 offen sc1 lds
    s_add_u32 m0, s70, 8192
    s_lshr_b32 s64, 31367, s64
    s_and_b32 s64, s64, 15
    buffer_load_dwordx4 v20, s[8:11], s68 offen sc1 lds
    s_add_u32 m0, s70, 10240
    s_add_u32 s64, s64, s87
    buffer_load_dwordx4 v21, s[8:11], s68 offen sc1 lds
    s_add_u32 m0, s70, 12288
    s_sub_u32 s64, s64, 8
    s_sub_u32 s65, s6, s87
    buffer_load_dwordx4 v22, s[8:11], s68 offen sc1 lds
    s_add_u32 m0, s70, 14336
    s_and_b32 s65, s65, 3
    s_add_u32 s65, s65, s87
    buffer_load_dwordx4 v23, s[8:11], s68 offen sc1 lds
    s_add_u32 m0, s71, 65536
    s_sub_u32 s65, s65, 2
    buffer_load_dwordx4 v68, s[20:23], s69 offen  lds
    s_add_u32 m0, s71, 67584
    s_cmp_ge_u32 s65, 14
    s_cselect_b32 s64, s87, s64
    s_lshl_b32 s60, s64, 12
    buffer_load_dwordx4 v69, s[20:23], s69 offen  lds
    s_add_u32 m0, s71, 69632
    s_mul_i32 s61, s64, 458752
    buffer_load_dwordx4 v70, s[20:23], s69 offen  lds
    s_add_u32 m0, s71, 71680
    s_add_u32 s61, s61, s96
    s_mul_i32 s62, s81, 16384
    buffer_load_dwordx4 v71, s[20:23], s69 offen  lds
    s_add_u32 m0, s71, 73728
    s_add_u32 s62, s62, s86
    s_mul_i32 s63, s81, 16384
    buffer_load_dwordx4 v72, s[20:23], s69 offen  lds
    s_add_u32 m0, s71, 75776
    s_add_u32 s63, s63, s86
    buffer_load_dwordx4 v73, s[20:23], s69 offen  lds
    s_add_u32 m0, s71, 77824
    s_add_u32 s87, s87, 1
    s_add_u32 s81, s81, 1
    buffer_load_dwordx4 v74, s[20:23], s69 offen  lds
    s_add_u32 m0, s71, 79872
    s_cmp_eq_u32 s81, 4
    s_cselect_b32 s81, 0, s81
    buffer_load_dwordx4 v75, s[20:23], s69 offen  lds
    s_add_u32 m0, s62, 0
    s_waitcnt vmcnt(16)
    s_barrier
    buffer_load_dwordx4 v16, s[8:11], s60 offen sc1 lds
    s_add_u32 m0, s62, 2048
    s_sub_u32 s64, s87, s6
    s_and_b32 s64, s64, 3
    buffer_load_dwordx4 v17, s[8:11], s60 offen sc1 lds
    s_add_u32 m0, s62, 4096
    s_lshl_b32 s64, s64, 2
    buffer_load_dwordx4 v18, s[8:11], s60 offen sc1 lds
    s_add_u32 m0, s62, 6144
    s_lshr_b32 s64, 31367, s64
    s_and_b32 s64, s64, 15
    buffer_load_dwordx4 v19, s[8:11], s60 offen sc1 lds
    s_add_u32 m0, s62, 8192
    s_add_u32 s64, s64, s87
    buffer_load_dwordx4 v20, s[8:11], s60 offen sc1 lds
    s_add_u32 m0, s62, 10240
    s_sub_u32 s64, s64, 8
    s_sub_u32 s65, s6, s87
    buffer_load_dwordx4 v21, s[8:11], s60 offen sc1 lds
    s_add_u32 m0, s62, 12288
    s_and_b32 s65, s65, 3
    buffer_load_dwordx4 v22, s[8:11], s60 offen sc1 lds
    s_add_u32 m0, s62, 14336
    s_add_u32 s65, s65, s87
    s_sub_u32 s65, s65, 2
    buffer_load_dwordx4 v23, s[8:11], s60 offen sc1 lds
    s_add_u32 m0, s63, 65536
    s_cmp_ge_u32 s65, 14
    s_cselect_b32 s64, s87, s64
    buffer_load_dwordx4 v68, s[20:23], s61 offen  lds
    s_add_u32 m0, s63, 67584
    s_lshl_b32 s68, s64, 12
    s_mul_i32 s69, s64, 458752
    buffer_load_dwordx4 v69, s[20:23], s61 offen  lds
    s_add_u32 m0, s63, 69632
    s_add_u32 s69, s69, s96
    buffer_load_dwordx4 v70, s[20:23], s61 offen  lds
    s_add_u32 m0, s63, 71680
    s_mul_i32 s70, s81, 16384
    s_add_u32 s70, s70, s86
    buffer_load_dwordx4 v71, s[20:23], s61 offen  lds
    s_add_u32 m0, s63, 73728
    s_mul_i32 s71, s81, 16384
    buffer_load_dwordx4 v72, s[20:23], s61 offen  lds
    s_add_u32 m0, s63, 75776
    s_add_u32 s71, s71, s86
    s_add_u32 s87, s87, 1
    buffer_load_dwordx4 v73, s[20:23], s61 offen  lds
    s_add_u32 m0, s63, 77824
    s_add_u32 s81, s81, 1
    buffer_load_dwordx4 v74, s[20:23], s61 offen  lds
    s_add_u32 m0, s63, 79872
    s_cmp_eq_u32 s81, 4
    s_cselect_b32 s81, 0, s81
    buffer_load_dwordx4 v75, s[20:23], s61 offen  lds
    s_add_u32 m0, s70, 0
    s_waitcnt vmcnt(16)
    s_barrier
    buffer_load_dwordx4 v16, s[8:11], s68 offen sc1 lds
    s_add_u32 m0, s70, 2048
    s_sub_u32 s64, s87, s6
    s_and_b32 s64, s64, 3
    buffer_load_dwordx4 v17, s[8:11], s68 offen sc1 lds
    s_add_u32 m0, s70, 4096
    s_lshl_b32 s64, s64, 2
    buffer_load_dwordx4 v18, s[8:11], s68 offen sc1 lds
    s_add_u32 m0, s70, 6144
    s_lshr_b32 s64, 31367, s64
    s_and_b32 s64, s64, 15
    buffer_load_dwordx4 v19, s[8:11], s68 offen sc1 lds
    s_add_u32 m0, s70, 8192
    s_add_u32 s64, s64, s87
    buffer_load_dwordx4 v20, s[8:11], s68 offen sc1 lds
    s_add_u32 m0, s70, 10240
    s_sub_u32 s64, s64, 8
    s_sub_u32 s65, s6, s87
    buffer_load_dwordx4 v21, s[8:11], s68 offen sc1 lds
    s_add_u32 m0, s70, 12288
    s_and_b32 s65, s65, 3
    buffer_load_dwordx4 v22, s[8:11], s68 offen sc1 lds
    s_add_u32 m0, s70, 14336
    s_add_u32 s65, s65, s87
    s_sub_u32 s65, s65, 2
    buffer_load_dwordx4 v23, s[8:11], s68 offen sc1 lds
    s_add_u32 m0, s71, 65536
    s_cmp_ge_u32 s65, 14
    s_cselect_b32 s64, s87, s64
    buffer_load_dwordx4 v68, s[20:23], s69 offen  lds
    s_add_u32 m0, s71, 67584
    s_lshl_b32 s60, s64, 12
    s_mul_i32 s61, s64, 458752
    buffer_load_dwordx4 v69, s[20:23], s69 offen  lds
    s_add_u32 m0, s71, 69632
    s_add_u32 s61, s61, s96
    buffer_load_dwordx4 v70, s[20:23], s69 offen  lds
    s_add_u32 m0, s71, 71680
    s_mul_i32 s62, s81, 16384
    s_add_u32 s62, s62, s86
    buffer_load_dwordx4 v71, s[20:23], s69 offen  lds
    s_add_u32 m0, s71, 73728
    s_mul_i32 s63, s81, 16384
    buffer_load_dwordx4 v72, s[20:23], s69 offen  lds
    s_add_u32 m0, s71, 75776
    s_add_u32 s63, s63, s86
    s_add_u32 s87, s87, 1
    buffer_load_dwordx4 v73, s[20:23], s69 offen  lds
    s_add_u32 m0, s71, 77824
    s_add_u32 s81, s81, 1
    buffer_load_dwordx4 v74, s[20:23], s69 offen  lds
    s_add_u32 m0, s71, 79872
    s_cmp_eq_u32 s81, 4
    s_cselect_b32 s81, 0, s81
    buffer_load_dwordx4 v75, s[20:23], s69 offen  lds
    s_add_u32 m0, s62, 0
    s_waitcnt vmcnt(16)
    s_barrier
    buffer_load_dwordx4 v16, s[8:11], s60 offen sc1 lds
    s_add_u32 m0, s62, 2048
    s_sub_u32 s64, s87, s6
    s_and_b32 s64, s64, 3
    buffer_load_dwordx4 v17, s[8:11], s60 offen sc1 lds
    s_add_u32 m0, s62, 4096
    s_lshl_b32 s64, s64, 2
    buffer_load_dwordx4 v18, s[8:11], s60 offen sc1 lds
    s_add_u32 m0, s62, 6144
    s_lshr_b32 s64, 31367, s64
    s_and_b32 s64, s64, 15
    buffer_load_dwordx4 v19, s[8:11], s60 offen sc1 lds
    s_add_u32 m0, s62, 8192
    s_add_u32 s64, s64, s87
    buffer_load_dwordx4 v20, s[8:11], s60 offen sc1 lds
    s_add_u32 m0, s62, 10240
    s_sub_u32 s64, s64, 8
    s_sub_u32 s65, s6, s87
    buffer_load_dwordx4 v21, s[8:11], s60 offen sc1 lds
    s_add_u32 m0, s62, 12288
    s_and_b32 s65, s65, 3
    buffer_load_dwordx4 v22, s[8:11], s60 offen sc1 lds
    s_add_u32 m0, s62, 14336
    s_add_u32 s65, s65, s87
    s_sub_u32 s65, s65, 2
    buffer_load_dwordx4 v23, s[8:11], s60 offen sc1 lds
    s_add_u32 m0, s63, 65536
    s_cmp_ge_u32 s65, 14
    s_cselect_b32 s64, s87, s64
    buffer_load_dwordx4 v68, s[20:23], s61 offen  lds
    s_add_u32 m0, s63, 67584
    s_lshl_b32 s68, s64, 12
    s_mul_i32 s69, s64, 458752
    buffer_load_dwordx4 v69, s[20:23], s61 offen  lds
    s_add_u32 m0, s63, 69632
    s_add_u32 s69, s69, s96
    buffer_load_dwordx4 v70, s[20:23], s61 offen  lds
    s_add_u32 m0, s63, 71680
    s_mul_i32 s70, s81, 16384
    s_add_u32 s70, s70, s86
    buffer_load_dwordx4 v71, s[20:23], s61 offen  lds
    s_add_u32 m0, s63, 73728
    s_mul_i32 s71, s81, 16384
    buffer_load_dwordx4 v72, s[20:23], s61 offen  lds
    s_add_u32 m0, s63, 75776
    s_add_u32 s71, s71, s86
    s_add_u32 s87, s87, 1
    buffer_load_dwordx4 v73, s[20:23], s61 offen  lds
    s_add_u32 m0, s63, 77824
    s_add_u32 s81, s81, 1
    buffer_load_dwordx4 v74, s[20:23], s61 offen  lds
    s_add_u32 m0, s63, 79872
    s_cmp_eq_u32 s81, 4
    s_cselect_b32 s81, 0, s81
    buffer_load_dwordx4 v75, s[20:23], s61 offen  lds
    s_add_u32 m0, s70, 0
    s_nop 0
    buffer_load_dwordx4 v16, s[8:11], s68 offen sc1 lds
    s_add_u32 m0, s70, 2048
    s_sub_u32 s64, s87, s6
    s_and_b32 s64, s64, 3
    buffer_load_dwordx4 v17, s[8:11], s68 offen sc1 lds
    s_add_u32 m0, s70, 4096
    s_lshl_b32 s64, s64, 2
    buffer_load_dwordx4 v18, s[8:11], s68 offen sc1 lds
    s_add_u32 m0, s70, 6144
    s_lshr_b32 s64, 31367, s64
    s_and_b32 s64, s64, 15
    buffer_load_dwordx4 v19, s[8:11], s68 offen sc1 lds
    s_add_u32 m0, s70, 8192
    s_add_u32 s64, s64, s87
    buffer_load_dwordx4 v20, s[8:11], s68 offen sc1 lds
    s_add_u32 m0, s70, 10240
    s_sub_u32 s64, s64, 8
    s_sub_u32 s65, s6, s87
    buffer_load_dwordx4 v21, s[8:11], s68 offen sc1 lds
    s_add_u32 m0, s70, 12288
    s_and_b32 s65, s65, 3
    buffer_load_dwordx4 v22, s[8:11], s68 offen sc1 lds
    s_add_u32 m0, s70, 14336
    s_add_u32 s65, s65, s87
    s_sub_u32 s65, s65, 2
    buffer_load_dwordx4 v23, s[8:11], s68 offen sc1 lds
    s_add_u32 m0, s71, 65536
    s_cmp_ge_u32 s65, 14
    s_cselect_b32 s64, s87, s64
    buffer_load_dwordx4 v68, s[20:23], s69 offen  lds
    s_add_u32 m0, s71, 67584
    s_lshl_b32 s60, s64, 12
    s_mul_i32 s61, s64, 458752
    buffer_load_dwordx4 v69, s[20:23], s69 offen  lds
    s_add_u32 m0, s71, 69632
    s_add_u32 s61, s61, s96
    buffer_load_dwordx4 v70, s[20:23], s69 offen  lds
    s_add_u32 m0, s71, 71680
    s_mul_i32 s62, s81, 16384
    s_add_u32 s62, s62, s86
    buffer_load_dwordx4 v71, s[20:23], s69 offen  lds
    s_add_u32 m0, s71, 73728
    s_mul_i32 s63, s81, 16384
    buffer_load_dwordx4 v72, s[20:23], s69 offen  lds
    s_add_u32 m0, s71, 75776
    s_add_u32 s63, s63, s86
    s_add_u32 s87, s87, 1
    buffer_load_dwordx4 v73, s[20:23], s69 offen  lds
    s_add_u32 m0, s71, 77824
    s_add_u32 s81, s81, 1
    buffer_load_dwordx4 v74, s[20:23], s69 offen  lds
    s_add_u32 m0, s71, 79872
    s_cmp_eq_u32 s81, 4
    s_cselect_b32 s81, 0, s81
    buffer_load_dwordx4 v75, s[20:23], s69 offen  lds
    s_barrier
    s_add_u32 m0, s62, 0
    s_waitcnt vmcnt(32)
    s_barrier
    buffer_load_dwordx4 v16, s[8:11], s60 offen sc1 lds
    s_add_u32 m0, s62, 2048
    s_sub_u32 s64, s87, s6
    s_and_b32 s64, s64, 3
    buffer_load_dwordx4 v17, s[8:11], s60 offen sc1 lds
    s_add_u32 m0, s62, 4096
    s_lshl_b32 s64, s64, 2
    buffer_load_dwordx4 v18, s[8:11], s60 offen sc1 lds
    s_add_u32 m0, s62, 6144
    s_lshr_b32 s64, 31367, s64
    s_and_b32 s64, s64, 15
    buffer_load_dwordx4 v19, s[8:11], s60 offen sc1 lds
    s_add_u32 m0, s62, 8192
    s_add_u32 s64, s64, s87
    buffer_load_dwordx4 v20, s[8:11], s60 offen sc1 lds
    s_add_u32 m0, s62, 10240
    s_sub_u32 s64, s64, 8
    s_sub_u32 s65, s6, s87
    buffer_load_dwordx4 v21, s[8:11], s60 offen sc1 lds
    s_add_u32 m0, s62, 12288
    s_and_b32 s65, s65, 3
    buffer_load_dwordx4 v22, s[8:11], s60 offen sc1 lds
    s_add_u32 m0, s62, 14336
    s_add_u32 s65, s65, s87
    s_sub_u32 s65, s65, 2
    buffer_load_dwordx4 v23, s[8:11], s60 offen sc1 lds
    s_add_u32 m0, s63, 65536
    s_cmp_ge_u32 s65, 14
    s_cselect_b32 s64, s87, s64
    buffer_load_dwordx4 v68, s[20:23], s61 offen  lds
    s_add_u32 m0, s63, 67584
    s_lshl_b32 s68, s64, 12
    s_mul_i32 s69, s64, 458752
    buffer_load_dwordx4 v69, s[20:23], s61 offen  lds
    s_add_u32 m0, s63, 69632
    s_add_u32 s69, s69, s96
    buffer_load_dwordx4 v70, s[20:23], s61 offen  lds
    s_add_u32 m0, s63, 71680
    s_mul_i32 s70, s81, 16384
    s_add_u32 s70, s70, s86
    buffer_load_dwordx4 v71, s[20:23], s61 offen  lds
    s_add_u32 m0, s63, 73728
    s_mul_i32 s71, s81, 16384
    buffer_load_dwordx4 v72, s[20:23], s61 offen  lds
    s_add_u32 m0, s63, 75776
    s_add_u32 s71, s71, s86
    s_add_u32 s87, s87, 1
    buffer_load_dwordx4 v73, s[20:23], s61 offen  lds
    s_add_u32 m0, s63, 77824
    s_add_u32 s81, s81, 1
    buffer_load_dwordx4 v74, s[20:23], s61 offen  lds
    s_add_u32 m0, s63, 79872
    s_cmp_eq_u32 s81, 4
    s_cselect_b32 s81, 0, s81
    buffer_load_dwordx4 v75, s[20:23], s61 offen  lds
    s_mov_b32 s80, 5
L_p_lp_12:
    s_add_u32 m0, s70, 0
    s_waitcnt vmcnt(32)
    s_barrier
    buffer_load_dwordx4 v16, s[8:11], s68 offen sc1 lds
    s_add_u32 m0, s70, 2048
    s_sub_u32 s80, s80, 1
    s_sub_u32 s64, s87, s6
    buffer_load_dwordx4 v17, s[8:11], s68 offen sc1 lds
    s_add_u32 m0, s70, 4096
    s_and_b32 s64, s64, 3
    s_lshl_b32 s64, s64, 2
    buffer_load_dwordx4 v18, s[8:11], s68 offen sc1 lds
    s_add_u32 m0, s70, 6144
    s_lshr_b32 s64, 31367, s64
    buffer_load_dwordx4 v19, s[8:11], s68 offen sc1 lds
    s_add_u32 m0, s70, 8192
    s_and_b32 s64, s64, 15
    s_add_u32 s64, s64, s87
    buffer_load_dwordx4 v20, s[8:11], s68 offen sc1 lds
    s_add_u32 m0, s70, 10240
    s_sub_u32 s64, s64, 8
    buffer_load_dwordx4 v21, s[8:11], s68 offen sc1 lds
    s_add_u32 m0, s70, 12288
    s_sub_u32 s65, s6, s87
    s_and_b32 s65, s65, 3
    buffer_load_dwordx4 v22, s[8:11], s68 offen sc1 lds
    s_add_u32 m0, s70, 14336
    s_add_u32 s65, s65, s87
    buffer_load_dwordx4 v23, s[8:11], s68 offen sc1 lds
    s_add_u32 m0, s71, 65536
    s_sub_u32 s65, s65, 2
    s_cmp_ge_u32 s65, 14
    s_cselect_b32 s64, s87, s64
    buffer_load_dwordx4 v68, s[20:23], s69 offen  lds
    s_add_u32 m0, s71, 67584
    s_lshl_b32 s60, s64, 12
    buffer_load_dwordx4 v69, s[20:23], s69 offen  lds
    s_add_u32 m0, s71, 69632
    s_mul_i32 s61, s64, 458752
    s_add_u32 s61, s61, s96
    buffer_load_dwordx4 v70, s[20:23], s69 offen  lds
    s_add_u32 m0, s71, 71680
    s_mul_i32 s62, s81, 16384
    buffer_load_dwordx4 v71, s[20:23], s69 offen  lds
    s_add_u32 m0, s71, 73728
    s_add_u32 s62, s62, s86
    s_mul_i32 s63, s81, 16384
    buffer_load_dwordx4 v72, s[20:23], s69 offen  lds
    s_add_u32 m0, s71, 75776
    s_add_u32 s63, s63, s86
    buffer_load_dwordx4 v73, s[20:23], s69 offen  lds
    s_add_u32 m0, s71, 77824
    s_add_u32 s87, s87, 1
    s_add_u32 s81, s81, 1
    buffer_load_dwordx4 v74, s[20:23], s69 offen  lds
    s_add_u32 m0, s71, 79872
    s_cmp_eq_u32 s81, 4
    s_cselect_b32 s81, 0, s81
    buffer_load_dwordx4 v75, s[20:23], s69 offen  lds
    s_add_u32 m0, s62, 0
    s_waitcnt vmcnt(32)
    s_barrier
    buffer_load_dwordx4 v16, s[8:11], s60 offen sc1 lds
    s_add_u32 m0, s62, 2048
    s_sub_u32 s64, s87, s6
    s_and_b32 s64, s64, 3
    buffer_load_dwordx4 v17, s[8:11], s60 offen sc1 lds
    s_add_u32 m0, s62, 4096
    s_lshl_b32 s64, s64, 2
    buffer_load_dwordx4 v18, s[8:11], s60 offen sc1 lds
    s_add_u32 m0, s62, 6144
    s_lshr_b32 s64, 31367, s64
    s_and_b32 s64, s64, 15
    buffer_load_dwordx4 v19, s[8:11], s60 offen sc1 lds
    s_add_u32 m0, s62, 8192
    s_add_u32 s64, s64, s87
    buffer_load_dwordx4 v20, s[8:11], s60 offen sc1 lds
    s_add_u32 m0, s62, 10240
    s_sub_u32 s64, s64, 8
    s_sub_u32 s65, s6, s87
    buffer_load_dwordx4 v21, s[8:11], s60 offen sc1 lds
    s_add_u32 m0, s62, 12288
    s_and_b32 s65, s65, 3
    buffer_load_dwordx4 v22, s[8:11], s60 offen sc1 lds
    s_add_u32 m0, s62, 14336
    s_add_u32 s65, s65, s87
    s_sub_u32 s65, s65, 2
    buffer_load_dwordx4 v23, s[8:11], s60 offen sc1 lds
    s_add_u32 m0, s63, 65536
    s_cmp_ge_u32 s65, 14
    s_cselect_b32 s64, s87, s64
    buffer_load_dwordx4 v68, s[20:23], s61 offen  lds
    s_add_u32 m0, s63, 67584
    s_lshl_b32 s68, s64, 12
    s_mul_i32 s69, s64, 458752
    buffer_load_dwordx4 v69, s[20:23], s61 offen  lds
    s_add_u32 m0, s63, 69632
    s_add_u32 s69, s69, s96
    buffer_load_dwordx4 v70, s[20:23], s61 offen  lds
    s_add_u32 m0, s63, 71680
    s_mul_i32 s70, s81, 16384
    s_add_u32 s70, s70, s86
    buffer_load_dwordx4 v71, s[20:23], s61 offen  lds
    s_add_u32 m0, s63, 73728
    s_mul_i32 s71, s81, 16384
    buffer_load_dwordx4 v72, s[20:23], s61 offen  lds
    s_add_u32 m0, s63, 75776
    s_add_u32 s71, s71, s86
    s_add_u32 s87, s87, 1
    buffer_load_dwordx4 v73, s[20:23], s61 offen  lds
    s_add_u32 m0, s63, 77824
    s_add_u32 s81, s81, 1
    buffer_load_dwordx4 v74, s[20:23], s61 offen  lds
    s_add_u32 m0, s63, 79872
    s_cmp_eq_u32 s81, 4
    s_cselect_b32 s81, 0, s81
    buffer_load_dwordx4 v75, s[20:23], s61 offen  lds
    s_cmp_lg_u32 s80, 0
    s_cbranch_scc1 L_p_lp_12
    s_add_u32 m0, s70, 0
    s_waitcnt vmcnt(32)
    s_barrier
    buffer_load_dwordx4 v16, s[8:11], s68 offen sc1 lds
    s_add_u32 m0, s70, 2048
    s_mov_b32 s87, 0
    s_sub_u32 s64, s87, s6
    buffer_load_dwordx4 v17, s[8:11], s68 offen sc1 lds
    s_add_u32 m0, s70, 4096
    s_and_b32 s64, s64, 3
    s_lshl_b32 s64, s64, 2
    buffer_load_dwordx4 v18, s[8:11], s68 offen sc1 lds
    s_add_u32 m0, s70, 6144
    s_lshr_b32 s64, 31367, s64
    s_and_b32 s64, s64, 15
    buffer_load_dwordx4 v19, s[8:11], s68 offen sc1 lds
    s_add_u32 m0, s70, 8192
    s_add_u32 s64, s64, s87
    s_sub_u32 s64, s64, 8
    buffer_load_dwordx4 v20, s[8:11], s68 offen sc1 lds
    s_add_u32 m0, s70, 10240
    s_sub_u32 s65, s6, s87
    s_and_b32 s65, s65, 3
    buffer_load_dwordx4 v21, s[8:11], s68 offen sc1 lds
    s_add_u32 m0, s70, 12288
    s_add_u32 s65, s65, s87
    s_sub_u32 s65, s65, 4
    buffer_load_dwordx4 v22, s[8:11], s68 offen sc1 lds
    s_add_u32 m0, s70, 14336
    s_cmp_ge_u32 s65, 28
    s_cselect_b32 s64, s87, s64
    s_sub_u32 s65, s64, 2
    buffer_load_dwordx4 v23, s[8:11], s68 offen sc1 lds
    s_add_u32 m0, s71, 65536
    s_cmp_lt_u32 s65, s75
    s_cselect_b32 s64, s65, s64
    buffer_load_dwordx4 v68, s[20:23], s69 offen  lds
    s_add_u32 m0, s71, 67584
    s_add_u32 s65, s75, s87
    s_cmp_lt_u32 s87, 2
    s_cselect_b32 s64, s65, s64
    buffer_load_dwordx4 v69, s[20:23], s69 offen  lds
    s_add_u32 m0, s71, 69632
    s_add_u32 s64, s64, s93
    s_and_b32 s64, s64, 31
    buffer_load_dwordx4 v70, s[20:23], s69 offen  lds
    s_add_u32 m0, s71, 71680
    s_lshl_b32 s60, s64, 7
    s_mul_i32 s61, s64, 16384
    buffer_load_dwordx4 v71, s[20:23], s69 offen  lds
    s_add_u32 m0, s71, 73728
    s_mul_i32 s62, s81, 16384
    s_add_u32 s62, s62, s86
    buffer_load_dwordx4 v72, s[20:23], s69 offen  lds
    s_add_u32 m0, s71, 75776
    s_mul_i32 s63, s81, 16384
    s_add_u32 s63, s63, s86
    buffer_load_dwordx4 v73, s[20:23], s69 offen  lds
    s_add_u32 m0, s71, 77824
    s_add_u32 s87, s87, 1
    s_add_u32 s81, s81, 1
    buffer_load_dwordx4 v74, s[20:23], s69 offen  lds
    s_add_u32 m0, s71, 79872
    s_cmp_eq_u32 s81, 4
    s_cselect_b32 s81, 0, s81
    buffer_load_dwordx4 v75, s[20:23], s69 offen  lds
    s_add_u32 s8, s54, 29360128
    s_addc_u32 s9, s55, 0
    s_mov_b32 s10, 7340032
    s_mov_b32 s11, 0x20000
    s_mov_b32 s12, s48
    s_mov_b32 s13, s49
    s_mov_b32 s14, 3670016
    s_mov_b32 s15, 0x20000
    s_add_u32 m0, s62, 0
    s_waitcnt vmcnt(32)
    s_barrier
    buffer_load_dwordx4 v36, s[16:19], s60 offen  lds
    s_add_u32 m0, s62, 2048
    s_sub_u32 s64, s87, s6
    s_and_b32 s64, s64, 3
    buffer_load_dwordx4 v37, s[16:19], s60 offen  lds
    s_add_u32 m0, s62, 4096
    s_lshl_b32 s64, s64, 2
    s_lshr_b32 s64, 31367, s64
    buffer_load_dwordx4 v38, s[16:19], s60 offen  lds
    s_add_u32 m0, s62, 6144
    s_and_b32 s64, s64, 15
    s_add_u32 s64, s64, s87
    buffer_load_dwordx4 v39, s[16:19], s60 offen  lds
    s_add_u32 m0, s62, 8192
    s_sub_u32 s64, s64, 8
    s_sub_u32 s65, s6, s87
    buffer_load_dwordx4 v40, s[16:19], s60 offen  lds
    s_add_u32 m0, s62, 10240
    s_and_b32 s65, s65, 3
    buffer_load_dwordx4 v41, s[16:19], s60 offen  lds
    s_add_u32 m0, s62, 12288
    s_add_u32 s65, s65, s87
    s_sub_u32 s65, s65, 4
    buffer_load_dwordx4 v42, s[16:19], s60 offen  lds
    s_add_u32 m0, s62, 14336
    s_cmp_ge_u32 s65, 28
    s_cselect_b32 s64, s87, s64
    s_sub_u32 s65, s64, 2
    buffer_load_dwordx4 v43, s[16:19], s60 offen  lds
    s_add_u32 m0, s63, 65536
    s_cmp_lt_u32 s65, s75
    s_cselect_b32 s64, s65, s64
    s_add_u32 s65, s75, s87
    buffer_load_dwordx4 v44, s[28:31], s61 offen sc1 lds
    s_add_u32 m0, s63, 67584
    s_cmp_lt_u32 s87, 2
    s_cselect_b32 s64, s65, s64
    s_add_u32 s64, s64, s93
    buffer_load_dwordx4 v45, s[28:31], s61 offen sc1 lds
    s_add_u32 m0, s63, 69632
    s_and_b32 s64, s64, 31
    buffer_load_dwordx4 v46, s[28:31], s61 offen sc1 lds
    s_add_u32 m0, s63, 71680
    s_lshl_b32 s68, s64, 7
    s_mul_i32 s69, s64, 16384
    buffer_load_dwordx4 v47, s[28:31], s61 offen sc1 lds
    s_add_u32 m0, s63, 73728
    s_mul_i32 s70, s81, 16384
    s_add_u32 s70, s70, s86
    buffer_load_dwordx4 v48, s[28:31], s61 offen sc1 lds
    s_add_u32 m0, s63, 75776
    s_mul_i32 s71, s81, 16384
    s_add_u32 s71, s71, s86
    buffer_load_dwordx4 v49, s[28:31], s61 offen sc1 lds
    s_add_u32 m0, s63, 77824
    s_add_u32 s87, s87, 1
    s_add_u32 s81, s81, 1
    buffer_load_dwordx4 v50, s[28:31], s61 offen sc1 lds
    s_add_u32 m0, s63, 79872
    s_cmp_eq_u32 s81, 4
    s_cselect_b32 s81, 0, s81
    buffer_load_dwordx4 v51, s[28:31], s61 offen sc1 lds
    s_mov_b32 s80, 15
L_p_lp_13:
    s_add_u32 m0, s70, 0
    s_waitcnt vmcnt(32)
    s_barrier
    buffer_load_dwordx4 v36, s[16:19], s68 offen  lds
    s_add_u32 m0, s70, 2048
    s_sub_u32 s80, s80, 1
    s_sub_u32 s64, s87, s6
    buffer_load_dwordx4 v37, s[16:19], s68 offen  lds
    s_add_u32 m0, s70, 4096
    s_and_b32 s64, s64, 3
    s_lshl_b32 s64, s64, 2
    buffer_load_dwordx4 v38, s[16:19], s68 offen  lds
    s_add_u32 m0, s70, 6144
    s_lshr_b32 s64, 31367, s64
    s_and_b32 s64, s64, 15
    buffer_load_dwordx4 v39, s[16:19], s68 offen  lds
    s_add_u32 m0, s70, 8192
    s_add_u32 s64, s64, s87
    s_sub_u32 s64, s64, 8
    buffer_load_dwordx4 v40, s[16:19], s68 offen  lds
    s_add_u32 m0, s70, 10240
    s_sub_u32 s65, s6, s87
    s_and_b32 s65, s65, 3
    buffer_load_dwordx4 v41, s[16:19], s68 offen  lds
    s_add_u32 m0, s70, 12288
    s_add_u32 s65, s65, s87
    s_sub_u32 s65, s65, 4
    buffer_load_dwordx4 v42, s[16:19], s68 offen  lds
    s_add_u32 m0, s70, 14336
L_pad3:
    s_cbranch_execz L_padr3
    s_cmp_ge_u32 s65, 28
    s_cselect_b32 s64, s87, s64
    s_sub_u32 s65, s64, 2
    buffer_load_dwordx4 v43, s[16:19], s68 offen  lds
    s_add_u32 m0, s71, 65536
    s_cmp_lt_u32 s65, s75
    s_cselect_b32 s64, s65, s64
    buffer_load_dwordx4 v44, s[28:31], s69 offen sc1 lds
    s_add_u32 m0, s71, 67584
    s_add_u32 s65, s75, s87
    s_cmp_lt_u32 s87, 2
    s_cselect_b32 s64, s65, s64
    buffer_load_dwordx4 v45, s[28:31], s69 offen sc1 lds
    s_add_u32 m0, s71, 69632
    s_add_u32 s64, s64, s93
    s_and_b32 s64, s64, 31
    buffer_load_dwordx4 v46, s[28:31], s69 offen sc1 lds
    s_add_u32 m0, s71, 71680
    s_lshl_b32 s60, s64, 7
    s_mul_i32 s61, s64, 16384
    buffer_load_dwordx4 v47, s[28:31], s69 offen sc1 lds
    s_add_u32 m0, s71, 73728
    s_mul_i32 s62, s81, 16384
    s_add_u32 s62, s62, s86
    buffer_load_dwordx4 v48, s[28:31], s69 offen sc1 lds
    s_add_u32 m0, s71, 75776
    s_mul_i32 s63, s81, 16384
    s_add_u32 s63, s63, s86
    buffer_load_dwordx4 v49, s[28:31], s69 offen sc1 lds
    s_add_u32 m0, s71, 77824
    s_add_u32 s87, s87, 1
    s_add_u32 s81, s81, 1
    buffer_load_dwordx4 v50, s[28:31], s69 offen sc1 lds
    s_add_u32 m0, s71, 79872
    s_cmp_eq_u32 s81, 4
    s_cselect_b32 s81, 0, s81
    buffer_load_dwordx4 v51, s[28:31], s69 offen sc1 lds
    s_add_u32 m0, s62, 0
    s_waitcnt vmcnt(32)
    s_barrier
    buffer_load_dwordx4 v36, s[16:19], s60 offen  lds
    s_add_u32 m0, s62, 2048
    s_sub_u32 s64, s87, s6
    s_and_b32 s64, s64, 3
    buffer_load_dwordx4 v37, s[16:19], s60 offen  lds
    s_add_u32 m0, s62, 4096
    s_lshl_b32 s64, s64, 2
    s_lshr_b32 s64, 31367, s64
    buffer_load_dwordx4 v38, s[16:19], s60 offen  lds
    s_add_u32 m0, s62, 6144
    s_and_b32 s64, s64, 15
    s_add_u32 s64, s64, s87
    buffer_load_dwordx4 v39, s[16:19], s60 offen  lds
    s_add_u32 m0, s62, 8192
    s_sub_u32 s64, s64, 8
    s_sub_u32 s65, s6, s87
    buffer_load_dwordx4 v40, s[16:19], s60 offen  lds
    s_add_u32 m0, s62, 10240
    s_and_b32 s65, s65, 3
    buffer_load_dwordx4 v41, s[16:19], s60 offen  lds
    s_add_u32 m0, s62, 12288
    s_add_u32 s65, s65, s87
    s_sub_u32 s65, s65, 4
    buffer_load_dwordx4 v42, s[16:19], s60 offen  lds
    s_add_u32 m0, s62, 14336
    s_cmp_ge_u32 s65, 28
    s_cselect_b32 s64, s87, s64
    s_sub_u32 s65, s64, 2
    buffer_load_dwordx4 v43, s[16:19], s60 offen  lds
    s_add_u32 m0, s63, 65536
    s_cmp_lt_u32 s65, s75
    s_cselect_b32 s64, s65, s64
    s_add_u32 s65, s75, s87
    buffer_load_dwordx4 v44, s[28:31], s61 offen sc1 lds
    s_add_u32 m0, s63, 67584
    s_cmp_lt_u32 s87, 2
    s_cselect_b32 s64, s65, s64
    s_add_u32 s64, s64, s93
    buffer_load_dwordx4 v45, s[28:31], s61 offen sc1 lds
    s_add_u32 m0, s63, 69632
    s_and_b32 s64, s64, 31
    buffer_load_dwordx4 v46, s[28:31], s61 offen sc1 lds
    s_add_u32 m0, s63, 71680
    s_lshl_b32 s68, s64, 7
    s_mul_i32 s69, s64, 16384
    buffer_load_dwordx4 v47, s[28:31], s61 offen sc1 lds
    s_add_u32 m0, s63, 73728
    s_mul_i32 s70, s81, 16384
    s_add_u32 s70, s70, s86
    buffer_load_dwordx4 v48, s[28:31], s61 offen sc1 lds
    s_add_u32 m0, s63, 75776
    s_mul_i32 s71, s81, 16384
    s_add_u32 s71, s71, s86
    buffer_load_dwordx4 v49, s[28:31], s61 offen sc1 lds
    s_add_u32 m0, s63, 77824
    s_add_u32 s87, s87, 1
    s_add_u32 s81, s81, 1
    buffer_load_dwordx4 v50, s[28:31], s61 offen sc1 lds
    s_add_u32 m0, s63, 79872
    s_cmp_eq_u32 s81, 4
    s_cselect_b32 s81, 0, s81
    buffer_load_dwordx4 v51, s[28:31], s61 offen sc1 lds
    s_cmp_lg_u32 s80, 0
    s_cbranch_scc1 L_p_lp_13
    s_add_u32 m0, s70, 0
    s_waitcnt vmcnt(32)
    s_barrier
    buffer_load_dwordx4 v36, s[16:19], s68 offen  lds
    s_add_u32 m0, s70, 2048
    s_mov_b32 s87, 0
    s_mov_b32 s81, 2
    buffer_load_dwordx4 v37, s[16:19], s68 offen  lds
    s_add_u32 m0, s70, 4096
    s_sub_u32 s64, s87, s6
    s_and_b32 s64, s64, 3
    buffer_load_dwordx4 v38, s[16:19], s68 offen  lds
    s_add_u32 m0, s70, 6144
    s_lshl_b32 s64, s64, 2
    buffer_load_dwordx4 v39, s[16:19], s68 offen  lds
    s_add_u32 m0, s70, 8192
    s_lshr_b32 s64, 39047, s64
    s_and_b32 s64, s64, 15
    buffer_load_dwordx4 v40, s[16:19], s68 offen  lds
    s_add_u32 m0, s70, 10240
    s_add_u32 s64, s64, s87
    buffer_load_dwordx4 v41, s[16:19], s68 offen  lds
    s_add_u32 m0, s70, 12288
    s_sub_u32 s64, s64, 8
    s_add_u32 s65, s64, s87
    buffer_load_dwordx4 v42, s[16:19], s68 offen  lds
    s_add_u32 m0, s70, 14336
    s_cmp_eq_u32 s65, 13
    s_cselect_b32 s64, s87, s64
    buffer_load_dwordx4 v43, s[16:19], s68 offen  lds
    s_add_u32 m0, s71, 65536
    s_cmp_ge_u32 s64, 14
    s_cselect_b32 s64, s87, s64
    s_add_u32 s65, s64, 7
    buffer_load_dwordx4 v44, s[28:31], s69 offen sc1 lds
    s_add_u32 m0, s71, 67584
    s_cmp_ge_u32 s64, 7
    s_cselect_b32 s64, s65, s64
    buffer_load_dwordx4 v45, s[28:31], s69 offen sc1 lds
    s_add_u32 m0, s71, 69632
    s_lshl_b32 s60, s64, 12
    s_mul_i32 s61, s64, 131072
    buffer_load_dwordx4 v46, s[28:31], s69 offen sc1 lds
    s_add_u32 m0, s71, 71680
    s_mul_i32 s62, s81, 16384
    buffer_load_dwordx4 v47, s[28:31], s69 offen sc1 lds
    s_add_u32 m0, s71, 73728
    s_add_u32 s62, s62, s86
    s_mul_i32 s63, s81, 16384
    buffer_load_dwordx4 v48, s[28:31], s69 offen sc1 lds
    s_add_u32 m0, s71, 75776
    s_add_u32 s63, s63, s86
    buffer_load_dwordx4 v49, s[28:31], s69 offen sc1 lds
    s_add_u32 m0, s71, 77824
    s_add_u32 s87, s87, 1
    s_add_u32 s81, s81, 1
    buffer_load_dwordx4 v50, s[28:31], s69 offen sc1 lds
    s_add_u32 m0, s71, 79872
    s_cmp_eq_u32 s81, 4
    s_cselect_b32 s81, 0, s81
    buffer_load_dwordx4 v51, s[28:31], s69 offen sc1 lds
    s_add_u32 m0, s63, 98304
    s_waitcnt vmcnt(32)
    s_barrier
    buffer_load_dwordx4 v60, s[12:15], s61 offen  lds
    s_add_u32 m0, s63, 100352
    s_sub_u32 s64, s87, s6
    s_and_b32 s64, s64, 3
    s_lshl_b32 s64, s64, 2
    buffer_load_dwordx4 v61, s[12:15], s61 offen  lds
    s_add_u32 m0, s63, 102400
    s_lshr_b32 s64, 39047, s64
    s_and_b32 s64, s64, 15
    s_add_u32 s64, s64, s87
    buffer_load_dwordx4 v62, s[12:15], s61 offen  lds
    s_add_u32 m0, s63, 104448
    s_sub_u32 s64, s64, 8
    s_add_u32 s65, s64, s87
    s_cmp_eq_u32 s65, 13
    s_cselect_b32 s64, s87, s64
    buffer_load_dwordx4 v63, s[12:15], s61 offen  lds
    s_add_u32 m0, s63, 106496
    s_cmp_ge_u32 s64, 14
    s_cselect_b32 s64, s87, s64
    s_add_u32 s65, s64, 7
    s_cmp_ge_u32 s64, 7
    s_cselect_b32 s64, s65, s64
    buffer_load_dwordx4 v64, s[12:15], s61 offen  lds
    s_add_u32 m0, s63, 108544
    s_lshl_b32 s68, s64, 12
    s_mul_i32 s69, s64, 131072
    s_mul_i32 s70, s81, 16384
    buffer_load_dwordx4 v65, s[12:15], s61 offen  lds
    s_add_u32 m0, s63, 110592
    s_add_u32 s70, s70, s86
    s_mul_i32 s71, s81, 16384
    s_add_u32 s71, s71, s86
    buffer_load_dwordx4 v66, s[12:15], s61 offen  lds
    s_add_u32 m0, s63, 112640
    s_add_u32 s87, s87, 1
    s_add_u32 s81, s81, 1
    s_cmp_eq_u32 s81, 4
    s_cselect_b32 s81, 0, s81
    buffer_load_dwordx4 v67, s[12:15], s61 offen  lds
    s_add_u32 m0, s71, 98304
    s_waitcnt vmcnt(24)
    s_barrier
    buffer_load_dwordx4 v60, s[12:15], s69 offen  lds
    s_add_u32 m0, s71, 100352
    s_nop 0
    buffer_load_dwordx4 v61, s[12:15], s69 offen  lds
    s_add_u32 m0, s71, 102400
    s_nop 0
    buffer_load_dwordx4 v62, s[12:15], s69 offen  lds
    s_add_u32 m0, s71, 104448
    s_nop 0
    buffer_load_dwordx4 v63, s[12:15], s69 offen  lds
    s_add_u32 m0, s71, 106496
    s_nop 0
    buffer_load_dwordx4 v64, s[12:15], s69 offen  lds
    s_add_u32 m0, s71, 108544
    s_nop 0
    buffer_load_dwordx4 v65, s[12:15], s69 offen  lds
    s_add_u32 m0, s71, 110592
    s_nop 0
    buffer_load_dwordx4 v66, s[12:15], s69 offen  lds
    s_add_u32 m0, s71, 112640
    s_nop 0
    buffer_load_dwordx4 v67, s[12:15], s69 offen  lds
    s_waitcnt vmcnt(16)
    s_barrier
    s_barrier
L_ld_p5:
    s_mov_b32 s87, 0
    s_mov_b32 s81, 2
    s_sub_u32 s64, s87, s6
    s_and_b32 s64, s64, 3
    s_lshl_b32 s64, s64, 2
    s_lshr_b32 s64, 39047, s64
    s_and_b32 s64, s64, 15
    s_add_u32 s64, s64, s87
    s_sub_u32 s64, s64, 8
    s_add_u32 s65, s64, s87
    s_cmp_eq_u32 s65, 13
    s_cselect_b32 s64, s87, s64
    s_cmp_ge_u32 s64, 14
    s_cselect_b32 s64, s87, s64
    s_add_u32 s65, s64, 7
    s_cmp_ge_u32 s64, 7
    s_cselect_b32 s64, s65, s64
    s_lshl_b32 s60, s64, 12
    s_mul_i32 s61, s64, 131072
    s_mul_i32 s62, s81, 16384
    s_add_u32 s62, s62, s86
    s_mul_i32 s63, s81, 16384
    s_add_u32 s63, s63, s86
    s_add_u32 s87, s87, 1
    s_add_u32 s81, s81, 1
    s_cmp_eq_u32 s81, 4
    s_cselect_b32 s81, 0, s81
    s_bitcmp1_b32 s2, 0
    s_cbranch_scc1 L_p_par_14
    s_barrier
L_p_par_14:
    s_add_u32 m0, s62, 0
    s_barrier
    buffer_load_dwordx4 v52, s[8:11], s60 offen sc1 lds
    s_add_u32 m0, s62, 2048
    s_sub_u32 s64, s87, s6
    s_and_b32 s64, s64, 3
    s_lshl_b32 s64, s64, 2
    buffer_load_dwordx4 v53, s[8:11], s60 offen sc1 lds
    s_add_u32 m0, s62, 4096
    s_lshr_b32 s64, 39047, s64
    s_and_b32 s64, s64, 15
    s_add_u32 s64, s64, s87
    buffer_load_dwordx4 v54, s[8:11], s60 offen sc1 lds
    s_add_u32 m0, s62, 6144
    s_sub_u32 s64, s64, 8
    s_add_u32 s65, s64, s87
    s_cmp_eq_u32 s65, 13
    s_cselect_b32 s64, s87, s64
    buffer_load_dwordx4 v55, s[8:11], s60 offen sc1 lds
    s_add_u32 m0, s62, 8192
    s_cmp_ge_u32 s64, 14
    s_cselect_b32 s64, s87, s64
    s_add_u32 s65, s64, 7
    s_cmp_ge_u32 s64, 7
    s_cselect_b32 s64, s65, s64
    buffer_load_dwordx4 v56, s[8:11], s60 offen sc1 lds
    s_add_u32 m0, s62, 10240
    s_lshl_b32 s68, s64, 12
    s_mul_i32 s69, s64, 131072
    s_mul_i32 s70, s81, 16384
    buffer_load_dwordx4 v57, s[8:11], s60 offen sc1 lds
    s_add_u32 m0, s62, 12288
    s_add_u32 s70, s70, s86
    s_mul_i32 s71, s81, 16384
    s_add_u32 s71, s71, s86
    buffer_load_dwordx4 v58, s[8:11], s60 offen sc1 lds
    s_add_u32 m0, s62, 14336
    s_add_u32 s87, s87, 1
    s_add_u32 s81, s81, 1
    s_cmp_eq_u32 s81, 4
    s_cselect_b32 s81, 0, s81
    buffer_load_dwordx4 v59, s[8:11], s60 offen sc1 lds
    s_add_u32 m0, s70, 0
    s_nop 0
    buffer_load_dwordx4 v52, s[8:11], s68 offen sc1 lds
    s_add_u32 m0, s70, 2048
    s_sub_u32 s64, s87, s6
    s_and_b32 s64, s64, 3
    s_lshl_b32 s64, s64, 2
    buffer_load_dwordx4 v53, s[8:11], s68 offen sc1 lds
    s_add_u32 m0, s70, 4096
    s_lshr_b32 s64, 39047, s64
    s_and_b32 s64, s64, 15
    s_add_u32 s64, s64, s87
    buffer_load_dwordx4 v54, s[8:11], s68 offen sc1 lds
    s_add_u32 m0, s70, 6144
    s_sub_u32 s64, s64, 8
    s_add_u32 s65, s64, s87
    s_cmp_eq_u32 s65, 13
    s_cselect_b32 s64, s87, s64
    buffer_load_dwordx4 v55, s[8:11], s68 offen sc1 lds
    s_add_u32 m0, s70, 8192
    s_cmp_ge_u32 s64, 14
    s_cselect_b32 s64, s87, s64
    s_add_u32 s65, s64, 7
    s_cmp_ge_u32 s64, 7
    s_cselect_b32 s64, s65, s64
    buffer_load_dwordx4 v56, s[8:11], s68 offen sc1 lds
    s_add_u32 m0, s70, 10240
    s_lshl_b32 s60, s64, 12
    s_mul_i32 s61, s64, 131072
    s_mul_i32 s62, s81, 16384
    buffer_load_dwordx4 v57, s[8:11], s68 offen sc1 lds
    s_add_u32 m0, s70, 12288
    s_add_u32 s62, s62, s86
    s_mul_i32 s63, s81, 16384
    s_add_u32 s63, s63, s86
    buffer_load_dwordx4 v58, s[8:11], s68 offen sc1 lds
    s_add_u32 m0, s70, 14336
    s_add_u32 s87, s87, 1
    s_add_u32 s81, s81, 1
    s_cmp_eq_u32 s81, 4
    s_cselect_b32 s81, 0, s81
    buffer_load_dwordx4 v59, s[8:11], s68 offen sc1 lds
    s_bitcmp1_b32 s2, 0
    s_cbranch_scc0 L_p_par_15
    s_barrier
L_p_par_15:
    s_add_u32 m0, s62, 0
    s_waitcnt vmcnt(8)
    s_barrier
    buffer_load_dwordx4 v52, s[8:11], s60 offen sc1 lds
    s_add_u32 m0, s62, 2048
    s_sub_u32 s64, s87, s6
    s_and_b32 s64, s64, 3
    buffer_load_dwordx4 v53, s[8:11], s60 offen sc1 lds
    s_add_u32 m0, s62, 4096
    s_lshl_b32 s64, s64, 2
    buffer_load_dwordx4 v54, s[8:11], s60 offen sc1 lds
    s_add_u32 m0, s62, 6144
    s_lshr_b32 s64, 39047, s64
    s_and_b32 s64, s64, 15
    buffer_load_dwordx4 v55, s[8:11], s60 offen sc1 lds
    s_add_u32 m0, s62, 8192
    s_add_u32 s64, s64, s87
    buffer_load_dwordx4 v56, s[8:11], s60 offen sc1 lds
    s_add_u32 m0, s62, 10240
    s_sub_u32 s64, s64, 8
    buffer_load_dwordx4 v57, s[8:11], s60 offen sc1 lds
    s_add_u32 m0, s62, 12288
    s_add_u32 s65, s64, s87
    s_cmp_eq_u32 s65, 13
    s_cselect_b32 s64, s87, s64
    buffer_load_dwordx4 v58, s[8:11], s60 offen sc1 lds
    s_add_u32 m0, s62, 14336
    s_cmp_ge_u32 s64, 14
    s_cselect_b32 s64, s87, s64
    buffer_load_dwordx4 v59, s[8:11], s60 offen sc1 lds
    s_add_u32 m0, s63, 98304
    s_add_u32 s65, s64, 7
    s_cmp_ge_u32 s64, 7
    s_cselect_b32 s64, s65, s64
    buffer_load_dwordx4 v60, s[12:15], s61 offen  lds
    s_add_u32 m0, s63, 100352
    s_lshl_b32 s68, s64, 12
    buffer_load_dwordx4 v61, s[12:15], s61 offen  lds
    s_add_u32 m0, s63, 102400
    s_mul_i32 s69, s64, 131072
    buffer_load_dwordx4 v62, s[12:15], s61 offen  lds
    s_add_u32 m0, s63, 104448
    s_mul_i32 s70, s81, 16384
    s_add_u32 s70, s70, s86
    buffer_load_dwordx4 v63, s[12:15], s61 offen  lds
    s_add_u32 m0, s63, 106496
    s_mul_i32 s71, s81, 16384
    buffer_load_dwordx4 v64, s[12:15], s61 offen  lds
    s_add_u32 m0, s63, 108544
    s_add_u32 s71, s71, s86
    s_add_u32 s87, s87, 1
    buffer_load_dwordx4 v65, s[12:15], s61 offen  lds
    s_add_u32 m0, s63, 110592
    s_add_u32 s81, s81, 1
    buffer_load_dwordx4 v66, s[12:15], s61 offen  lds
    s_add_u32 m0, s63, 112640
    s_cmp_eq_u32 s81, 4
    s_cselect_b32 s81, 0, s81
    buffer_load_dwordx4 v67, s[12:15], s61 offen  lds
    s_mov_b32 s80, 5
L_p_lp_16:
    s_add_u32 m0, s70, 0
    s_waitcnt vmcnt(16)
    s_barrier
    buffer_load_dwordx4 v52, s[8:11], s68 offen sc1 lds
    s_add_u32 m0, s70, 2048
    s_sub_u32 s80, s80, 1
    s_sub_u32 s64, s87, s6
    buffer_load_dwordx4 v53, s[8:11], s68 offen sc1 lds
    s_add_u32 m0, s70, 4096
    s_and_b32 s64, s64, 3
    buffer_load_dwordx4 v54, s[8:11], s68 offen sc1 lds
    s_add_u32 m0, s70, 6144
    s_lshl_b32 s64, s64, 2
    s_lshr_b32 s64, 39047, s64
    buffer_load_dwordx4 v55, s[8:11], s68 offen sc1 lds
    s_add_u32 m0, s70, 8192
    s_and_b32 s64, s64, 15
    buffer_load_dwordx4 v56, s[8:11], s68 offen sc1 lds
    s_add_u32 m0, s70, 10240
    s_add_u32 s64, s64, s87
    s_sub_u32 s64, s64, 8
    buffer_load_dwordx4 v57, s[8:11], s68 offen sc1 lds
    s_add_u32 m0, s70, 12288
    s_add_u32 s65, s64, s87
    buffer_load_dwordx4 v58, s[8:11], s68 offen sc1 lds
    s_add_u32 m0, s70, 14336
    s_cmp_eq_u32 s65, 13
    s_cselect_b32 s64, s87, s64
    s_cmp_ge_u32 s64, 14
    s_cselect_b32 s64, s87, s64
    buffer_load_dwordx4 v59, s[8:11], s68 offen sc1 lds
    s_add_u32 m0, s71, 98304
    s_add_u32 s65, s64, 7
    buffer_load_dwordx4 v60, s[12:15], s69 offen  lds
    s_add_u32 m0, s71, 100352
    s_cmp_ge_u32 s64, 7
    s_cselect_b32 s64, s65, s64
    s_lshl_b32 s60, s64, 12
    buffer_load_dwordx4 v61, s[12:15], s69 offen  lds
    s_add_u32 m0, s71, 102400
    s_mul_i32 s61, s64, 131072
    buffer_load_dwordx4 v62, s[12:15], s69 offen  lds
    s_add_u32 m0, s71, 104448
    s_mul_i32 s62, s81, 16384
    s_add_u32 s62, s62, s86
    buffer_load_dwordx4 v63, s[12:15], s69 offen  lds
    s_add_u32 m0, s71, 106496
    s_mul_i32 s63, s81, 16384
    buffer_load_dwordx4 v64, s[12:15], s69 offen  lds
    s_add_u32 m0, s71, 108544
    s_add_u32 s63, s63, s86
    s_add_u32 s87, s87, 1
    buffer_load_dwordx4 v65, s[12:15], s69 offen  lds
    s_add_u32 m0, s71, 110592
    s_add_u32 s81, s81, 1
    buffer_load_dwordx4 v66, s[12:15], s69 offen  lds
    s_add_u32 m0, s71, 112640
    s_cmp_eq_u32 s81, 4
    s_cselect_b32 s81, 0, s81
    buffer_load_dwordx4 v67, s[12:15], s69 offen  lds
    s_add_u32 m0, s62, 0
    s_waitcnt vmcnt(16)
    s_barrier
    buffer_load_dwordx4 v52, s[8:11], s60 offen sc1 lds
    s_add_u32 m0, s62, 2048
    s_sub_u32 s64, s87, s6
    s_and_b32 s64, s64, 3
    buffer_load_dwordx4 v53, s[8:11], s60 offen sc1 lds
    s_add_u32 m0, s62, 4096
    s_lshl_b32 s64, s64, 2
    buffer_load_dwordx4 v54, s[8:11], s60 offen sc1 lds
    s_add_u32 m0, s62, 6144
    s_lshr_b32 s64, 39047, s64
    s_and_b32 s64, s64, 15
    buffer_load_dwordx4 v55, s[8:11], s60 offen sc1 lds
    s_add_u32 m0, s62, 8192
    s_add_u32 s64, s64, s87
    buffer_load_dwordx4 v56, s[8:11], s60 offen sc1 lds
    s_add_u32 m0, s62, 10240
    s_sub_u32 s64, s64, 8
    buffer_load_dwordx4 v57, s[8:11], s60 offen sc1 lds
    s_add_u32 m0, s62, 12288
    s_add_u32 s65, s64, s87
    s_cmp_eq_u32 s65, 13
    s_cselect_b32 s64, s87, s64
    buffer_load_dwordx4 v58, s[8:11], s60 offen sc1 lds
    s_add_u32 m0, s62, 14336
    s_cmp_ge_u32 s64, 14
    s_cselect_b32 s64, s87, s64
    buffer_load_dwordx4 v59, s[8:11], s60 offen sc1 lds
    s_add_u32 m0, s63, 98304
    s_add_u32 s65, s64, 7
    s_cmp_ge_u32 s64, 7
    s_cselect_b32 s64, s65, s64
    buffer_load_dwordx4 v60, s[12:15], s61 offen  lds
    s_add_u32 m0, s63, 100352
    s_lshl_b32 s68, s64, 12
    buffer_load_dwordx4 v61, s[12:15], s61 offen  lds
    s_add_u32 m0, s63, 102400
    s_mul_i32 s69, s64, 131072
    buffer_load_dwordx4 v62, s[12:15], s61 offen  lds
    s_add_u32 m0, s63, 104448
    s_mul_i32 s70, s81, 16384
    s_add_u32 s70, s70, s86
    buffer_load_dwordx4 v63, s[12:15], s61 offen  lds
    s_add_u32 m0, s63, 106496
    s_mul_i32 s71, s81, 16384
    buffer_load_dwordx4 v64, s[12:15], s61 offen  lds
    s_add_u32 m0, s63, 108544
    s_add_u32 s71, s71, s86
    s_add_u32 s87, s87, 1
    buffer_load_dwordx4 v65, s[12:15], s61 offen  lds
    s_add_u32 m0, s63, 110592
    s_add_u32 s81, s81, 1
    buffer_load_dwordx4 v66, s[12:15], s61 offen  lds
    s_add_u32 m0, s63, 112640
    s_cmp_eq_u32 s81, 4
    s_cselect_b32 s81, 0, s81
    buffer_load_dwordx4 v67, s[12:15], s61 offen  lds
    s_cmp_lg_u32 s80, 0
    s_cbranch_scc1 L_p_lp_16
    s_add_u32 m0, s70, 0
    s_waitcnt vmcnt(16)
    s_barrier
    buffer_load_dwordx4 v52, s[8:11], s68 offen sc1 lds
    s_add_u32 m0, s70, 2048
    s_nop 0
    buffer_load_dwordx4 v53, s[8:11], s68 offen sc1 lds
    s_add_u32 m0, s70, 4096
    s_nop 0
    buffer_load_dwordx4 v54, s[8:11], s68 offen sc1 lds
    s_add_u32 m0, s70, 6144
    s_nop 0
    buffer_load_dwordx4 v55, s[8:11], s68 offen sc1 lds
    s_add_u32 m0, s70, 8192
    s_nop 0
    buffer_load_dwordx4 v56, s[8:11], s68 offen sc1 lds
    s_add_u32 m0, s70, 10240
    s_nop 0
    buffer_load_dwordx4 v57, s[8:11], s68 offen sc1 lds
    s_add_u32 m0, s70, 12288
    s_nop 0
    buffer_load_dwordx4 v58, s[8:11], s68 offen sc1 lds
    s_add_u32 m0, s70, 14336
    s_nop 0
    buffer_load_dwordx4 v59, s[8:11], s68 offen sc1 lds
    s_add_u32 m0, s71, 98304
    s_nop 0
    buffer_load_dwordx4 v60, s[12:15], s69 offen  lds
    s_add_u32 m0, s71, 100352
    s_nop 0
    buffer_load_dwordx4 v61, s[12:15], s69 offen  lds
    s_add_u32 m0, s71, 102400
    s_nop 0
    buffer_load_dwordx4 v62, s[12:15], s69 offen  lds
    s_add_u32 m0, s71, 104448
    s_nop 0
    buffer_load_dwordx4 v63, s[12:15], s69 offen  lds
    s_add_u32 m0, s71, 106496
    s_nop 0
    buffer_load_dwordx4 v64, s[12:15], s69 offen  lds
    s_add_u32 m0, s71, 108544
    s_nop 0
    buffer_load_dwordx4 v65, s[12:15], s69 offen  lds
    s_add_u32 m0, s71, 110592
    s_nop 0
    buffer_load_dwordx4 v66, s[12:15], s69 offen  lds
    s_add_u32 m0, s71, 112640
    s_nop 0
    buffer_load_dwordx4 v67, s[12:15], s69 offen  lds
    s_waitcnt vmcnt(16)
    s_barrier
    s_waitcnt vmcnt(0)
    s_barrier
    s_barrier
    s_branch L_fin
L_ld_helper:
    s_waitcnt vmcnt(24)
    s_barrier
    s_waitcnt vmcnt(12)
    s_barrier
    s_waitcnt vmcnt(0)
    s_barrier
    s_barrier
    s_barrier
    s_barrier
    s_add_u32 s8, s54, 29360128
    s_addc_u32 s9, s55, 0
    s_mov_b32 s10, 7340032
    s_mov_b32 s11, 0x20000
    s_mov_b32 s12, s48
    s_mov_b32 s13, s49
    s_mov_b32 s14, 3670016
    s_mov_b32 s15, 0x20000
    s_mov_b32 s87, 0
    s_mov_b32 s81, 2
L_p_if_17:
    s_sub_u32 s64, s87, s6
    s_and_b32 s64, s64, 3
    s_lshl_b32 s64, s64, 2
    s_lshr_b32 s64, 39047, s64
    s_and_b32 s64, s64, 15
    s_add_u32 s64, s64, s87
    s_sub_u32 s64, s64, 8
    s_add_u32 s65, s64, s87
    s_cmp_eq_u32 s65, 13
    s_cselect_b32 s64, s87, s64
    s_cmp_ge_u32 s64, 14
    s_cselect_b32 s64, s87, s64
    s_add_u32 s65, s64, 7
    s_cmp_ge_u32 s64, 7
    s_cselect_b32 s64, s65, s64
    s_mul_i32 s85, s64, 131072
    s_mul_i32 s65, s81, 16384
    s_add_u32 s65, s65, s86
    s_add_u32 m0, s65, 98304
    s_nop 0
    buffer_load_dwordx4 v60, s[12:15], s85 offen  lds
    s_add_u32 m0, m0, 2048
    s_nop 0
    buffer_load_dwordx4 v61, s[12:15], s85 offen  lds
    s_add_u32 m0, m0, 2048
    s_nop 0
    buffer_load_dwordx4 v62, s[12:15], s85 offen  lds
    s_add_u32 m0, m0, 2048
    s_nop 0
    buffer_load_dwordx4 v63, s[12:15], s85 offen  lds
    s_add_u32 m0, m0, 2048
    s_nop 0
    buffer_load_dwordx4 v64, s[12:15], s85 offen  lds
    s_add_u32 m0, m0, 2048
    s_nop 0
    buffer_load_dwordx4 v65, s[12:15], s85 offen  lds
    s_add_u32 m0, m0, 2048
    s_nop 0
    buffer_load_dwordx4 v66, s[12:15], s85 offen  lds
    s_add_u32 m0, m0, 2048
    s_nop 0
    buffer_load_dwordx4 v67, s[12:15], s85 offen  lds
    s_add_u32 s87, s87, 1
    s_add_u32 s81, s81, 1
    s_cmp_eq_u32 s81, 4
    s_cselect_b32 s81, 0, s81
    s_cmp_lt_u32 s87, 2
    s_cbranch_scc1 L_p_if_17
    s_branch L_ld_p5
L_aux:
    s_setprio 3
    s_lshl_b32 s56, s4, 7
    s_lshl_b32 s57, s5, 3
    s_add_u32 s56, s56, s57
    s_lshl_b32 s57, s74, 2
    s_add_u32 s56, s56, s57
    v_lshrrev_b32 v14, 4, v1
    v_add_u32 v14, s56, v14
    v_and_b32 v3, 15, v1
    v_lshlrev_b32 v3, 4, v3
    v_lshl_add_u32 v3, v14, 11, v3
    s_waitcnt lgkmcnt(0)
    s_mov_b32 s20, s32
    s_mov_b32 s21, s33
    s_mov_b32 s22, 4194304
    s_mov_b32 s23, 0x20000
    buffer_load_dwordx4 v[64:67], v3, s[20:23], 0 offen offset:0
    buffer_load_dwordx4 v[68:71], v3, s[20:23], 0 offen offset:256
    buffer_load_dwordx4 v[72:75], v3, s[20:23], 0 offen offset:512
    buffer_load_dwordx4 v[76:79], v3, s[20:23], 0 offen offset:768
    buffer_load_dwordx4 v[80:83], v3, s[20:23], 0 offen offset:1024
    buffer_load_dwordx4 v[84:87], v3, s[20:23], 0 offen offset:1280
    buffer_load_dwordx4 v[88:91], v3, s[20:23], 0 offen offset:1536
    buffer_load_dwordx4 v[92:95], v3, s[20:23], 0 offen offset:1792
    s_mov_b32 s24, s54
    s_mov_b32 s25, s55
L_pad4:
    s_cbranch_execz L_padr4
    s_mov_b32 s26, 45088768
    s_mov_b32 s27, 0x20000
    s_mov_b32 s16, s36
    s_mov_b32 s17, s37
    s_mov_b32 s18, 65536
    s_mov_b32 s19, 0x20000
    s_mov_b32 s28, s52
    s_mov_b32 s29, s53
    s_mov_b32 s30, 256
    s_mov_b32 s31, 0x20000
    s_mov_b32 s8, s32
    s_mov_b32 s9, s33
    s_mov_b32 s10, 0
    s_mov_b32 s11, 0x20000
    s_mov_b32 s12, s32
    s_mov_b32 s13, s33
    s_mov_b32 s14, 0
    s_mov_b32 s15, 0x20000
    v_lshlrev_b32 v2, 4, v1
    v_mov_b32 v11, 1
    v_mov_b32 v44, -1
    v_mov_b32 v45, -1
    v_mov_b32 v46, -1
    v_mov_b32 v47, -1
    v_lshrrev_b32 v4, 5, v1
    v_lshlrev_b32 v4, 13, v4
    v_and_b32 v5, 31, v1
    v_lshl_add_u32 v4, v5, 4, v4
    v_bfe_u32 v12, v1, 2, 2
    v_min_u32 v12, 2, v12
    v_lshlrev_b32 v12, 13, v12
    v_lshrrev_b32 v5, 4, v1
    v_lshl_add_u32 v12, v5, 11, v12
    v_and_b32 v5, 3, v1
    v_lshl_add_u32 v12, v5, 4, v12
    s_mov_b32 s56, s93
    s_sub_u32 s57, s56, 3
    s_cmp_ge_u32 s56, 3
    s_cselect_b32 s56, s57, s56
    s_mul_i32 s56, s56, 24576
    s_add_u32 s56, s56, 49152
    v_add_u32 v12, s56, v12
    v_bfe_u32 v13, v1, 2, 2
    v_lshl_add_u32 v12, v13, 7, v12
    v_lshrrev_b32 v13, 1, v13
    v_xor_b32 v13, s74, v13
    v_lshl_add_u32 v24, v13, 6, v12
    v_xor_b32 v25, 128, v24
    v_xor_b32 v26, 320, v24
    v_xor_b32 v27, 448, v24
    v_lshlrev_b32 v14, 2, v14
    s_waitcnt vmcnt(7)
    v_lshlrev_b32 v128, 16, v64
    v_and_b32 v129, 0xffff0000, v64
    v_lshlrev_b32 v130, 16, v65
    v_and_b32 v131, 0xffff0000, v65
    v_lshlrev_b32 v132, 16, v66
    v_and_b32 v133, 0xffff0000, v66
    v_pk_add_f32 v[32:33], v[128:129], v[132:133]
    v_lshlrev_b32 v134, 16, v67
    v_and_b32 v135, 0xffff0000, v67
    v_pk_add_f32 v[34:35], v[130:131], v[134:135]
    s_waitcnt vmcnt(6)
    v_lshlrev_b32 v136, 16, v68
    v_and_b32 v137, 0xffff0000, v68
    v_pk_add_f32 v[32:33], v[32:33], v[136:137]
    v_lshlrev_b32 v138, 16, v69
    v_and_b32 v139, 0xffff0000, v69
    v_pk_add_f32 v[34:35], v[34:35], v[138:139]
    v_lshlrev_b32 v140, 16, v70
    v_and_b32 v141, 0xffff0000, v70
    v_pk_add_f32 v[32:33], v[32:33], v[140:141]
    v_lshlrev_b32 v142, 16, v71
    v_and_b32 v143, 0xffff0000, v71
    v_pk_add_f32 v[34:35], v[34:35], v[142:143]
    s_waitcnt vmcnt(5)
    v_lshlrev_b32 v144, 16, v72
    v_and_b32 v145, 0xffff0000, v72
    v_pk_add_f32 v[32:33], v[32:33], v[144:145]
    v_lshlrev_b32 v146, 16, v73
    v_and_b32 v147, 0xffff0000, v73
    v_pk_add_f32 v[34:35], v[34:35], v[146:147]
    v_lshlrev_b32 v148, 16, v74
    v_and_b32 v149, 0xffff0000, v74
    v_pk_add_f32 v[32:33], v[32:33], v[148:149]
    v_lshlrev_b32 v150, 16, v75
    v_and_b32 v151, 0xffff0000, v75
    v_pk_add_f32 v[34:35], v[34:35], v[150:151]
    s_waitcnt vmcnt(4)
    v_lshlrev_b32 v152, 16, v76
    v_and_b32 v153, 0xffff0000, v76
    v_pk_add_f32 v[32:33], v[32:33], v[152:153]
    v_lshlrev_b32 v154, 16, v77
    v_and_b32 v155, 0xffff0000, v77
    v_pk_add_f32 v[34:35], v[34:35], v[154:155]
    v_lshlrev_b32 v156, 16, v78
    v_and_b32 v157, 0xffff0000, v78
    v_pk_add_f32 v[32:33], v[32:33], v[156:157]
    v_lshlrev_b32 v158, 16, v79
    v_and_b32 v159, 0xffff0000, v79
    v_pk_add_f32 v[34:35], v[34:35], v[158:159]
    s_waitcnt vmcnt(3)
    v_lshlrev_b32 v160, 16, v80
    v_and_b32 v161, 0xffff0000, v80
    v_pk_add_f32 v[32:33], v[32:33], v[160:161]
    v_lshlrev_b32 v162, 16, v81
    v_and_b32 v163, 0xffff0000, v81
    v_pk_add_f32 v[34:35], v[34:35], v[162:163]
    v_lshlrev_b32 v164, 16, v82
    v_and_b32 v165, 0xffff0000, v82
    v_pk_add_f32 v[32:33], v[32:33], v[164:165]
    v_lshlrev_b32 v166, 16, v83
    v_and_b32 v167, 0xffff0000, v83
    v_pk_add_f32 v[34:35], v[34:35], v[166:167]
    s_waitcnt vmcnt(2)
    v_lshlrev_b32 v168, 16, v84
    v_and_b32 v169, 0xffff0000, v84
    v_pk_add_f32 v[32:33], v[32:33], v[168:169]
    v_lshlrev_b32 v170, 16, v85
    v_and_b32 v171, 0xffff0000, v85
    v_pk_add_f32 v[34:35], v[34:35], v[170:171]
    v_lshlrev_b32 v172, 16, v86
    v_and_b32 v173, 0xffff0000, v86
    v_pk_add_f32 v[32:33], v[32:33], v[172:173]
    v_lshlrev_b32 v174, 16, v87
    v_and_b32 v175, 0xffff0000, v87
    v_pk_add_f32 v[34:35], v[34:35], v[174:175]
    s_waitcnt vmcnt(1)
    v_lshlrev_b32 v176, 16, v88
    v_and_b32 v177, 0xffff0000, v88
    v_pk_add_f32 v[32:33], v[32:33], v[176:177]
    v_lshlrev_b32 v178, 16, v89
    v_and_b32 v179, 0xffff0000, v89
    v_pk_add_f32 v[34:35], v[34:35], v[178:179]
    v_lshlrev_b32 v180, 16, v90
    v_and_b32 v181, 0xffff0000, v90
    v_pk_add_f32 v[32:33], v[32:33], v[180:181]
    v_lshlrev_b32 v182, 16, v91
    v_and_b32 v183, 0xffff0000, v91
    v_pk_add_f32 v[34:35], v[34:35], v[182:183]
    s_waitcnt vmcnt(0)
    v_lshlrev_b32 v184, 16, v92
    v_and_b32 v185, 0xffff0000, v92
    v_pk_add_f32 v[32:33], v[32:33], v[184:185]
    v_lshlrev_b32 v186, 16, v93
    v_and_b32 v187, 0xffff0000, v93
    v_pk_add_f32 v[34:35], v[34:35], v[186:187]
    v_lshlrev_b32 v188, 16, v94
    v_and_b32 v189, 0xffff0000, v94
    v_pk_add_f32 v[32:33], v[32:33], v[188:189]
    v_lshlrev_b32 v190, 16, v95
    v_and_b32 v191, 0xffff0000, v95
    v_pk_add_f32 v[34:35], v[34:35], v[190:191]
    s_barrier
    s_getpc_b64 s[76:77]
L_p_pc_19:
    s_add_u32 s76, s76, sequential_preLN__linear_kernel_hedgehog__mixer_gmlp__prompt_kernel-L_p_pc_19
    s_addc_u32 s77, s77, -1
    s_lshr_b32 s56, s2, 3
    s_sub_u32 s56, s56, 0
    s_lshl_b32 s56, s56, 1
    s_add_u32 s56, s56, s74
    s_mul_i32 s56, s56, 1408
    v_min_u32 v249, 10, v1
    v_lshlrev_b32 v249, 7, v249
    v_add_u32 v249, s56, v249
    v_min_u32 v249, L_end-sequential_preLN__linear_kernel_hedgehog__mixer_gmlp__prompt_kernel, v249
    global_load_dword v250, v249, s[76:77]
    s_mov_b32 s70, 40894464
    s_mov_b32 s71, 40902656
    s_mov_b32 exec_lo, 0x10001
    s_mov_b32 exec_hi, 0x10001
    buffer_store_dword v44, v14, s[24:27], s70 offen sc1
    buffer_store_dword v44, v14, s[24:27], s71 offen sc1
    s_mov_b64 exec, -1
    s_lshl_b32 s56, s5, 17
    s_lshl_b32 s57, s4, 9
    s_add_u32 s56, s56, s57
    s_lshl_b32 s57, s74, 16
    s_add_u32 s56, s56, s57
    s_add_u32 s56, s56, 37748736
    buffer_store_dwordx4 v[44:47], v4, s[24:27], s56 offen sc1
    s_add_u32 s56, s56, 16384
    buffer_store_dwordx4 v[44:47], v4, s[24:27], s56 offen sc1
    s_add_u32 s56, s56, 16384
    buffer_store_dwordx4 v[44:47], v4, s[24:27], s56 offen sc1
    v_add_f32 v32, v32, v34
    v_add_f32 v33, v33, v35
    v_add_f32 v32, v32, v33
    s_nop 1
    v_add_f32_dpp v32, v32, v32 row_ror:8 row_mask:0xf bank_mask:0xf
    s_nop 1
    v_add_f32_dpp v32, v32, v32 row_ror:4 row_mask:0xf bank_mask:0xf
    s_nop 1
    v_add_f32_dpp v32, v32, v32 row_ror:2 row_mask:0xf bank_mask:0xf
    s_nop 1
    v_add_f32_dpp v32, v32, v32 row_ror:1 row_mask:0xf bank_mask:0xf
    v_mul_f32 v32, 981467136, v32
    v_sub_f32 v40, v128, v32
    v_mul_f32 v34, v40, v40
    v_sub_f32 v41, v129, v32
    v_mul_f32 v35, v41, v41
    v_sub_f32 v42, v130, v32
    v_mul_f32 v36, v42, v42
    v_sub_f32 v43, v131, v32
    v_mul_f32 v37, v43, v43
    v_sub_f32 v40, v132, v32
    v_fmac_f32 v34, v40, v40
    v_sub_f32 v41, v133, v32
    s_barrier
    s_cmp_lg_u32 s93, 1
    s_cbranch_scc1 L_nsp1
    ds_read_b128 v[64:67], v24 offset:0
    ds_read_b128 v[68:71], v25 offset:0
    ds_read_b128 v[72:75], v26 offset:0
    ds_read_b128 v[76:79], v27 offset:0
    ds_read_b128 v[80:83], v24 offset:512
    ds_read_b128 v[84:87], v25 offset:512
    ds_read_b128 v[88:91], v26 offset:512
    ds_read_b128 v[92:95], v27 offset:512
    s_waitcnt lgkmcnt(4)
    v_xor_b32 v24, 32, v24
    v_xor_b32 v25, 32, v25
    v_xor_b32 v26, 32, v26
    v_xor_b32 v27, 32, v27
    ds_read_b128 v[96:99], v24 offset:1024
    ds_read_b128 v[100:103], v25 offset:1024
    ds_read_b128 v[104:107], v26 offset:1024
    ds_read_b128 v[108:111], v27 offset:1024
    ds_read_b128 v[112:115], v24 offset:1536
    ds_read_b128 v[116:119], v25 offset:1536
    ds_read_b128 v[120:123], v26 offset:1536
    ds_read_b128 v[124:127], v27 offset:1536
    s_waitcnt lgkmcnt(0)
L_nsp1:
    s_add_u32 s56, s56, 16384
    buffer_store_dwordx4 v[44:47], v4, s[24:27], s56 offen sc1
    s_add_u32 s56, s56, 16384
    s_lshl_b32 s68, s5, 4
    s_add_u32 s68, s68, s4
    s_lshl_b32 s68, s68, 1
    s_add_u32 s68, s68, s74
    s_mul_i32 s68, s68, 384
    s_add_u32 s68, s68, 40960000
    s_mov_b64 exec, 0xffffff
    buffer_store_dwordx4 v[44:47], v2, s[24:27], s68 offen sc1
    s_lshl_b32 s56, s2, 10
    s_add_u32 s56, s56, 41943040
    s_mul_i32 s57, s2, 528
    s_add_u32 s57, s57, 39976960
    s_mul_i32 s58, s2, 896
    s_add_u32 s59, s58, 41418752
    s_add_u32 s58, s58, 42991616
    s_mov_b32 s60, 0xffffff
    s_cmp_eq_u32 s74, 0
    s_cselect_b32 s56, s56, s58
    s_cselect_b32 s57, s57, s59
    s_cselect_b32 s61, -1, s60
    s_cselect_b32 s62, 1, s60
    s_mov_b32 exec_lo, -1
    s_mov_b32 exec_hi, s61
    buffer_store_dwordx4 v[44:47], v2, s[24:27], s56 offen sc1
    s_mov_b32 exec_hi, s62
    buffer_store_dwordx4 v[44:47], v2, s[24:27], s57 offen sc1
    s_mov_b64 exec, -1
    s_mul_i32 s56, s2, 4352
    s_add_u32 s56, s56, 44040192
    s_cmp_lt_u32 s2, 64
    s_cselect_b32 s56, s56, 45088768
    s_lshl_b32 s57, s2, 8
    s_add_u32 s57, s57, 39845888
    s_cmp_eq_u32 s74, 0
    s_cselect_b32 s56, s56, s57
    s_cselect_b32 s57, 0, -1
    v_mov_b32 v48, s57
    v_lshlrev_b32 v5, 2, v1
    buffer_store_dword v48, v5, s[24:27], s56 offen sc1
    v_fmac_f32 v35, v41, v41
    v_sub_f32 v42, v134, v32
    v_fmac_f32 v36, v42, v42
    v_sub_f32 v43, v135, v32
    v_fmac_f32 v37, v43, v43
    v_sub_f32 v40, v136, v32
    v_fmac_f32 v34, v40, v40
    v_sub_f32 v41, v137, v32
    v_fmac_f32 v35, v41, v41
    v_sub_f32 v42, v138, v32
    v_fmac_f32 v36, v42, v42
    v_sub_f32 v43, v139, v32
    v_fmac_f32 v37, v43, v43
    v_sub_f32 v40, v140, v32
    v_fmac_f32 v34, v40, v40
    v_sub_f32 v41, v141, v32
    v_fmac_f32 v35, v41, v41
    v_sub_f32 v42, v142, v32
    v_fmac_f32 v36, v42, v42
    v_sub_f32 v43, v143, v32
    v_fmac_f32 v37, v43, v43
    v_sub_f32 v40, v144, v32
    v_fmac_f32 v34, v40, v40
    s_barrier
    s_cmp_lg_u32 s93, 2
    s_cbranch_scc1 L_nsp2
    ds_read_b128 v[64:67], v24 offset:0
    ds_read_b128 v[68:71], v25 offset:0
    ds_read_b128 v[72:75], v26 offset:0
    ds_read_b128 v[76:79], v27 offset:0
    ds_read_b128 v[80:83], v24 offset:512
    ds_read_b128 v[84:87], v25 offset:512
    ds_read_b128 v[88:91], v26 offset:512
    ds_read_b128 v[92:95], v27 offset:512
    s_waitcnt lgkmcnt(4)
    v_xor_b32 v24, 32, v24
    v_xor_b32 v25, 32, v25
    v_xor_b32 v26, 32, v26
    v_xor_b32 v27, 32, v27
    ds_read_b128 v[96:99], v24 offset:1024
    ds_read_b128 v[100:103], v25 offset:1024
    ds_read_b128 v[104:107], v26 offset:1024
    ds_read_b128 v[108:111], v27 offset:1024
    ds_read_b128 v[112:115], v24 offset:1536
    ds_read_b128 v[116:119], v25 offset:1536
    ds_read_b128 v[120:123], v26 offset:1536
    ds_read_b128 v[124:127], v27 offset:1536
    s_waitcnt lgkmcnt(0)
L_nsp2:
    v_sub_f32 v41, v145, v32
    v_fmac_f32 v35, v41, v41
    v_sub_f32 v42, v146, v32
    v_fmac_f32 v36, v42, v42
    v_sub_f32 v43, v147, v32
    v_fmac_f32 v37, v43, v43
    v_sub_f32 v40, v148, v32
    v_fmac_f32 v34, v40, v40
    v_sub_f32 v41, v149, v32
    v_fmac_f32 v35, v41, v41
    v_sub_f32 v42, v150, v32
    v_fmac_f32 v36, v42, v42
    v_sub_f32 v43, v151, v32
    v_fmac_f32 v37, v43, v43
    v_sub_f32 v40, v152, v32
    v_fmac_f32 v34, v40, v40
    v_sub_f32 v41, v153, v32
    v_fmac_f32 v35, v41, v41
    v_sub_f32 v42, v154, v32
    v_fmac_f32 v36, v42, v42
    v_sub_f32 v43, v155, v32
    v_fmac_f32 v37, v43, v43
    v_sub_f32 v40, v156, v32
    v_fmac_f32 v34, v40, v40
    v_sub_f32 v41, v157, v32
    v_fmac_f32 v35, v41, v41
    v_sub_f32 v42, v158, v32
    v_fmac_f32 v36, v42, v42
    v_sub_f32 v43, v159, v32
    v_fmac_f32 v37, v43, v43
    v_sub_f32 v40, v160, v32
    v_fmac_f32 v34, v40, v40
    v_sub_f32 v41, v161, v32
    v_fmac_f32 v35, v41, v41
    v_sub_f32 v42, v162, v32
    v_fmac_f32 v36, v42, v42
    v_sub_f32 v43, v163, v32
    v_fmac_f32 v37, v43, v43
    v_sub_f32 v40, v164, v32
    v_fmac_f32 v34, v40, v40
    v_sub_f32 v41, v165, v32
    v_fmac_f32 v35, v41, v41
    v_sub_f32 v42, v166, v32
    v_fmac_f32 v36, v42, v42
    s_barrier
    s_cmp_lg_u32 s93, 3
    s_cbranch_scc1 L_nsp3
    ds_read_b128 v[64:67], v24 offset:0
    ds_read_b128 v[68:71], v25 offset:0
    ds_read_b128 v[72:75], v26 offset:0
    ds_read_b128 v[76:79], v27 offset:0
    ds_read_b128 v[80:83], v24 offset:512
    ds_read_b128 v[84:87], v25 offset:512
    ds_read_b128 v[88:91], v26 offset:512
    ds_read_b128 v[92:95], v27 offset:512
    s_waitcnt lgkmcnt(4)
    v_xor_b32 v24, 32, v24
    v_xor_b32 v25, 32, v25
    v_xor_b32 v26, 32, v26
    v_xor_b32 v27, 32, v27
    ds_read_b128 v[96:99], v24 offset:1024
    ds_read_b128 v[100:103], v25 offset:1024
    ds_read_b128 v[104:107], v26 offset:1024
    ds_read_b128 v[108:111], v27 offset:1024
    ds_read_b128 v[112:115], v24 offset:1536
    ds_read_b128 v[116:119], v25 offset:1536
    ds_read_b128 v[120:123], v26 offset:1536
    ds_read_b128 v[124:127], v27 offset:1536
    s_waitcnt lgkmcnt(0)
L_nsp3:
    v_sub_f32 v43, v167, v32
    v_fmac_f32 v37, v43, v43
    v_sub_f32 v40, v168, v32
    v_fmac_f32 v34, v40, v40
    v_sub_f32 v41, v169, v32
    v_fmac_f32 v35, v41, v41
    v_sub_f32 v42, v170, v32
    v_fmac_f32 v36, v42, v42
    v_sub_f32 v43, v171, v32
    v_fmac_f32 v37, v43, v43
    v_sub_f32 v40, v172, v32
    v_fmac_f32 v34, v40, v40
    v_sub_f32 v41, v173, v32
    v_fmac_f32 v35, v41, v41
    v_sub_f32 v42, v174, v32
    v_fmac_f32 v36, v42, v42
    v_sub_f32 v43, v175, v32
    v_fmac_f32 v37, v43, v43
    v_sub_f32 v40, v176, v32
    v_fmac_f32 v34, v40, v40
    v_sub_f32 v41, v177, v32
    v_fmac_f32 v35, v41, v41
    v_sub_f32 v42, v178, v32
    v_fmac_f32 v36, v42, v42
    v_sub_f32 v43, v179, v32
    v_fmac_f32 v37, v43, v43
    v_sub_f32 v40, v180, v32
    v_fmac_f32 v34, v40, v40
    v_sub_f32 v41, v181, v32
    v_fmac_f32 v35, v41, v41
    v_sub_f32 v42, v182, v32
    v_fmac_f32 v36, v42, v42
    v_sub_f32 v43, v183, v32
    v_fmac_f32 v37, v43, v43
    v_sub_f32 v40, v184, v32
    v_fmac_f32 v34, v40, v40
    v_sub_f32 v41, v185, v32
    v_fmac_f32 v35, v41, v41
    v_sub_f32 v42, v186, v32
    v_fmac_f32 v36, v42, v42
    v_sub_f32 v43, v187, v32
    v_fmac_f32 v37, v43, v43
    v_sub_f32 v40, v188, v32
    v_fmac_f32 v34, v40, v40
    s_waitcnt vmcnt(0)
    s_barrier
    s_cmp_lg_u32 s74, 0
    s_cbranch_scc1 L_a_noarr
    s_and_b32 s56, s2, 7
    s_lshl_b32 s56, s56, 5
    v_mov_b32 v4, s56
    s_mov_b64 exec, 1
    buffer_atomic_add v11, v4, s[28:31], 0 offen sc1
    s_mov_b64 exec, -1
L_a_noarr:
    s_cmp_lg_u32 s93, 4
    s_cbranch_scc1 L_nsp4
    ds_read_b128 v[64:67], v24 offset:0
    ds_read_b128 v[68:71], v25 offset:0
    ds_read_b128 v[72:75], v26 offset:0
    ds_read_b128 v[76:79], v27 offset:0
    ds_read_b128 v[80:83], v24 offset:512
    ds_read_b128 v[84:87], v25 offset:512
    ds_read_b128 v[88:91], v26 offset:512
    ds_read_b128 v[92:95], v27 offset:512
    s_waitcnt lgkmcnt(4)
    v_xor_b32 v24, 32, v24
    v_xor_b32 v25, 32, v25
    v_xor_b32 v26, 32, v26
    v_xor_b32 v27, 32, v27
    ds_read_b128 v[96:99], v24 offset:1024
    ds_read_b128 v[100:103], v25 offset:1024
    ds_read_b128 v[104:107], v26 offset:1024
    ds_read_b128 v[108:111], v27 offset:1024
    ds_read_b128 v[112:115], v24 offset:1536
    ds_read_b128 v[116:119], v25 offset:1536
    ds_read_b128 v[120:123], v26 offset:1536
    ds_read_b128 v[124:127], v27 offset:1536
    s_waitcnt lgkmcnt(0)
L_nsp4:
    s_lshl_b32 s56, s5, 12
    s_lshl_b32 s57, s74, 11
    s_add_u32 s56, s56, s57
    s_add_u32 m0, s57, 147456
    s_nop 0
    buffer_load_dwordx4 v2, s[16:19], s56 offen lds
    buffer_load_dwordx4 v2, s[16:19], s56 offen offset:1024 lds
    v_sub_f32 v41, v189, v32
    v_fmac_f32 v35, v41, v41
    v_sub_f32 v42, v190, v32
    v_fmac_f32 v36, v42, v42
    v_sub_f32 v43, v191, v32
    v_fmac_f32 v37, v43, v43
    v_add_f32 v34, v34, v35
    v_add_f32 v36, v36, v37
    v_add_f32 v33, v34, v36
    s_nop 1
    v_add_f32_dpp v33, v33, v33 row_ror:8 row_mask:0xf bank_mask:0xf
    s_nop 1
    v_add_f32_dpp v33, v33, v33 row_ror:4 row_mask:0xf bank_mask:0xf
    s_nop 1
    v_add_f32_dpp v33, v33, v33 row_ror:2 row_mask:0xf bank_mask:0xf
    s_nop 1
    v_add_f32_dpp v33, v33, v33 row_ror:1 row_mask:0xf bank_mask:0xf
    v_mul_f32 v33, 981467136, v33
    v_add_f32 v33, 925353388, v33
    v_rsq_f32 v33, v33
    s_nop 0
    v_mul_f32 v32, -v32, v33
    s_barrier
    s_mov_b32 exec_lo, 0x10001
    s_mov_b32 exec_hi, 0x10001
    buffer_store_dword v32, v14, s[24:27], s70 offen sc1
    buffer_store_dword v33, v14, s[24:27], s71 offen sc1
    s_mov_b64 exec, -1
    s_cmp_lg_u32 s93, 5
    s_cbranch_scc1 L_nsp5
    ds_read_b128 v[64:67], v24 offset:0
    ds_read_b128 v[68:71], v25 offset:0
    ds_read_b128 v[72:75], v26 offset:0
    ds_read_b128 v[76:79], v27 offset:0
    ds_read_b128 v[80:83], v24 offset:512
    ds_read_b128 v[84:87], v25 offset:512
    ds_read_b128 v[88:91], v26 offset:512
    ds_read_b128 v[92:95], v27 offset:512
    s_waitcnt lgkmcnt(4)
    v_xor_b32 v24, 32, v24
    v_xor_b32 v25, 32, v25
    v_xor_b32 v26, 32, v26
    v_xor_b32 v27, 32, v27
    ds_read_b128 v[96:99], v24 offset:1024
    ds_read_b128 v[100:103], v25 offset:1024
    ds_read_b128 v[104:107], v26 offset:1024
    ds_read_b128 v[108:111], v27 offset:1024
    ds_read_b128 v[112:115], v24 offset:1536
    ds_read_b128 v[116:119], v25 offset:1536
    ds_read_b128 v[120:123], v26 offset:1536
    ds_read_b128 v[124:127], v27 offset:1536
    s_waitcnt lgkmcnt(0)
L_nsp5:
    s_barrier
    v_lshlrev_b32 v128, 16, v64
    v_and_b32 v129, 0xffff0000, v64
    v_lshlrev_b32 v130, 16, v65
    v_and_b32 v131, 0xffff0000, v65
    v_lshlrev_b32 v132, 16, v66
    v_and_b32 v133, 0xffff0000, v66
    v_lshlrev_b32 v134, 16, v67
    v_and_b32 v135, 0xffff0000, v67
    v_lshlrev_b32 v50, 16, v68
    v_and_b32 v51, 0xffff0000, v68
    v_add_f32 v128, v128, v50
    v_add_f32 v129, v129, v51
    v_lshlrev_b32 v52, 16, v69
    v_and_b32 v53, 0xffff0000, v69
    v_add_f32 v130, v130, v52
    v_add_f32 v131, v131, v53
    v_lshlrev_b32 v50, 16, v70
    v_and_b32 v51, 0xffff0000, v70
    v_add_f32 v132, v132, v50
    v_add_f32 v133, v133, v51
    v_lshlrev_b32 v52, 16, v71
    v_and_b32 v53, 0xffff0000, v71
    v_add_f32 v134, v134, v52
    v_add_f32 v135, v135, v53
    v_lshlrev_b32 v50, 16, v72
    v_and_b32 v51, 0xffff0000, v72
    v_add_f32 v128, v128, v50
    v_add_f32 v129, v129, v51
    v_lshlrev_b32 v52, 16, v73
    v_and_b32 v53, 0xffff0000, v73
    v_add_f32 v130, v130, v52
    v_add_f32 v131, v131, v53
    v_lshlrev_b32 v50, 16, v74
    v_and_b32 v51, 0xffff0000, v74
    v_add_f32 v132, v132, v50
    v_add_f32 v133, v133, v51
    v_lshlrev_b32 v52, 16, v75
    v_and_b32 v53, 0xffff0000, v75
    v_add_f32 v134, v134, v52
    v_add_f32 v135, v135, v53
    v_lshlrev_b32 v50, 16, v76
    v_and_b32 v51, 0xffff0000, v76
    v_add_f32 v128, v128, v50
    v_add_f32 v129, v129, v51
    v_lshlrev_b32 v52, 16, v77
    v_and_b32 v53, 0xffff0000, v77
    v_add_f32 v130, v130, v52
    v_add_f32 v131, v131, v53
    v_lshlrev_b32 v50, 16, v78
    v_and_b32 v51, 0xffff0000, v78
    v_add_f32 v132, v132, v50
    v_add_f32 v133, v133, v51
    v_lshlrev_b32 v52, 16, v79
    v_and_b32 v53, 0xffff0000, v79
    v_add_f32 v134, v134, v52
    v_add_f32 v135, v135, v53
    v_lshlrev_b32 v50, 16, v80
    v_and_b32 v51, 0xffff0000, v80
    v_add_f32 v128, v128, v50
    s_barrier
    v_add_f32 v129, v129, v51
    v_lshlrev_b32 v52, 16, v81
    v_and_b32 v53, 0xffff0000, v81
    v_add_f32 v130, v130, v52
    v_add_f32 v131, v131, v53
    v_lshlrev_b32 v50, 16, v82
    v_and_b32 v51, 0xffff0000, v82
    v_add_f32 v132, v132, v50
    v_add_f32 v133, v133, v51
    v_lshlrev_b32 v52, 16, v83
    v_and_b32 v53, 0xffff0000, v83
    v_add_f32 v134, v134, v52
    v_add_f32 v135, v135, v53
    v_lshlrev_b32 v50, 16, v84
    v_and_b32 v51, 0xffff0000, v84
    v_add_f32 v128, v128, v50
    v_add_f32 v129, v129, v51
    v_lshlrev_b32 v52, 16, v85
    v_and_b32 v53, 0xffff0000, v85
    v_add_f32 v130, v130, v52
    v_add_f32 v131, v131, v53
    v_lshlrev_b32 v50, 16, v86
    v_and_b32 v51, 0xffff0000, v86
    v_add_f32 v132, v132, v50
    v_add_f32 v133, v133, v51
    v_lshlrev_b32 v52, 16, v87
    v_and_b32 v53, 0xffff0000, v87
    v_add_f32 v134, v134, v52
    v_add_f32 v135, v135, v53
    v_lshlrev_b32 v50, 16, v88
    v_and_b32 v51, 0xffff0000, v88
    v_add_f32 v128, v128, v50
    v_add_f32 v129, v129, v51
    v_lshlrev_b32 v52, 16, v89
    v_and_b32 v53, 0xffff0000, v89
    v_add_f32 v130, v130, v52
    v_add_f32 v131, v131, v53
    v_lshlrev_b32 v50, 16, v90
    v_and_b32 v51, 0xffff0000, v90
    v_add_f32 v132, v132, v50
    v_add_f32 v133, v133, v51
    v_lshlrev_b32 v52, 16, v91
    v_and_b32 v53, 0xffff0000, v91
    v_add_f32 v134, v134, v52
    v_add_f32 v135, v135, v53
    v_lshlrev_b32 v50, 16, v92
    v_and_b32 v51, 0xffff0000, v92
    v_add_f32 v128, v128, v50
    v_add_f32 v129, v129, v51
    v_lshlrev_b32 v52, 16, v93
    v_and_b32 v53, 0xffff0000, v93
    v_add_f32 v130, v130, v52
    v_add_f32 v131, v131, v53
    v_lshlrev_b32 v50, 16, v94
    v_and_b32 v51, 0xffff0000, v94
    v_add_f32 v132, v132, v50
    v_add_f32 v133, v133, v51
    v_lshlrev_b32 v52, 16, v95
    v_and_b32 v53, 0xffff0000, v95
    v_add_f32 v134, v134, v52
    s_barrier
    v_add_f32 v135, v135, v53
    v_lshlrev_b32 v50, 16, v96
    v_and_b32 v51, 0xffff0000, v96
    v_add_f32 v128, v128, v50
    v_add_f32 v129, v129, v51
    v_lshlrev_b32 v52, 16, v97
    v_and_b32 v53, 0xffff0000, v97
    v_add_f32 v130, v130, v52
    v_add_f32 v131, v131, v53
    v_lshlrev_b32 v50, 16, v98
    v_and_b32 v51, 0xffff0000, v98
    v_add_f32 v132, v132, v50
    v_add_f32 v133, v133, v51
    v_lshlrev_b32 v52, 16, v99
    v_and_b32 v53, 0xffff0000, v99
    v_add_f32 v134, v134, v52
    v_add_f32 v135, v135, v53
    v_lshlrev_b32 v50, 16, v100
    v_and_b32 v51, 0xffff0000, v100
    v_add_f32 v128, v128, v50
    v_add_f32 v129, v129, v51
    v_lshlrev_b32 v52, 16, v101
    v_and_b32 v53, 0xffff0000, v101
    v_add_f32 v130, v130, v52
    v_add_f32 v131, v131, v53
    v_lshlrev_b32 v50, 16, v102
    v_and_b32 v51, 0xffff0000, v102
    v_add_f32 v132, v132, v50
    v_add_f32 v133, v133, v51
    v_lshlrev_b32 v52, 16, v103
    v_and_b32 v53, 0xffff0000, v103
    v_add_f32 v134, v134, v52
    v_add_f32 v135, v135, v53
    v_lshlrev_b32 v50, 16, v104
    v_and_b32 v51, 0xffff0000, v104
    v_add_f32 v128, v128, v50
    v_add_f32 v129, v129, v51
    v_lshlrev_b32 v52, 16, v105
    v_and_b32 v53, 0xffff0000, v105
    v_add_f32 v130, v130, v52
    v_add_f32 v131, v131, v53
    v_lshlrev_b32 v50, 16, v106
    v_and_b32 v51, 0xffff0000, v106
    v_add_f32 v132, v132, v50
    v_add_f32 v133, v133, v51
    v_lshlrev_b32 v52, 16, v107
    v_and_b32 v53, 0xffff0000, v107
    v_add_f32 v134, v134, v52
    v_add_f32 v135, v135, v53
    v_lshlrev_b32 v50, 16, v108
    v_and_b32 v51, 0xffff0000, v108
    v_add_f32 v128, v128, v50
    v_add_f32 v129, v129, v51
    v_lshlrev_b32 v52, 16, v109
    v_and_b32 v53, 0xffff0000, v109
    v_add_f32 v130, v130, v52
    v_add_f32 v131, v131, v53
    v_lshlrev_b32 v50, 16, v110
    v_and_b32 v51, 0xffff0000, v110
    s_barrier
    v_add_f32 v132, v132, v50
    v_add_f32 v133, v133, v51
    v_lshlrev_b32 v52, 16, v111
    v_and_b32 v53, 0xffff0000, v111
    v_add_f32 v134, v134, v52
    v_add_f32 v135, v135, v53
    v_lshlrev_b32 v50, 16, v112
    v_and_b32 v51, 0xffff0000, v112
    v_add_f32 v128, v128, v50
    v_add_f32 v129, v129, v51
    v_lshlrev_b32 v52, 16, v113
    v_and_b32 v53, 0xffff0000, v113
    v_add_f32 v130, v130, v52
    v_add_f32 v131, v131, v53
    v_lshlrev_b32 v50, 16, v114
    v_and_b32 v51, 0xffff0000, v114
    v_add_f32 v132, v132, v50
    v_add_f32 v133, v133, v51
    v_lshlrev_b32 v52, 16, v115
    v_and_b32 v53, 0xffff0000, v115
    v_add_f32 v134, v134, v52
    v_add_f32 v135, v135, v53
    v_lshlrev_b32 v50, 16, v116
    v_and_b32 v51, 0xffff0000, v116
    v_add_f32 v128, v128, v50
    v_add_f32 v129, v129, v51
    v_lshlrev_b32 v52, 16, v117
    v_and_b32 v53, 0xffff0000, v117
    v_add_f32 v130, v130, v52
    v_add_f32 v131, v131, v53
    v_lshlrev_b32 v50, 16, v118
    v_and_b32 v51, 0xffff0000, v118
    v_add_f32 v132, v132, v50
    v_add_f32 v133, v133, v51
    v_lshlrev_b32 v52, 16, v119
    v_and_b32 v53, 0xffff0000, v119
    v_add_f32 v134, v134, v52
L_pad5:
    s_cbranch_execz L_padr5
    v_add_f32 v135, v135, v53
    v_lshlrev_b32 v50, 16, v120
    v_and_b32 v51, 0xffff0000, v120
    v_add_f32 v128, v128, v50
    v_add_f32 v129, v129, v51
    v_lshlrev_b32 v52, 16, v121
    v_and_b32 v53, 0xffff0000, v121
    v_add_f32 v130, v130, v52
    v_add_f32 v131, v131, v53
    v_lshlrev_b32 v50, 16, v122
    v_and_b32 v51, 0xffff0000, v122
    v_add_f32 v132, v132, v50
    v_add_f32 v133, v133, v51
    v_lshlrev_b32 v52, 16, v123
    v_and_b32 v53, 0xffff0000, v123
    v_add_f32 v134, v134, v52
    v_add_f32 v135, v135, v53
    v_lshlrev_b32 v50, 16, v124
    v_and_b32 v51, 0xffff0000, v124
    v_add_f32 v128, v128, v50
    v_add_f32 v129, v129, v51
    v_lshlrev_b32 v52, 16, v125
    v_and_b32 v53, 0xffff0000, v125
    s_barrier
    v_add_f32 v130, v130, v52
    v_add_f32 v131, v131, v53
    v_lshlrev_b32 v50, 16, v126
    v_and_b32 v51, 0xffff0000, v126
    v_add_f32 v132, v132, v50
    v_add_f32 v133, v133, v51
    v_lshlrev_b32 v52, 16, v127
    v_and_b32 v53, 0xffff0000, v127
    v_add_f32 v134, v134, v52
    v_add_f32 v135, v135, v53
    v_mov_b32 v160, v128
    v_mov_b32 v161, v129
    v_mov_b32 v162, v130
    v_mov_b32 v163, v131
    v_mov_b32 v164, v132
    v_mov_b32 v165, v133
    v_mov_b32 v166, v134
    v_mov_b32 v167, v135
    s_nop 1
    v_permlane16_swap_b32 v128, v160
    v_permlane16_swap_b32 v129, v161
    v_permlane16_swap_b32 v130, v162
    v_permlane16_swap_b32 v131, v163
    v_permlane16_swap_b32 v132, v164
    v_permlane16_swap_b32 v133, v165
    v_permlane16_swap_b32 v134, v166
    v_permlane16_swap_b32 v135, v167
    v_add_f32 v128, v128, v160
    v_add_f32 v129, v129, v161
    v_add_f32 v130, v130, v162
    v_add_f32 v131, v131, v163
    v_add_f32 v132, v132, v164
    v_add_f32 v133, v133, v165
    v_add_f32 v134, v134, v166
    v_add_f32 v135, v135, v167
    v_mov_b32 v160, v128
    v_mov_b32 v161, v129
    v_mov_b32 v162, v130
    v_mov_b32 v163, v131
    v_mov_b32 v164, v132
    v_mov_b32 v165, v133
    v_mov_b32 v166, v134
    v_mov_b32 v167, v135
    s_nop 1
    v_permlane32_swap_b32 v128, v160
    v_permlane32_swap_b32 v129, v161
    v_permlane32_swap_b32 v130, v162
    v_permlane32_swap_b32 v131, v163
    v_permlane32_swap_b32 v132, v164
    v_permlane32_swap_b32 v133, v165
    v_permlane32_swap_b32 v134, v166
    v_permlane32_swap_b32 v135, v167
    v_add_f32 v128, v128, v160
    v_add_f32 v129, v129, v161
    v_add_f32 v130, v130, v162
    v_add_f32 v131, v131, v163
    v_add_f32 v132, v132, v164
    v_add_f32 v133, v133, v165
    v_add_f32 v134, v134, v166
    v_add_f32 v135, v135, v167
    v_lshlrev_b32 v4, 5, v1
    s_mov_b64 exec, 0xfff
    buffer_store_dwordx4 v[128:131], v4, s[24:27], s68 offen sc1
    buffer_store_dwordx4 v[132:135], v4, s[24:27], s68 offen offset:16 sc1
    s_mov_b64 exec, -1
    v_lshlrev_b32 v10, 5, v1
    s_barrier
    s_cmp_lg_u32 s74, 0
    s_cbranch_scc1 L_p_nosm_20
    buffer_load_dword v8, v10, s[28:31], 0 offen sc1
L_p_nosm_20:
    s_lshl_b32 s70, s74, 13
    s_lshl_b32 s57, s4, 9
    s_add_u32 s70, s70, s57
    s_add_u32 s70, s70, 40894464
    s_mul_i32 s68, s5, 12288
    s_mul_i32 s69, s74, 384
    s_add_u32 s68, s68, s69
    s_add_u32 s68, s68, 40960000
    v_and_b32 v12, 31, v1
    v_min_u32 v12, 23, v12
    v_lshlrev_b32 v12, 4, v12
    v_lshrrev_b32 v13, 5, v1
    v_mul_u32_u24 v13, 768, v13
    v_add_u32 v13, v13, v12
    v_lshlrev_b32 v5, 3, v1
    s_barrier
    s_cmp_lg_u32 s74, 0
    s_cbranch_scc1 L_p_polld_22
    s_waitcnt vmcnt(0)
    v_cmp_le_u32 vcc, 32, v8
    s_and_b32 s67, vcc_lo, 255
    s_cmp_eq_u32 s67, 255
    s_cbranch_scc1 L_p_polld_22
    s_mov_b32 s66, 0x40000
L_p_poll_21:
    buffer_load_dword v8, v10, s[28:31], 0 offen sc1
    s_waitcnt vmcnt(0)
    v_cmp_le_u32 vcc, 32, v8
    s_and_b32 s67, vcc_lo, 255
    s_cmp_eq_u32 s67, 255
    s_cbranch_scc1 L_p_polld_22
    s_sleep 4
    s_sub_u32 s66, s66, 1
    s_cmp_lg_u32 s66, 0
    s_cbranch_scc1 L_p_poll_21
L_p_polld_22:
    s_barrier
    s_mov_b32 s56, s68
    buffer_load_dwordx4 v[64:67], v13, s[24:27], s56 offen offset:0 sc1
    buffer_load_dwordx4 v[68:71], v13, s[24:27], s56 offen offset:1536 sc1
    s_add_u32 s56, s56, 3072
    buffer_load_dwordx4 v[72:75], v13, s[24:27], s56 offen offset:0 sc1
    buffer_load_dwordx4 v[76:79], v13, s[24:27], s56 offen offset:1536 sc1
    s_add_u32 s56, s56, 3072
    buffer_load_dwordx4 v[80:83], v13, s[24:27], s56 offen offset:0 sc1
    buffer_load_dwordx4 v[84:87], v13, s[24:27], s56 offen offset:1536 sc1
    s_add_u32 s56, s56, 3072
    buffer_load_dwordx4 v[88:91], v13, s[24:27], s56 offen offset:0 sc1
    buffer_load_dwordx4 v[92:95], v13, s[24:27], s56 offen offset:1536 sc1
    s_add_u32 s56, s56, 3072
    buffer_load_dwordx2 v[96:97], v5, s[24:27], s70 offen sc1
    s_barrier
    s_waitcnt vmcnt(0)
    v_max_u32 v3, v64, v65
    v_max3_u32 v3, v3, v66, v67
    v_max3_u32 v3, v3, v68, v69
    v_max3_u32 v3, v3, v70, v71
    v_max3_u32 v3, v3, v72, v73
    v_max3_u32 v3, v3, v74, v75
    v_max3_u32 v3, v3, v76, v77
    v_max3_u32 v3, v3, v78, v79
    v_max3_u32 v3, v3, v80, v81
    v_max3_u32 v3, v3, v82, v83
    v_max3_u32 v3, v3, v84, v85
    v_max3_u32 v3, v3, v86, v87
    v_max3_u32 v3, v3, v88, v89
    v_max3_u32 v3, v3, v90, v91
    v_max3_u32 v3, v3, v92, v93
    v_max3_u32 v3, v3, v94, v95
    v_max3_u32 v3, v3, v96, v97
    v_cmp_eq_u32 vcc, -1, v3
    s_cmp_eq_u64 vcc, 0
    s_cbranch_scc1 L_p_vok_24
    s_mov_b32 s66, 0x40000
L_p_vsp_23:
    s_mov_b32 s56, s68
    buffer_load_dwordx4 v[64:67], v13, s[24:27], s56 offen offset:0 sc1
    buffer_load_dwordx4 v[68:71], v13, s[24:27], s56 offen offset:1536 sc1
    s_add_u32 s56, s56, 3072
    buffer_load_dwordx4 v[72:75], v13, s[24:27], s56 offen offset:0 sc1
    buffer_load_dwordx4 v[76:79], v13, s[24:27], s56 offen offset:1536 sc1
    s_add_u32 s56, s56, 3072
    buffer_load_dwordx4 v[80:83], v13, s[24:27], s56 offen offset:0 sc1
    buffer_load_dwordx4 v[84:87], v13, s[24:27], s56 offen offset:1536 sc1
    s_add_u32 s56, s56, 3072
    buffer_load_dwordx4 v[88:91], v13, s[24:27], s56 offen offset:0 sc1
    buffer_load_dwordx4 v[92:95], v13, s[24:27], s56 offen offset:1536 sc1
    s_add_u32 s56, s56, 3072
    buffer_load_dwordx2 v[96:97], v5, s[24:27], s70 offen sc1
    s_waitcnt vmcnt(0)
    v_max_u32 v3, v64, v65
    v_max3_u32 v3, v3, v66, v67
    v_max3_u32 v3, v3, v68, v69
    v_max3_u32 v3, v3, v70, v71
    v_max3_u32 v3, v3, v72, v73
    v_max3_u32 v3, v3, v74, v75
    v_max3_u32 v3, v3, v76, v77
    v_max3_u32 v3, v3, v78, v79
    v_max3_u32 v3, v3, v80, v81
    v_max3_u32 v3, v3, v82, v83
    v_max3_u32 v3, v3, v84, v85
    v_max3_u32 v3, v3, v86, v87
    v_max3_u32 v3, v3, v88, v89
    v_max3_u32 v3, v3, v90, v91
    v_max3_u32 v3, v3, v92, v93
    v_max3_u32 v3, v3, v94, v95
    v_max3_u32 v3, v3, v96, v97
    v_cmp_eq_u32 vcc, -1, v3
    s_cmp_eq_u64 vcc, 0
    s_cbranch_scc1 L_p_vok_24
    s_sleep 2
    s_sub_u32 s66, s66, 1
    s_cmp_lg_u32 s66, 0
    s_cbranch_scc1 L_p_vsp_23
L_p_vok_24:
    v_add_f32 v64, v64, v68
    v_add_f32 v65, v65, v69
    v_add_f32 v66, v66, v70
    v_add_f32 v67, v67, v71
    v_add_f32 v64, v64, v72
    v_add_f32 v65, v65, v73
    v_add_f32 v66, v66, v74
    v_add_f32 v67, v67, v75
    v_add_f32 v64, v64, v76
    v_add_f32 v65, v65, v77
    v_add_f32 v66, v66, v78
    v_add_f32 v67, v67, v79
    v_add_f32 v64, v64, v80
    v_add_f32 v65, v65, v81
    v_add_f32 v66, v66, v82
    v_add_f32 v67, v67, v83
    v_add_f32 v64, v64, v84
    v_add_f32 v65, v65, v85
    v_add_f32 v66, v66, v86
    v_add_f32 v67, v67, v87
    v_add_f32 v64, v64, v88
    v_add_f32 v65, v65, v89
    v_add_f32 v66, v66, v90
    v_add_f32 v67, v67, v91
    v_add_f32 v64, v64, v92
    v_add_f32 v65, v65, v93
    v_add_f32 v66, v66, v94
    v_add_f32 v67, v67, v95
    s_barrier
    v_mov_b32 v68, v64
    v_mov_b32 v69, v65
    v_mov_b32 v70, v66
    v_mov_b32 v71, v67
    s_nop 1
    v_permlane32_swap_b32 v64, v68
    v_permlane32_swap_b32 v65, v69
    v_permlane32_swap_b32 v66, v70
    v_permlane32_swap_b32 v67, v71
    v_add_f32 v64, v64, v68
    v_add_f32 v65, v65, v69
    v_add_f32 v66, v66, v70
    v_add_f32 v67, v67, v71
    s_add_u32 s69, s69, 152576
    v_add_u32 v3, s69, v12
    ds_write_b128 v3, v[64:67]
    s_lshl_b32 s56, s74, 9
    s_add_u32 s56, s56, 151552
    v_add_u32 v5, s56, v5
    ds_write_b64 v5, v[96:97]
    s_waitcnt lgkmcnt(0)
    s_barrier
    s_mov_b32 s16, s38
    s_mov_b32 s17, s39
    s_mov_b32 s18, 2097152
    s_mov_b32 s19, 0x20000
    s_mov_b32 s20, s42
    s_mov_b32 s21, s43
    s_mov_b32 s22, 7340032
    s_mov_b32 s23, 0x20000
    s_lshr_b32 s56, s2, 3
    s_lshl_b32 s58, s56, 2
    s_add_u32 s58, s58, s92
    s_and_b32 s59, s2, 1
    s_lshl_b32 s57, s2, 2
    s_add_u32 s57, s57, s92
    s_lshl_b32 s57, s57, 11
    v_lshlrev_b32 v3, 7, v1
    s_mov_b64 exec, 0xffff
    buffer_load_dword v250, v3, s[16:19], s57 offen
    s_mov_b64 exec, -1
    s_lshr_b32 s60, s56, 1
    s_cmp_ge_u32 s60, 7
    s_cselect_b32 s61, 7, 0
    s_add_u32 s60, s60, s61
    s_mul_i32 s61, s59, 7
    s_add_u32 s90, s60, s61
    s_and_b32 s61, s2, 6
    s_and_b32 s62, s56, 1
    s_add_u32 s91, s61, s62
    s_lshl_b32 s61, s91, 2
    s_add_u32 s61, s61, s92
    s_mul_i32 s61, s61, 229376
    s_lshl_b32 s60, s90, 8
    s_add_u32 s61, s61, s60
    s_cmp_ge_u32 s2, 224
    s_cselect_b32 s61, 7340032, s61
    v_lshrrev_b32 v3, 4, v1
    v_mul_u32_u24 v3, 7168, v3
    v_and_b32 v4, 15, v1
    v_lshl_add_u32 v5, v4, 4, v3
    buffer_load_dwordx4 v[192:195], v5, s[20:23], s61 offen
    s_add_u32 s61, s61, 28672
    buffer_load_dwordx4 v[196:199], v5, s[20:23], s61 offen
    s_add_u32 s61, s61, 28672
    buffer_load_dwordx4 v[200:203], v5, s[20:23], s61 offen
    s_add_u32 s61, s61, 28672
    buffer_load_dwordx4 v[204:207], v5, s[20:23], s61 offen
    s_add_u32 s61, s61, 28672
    buffer_load_dwordx4 v[208:211], v5, s[20:23], s61 offen
    s_add_u32 s61, s61, 28672
    buffer_load_dwordx4 v[212:215], v5, s[20:23], s61 offen
    s_add_u32 s61, s61, 28672
    buffer_load_dwordx4 v[216:219], v5, s[20:23], s61 offen
    s_add_u32 s61, s61, 28672
    buffer_load_dwordx4 v[220:223], v5, s[20:23], s61 offen
    s_add_u32 s61, s61, 28672
    s_mul_i32 s56, s4, 4352
    s_add_u32 s56, s56, 44040192
    v_mov_b32 v9, s56
    s_lshl_b32 s68, s5, 17
    s_lshl_b32 s57, s4, 13
    s_add_u32 s68, s68, s57
    s_lshl_b32 s58, s74, 8
    s_add_u32 s68, s68, s58
    s_add_u32 s68, s68, 37748736
    s_add_u32 s69, s68, 4096
    s_lshl_b32 s70, s5, 13
    s_lshl_b32 s57, s4, 9
    s_add_u32 s70, s70, s57
    s_add_u32 s70, s70, s58
    s_add_u32 s70, s70, 39976960
    v_and_b32 v12, 15, v1
    v_lshlrev_b32 v12, 4, v12
    v_lshrrev_b32 v5, 4, v1
    v_lshl_add_u32 v13, v5, 9, v12
    v_lshl_add_u32 v12, v5, 2, v12
    s_barrier
    s_barrier
    s_sleep 20
    s_mov_b32 s66, 0x40000
L_p_vsp_25:
    buffer_load_dwordx4 v[64:67], v13, s[24:27], s68 offen offset:0 sc1
    buffer_load_dwordx4 v[68:71], v13, s[24:27], s68 offen offset:2048 sc1
    buffer_load_dwordx4 v[72:75], v13, s[24:27], s69 offen offset:0 sc1
    buffer_load_dwordx4 v[76:79], v13, s[24:27], s69 offen offset:2048 sc1
    s_waitcnt vmcnt(0)
    v_max_u32 v3, v64, v65
    v_max3_u32 v3, v3, v66, v67
    v_max3_u32 v3, v3, v68, v69
    v_max3_u32 v3, v3, v70, v71
    v_max3_u32 v3, v3, v72, v73
    v_max3_u32 v3, v3, v74, v75
    v_max3_u32 v3, v3, v76, v77
    v_max3_u32 v3, v3, v78, v79
    v_cmp_eq_u32 vcc, -1, v3
    s_cmp_eq_u64 vcc, 0
    s_cbranch_scc1 L_p_vok_26
    s_sleep 2
    s_sub_u32 s66, s66, 1
    s_cmp_lg_u32 s66, 0
    s_cbranch_scc1 L_p_vsp_25
L_p_vok_26:
    v_lshlrev_b32 v128, 16, v64
    v_and_b32 v129, 0xffff0000, v64
    v_lshlrev_b32 v130, 16, v65
    v_and_b32 v131, 0xffff0000, v65
    v_lshlrev_b32 v132, 16, v66
    v_and_b32 v133, 0xffff0000, v66
    v_lshlrev_b32 v134, 16, v67
    v_and_b32 v135, 0xffff0000, v67
    v_lshlrev_b32 v48, 16, v68
    v_and_b32 v49, 0xffff0000, v68
    v_pk_add_f32 v[128:129], v[128:129], v[48:49]
    v_lshlrev_b32 v50, 16, v69
    v_and_b32 v51, 0xffff0000, v69
    v_pk_add_f32 v[130:131], v[130:131], v[50:51]
    v_lshlrev_b32 v48, 16, v70
    v_and_b32 v49, 0xffff0000, v70
    v_pk_add_f32 v[132:133], v[132:133], v[48:49]
    v_lshlrev_b32 v50, 16, v71
    v_and_b32 v51, 0xffff0000, v71
    v_pk_add_f32 v[134:135], v[134:135], v[50:51]
    v_lshlrev_b32 v48, 16, v72
    v_and_b32 v49, 0xffff0000, v72
    v_pk_add_f32 v[128:129], v[128:129], v[48:49]
    v_lshlrev_b32 v50, 16, v73
    v_and_b32 v51, 0xffff0000, v73
    v_pk_add_f32 v[130:131], v[130:131], v[50:51]
    v_lshlrev_b32 v48, 16, v74
    v_and_b32 v49, 0xffff0000, v74
    v_pk_add_f32 v[132:133], v[132:133], v[48:49]
    v_lshlrev_b32 v50, 16, v75
    v_and_b32 v51, 0xffff0000, v75
    v_pk_add_f32 v[134:135], v[134:135], v[50:51]
    v_lshlrev_b32 v48, 16, v76
    v_and_b32 v49, 0xffff0000, v76
    v_pk_add_f32 v[128:129], v[128:129], v[48:49]
    v_lshlrev_b32 v50, 16, v77
    v_and_b32 v51, 0xffff0000, v77
    v_pk_add_f32 v[130:131], v[130:131], v[50:51]
    v_lshlrev_b32 v48, 16, v78
    v_and_b32 v49, 0xffff0000, v78
    v_pk_add_f32 v[132:133], v[132:133], v[48:49]
    v_lshlrev_b32 v50, 16, v79
    v_and_b32 v51, 0xffff0000, v79
    v_pk_add_f32 v[134:135], v[134:135], v[50:51]
    s_nop 0
    v_permlane32_swap_b32 v128, v132
    v_permlane32_swap_b32 v129, v133
    v_permlane32_swap_b32 v130, v134
    v_permlane32_swap_b32 v131, v135
    v_pk_add_f32 v[128:129], v[128:129], v[132:133]
    v_pk_add_f32 v[130:131], v[130:131], v[134:135]
    s_nop 1
    v_permlane16_swap_b32 v128, v130
    v_permlane16_swap_b32 v129, v131
    v_pk_add_f32 v[128:129], v[128:129], v[130:131]
    v_cvt_pk_bf16_f32 v52, v128, v129
    buffer_store_dword v52, v12, s[24:27], s70 offen sc1
    s_sleep 21
L_a_kvd:
    s_lshl_b32 s56, s5, 1
    s_add_u32 s56, s56, s74
    s_lshl_b32 s68, s56, 12
    s_add_u32 s68, s68, 39976960
    s_lshl_b32 s69, s56, 7
    s_add_u32 s69, s69, 40108032
    v_and_b32 v13, 7, v1
    v_lshlrev_b32 v13, 4, v13
    s_lshl_b32 s56, s74, 12
    v_add_u32 v4, s56, v2
    s_lshl_b32 s56, s74, 7
    v_add_u32 v5, s56, v13
    s_mov_b32 s66, 0x40000
L_p_vsp_27:
    buffer_load_dwordx4 v[64:67], v2, s[24:27], s68 offen offset:0 sc1
    buffer_load_dwordx4 v[68:71], v2, s[24:27], s68 offen offset:1024 sc1
    buffer_load_dwordx4 v[72:75], v2, s[24:27], s68 offen offset:2048 sc1
    buffer_load_dwordx4 v[76:79], v2, s[24:27], s68 offen offset:3072 sc1
    buffer_load_dwordx4 v[80:83], v13, s[24:27], s69 offen sc1
    s_waitcnt vmcnt(0)
    v_max_u32 v3, v64, v65
    v_max3_u32 v3, v3, v66, v67
    v_max3_u32 v3, v3, v68, v69
    v_max3_u32 v3, v3, v70, v71
    v_max3_u32 v3, v3, v72, v73
    v_max3_u32 v3, v3, v74, v75
    v_max3_u32 v3, v3, v76, v77
    v_max3_u32 v3, v3, v78, v79
    v_max3_u32 v3, v3, v80, v81
    v_max3_u32 v3, v3, v82, v83
    v_cmp_eq_u32 vcc, -1, v3
    s_cmp_eq_u64 vcc, 0
    s_cbranch_scc1 L_p_vok_28
    s_sleep 2
    s_sub_u32 s66, s66, 1
    s_cmp_lg_u32 s66, 0
    s_cbranch_scc1 L_p_vsp_27
L_p_vok_28:
    ds_write_b128 v4, v[64:67] offset:49152
    ds_write_b128 v4, v[68:71] offset:50176
    ds_write_b128 v4, v[72:75] offset:51200
    ds_write_b128 v4, v[76:79] offset:52224
    ds_write_b128 v5, v[80:83] offset:57344
    s_waitcnt lgkmcnt(0)
    s_barrier
    s_and_b32 s56, s2, 7
    s_lshr_b32 s57, s2, 3
    s_and_b32 s58, s57, 3
    s_lshr_b32 s59, s57, 2
    s_lshr_b32 s4, s56, 1
    s_mul_i32 s4, s4, 4
    s_add_u32 s4, s4, s58
    s_and_b32 s5, s56, 1
    s_mul_i32 s5, s5, 8
    s_add_u32 s5, s5, s59
    s_add_u32 s6, s58, s59
    s_mul_i32 s56, s4, 4352
    s_add_u32 s56, s56, 44040192
    v_mov_b32 v10, s56
    s_and_b32 s56, s101, 1
    s_lshl_b32 s56, s56, 7
    v_add_u32 v9, s56, v9
    v_add_u32 v27, 128, v10
    s_setprio 0
    v_lshlrev_b32 v224, 16, v192
    v_and_b32 v225, 0xffff0000, v192
    v_lshlrev_b32 v226, 16, v193
    v_and_b32 v227, 0xffff0000, v193
    v_lshlrev_b32 v228, 16, v194
    v_and_b32 v229, 0xffff0000, v194
    v_lshlrev_b32 v230, 16, v195
    v_and_b32 v231, 0xffff0000, v195
    v_lshlrev_b32 v232, 16, v196
    v_and_b32 v233, 0xffff0000, v196
    v_pk_add_f32 v[224:225], v[224:225], v[232:233]
    v_lshlrev_b32 v234, 16, v197
    v_and_b32 v235, 0xffff0000, v197
    v_pk_add_f32 v[226:227], v[226:227], v[234:235]
    v_lshlrev_b32 v232, 16, v198
    v_and_b32 v233, 0xffff0000, v198
    v_pk_add_f32 v[228:229], v[228:229], v[232:233]
    v_lshlrev_b32 v234, 16, v199
    v_and_b32 v235, 0xffff0000, v199
    v_pk_add_f32 v[230:231], v[230:231], v[234:235]
    v_lshlrev_b32 v232, 16, v200
    v_and_b32 v233, 0xffff0000, v200
    v_pk_add_f32 v[224:225], v[224:225], v[232:233]
    v_lshlrev_b32 v234, 16, v201
    v_and_b32 v235, 0xffff0000, v201
    v_pk_add_f32 v[226:227], v[226:227], v[234:235]
    v_lshlrev_b32 v232, 16, v202
    v_and_b32 v233, 0xffff0000, v202
    v_pk_add_f32 v[228:229], v[228:229], v[232:233]
    v_lshlrev_b32 v234, 16, v203
    v_and_b32 v235, 0xffff0000, v203
    v_pk_add_f32 v[230:231], v[230:231], v[234:235]
    v_lshlrev_b32 v232, 16, v204
    v_and_b32 v233, 0xffff0000, v204
    v_pk_add_f32 v[224:225], v[224:225], v[232:233]
    v_lshlrev_b32 v234, 16, v205
    v_and_b32 v235, 0xffff0000, v205
    v_pk_add_f32 v[226:227], v[226:227], v[234:235]
    v_lshlrev_b32 v232, 16, v206
    v_and_b32 v233, 0xffff0000, v206
    v_pk_add_f32 v[228:229], v[228:229], v[232:233]
    v_lshlrev_b32 v234, 16, v207
    v_and_b32 v235, 0xffff0000, v207
    v_pk_add_f32 v[230:231], v[230:231], v[234:235]
    v_lshlrev_b32 v232, 16, v208
    v_and_b32 v233, 0xffff0000, v208
    v_pk_add_f32 v[224:225], v[224:225], v[232:233]
    v_lshlrev_b32 v234, 16, v209
    v_and_b32 v235, 0xffff0000, v209
    v_pk_add_f32 v[226:227], v[226:227], v[234:235]
    v_lshlrev_b32 v232, 16, v210
    v_and_b32 v233, 0xffff0000, v210
    v_pk_add_f32 v[228:229], v[228:229], v[232:233]
    v_lshlrev_b32 v234, 16, v211
    v_and_b32 v235, 0xffff0000, v211
    v_pk_add_f32 v[230:231], v[230:231], v[234:235]
    v_lshlrev_b32 v232, 16, v212
    v_and_b32 v233, 0xffff0000, v212
    v_pk_add_f32 v[224:225], v[224:225], v[232:233]
    v_lshlrev_b32 v234, 16, v213
    v_and_b32 v235, 0xffff0000, v213
    v_pk_add_f32 v[226:227], v[226:227], v[234:235]
    v_lshlrev_b32 v232, 16, v214
    v_and_b32 v233, 0xffff0000, v214
    v_pk_add_f32 v[228:229], v[228:229], v[232:233]
    v_lshlrev_b32 v234, 16, v215
    v_and_b32 v235, 0xffff0000, v215
    v_pk_add_f32 v[230:231], v[230:231], v[234:235]
    v_lshlrev_b32 v232, 16, v216
    v_and_b32 v233, 0xffff0000, v216
    v_pk_add_f32 v[224:225], v[224:225], v[232:233]
    v_lshlrev_b32 v234, 16, v217
    v_and_b32 v235, 0xffff0000, v217
    v_pk_add_f32 v[226:227], v[226:227], v[234:235]
    v_lshlrev_b32 v232, 16, v218
    v_and_b32 v233, 0xffff0000, v218
    v_pk_add_f32 v[228:229], v[228:229], v[232:233]
    v_lshlrev_b32 v234, 16, v219
    v_and_b32 v235, 0xffff0000, v219
    v_pk_add_f32 v[230:231], v[230:231], v[234:235]
    v_lshlrev_b32 v232, 16, v220
    v_and_b32 v233, 0xffff0000, v220
    v_pk_add_f32 v[224:225], v[224:225], v[232:233]
    v_lshlrev_b32 v234, 16, v221
    v_and_b32 v235, 0xffff0000, v221
    v_pk_add_f32 v[226:227], v[226:227], v[234:235]
    v_lshlrev_b32 v232, 16, v222
    v_and_b32 v233, 0xffff0000, v222
    v_pk_add_f32 v[228:229], v[228:229], v[232:233]
    v_lshlrev_b32 v234, 16, v223
    v_and_b32 v235, 0xffff0000, v223
    v_pk_add_f32 v[230:231], v[230:231], v[234:235]
    v_mov_b32 v232, v224
    v_mov_b32 v233, v225
    v_mov_b32 v234, v226
    v_mov_b32 v235, v227
    v_mov_b32 v236, v228
    v_mov_b32 v237, v229
    v_mov_b32 v238, v230
    v_mov_b32 v239, v231
    s_nop 1
    v_permlane32_swap_b32 v224, v232
    v_permlane32_swap_b32 v225, v233
    v_permlane32_swap_b32 v226, v234
    v_permlane32_swap_b32 v227, v235
    v_permlane32_swap_b32 v228, v236
    v_permlane32_swap_b32 v229, v237
    v_permlane32_swap_b32 v230, v238
    v_permlane32_swap_b32 v231, v239
    v_add_f32 v224, v224, v232
    v_add_f32 v225, v225, v233
    v_add_f32 v226, v226, v234
    v_add_f32 v227, v227, v235
    v_add_f32 v228, v228, v236
    v_add_f32 v229, v229, v237
    v_add_f32 v230, v230, v238
    v_add_f32 v231, v231, v239
    s_lshl_b32 s56, s92, 10
    s_add_u32 s56, s56, 131072
    v_and_b32 v4, 31, v1
    v_lshl_add_u32 v4, v4, 5, s56
    ds_write_b128 v4, v[224:227]
    ds_write_b128 v4, v[228:231] offset:16
    s_waitcnt lgkmcnt(0)
    s_setprio 3
    s_bitcmp1_b32 s101, 0
    s_cbranch_scc1 L_p_par_30
    s_barrier
    s_cmp_lg_u32 s74, 0
    s_cbranch_scc1 L_p_nofl_29
    s_mov_b64 exec, 1
    buffer_atomic_add v11, v9, s[24:27], 0 offen sc1
    s_mov_b64 exec, -1
L_p_nofl_29:
L_p_par_30:
    s_cmp_lg_u32 s74, 0
    s_cbranch_scc1 L_p_polld_32
    s_mov_b32 s66, 0x40000
L_p_poll_31:
    buffer_load_dword v8, v10, s[24:27], 0 offen sc1
    s_waitcnt vmcnt(0)
    v_cmp_le_u32 vcc, 6, v8
    s_and_b32 s67, vcc_lo, 1
    s_cmp_eq_u32 s67, 1
    s_cbranch_scc1 L_p_polld_32
    s_sleep 4
    s_sub_u32 s66, s66, 1
    s_cmp_lg_u32 s66, 0
    s_cbranch_scc1 L_p_poll_31
L_p_polld_32:
    s_barrier
    s_bitcmp1_b32 s101, 0
    s_cbranch_scc0 L_p_par_34
    s_barrier
    s_cmp_lg_u32 s74, 0
    s_cbranch_scc1 L_p_nofl_33
    s_mov_b64 exec, 1
    buffer_atomic_add v11, v9, s[24:27], 0 offen sc1
    s_mov_b64 exec, -1
L_p_nofl_33:
L_p_par_34:
    s_cmp_eq_u32 s74, 0
    s_cbranch_scc1 L_a_nocw
    s_cmp_ge_u32 s2, 224
    s_cbranch_scc1 L_a_nocw
    v_lshlrev_b32 v4, 3, v1
    v_add_u32 v3, 131072, v4
    ds_read_b64 v[192:193], v3 offset:0
    ds_read_b64 v[194:195], v3 offset:512
    ds_read_b64 v[196:197], v3 offset:1024
    ds_read_b64 v[198:199], v3 offset:1536
    ds_read_b64 v[200:201], v3 offset:2048
    ds_read_b64 v[202:203], v3 offset:2560
    ds_read_b64 v[204:205], v3 offset:3072
    ds_read_b64 v[206:207], v3 offset:3584
    s_mul_i32 s56, s91, 14336
    s_lshl_b32 s57, s90, 9
    s_add_u32 s56, s56, s57
    s_add_u32 s56, s56, 41418752
    s_waitcnt lgkmcnt(0)
    v_pk_add_f32 v[192:193], v[192:193], v[194:195]
    v_pk_add_f32 v[192:193], v[192:193], v[196:197]
    v_pk_add_f32 v[192:193], v[192:193], v[198:199]
    v_pk_add_f32 v[192:193], v[192:193], v[200:201]
    v_pk_add_f32 v[192:193], v[192:193], v[202:203]
    v_pk_add_f32 v[192:193], v[192:193], v[204:205]
    v_pk_add_f32 v[192:193], v[192:193], v[206:207]
    buffer_store_dwordx2 v[192:193], v4, s[24:27], s56 offen sc1
L_a_nocw:
    s_mul_i32 s56, s4, 4352
    s_add_u32 s56, s56, 44109824
    v_mov_b32 v9, s56
    s_and_b32 s56, s2, 7
    s_lshr_b32 s57, s2, 3
    s_and_b32 s58, s57, 3
    s_lshr_b32 s59, s57, 2
    s_lshr_b32 s4, s56, 1
    s_mul_i32 s4, s4, 4
    s_add_u32 s4, s4, s58
    s_and_b32 s5, s56, 1
    s_mul_i32 s5, s5, 7
    s_add_u32 s5, s5, s59
    s_add_u32 s6, s58, s59
    v_and_b32 v14, 31, v1
    v_lshlrev_b32 v14, 4, v14
    v_lshrrev_b32 v15, 5, v1
    v_mul_u32_u24 v13, 7168, v15
    v_add_u32 v13, v13, v14
    s_lshl_b32 s56, s74, 9
    v_add_u32 v14, s56, v14
    s_lshl_b32 s69, s5, 9
    s_add_u32 s69, s69, 41418752
    s_lshl_b32 s68, s4, 10
    s_add_u32 s68, s68, 41943040
    v_mov_b32 v23, v9
    v_add_u32 v24, 128, v9
    s_and_b32 s56, s2, 1
    s_lshl_b32 s56, s56, 7
    v_add_u32 v9, s56, v9
    s_lshl_b32 s71, s4, 1
    s_and_b32 s56, s2, 1
    s_add_u32 s71, s71, s56
    s_lshl_b32 s71, s71, 1
    s_add_u32 s71, s71, s74
    s_lshl_b32 s71, s71, 10
    s_add_u32 s71, s71, 43515904
    s_cmp_ge_u32 s2, 224
    s_cselect_b32 s56, s71, 45088768
    buffer_store_dwordx4 v[44:47], v2, s[24:27], s56 offen sc1
    s_barrier
    s_barrier
    s_cmp_lg_u32 s74, 0
    s_cbranch_scc1 L_p_nosm_35
    buffer_load_dword v8, v27, s[24:27], 0 offen sc1
L_p_nosm_35:
    s_barrier
    s_cmp_lg_u32 s74, 0
    s_cbranch_scc1 L_p_polld_37
    s_waitcnt vmcnt(0)
    v_cmp_le_u32 vcc, 10, v8
    s_and_b32 s67, vcc_lo, 1
    s_cmp_eq_u32 s67, 1
    s_cbranch_scc1 L_p_polld_37
    s_mov_b32 s66, 0x40000
L_p_poll_36:
    buffer_load_dword v8, v27, s[24:27], 0 offen sc1
    s_waitcnt vmcnt(0)
    v_cmp_le_u32 vcc, 10, v8
    s_and_b32 s67, vcc_lo, 1
    s_cmp_eq_u32 s67, 1
    s_cbranch_scc1 L_p_polld_37
    s_sleep 4
    s_sub_u32 s66, s66, 1
    s_cmp_lg_u32 s66, 0
    s_cbranch_scc1 L_p_poll_36
L_p_polld_37:
    s_mov_b32 s80, 11
L_p_bars_38:
    s_barrier
    s_sub_u32 s80, s80, 1
    s_cmp_lg_u32 s80, 0
    s_cbranch_scc1 L_p_bars_38
    s_cmp_ge_u32 s2, 224
    s_cbranch_scc1 L_a_helper
    s_cmp_eq_u32 s74, 0
    s_cbranch_scc1 L_a_nocs
    s_mov_b32 s56, s69
L_pad6:
    s_cbranch_execz L_padr6
    buffer_load_dwordx4 v[64:67], v13, s[24:27], s56 offen sc1
    s_add_u32 s56, s56, 14336
    buffer_load_dwordx4 v[68:71], v13, s[24:27], s56 offen sc1
    s_add_u32 s56, s56, 14336
    buffer_load_dwordx4 v[72:75], v13, s[24:27], s56 offen sc1
    s_add_u32 s56, s56, 14336
    buffer_load_dwordx4 v[76:79], v13, s[24:27], s56 offen sc1
    s_add_u32 s56, s56, 14336
    buffer_load_dwordx4 v[80:83], v13, s[24:27], s56 offen sc1
    s_add_u32 s56, s56, 14336
    buffer_load_dwordx4 v[84:87], v13, s[24:27], s56 offen sc1
    s_add_u32 s56, s56, 14336
    buffer_load_dwordx4 v[88:91], v13, s[24:27], s56 offen sc1
    s_add_u32 s56, s56, 14336
    buffer_load_dwordx4 v[92:95], v13, s[24:27], s56 offen sc1
    s_add_u32 s56, s56, 14336
    s_barrier
    s_barrier
    s_barrier
    s_waitcnt vmcnt(0)
    v_max_u32 v3, v64, v65
    v_max3_u32 v3, v3, v66, v67
    v_max3_u32 v3, v3, v68, v69
    v_max3_u32 v3, v3, v70, v71
    v_max3_u32 v3, v3, v72, v73
    v_max3_u32 v3, v3, v74, v75
    v_max3_u32 v3, v3, v76, v77
    v_max3_u32 v3, v3, v78, v79
    v_max3_u32 v3, v3, v80, v81
    v_max3_u32 v3, v3, v82, v83
    v_max3_u32 v3, v3, v84, v85
    v_max3_u32 v3, v3, v86, v87
    v_max3_u32 v3, v3, v88, v89
    v_max3_u32 v3, v3, v90, v91
    v_max3_u32 v3, v3, v92, v93
    v_max3_u32 v3, v3, v94, v95
    v_cmp_eq_u32 vcc, -1, v3
    s_cmp_eq_u64 vcc, 0
    s_cbranch_scc1 L_p_vok_40
    s_mov_b32 s66, 0x40000
L_p_vsp_39:
    s_mov_b32 s56, s69
    buffer_load_dwordx4 v[64:67], v13, s[24:27], s56 offen sc1
    s_add_u32 s56, s56, 14336
    buffer_load_dwordx4 v[68:71], v13, s[24:27], s56 offen sc1
    s_add_u32 s56, s56, 14336
    buffer_load_dwordx4 v[72:75], v13, s[24:27], s56 offen sc1
    s_add_u32 s56, s56, 14336
    buffer_load_dwordx4 v[76:79], v13, s[24:27], s56 offen sc1
    s_add_u32 s56, s56, 14336
    buffer_load_dwordx4 v[80:83], v13, s[24:27], s56 offen sc1
    s_add_u32 s56, s56, 14336
    buffer_load_dwordx4 v[84:87], v13, s[24:27], s56 offen sc1
    s_add_u32 s56, s56, 14336
    buffer_load_dwordx4 v[88:91], v13, s[24:27], s56 offen sc1
    s_add_u32 s56, s56, 14336
    buffer_load_dwordx4 v[92:95], v13, s[24:27], s56 offen sc1
    s_add_u32 s56, s56, 14336
    s_waitcnt vmcnt(0)
    v_max_u32 v3, v64, v65
    v_max3_u32 v3, v3, v66, v67
    v_max3_u32 v3, v3, v68, v69
    v_max3_u32 v3, v3, v70, v71
    v_max3_u32 v3, v3, v72, v73
    v_max3_u32 v3, v3, v74, v75
    v_max3_u32 v3, v3, v76, v77
    v_max3_u32 v3, v3, v78, v79
    v_max3_u32 v3, v3, v80, v81
    v_max3_u32 v3, v3, v82, v83
    v_max3_u32 v3, v3, v84, v85
    v_max3_u32 v3, v3, v86, v87
    v_max3_u32 v3, v3, v88, v89
    v_max3_u32 v3, v3, v90, v91
    v_max3_u32 v3, v3, v92, v93
    v_max3_u32 v3, v3, v94, v95
    v_cmp_eq_u32 vcc, -1, v3
    s_cmp_eq_u64 vcc, 0
    s_cbranch_scc1 L_p_vok_40
    s_sleep 2
    s_sub_u32 s66, s66, 1
    s_cmp_lg_u32 s66, 0
    s_cbranch_scc1 L_p_vsp_39
L_p_vok_40:
    v_pk_add_f32 v[64:65], v[64:65], v[68:69]
    v_pk_add_f32 v[66:67], v[66:67], v[70:71]
    v_pk_add_f32 v[64:65], v[64:65], v[72:73]
    v_pk_add_f32 v[66:67], v[66:67], v[74:75]
    v_pk_add_f32 v[64:65], v[64:65], v[76:77]
    v_pk_add_f32 v[66:67], v[66:67], v[78:79]
    v_pk_add_f32 v[64:65], v[64:65], v[80:81]
    v_pk_add_f32 v[66:67], v[66:67], v[82:83]
    v_pk_add_f32 v[64:65], v[64:65], v[84:85]
    v_pk_add_f32 v[66:67], v[66:67], v[86:87]
    v_pk_add_f32 v[64:65], v[64:65], v[88:89]
    v_pk_add_f32 v[66:67], v[66:67], v[90:91]
    v_pk_add_f32 v[64:65], v[64:65], v[92:93]
    v_pk_add_f32 v[66:67], v[66:67], v[94:95]
    v_add_u32 v3, 155648, v2
    ds_write_b128 v3, v[64:67]
    s_branch L_a_cs
L_a_nocs:
    s_barrier
    s_barrier
    s_barrier
L_a_cs:
    s_bitcmp1_b32 s2, 0
    s_cbranch_scc1 L_p_par_42
    s_barrier
    s_cmp_lg_u32 s74, 0
    s_cbranch_scc1 L_p_nofl_41
    s_mov_b64 exec, 1
    buffer_atomic_add v11, v9, s[24:27], 0 offen sc1
    s_mov_b64 exec, -1
L_p_nofl_41:
L_p_par_42:
    s_cmp_lg_u32 s74, 0
    s_cbranch_scc1 L_p_polld_44
    s_mov_b32 s66, 0x40000
L_p_poll_43:
    buffer_load_dword v8, v23, s[24:27], 0 offen sc1
    s_waitcnt vmcnt(0)
    v_cmp_le_u32 vcc, 8, v8
    s_and_b32 s67, vcc_lo, 1
    s_cmp_eq_u32 s67, 1
    s_cbranch_scc1 L_p_polld_44
    s_sleep 4
    s_sub_u32 s66, s66, 1
    s_cmp_lg_u32 s66, 0
    s_cbranch_scc1 L_p_poll_43
L_p_polld_44:
    s_barrier
    s_bitcmp1_b32 s2, 0
    s_cbranch_scc0 L_p_par_46
    s_barrier
    s_cmp_lg_u32 s74, 0
    s_cbranch_scc1 L_p_nofl_45
    s_mov_b64 exec, 1
    buffer_atomic_add v11, v9, s[24:27], 0 offen sc1
    s_mov_b64 exec, -1
L_p_nofl_45:
L_p_par_46:
    v_lshl_add_u32 v13, v15, 17, v14
    s_barrier
    s_barrier
    s_cmp_lg_u32 s74, 0
    s_cbranch_scc1 L_p_nosm_47
    buffer_load_dword v8, v24, s[24:27], 0 offen sc1
L_p_nosm_47:
    s_barrier
    s_barrier
    s_cmp_lg_u32 s74, 0
    s_cbranch_scc1 L_p_polld_49
    s_waitcnt vmcnt(0)
    v_cmp_le_u32 vcc, 8, v8
    s_and_b32 s67, vcc_lo, 1
    s_cmp_eq_u32 s67, 1
    s_cbranch_scc1 L_p_polld_49
    s_mov_b32 s66, 0x40000
L_p_poll_48:
    buffer_load_dword v8, v24, s[24:27], 0 offen sc1
    s_waitcnt vmcnt(0)
    v_cmp_le_u32 vcc, 8, v8
    s_and_b32 s67, vcc_lo, 1
    s_cmp_eq_u32 s67, 1
    s_cbranch_scc1 L_p_polld_49
    s_sleep 4
    s_sub_u32 s66, s66, 1
    s_cmp_lg_u32 s66, 0
    s_cbranch_scc1 L_p_poll_48
L_p_polld_49:
    s_barrier
    s_barrier
    s_barrier
    s_lshl_b32 s70, s2, 11
    s_add_u32 s70, s70, 40370176
    s_lshl_b32 s56, s74, 10
    s_add_u32 s70, s70, s56
    s_add_u32 m0, s56, 153600
    s_mul_i32 s68, s4, 14336
    s_add_u32 s68, s68, 42991616
    s_lshl_b32 s69, s5, 10
    s_add_u32 s69, s69, s68
    s_lshl_b32 s56, s74, 9
    v_lshlrev_b32 v22, 3, v1
    v_add_u32 v22, s56, v22
    v_add_u32 v12, 156672, v22
    v_mul_u32_u24 v13, 7168, v15
    v_add_u32 v13, v13, v14
    s_mul_i32 s56, s5, 4352
    s_add_u32 s56, s56, 44179456
    v_mov_b32 v10, s56
    s_mul_i32 s56, s4, 4352
    s_add_u32 s56, s56, 44249088
    v_mov_b32 v9, s56
    s_and_b32 s56, s2, 1
    s_lshl_b32 s56, s56, 7
    v_add_u32 v9, s56, v9
    s_lshr_b32 s56, s4, 2
    s_lshl_b32 s56, s56, 5
    s_add_u32 s56, s56, 128
    v_add_u32 v25, s56, v10
    v_mul_u32_u24 v26, s56, v1
    v_add_u32 v26, v26, v10
    s_barrier
    s_barrier
    s_barrier
    s_barrier
    buffer_load_dwordx4 v[64:67], v2, s[24:27], s71 offen sc1
    s_barrier
    s_barrier
    s_waitcnt vmcnt(0) lgkmcnt(0)
    v_max_u32 v3, v64, v65
    v_max3_u32 v3, v3, v66, v67
    v_cmp_eq_u32 vcc, -1, v3
    s_cmp_eq_u64 vcc, 0
    s_cbranch_scc1 L_p_vok_51
    s_mov_b32 s66, 0x40000
L_p_vsp_50:
    buffer_load_dwordx4 v[64:67], v2, s[24:27], s71 offen sc1
    s_waitcnt vmcnt(0)
    v_max_u32 v3, v64, v65
    v_max3_u32 v3, v3, v66, v67
    v_cmp_eq_u32 vcc, -1, v3
    s_cmp_eq_u64 vcc, 0
    s_cbranch_scc1 L_p_vok_51
    s_sleep 2
    s_sub_u32 s66, s66, 1
    s_cmp_lg_u32 s66, 0
    s_cbranch_scc1 L_p_vsp_50
L_p_vok_51:
    buffer_load_dwordx4 v2, s[24:27], s71 offen sc1 lds
    s_barrier
    s_barrier
    s_barrier
    s_waitcnt vmcnt(0)
    s_barrier
    s_sleep 4
    s_lshl_b32 s56, s2, 14
    s_lshl_b32 s57, s74, 13
    s_add_u32 s56, s56, s57
    s_add_u32 s56, s56, 12582912
    s_add_u32 s57, s56, 4096
    buffer_store_dwordx4 v[44:47], v2, s[24:27], s56 offen offset:0 sc1
    buffer_store_dwordx4 v[44:47], v2, s[24:27], s56 offen offset:1024 sc1
    buffer_store_dwordx4 v[44:47], v2, s[24:27], s56 offen offset:2048 sc1
    buffer_store_dwordx4 v[44:47], v2, s[24:27], s56 offen offset:3072 sc1
    buffer_store_dwordx4 v[44:47], v2, s[24:27], s57 offen offset:0 sc1
    buffer_store_dwordx4 v[44:47], v2, s[24:27], s57 offen offset:1024 sc1
    buffer_store_dwordx4 v[44:47], v2, s[24:27], s57 offen offset:2048 sc1
    buffer_store_dwordx4 v[44:47], v2, s[24:27], s57 offen offset:3072 sc1
    s_waitcnt vmcnt(0)
    s_barrier
    ds_read_b64 v[64:65], v12
    ds_read_b64 v[66:67], v12 offset:1024
    s_waitcnt lgkmcnt(0)
    v_add_f32 v4, v64, v66
    v_mul_f32 v4, 0.5, v4
    v_sub_f32 v6, v64, v66
    v_mul_f32 v6, v6, v6
    v_add_f32 v5, v65, v67
    v_fmac_f32 v5, 1107296256, v6
    buffer_store_dwordx2 v[4:5], v22, s[24:27], s69 offen sc1
    s_barrier
    s_barrier
    s_barrier
    s_add_u32 s56, s68, 4096
    buffer_load_dwordx4 v[64:67], v13, s[24:27], s68 offen offset:0 sc1
    buffer_load_dwordx4 v[68:71], v13, s[24:27], s68 offen offset:1024 sc1
    buffer_load_dwordx4 v[72:75], v13, s[24:27], s68 offen offset:2048 sc1
    buffer_load_dwordx4 v[76:79], v13, s[24:27], s68 offen offset:3072 sc1
    buffer_load_dwordx4 v[80:83], v13, s[24:27], s56 offen offset:0 sc1
    buffer_load_dwordx4 v[84:87], v13, s[24:27], s56 offen offset:1024 sc1
    buffer_load_dwordx4 v[88:91], v13, s[24:27], s56 offen offset:2048 sc1
    s_barrier
    s_waitcnt vmcnt(0)
    v_max_u32 v3, v65, v67
    v_max3_u32 v3, v3, v69, v71
    v_max3_u32 v3, v3, v73, v75
    v_max3_u32 v3, v3, v77, v79
    v_max3_u32 v3, v3, v81, v83
    v_max3_u32 v3, v3, v85, v87
    v_max3_u32 v3, v3, v89, v91
    v_cmp_eq_u32 vcc, -1, v3
    s_cmp_eq_u64 vcc, 0
    s_cbranch_scc1 L_p_vok_53
    s_mov_b32 s66, 0x40000
L_p_vsp_52:
    s_add_u32 s56, s68, 4096
    buffer_load_dwordx4 v[64:67], v13, s[24:27], s68 offen offset:0 sc1
    buffer_load_dwordx4 v[68:71], v13, s[24:27], s68 offen offset:1024 sc1
    buffer_load_dwordx4 v[72:75], v13, s[24:27], s68 offen offset:2048 sc1
    buffer_load_dwordx4 v[76:79], v13, s[24:27], s68 offen offset:3072 sc1
    buffer_load_dwordx4 v[80:83], v13, s[24:27], s56 offen offset:0 sc1
    buffer_load_dwordx4 v[84:87], v13, s[24:27], s56 offen offset:1024 sc1
    buffer_load_dwordx4 v[88:91], v13, s[24:27], s56 offen offset:2048 sc1
    s_waitcnt vmcnt(0)
    v_max_u32 v3, v65, v67
    v_max3_u32 v3, v3, v69, v71
    v_max3_u32 v3, v3, v73, v75
    v_max3_u32 v3, v3, v77, v79
    v_max3_u32 v3, v3, v81, v83
    v_max3_u32 v3, v3, v85, v87
    v_max3_u32 v3, v3, v89, v91
    v_cmp_eq_u32 vcc, -1, v3
    s_cmp_eq_u64 vcc, 0
    s_cbranch_scc1 L_p_vok_53
    s_sleep 2
    s_sub_u32 s66, s66, 1
    s_cmp_lg_u32 s66, 0
    s_cbranch_scc1 L_p_vsp_52
L_p_vok_53:
    v_add_f32 v4, v64, v68
    v_add_f32 v5, v65, v69
    v_add_f32 v4, v4, v72
    v_add_f32 v5, v5, v73
    v_add_f32 v4, v4, v76
    v_add_f32 v5, v5, v77
    v_add_f32 v4, v4, v80
    v_add_f32 v5, v5, v81
    v_add_f32 v4, v4, v84
    v_add_f32 v5, v5, v85
    v_add_f32 v4, v4, v88
    v_add_f32 v5, v5, v89
    v_mov_b32 v20, v4
    s_nop 1
    v_permlane32_swap_b32 v4, v20
    v_add_f32 v4, v4, v20
    v_mul_f32 v4, 1032997157, v4
    v_sub_f32 v20, v64, v4
    v_mul_f32 v21, v20, v20
    v_sub_f32 v20, v68, v4
    v_fmac_f32 v21, v20, v20
    v_sub_f32 v20, v72, v4
    v_fmac_f32 v21, v20, v20
    v_sub_f32 v20, v76, v4
    v_fmac_f32 v21, v20, v20
    v_sub_f32 v20, v80, v4
    v_fmac_f32 v21, v20, v20
    v_sub_f32 v20, v84, v4
    v_fmac_f32 v21, v20, v20
    v_sub_f32 v20, v88, v4
    v_fmac_f32 v21, v20, v20
    v_fmac_f32 v5, 1124073472, v21
    v_mov_b32 v20, v5
    s_nop 1
    v_permlane32_swap_b32 v5, v20
    v_add_f32 v5, v5, v20
    v_mul_f32 v5, 974276901, v5
    v_add_f32 v5, 925353388, v5
    v_rsq_f32 v5, v5
    s_nop 0
    v_mul_f32 v4, -v4, v5
    v_add_f32 v6, v66, v70
    v_add_f32 v7, v67, v71
    v_add_f32 v6, v6, v74
    v_add_f32 v7, v7, v75
    v_add_f32 v6, v6, v78
    v_add_f32 v7, v7, v79
    s_barrier
    v_add_f32 v6, v6, v82
    v_add_f32 v7, v7, v83
    v_add_f32 v6, v6, v86
    v_add_f32 v7, v7, v87
    v_add_f32 v6, v6, v90
    v_add_f32 v7, v7, v91
    v_mov_b32 v20, v6
    s_nop 1
    v_permlane32_swap_b32 v6, v20
    v_add_f32 v6, v6, v20
    v_mul_f32 v6, 1032997157, v6
    v_sub_f32 v20, v66, v6
    v_mul_f32 v21, v20, v20
    v_sub_f32 v20, v70, v6
    v_fmac_f32 v21, v20, v20
    v_sub_f32 v20, v74, v6
    v_fmac_f32 v21, v20, v20
    v_sub_f32 v20, v78, v6
    v_fmac_f32 v21, v20, v20
    v_sub_f32 v20, v82, v6
    v_fmac_f32 v21, v20, v20
    v_sub_f32 v20, v86, v6
    v_fmac_f32 v21, v20, v20
    v_sub_f32 v20, v90, v6
    v_fmac_f32 v21, v20, v20
    v_fmac_f32 v7, 1124073472, v21
    v_mov_b32 v20, v7
    s_nop 1
    v_permlane32_swap_b32 v7, v20
    v_add_f32 v7, v7, v20
    v_mul_f32 v7, 974276901, v7
    v_add_f32 v7, 925353388, v7
    v_rsq_f32 v7, v7
    s_nop 0
    v_mul_f32 v6, -v6, v7
    s_lshl_b32 s56, s74, 9
    s_add_u32 m0, s56, 158720
    s_mov_b32 exec_hi, 0
    buffer_store_dwordx4 v[4:7], v2, s[24:27], s70 offen
    s_barrier
    s_waitcnt vmcnt(0)
    buffer_load_dwordx4 v2, s[24:27], s70 offen sc1 lds
    s_mov_b32 exec_hi, -1
    s_barrier
    s_waitcnt vmcnt(0)
    s_barrier
    s_barrier
    s_barrier
    s_cmp_lg_u32 s74, 0
    s_cbranch_scc1 L_p_nofl_54
    s_mov_b64 exec, 3
    buffer_atomic_add v11, v26, s[24:27], 0 offen sc1
    s_mov_b64 exec, -1
L_p_nofl_54:
    s_barrier
    s_barrier
    s_barrier
    s_cmp_lg_u32 s74, 0
    s_cbranch_scc1 L_p_nosm_55
    buffer_load_dword v8, v25, s[24:27], 0 offen sc1
L_p_nosm_55:
    s_barrier
    s_cmp_lg_u32 s74, 0
    s_cbranch_scc1 L_p_polld_57
    s_waitcnt vmcnt(0)
    v_cmp_le_u32 vcc, 4, v8
    s_and_b32 s67, vcc_lo, 1
    s_cmp_eq_u32 s67, 1
    s_cbranch_scc1 L_p_polld_57
    s_mov_b32 s66, 0x40000
L_p_poll_56:
    buffer_load_dword v8, v25, s[24:27], 0 offen sc1
    s_waitcnt vmcnt(0)
    v_cmp_le_u32 vcc, 4, v8
    s_and_b32 s67, vcc_lo, 1
    s_cmp_eq_u32 s67, 1
    s_cbranch_scc1 L_p_polld_57
    s_sleep 4
    s_sub_u32 s66, s66, 1
    s_cmp_lg_u32 s66, 0
    s_cbranch_scc1 L_p_poll_56
L_p_polld_57:
    s_barrier
    s_barrier
    s_cmp_lg_u32 s74, 0
    s_cbranch_scc1 L_p_nosm_58
    buffer_load_dword v8, v10, s[24:27], 0 offen sc1
L_p_nosm_58:
    s_barrier
    s_barrier
    s_cmp_lg_u32 s74, 0
    s_cbranch_scc1 L_p_polld_60
    s_waitcnt vmcnt(0)
    v_cmp_le_u32 vcc, 16, v8
    s_and_b32 s67, vcc_lo, 1
    s_cmp_eq_u32 s67, 1
    s_cbranch_scc1 L_p_polld_60
    s_mov_b32 s66, 0x40000
L_p_poll_59:
    buffer_load_dword v8, v10, s[24:27], 0 offen sc1
    s_waitcnt vmcnt(0)
    v_cmp_le_u32 vcc, 16, v8
    s_and_b32 s67, vcc_lo, 1
    s_cmp_eq_u32 s67, 1
    s_cbranch_scc1 L_p_polld_60
    s_sleep 4
    s_sub_u32 s66, s66, 1
    s_cmp_lg_u32 s66, 0
    s_cbranch_scc1 L_p_poll_59
L_p_polld_60:
    s_mov_b32 s80, 30
L_p_bars_61:
    s_barrier
    s_sub_u32 s80, s80, 1
    s_cmp_lg_u32 s80, 0
    s_cbranch_scc1 L_p_bars_61
L_a_p5:
    s_mul_i32 s56, s4, 4352
    s_add_u32 s56, s56, 44249088
    v_mov_b32 v9, s56
    v_mov_b32 v23, v9
    v_add_u32 v24, 128, v9
    s_and_b32 s56, s2, 1
    s_lshl_b32 s56, s56, 7
    v_add_u32 v9, s56, v9
    s_bitcmp1_b32 s2, 0
    s_cbranch_scc1 L_p_par_63
    s_barrier
    s_cmp_lg_u32 s74, 0
    s_cbranch_scc1 L_p_nofl_62
    s_mov_b64 exec, 1
    buffer_atomic_add v11, v9, s[24:27], 0 offen sc1
    s_mov_b64 exec, -1
L_p_nofl_62:
L_p_par_63:
    s_cmp_lg_u32 s74, 0
    s_cbranch_scc1 L_p_polld_65
    s_mov_b32 s66, 0x40000
L_p_poll_64:
    buffer_load_dword v8, v23, s[24:27], 0 offen sc1
    s_waitcnt vmcnt(0)
    v_cmp_le_u32 vcc, 7, v8
    s_and_b32 s67, vcc_lo, 1
    s_cmp_eq_u32 s67, 1
    s_cbranch_scc1 L_p_polld_65
    s_sleep 4
    s_sub_u32 s66, s66, 1
    s_cmp_lg_u32 s66, 0
    s_cbranch_scc1 L_p_poll_64
L_p_polld_65:
    s_barrier
    s_bitcmp1_b32 s2, 0
    s_cbranch_scc0 L_p_par_67
    s_barrier
    s_cmp_lg_u32 s74, 0
    s_cbranch_scc1 L_p_nofl_66
    s_mov_b64 exec, 1
    buffer_atomic_add v11, v9, s[24:27], 0 offen sc1
    s_mov_b64 exec, -1
L_p_nofl_66:
L_p_par_67:
    s_barrier
    s_barrier
    s_barrier
    s_cmp_lg_u32 s74, 0
    s_cbranch_scc1 L_p_nosm_68
    buffer_load_dword v8, v24, s[24:27], 0 offen sc1
L_p_nosm_68:
    s_barrier
    s_barrier
    s_cmp_lg_u32 s74, 0
    s_cbranch_scc1 L_p_polld_70
    s_waitcnt vmcnt(0)
    v_cmp_le_u32 vcc, 7, v8
    s_and_b32 s67, vcc_lo, 1
    s_cmp_eq_u32 s67, 1
    s_cbranch_scc1 L_p_polld_70
    s_mov_b32 s66, 0x40000
L_p_poll_69:
    buffer_load_dword v8, v24, s[24:27], 0 offen sc1
    s_waitcnt vmcnt(0)
    v_cmp_le_u32 vcc, 7, v8
    s_and_b32 s67, vcc_lo, 1
    s_cmp_eq_u32 s67, 1
    s_cbranch_scc1 L_p_polld_70
    s_sleep 4
    s_sub_u32 s66, s66, 1
    s_cmp_lg_u32 s66, 0
    s_cbranch_scc1 L_p_poll_69
L_p_polld_70:
    s_branch L_fin
L_a_helper:
    s_barrier
    s_barrier
    s_barrier
    s_waitcnt vmcnt(0)
    s_barrier
    s_cmp_lg_u32 s74, 0
    s_cbranch_scc1 L_p_nofl_71
    s_mov_b64 exec, 1
    buffer_atomic_add v11, v9, s[24:27], 0 offen sc1
    s_mov_b64 exec, -1
L_p_nofl_71:
    v_lshl_add_u32 v13, v15, 17, v14
    s_sleep 10
    s_mov_b32 s66, 0x40000
L_p_vsp_72:
    s_mov_b32 s56, s68
    buffer_load_dwordx4 v[64:67], v13, s[24:27], s56 offen sc1
    s_add_u32 s56, s56, 16384
    buffer_load_dwordx4 v[68:71], v13, s[24:27], s56 offen sc1
    s_add_u32 s56, s56, 16384
    buffer_load_dwordx4 v[72:75], v13, s[24:27], s56 offen sc1
    s_add_u32 s56, s56, 16384
    buffer_load_dwordx4 v[76:79], v13, s[24:27], s56 offen sc1
    s_add_u32 s56, s56, 16384
    buffer_load_dwordx4 v[80:83], v13, s[24:27], s56 offen sc1
    s_add_u32 s56, s56, 16384
    buffer_load_dwordx4 v[84:87], v13, s[24:27], s56 offen sc1
    s_add_u32 s56, s56, 16384
    buffer_load_dwordx4 v[88:91], v13, s[24:27], s56 offen sc1
    s_add_u32 s56, s56, 16384
    buffer_load_dwordx4 v[92:95], v13, s[24:27], s56 offen sc1
    s_add_u32 s56, s56, 16384
    s_waitcnt vmcnt(0)
    v_max_u32 v3, v65, v67
    v_max3_u32 v3, v3, v69, v71
    v_max3_u32 v3, v3, v73, v75
    v_max3_u32 v3, v3, v77, v79
    v_max3_u32 v3, v3, v81, v83
    v_max3_u32 v3, v3, v85, v87
    v_max3_u32 v3, v3, v89, v91
    v_max3_u32 v3, v3, v93, v95
    v_cmp_eq_u32 vcc, -1, v3
    s_cmp_eq_u64 vcc, 0
    s_cbranch_scc1 L_p_vok_73
    s_sleep 2
    s_sub_u32 s66, s66, 1
    s_cmp_lg_u32 s66, 0
    s_cbranch_scc1 L_p_vsp_72
L_p_vok_73:
    v_add_f32 v4, v64, v68
    v_add_f32 v5, v65, v69
    v_add_f32 v4, v4, v72
    v_add_f32 v5, v5, v73
    v_add_f32 v4, v4, v76
    v_add_f32 v5, v5, v77
    v_add_f32 v4, v4, v80
    v_add_f32 v5, v5, v81
    v_add_f32 v4, v4, v84
    v_add_f32 v5, v5, v85
    v_add_f32 v4, v4, v88
    v_add_f32 v5, v5, v89
    v_add_f32 v4, v4, v92
    v_add_f32 v5, v5, v93
    v_mov_b32 v20, v4
    s_nop 1
    v_permlane32_swap_b32 v4, v20
    v_add_f32 v4, v4, v20
    v_mul_f32 v4, 1031798784, v4
    v_sub_f32 v20, v64, v4
    v_mul_f32 v21, v20, v20
    v_sub_f32 v20, v68, v4
    v_fmac_f32 v21, v20, v20
    v_sub_f32 v20, v72, v4
    v_fmac_f32 v21, v20, v20
    v_sub_f32 v20, v76, v4
    v_fmac_f32 v21, v20, v20
    v_sub_f32 v20, v80, v4
    v_fmac_f32 v21, v20, v20
    v_sub_f32 v20, v84, v4
    v_fmac_f32 v21, v20, v20
    v_sub_f32 v20, v88, v4
    v_fmac_f32 v21, v20, v20
    v_sub_f32 v20, v92, v4
    v_fmac_f32 v21, v20, v20
    v_fmac_f32 v5, 1115684864, v21
    v_mov_b32 v20, v5
    s_nop 1
    v_permlane32_swap_b32 v5, v20
    v_add_f32 v5, v5, v20
    v_mul_f32 v5, 981467136, v5
    v_add_f32 v5, 925353388, v5
    v_rsq_f32 v20, v5
    v_sqrt_f32 v7, v5
    v_sub_f32 v4, 0, v4
    v_mul_f32 v5, 3222493025, v20
    v_mul_f32 v6, v20, v20
    v_mul_f32 v6, v6, v20
    v_mul_f32 v6, 3184710632, v6
    v_add_f32 v16, v66, v70
    v_add_f32 v17, v67, v71
    v_add_f32 v16, v16, v74
    v_add_f32 v17, v17, v75
    v_add_f32 v16, v16, v78
    v_add_f32 v17, v17, v79
    v_add_f32 v16, v16, v82
    v_add_f32 v17, v17, v83
    v_add_f32 v16, v16, v86
    v_add_f32 v17, v17, v87
    v_add_f32 v16, v16, v90
    v_add_f32 v17, v17, v91
    v_add_f32 v16, v16, v94
    v_add_f32 v17, v17, v95
    v_mov_b32 v20, v16
    s_nop 1
    v_permlane32_swap_b32 v16, v20
    v_add_f32 v16, v16, v20
    v_mul_f32 v16, 1031798784, v16
    v_sub_f32 v20, v66, v16
    v_mul_f32 v21, v20, v20
    v_sub_f32 v20, v70, v16
    v_fmac_f32 v21, v20, v20
    v_sub_f32 v20, v74, v16
    v_fmac_f32 v21, v20, v20
    v_sub_f32 v20, v78, v16
    v_fmac_f32 v21, v20, v20
    v_sub_f32 v20, v82, v16
    v_fmac_f32 v21, v20, v20
    v_sub_f32 v20, v86, v16
    v_fmac_f32 v21, v20, v20
    v_sub_f32 v20, v90, v16
    v_fmac_f32 v21, v20, v20
    v_sub_f32 v20, v94, v16
    v_fmac_f32 v21, v20, v20
    v_fmac_f32 v17, 1115684864, v21
    v_mov_b32 v20, v17
    s_nop 1
    v_permlane32_swap_b32 v17, v20
    v_add_f32 v17, v17, v20
    v_mul_f32 v17, 981467136, v17
    v_add_f32 v17, 925353388, v17
    v_rsq_f32 v20, v17
    v_sqrt_f32 v19, v17
    v_sub_f32 v16, 0, v16
    v_mul_f32 v17, 3222493025, v20
    v_mul_f32 v18, v20, v20
    v_mul_f32 v18, v18, v20
    v_mul_f32 v18, 3184710632, v18
    v_and_b32 v3, 31, v1
    v_lshlrev_b32 v3, 5, v3
    v_cmp_gt_u32 vcc, 32, v1
    v_lshl_add_u32 v3, v15, 4, v3
    s_nop 0
    v_cndmask_b32 v4, v16, v4, vcc
    v_cndmask_b32 v5, v17, v5, vcc
    v_cndmask_b32 v6, v18, v6, vcc
    v_cndmask_b32 v7, v19, v7, vcc
    buffer_store_dwordx4 v[4:7], v3, s[24:27], s71 offen sc1
    s_barrier
    s_getpc_b64 s[76:77]
L_p_pc_74:
    s_add_u32 s76, s76, L_c_p3-L_p_pc_74
    s_addc_u32 s77, s77, 0
    s_lshr_b32 s56, s2, 3
    s_sub_u32 s56, s56, 28
    s_lshl_b32 s56, s56, 1
    s_add_u32 s56, s56, s74
    s_mul_i32 s56, s56, 5632
    v_min_u32 v249, 43, v1
    v_lshlrev_b32 v249, 7, v249
    v_add_u32 v249, s56, v249
    v_min_u32 v249, L_end-L_c_p3, v249
    global_load_dword v250, v249, s[76:77]
    s_lshl_b32 s56, s2, 14
    s_lshl_b32 s57, s74, 13
    s_add_u32 s56, s56, s57
    s_add_u32 s56, s56, 12582912
    s_add_u32 s57, s56, 4096
    buffer_store_dwordx4 v[44:47], v2, s[24:27], s56 offen offset:0 sc1
    buffer_store_dwordx4 v[44:47], v2, s[24:27], s56 offen offset:1024 sc1
    buffer_store_dwordx4 v[44:47], v2, s[24:27], s56 offen offset:2048 sc1
    buffer_store_dwordx4 v[44:47], v2, s[24:27], s56 offen offset:3072 sc1
    buffer_store_dwordx4 v[44:47], v2, s[24:27], s57 offen offset:0 sc1
    buffer_store_dwordx4 v[44:47], v2, s[24:27], s57 offen offset:1024 sc1
    buffer_store_dwordx4 v[44:47], v2, s[24:27], s57 offen offset:2048 sc1
    buffer_store_dwordx4 v[44:47], v2, s[24:27], s57 offen offset:3072 sc1
    s_waitcnt vmcnt(0)
    v_mov_b32 v9, 44240384
    s_mov_b64 exec, 1
    buffer_atomic_add v11, v9, s[24:27], 0 offen sc1
    s_mov_b64 exec, -1
    s_sleep 64
    s_cmp_lg_u32 s74, 0
    s_cbranch_scc1 L_p_polld_76
    s_mov_b32 s66, 0x40000
L_p_poll_75:
    buffer_load_dword v8, v9, s[24:27], 0 offen sc1
    s_waitcnt vmcnt(0)
    v_cmp_le_u32 vcc, 64, v8
    s_and_b32 s67, vcc_lo, 1
    s_cmp_eq_u32 s67, 1
    s_cbranch_scc1 L_p_polld_76
    s_sleep 4
    s_sub_u32 s66, s66, 1
    s_cmp_lg_u32 s66, 0
    s_cbranch_scc1 L_p_poll_75
L_p_polld_76:
    s_mul_i32 s56, s4, 4352
    s_add_u32 s56, s56, 44249088
    v_mov_b32 v9, s56
    s_and_b32 s56, s2, 1
    s_lshl_b32 s56, s56, 7
    v_add_u32 v9, s56, v9
    v_mov_b32 v11, 0
    s_branch L_a_p5
L_cons:
    s_setprio 1
    s_mov_b32 s88, 1069066811
    s_mov_b32 s89, 1069066811
    s_waitcnt lgkmcnt(0)
    s_mov_b32 s20, s32
    s_mov_b32 s21, s33
    s_mov_b32 s22, 4194304
    s_mov_b32 s23, 0x20000
    s_mov_b32 s24, s54
    s_mov_b32 s25, s55
    s_mov_b32 s26, 45088768
    s_mov_b32 s27, 0x20000
    s_mov_b32 s8, s32
    s_mov_b32 s9, s33
    s_mov_b32 s10, 0
    s_mov_b32 s11, 0x20000
    s_mov_b32 s12, s32
    s_mov_b32 s13, s33
    s_mov_b32 s14, 0
    s_mov_b32 s15, 0x20000
    s_mov_b32 s16, s32
    s_mov_b32 s17, s33
    s_mov_b32 s18, 0
    s_mov_b32 s19, 0x20000
    s_mov_b32 s28, s32
    s_mov_b32 s29, s33
    s_mov_b32 s30, 0
    s_mov_b32 s31, 0x20000
    s_mov_b32 s81, 0
    s_mov_b32 s84, -32768
    s_mov_b32 s85, -49152
    s_add_u32 s81, s81, 1
    s_cmp_lg_u32 s81, 3
    s_cselect_b32 s82, 16384, s84
    s_cselect_b32 s83, 24576, s85
    s_cselect_b32 s81, s81, 0
    s_lshr_b32 s72, s3, 1
    s_and_b32 s73, s3, 1
    s_mul_i32 s62, s72, 8192
    s_add_u32 s62, s62, 0
    v_and_b32 v16, 15, v1
    v_lshrrev_b32 v17, 4, v1
    v_bfe_u32 v18, v1, 1, 3
    v_xor_b32 v18, v18, v17
    v_lshlrev_b32 v18, 4, v18
    v_lshl_add_u32 v18, v16, 7, v18
L_pad7:
    s_cbranch_execz L_padr7
    v_add_u32 v8, s62, v18
    v_xor_b32 v9, 64, v8
    v_bfe_u32 v18, v1, 2, 2
    v_lshlrev_b32 v10, 7, v18
    v_lshl_add_u32 v10, v17, 10, v10
    v_bfe_u32 v18, v1, 3, 1
    v_lshl_add_u32 v10, v18, 6, v10
    v_bfe_u32 v18, v1, 4, 1
    v_lshl_add_u32 v10, v18, 5, v10
    s_mov_b32 s62, 49152
    v_add_u32 v10, s62, v10
    s_lshl_b32 s63, s73, 6
    v_xor_b32 v10, s63, v10
    v_and_b32 v18, 1, v1
    v_lshl_add_u32 v12, v18, 4, v10
    v_bfe_u32 v18, v1, 1, 1
    v_lshl_add_u32 v12, v18, 3, v12
    v_add_u32 v12, 16384, v12
    v_xor_b32 v13, 32, v12
    v_and_b32 v18, 3, v1
    v_lshl_add_u32 v10, v18, 3, v10
    v_xor_b32 v11, 32, v10
    v_mov_b64 v[64:65], 0
    v_mov_b64 v[66:67], 0
    v_mov_b64 v[68:69], 0
    v_mov_b64 v[70:71], 0
    v_mov_b64 v[72:73], 0
    v_mov_b64 v[74:75], 0
    v_mov_b64 v[76:77], 0
    v_mov_b64 v[78:79], 0
    v_mov_b64 v[80:81], 0
    v_mov_b64 v[82:83], 0
    v_mov_b64 v[84:85], 0
    v_mov_b64 v[86:87], 0
    v_mov_b64 v[88:89], 0
    v_mov_b64 v[90:91], 0
    v_mov_b64 v[92:93], 0
    v_mov_b64 v[94:95], 0
    v_mov_b64 v[96:97], 0
    v_mov_b64 v[98:99], 0
    v_mov_b64 v[100:101], 0
    v_mov_b64 v[102:103], 0
    v_mov_b64 v[104:105], 0
    v_mov_b64 v[106:107], 0
    v_mov_b64 v[108:109], 0
    v_mov_b64 v[110:111], 0
    v_mov_b64 v[112:113], 0
    v_mov_b64 v[114:115], 0
    v_mov_b64 v[116:117], 0
    v_mov_b64 v[118:119], 0
    v_mov_b64 v[120:121], 0
    v_mov_b64 v[122:123], 0
    v_mov_b64 v[124:125], 0
    v_mov_b64 v[126:127], 0
    v_mov_b64 v[128:129], 0
    v_mov_b64 v[130:131], 0
    v_mov_b64 v[132:133], 0
    v_mov_b64 v[134:135], 0
    v_mov_b64 v[136:137], 0
    v_mov_b64 v[138:139], 0
    v_mov_b64 v[140:141], 0
    v_mov_b64 v[142:143], 0
    v_mov_b64 v[144:145], 0
    v_mov_b64 v[146:147], 0
    v_mov_b64 v[148:149], 0
    v_mov_b64 v[150:151], 0
    v_mov_b64 v[152:153], 0
    v_mov_b64 v[154:155], 0
    v_mov_b64 v[156:157], 0
    v_mov_b64 v[158:159], 0
    v_bfe_u32 v3, v1, 2, 2
    v_lshlrev_b32 v240, 6, v3
    v_lshrrev_b32 v3, 5, v1
    v_lshl_add_u32 v240, v3, 9, v240
    v_bfe_u32 v3, v1, 4, 1
    v_lshl_add_u32 v240, v3, 5, v240
    v_and_b32 v3, 1, v1
    v_lshl_add_u32 v240, v3, 4, v240
    v_bfe_u32 v3, v1, 1, 1
    v_lshl_add_u32 v240, v3, 3, v240
    s_lshl_b32 s56, s73, 11
    s_add_u32 s56, s56, 147456
    v_add_u32 v240, s56, v240
    v_lshrrev_b32 v3, 4, v1
    v_and_b32 v4, 15, v1
    s_lshl_b32 s56, s72, 8
    s_add_u32 s56, s56, 151552
    v_lshl_add_u32 v241, v4, 2, s56
    v_lshl_add_u32 v244, v3, 4, s56
    s_mul_i32 s57, s73, 384
    s_add_u32 s57, s57, 152576
    v_lshl_add_u32 v242, v3, 4, s57
    v_and_b32 v7, 3, v4
    v_bfe_u32 v5, v4, 2, 1
    v_lshl_or_b32 v7, v5, 3, v7
    v_bfe_u32 v5, v4, 3, 1
    v_lshl_or_b32 v7, v5, 2, v7
    v_lshl_add_u32 v243, v7, 2, s57
    v_lshrrev_b32 v3, 5, v1
    v_and_b32 v4, 31, v1
    v_lshlrev_b32 v5, 2, v3
    v_xor_b32 v5, v4, v5
    v_lshlrev_b32 v5, 4, v5
    v_lshl_add_u32 v5, v3, 9, v5
    s_lshl_b32 s56, s73, 14
    s_add_u32 s56, s56, 0
    s_lshl_b32 s57, s72, 13
    s_add_u32 s58, s56, s57
    v_add_u32 v245, s58, v5
    v_xor_b32 v246, 128, v245
    v_lshlrev_b32 v15, 4, v1
    s_lshl_b32 s59, s73, 13
    s_add_u32 s59, s59, 32768
    v_add_u32 v247, s59, v15
    s_lshl_b32 s60, s72, 12
    v_add_u32 v248, s60, v247
    v_lshlrev_b32 v14, 13, v3
    v_lshl_add_u32 v14, v4, 4, v14
    v_lshlrev_b32 v251, 8, v3
    v_lshlrev_b32 v252, 4, v3
    v_bfe_u32 v249, v1, 2, 2
    v_lshrrev_b32 v2, 5, v1
    v_lshl_add_u32 v249, v2, 3, v249
    v_and_b32 v2, 1, v1
    v_bfe_u32 v3, v1, 4, 1
    v_lshl_add_u32 v2, v3, 1, v2
    v_lshlrev_b32 v3, 2, v2
    v_xor_b32 v249, v249, v3
    v_lshlrev_b32 v249, 4, v249
    v_lshl_add_u32 v249, v2, 9, v249
    v_bfe_u32 v2, v1, 1, 1
    v_lshl_add_u32 v249, v2, 3, v249
    s_lshl_b32 s57, s72, 11
    s_add_u32 s57, s57, s56
    v_add_u32 v249, s57, v249
    v_xor_b32 v250, 64, v249
    v_mov_b32 v4, 0x3f803f80
    v_mov_b32 v5, 0x3f803f80
    v_mov_b32 v6, 0x3f803f80
    v_mov_b32 v7, 0x3f803f80
    s_lshl_b32 s56, s73, 1
    s_add_u32 s56, s56, s72
    s_lshl_b32 s57, s5, 2
    s_add_u32 s56, s56, s57
    s_lshl_b32 s58, s56, 15
    s_lshl_b32 s57, s4, 9
    s_add_u32 s58, s58, s57
    s_add_u32 s58, s58, 37748736
    s_add_u32 s59, s58, 16384
    s_lshl_b32 s60, s56, 10
    s_lshl_b32 s57, s4, 4
    s_add_u32 s60, s60, s57
    s_add_u32 s60, s60, 39845888
    s_lshl_b32 s56, s5, 1
    s_add_u32 s56, s56, s73
    s_lshl_b32 s68, s4, 2
    s_lshl_b32 s57, s72, 1
    s_add_u32 s68, s68, s57
    s_lshl_b32 s68, s68, 16
    s_lshl_b32 s57, s56, 11
    s_add_u32 s68, s68, s57
    s_add_u32 s68, s68, 4194304
    s_add_u32 s69, s68, 65536
    s_mov_b64 exec, 0
    s_cmp_lg_u32 s3, 0
    s_cbranch_scc1 L_padr0
    s_branch L_pad0
L_padr0:
    s_cmp_lg_u32 s3, 1
    s_cbranch_scc1 L_padr4
    s_branch L_pad4
L_padr4:
    s_cmp_lg_u32 s3, 2
    s_cbranch_scc1 L_padr5
    s_branch L_pad5
L_padr5:
    s_cmp_lg_u32 s3, 3
    s_cbranch_scc1 L_padr7
    s_branch L_pad7
L_padr7:
    s_cmp_lg_u32 s3, 0
    s_cbranch_scc1 L_padr8
    s_branch L_pad8
L_padr8:
    s_cmp_lg_u32 s3, 1
    s_cbranch_scc1 L_padr9
    s_branch L_pad9
L_padr9:
    s_nop 0
    s_nop 0
    s_nop 0
    s_nop 0
    s_nop 0
    s_nop 0
    s_mov_b64 exec, -1
    s_barrier
    ds_read_b64_tr_b16 v[48:49], v10 offset:8192
    ds_read_b64_tr_b16 v[50:51], v10 offset:8704
    ds_read_b64_tr_b16 v[52:53], v10 offset:12288
    ds_read_b64_tr_b16 v[54:55], v10 offset:12800
    ds_read_b128 v[16:19], v8 offset:0
    ds_read_b128 v[32:35], v9 offset:0
    ds_read_b128 v[20:23], v8 offset:2048
    ds_read_b128 v[36:39], v9 offset:2048
    ds_read_b128 v[24:27], v8 offset:4096
    ds_read_b128 v[40:43], v9 offset:4096
    s_mov_b32 s80, 5
    .p2align 6
L_p_c4_77:
    ds_read_b128 v[28:31], v8 offset:6144
    s_waitcnt lgkmcnt(5)
    v_mfma_f32_16x16x32_bf16 v[64:67], v[48:51], v[16:19], v[64:67]
    ds_read_b128 v[44:47], v9 offset:6144
    v_mfma_f32_16x16x32_bf16 v[64:67], v[52:55], v[32:35], v[64:67]
    ds_read_b64_tr_b16 v[56:57], v11 offset:8192
    s_waitcnt lgkmcnt(5)
    v_mfma_f32_16x16x32_bf16 v[68:71], v[48:51], v[20:23], v[68:71]
    ds_read_b64_tr_b16 v[58:59], v11 offset:8704
    v_mfma_f32_16x16x32_bf16 v[68:71], v[52:55], v[36:39], v[68:71]
    ds_read_b64_tr_b16 v[60:61], v11 offset:12288
    s_waitcnt lgkmcnt(5)
    v_mfma_f32_16x16x32_bf16 v[80:83], v[48:51], v[24:27], v[80:83]
    ds_read_b64_tr_b16 v[62:63], v11 offset:12800
    v_mfma_f32_16x16x32_bf16 v[80:83], v[52:55], v[40:43], v[80:83]
    s_waitcnt lgkmcnt(4)
    v_mfma_f32_16x16x32_bf16 v[84:87], v[48:51], v[28:31], v[84:87]
    ds_read_b64_tr_b16 v[48:49], v12 offset:0
    v_mfma_f32_16x16x32_bf16 v[84:87], v[52:55], v[44:47], v[84:87]
    ds_read_b64_tr_b16 v[50:51], v12 offset:512
    s_waitcnt lgkmcnt(4)
    v_mfma_f32_16x16x32_bf16 v[92:95], v[56:59], v[28:31], v[92:95]
    ds_read_b64_tr_b16 v[52:53], v12 offset:4096
    s_waitcnt lgkmcnt(3)
    v_mfma_f32_16x16x32_bf16 v[92:95], v[60:63], v[44:47], v[92:95]
    ds_read_b64_tr_b16 v[54:55], v12 offset:4608
    v_mfma_f32_16x16x32_bf16 v[88:91], v[56:59], v[24:27], v[88:91]
    v_mfma_f32_16x16x32_bf16 v[88:91], v[60:63], v[40:43], v[88:91]
    v_mfma_f32_16x16x32_bf16 v[76:79], v[56:59], v[20:23], v[76:79]
    v_mfma_f32_16x16x32_bf16 v[76:79], v[60:63], v[36:39], v[76:79]
    v_mfma_f32_16x16x32_bf16 v[72:75], v[56:59], v[16:19], v[72:75]
    ds_read_b64_tr_b16 v[56:57], v13 offset:0
    v_mfma_f32_16x16x32_bf16 v[72:75], v[60:63], v[32:35], v[72:75]
    ds_read_b64_tr_b16 v[58:59], v13 offset:512
    s_waitcnt lgkmcnt(2)
    v_mfma_f32_16x16x32_bf16 v[96:99], v[16:19], v[48:51], v[96:99]
    ds_read_b64_tr_b16 v[60:61], v13 offset:4096
    v_mfma_f32_16x16x32_bf16 v[96:99], v[32:35], v[52:55], v[96:99]
    ds_read_b64_tr_b16 v[62:63], v13 offset:4608
    v_mfma_f32_16x16x32_bf16 v[104:107], v[20:23], v[48:51], v[104:107]
    v_mfma_f32_16x16x32_bf16 v[104:107], v[36:39], v[52:55], v[104:107]
    v_mfma_f32_16x16x32_bf16 v[112:115], v[24:27], v[48:51], v[112:115]
    v_mfma_f32_16x16x32_bf16 v[112:115], v[40:43], v[52:55], v[112:115]
    v_mfma_f32_16x16x32_bf16 v[120:123], v[28:31], v[48:51], v[120:123]
    ds_read_b64_tr_b16 v[48:49], v10 offset:0
    v_mfma_f32_16x16x32_bf16 v[120:123], v[44:47], v[52:55], v[120:123]
    ds_read_b64_tr_b16 v[50:51], v10 offset:512
    s_waitcnt lgkmcnt(2)
    v_mfma_f32_16x16x32_bf16 v[124:127], v[28:31], v[56:59], v[124:127]
    ds_read_b64_tr_b16 v[52:53], v10 offset:4096
    v_mfma_f32_16x16x32_bf16 v[124:127], v[44:47], v[60:63], v[124:127]
    ds_read_b64_tr_b16 v[54:55], v10 offset:4608
    v_mfma_f32_16x16x32_bf16 v[116:119], v[24:27], v[56:59], v[116:119]
    v_mfma_f32_16x16x32_bf16 v[116:119], v[40:43], v[60:63], v[116:119]
    v_mfma_f32_16x16x32_bf16 v[108:111], v[20:23], v[56:59], v[108:111]
    v_mfma_f32_16x16x32_bf16 v[108:111], v[36:39], v[60:63], v[108:111]
    v_mfma_f32_16x16x32_bf16 v[100:103], v[16:19], v[56:59], v[100:103]
    ds_read_b64_tr_b16 v[56:57], v11 offset:0
    v_mfma_f32_16x16x32_bf16 v[100:103], v[32:35], v[60:63], v[100:103]
    ds_read_b64_tr_b16 v[58:59], v11 offset:512
    s_waitcnt lgkmcnt(2)
    v_mfma_f32_16x16x32_bf16 v[128:131], v[48:51], v[16:19], v[128:131]
    ds_read_b64_tr_b16 v[60:61], v11 offset:4096
    v_mfma_f32_16x16x32_bf16 v[128:131], v[52:55], v[32:35], v[128:131]
    ds_read_b64_tr_b16 v[62:63], v11 offset:4608
    v_mfma_f32_16x16x32_bf16 v[132:135], v[48:51], v[20:23], v[132:135]
    v_mfma_f32_16x16x32_bf16 v[132:135], v[52:55], v[36:39], v[132:135]
    v_mfma_f32_16x16x32_bf16 v[144:147], v[48:51], v[24:27], v[144:147]
    v_mfma_f32_16x16x32_bf16 v[144:147], v[52:55], v[40:43], v[144:147]
    v_mfma_f32_16x16x32_bf16 v[148:151], v[48:51], v[28:31], v[148:151]
    v_mfma_f32_16x16x32_bf16 v[148:151], v[52:55], v[44:47], v[148:151]
    s_waitcnt lgkmcnt(0)
    s_barrier
    ds_read_b64_tr_b16 v[48:49], v10 offset:32768
    ds_read_b64_tr_b16 v[50:51], v10 offset:33280
    v_mfma_f32_16x16x32_bf16 v[136:139], v[56:59], v[16:19], v[136:139]
    ds_read_b64_tr_b16 v[52:53], v10 offset:36864
    ds_read_b64_tr_b16 v[54:55], v10 offset:37376
    v_mfma_f32_16x16x32_bf16 v[136:139], v[60:63], v[32:35], v[136:139]
    ds_read_b128 v[16:19], v8 offset:16384
    v_mfma_f32_16x16x32_bf16 v[140:143], v[56:59], v[20:23], v[140:143]
    ds_read_b128 v[32:35], v9 offset:16384
    v_mfma_f32_16x16x32_bf16 v[140:143], v[60:63], v[36:39], v[140:143]
    ds_read_b128 v[20:23], v8 offset:18432
    v_mfma_f32_16x16x32_bf16 v[152:155], v[56:59], v[24:27], v[152:155]
    ds_read_b128 v[36:39], v9 offset:18432
    v_mfma_f32_16x16x32_bf16 v[152:155], v[60:63], v[40:43], v[152:155]
    ds_read_b128 v[24:27], v8 offset:20480
    v_mfma_f32_16x16x32_bf16 v[156:159], v[56:59], v[28:31], v[156:159]
    ds_read_b128 v[40:43], v9 offset:20480
    v_mfma_f32_16x16x32_bf16 v[156:159], v[60:63], v[44:47], v[156:159]
    ds_read_b128 v[28:31], v8 offset:22528
    s_waitcnt lgkmcnt(5)
    v_mfma_f32_16x16x32_bf16 v[64:67], v[48:51], v[16:19], v[64:67]
    ds_read_b128 v[44:47], v9 offset:22528
    v_mfma_f32_16x16x32_bf16 v[64:67], v[52:55], v[32:35], v[64:67]
    ds_read_b64_tr_b16 v[56:57], v11 offset:32768
    s_waitcnt lgkmcnt(5)
    v_mfma_f32_16x16x32_bf16 v[68:71], v[48:51], v[20:23], v[68:71]
    ds_read_b64_tr_b16 v[58:59], v11 offset:33280
    v_mfma_f32_16x16x32_bf16 v[68:71], v[52:55], v[36:39], v[68:71]
    ds_read_b64_tr_b16 v[60:61], v11 offset:36864
    s_waitcnt lgkmcnt(5)
    v_mfma_f32_16x16x32_bf16 v[80:83], v[48:51], v[24:27], v[80:83]
    ds_read_b64_tr_b16 v[62:63], v11 offset:37376
    v_mfma_f32_16x16x32_bf16 v[80:83], v[52:55], v[40:43], v[80:83]
    s_waitcnt lgkmcnt(4)
    v_mfma_f32_16x16x32_bf16 v[84:87], v[48:51], v[28:31], v[84:87]
    ds_read_b64_tr_b16 v[48:49], v12 offset:24576
    v_mfma_f32_16x16x32_bf16 v[84:87], v[52:55], v[44:47], v[84:87]
    ds_read_b64_tr_b16 v[50:51], v12 offset:25088
    s_waitcnt lgkmcnt(4)
    v_mfma_f32_16x16x32_bf16 v[92:95], v[56:59], v[28:31], v[92:95]
    ds_read_b64_tr_b16 v[52:53], v12 offset:28672
    s_waitcnt lgkmcnt(3)
    v_mfma_f32_16x16x32_bf16 v[92:95], v[60:63], v[44:47], v[92:95]
    ds_read_b64_tr_b16 v[54:55], v12 offset:29184
    v_mfma_f32_16x16x32_bf16 v[88:91], v[56:59], v[24:27], v[88:91]
    v_mfma_f32_16x16x32_bf16 v[88:91], v[60:63], v[40:43], v[88:91]
    v_mfma_f32_16x16x32_bf16 v[76:79], v[56:59], v[20:23], v[76:79]
    v_mfma_f32_16x16x32_bf16 v[76:79], v[60:63], v[36:39], v[76:79]
    v_mfma_f32_16x16x32_bf16 v[72:75], v[56:59], v[16:19], v[72:75]
    ds_read_b64_tr_b16 v[56:57], v13 offset:24576
    v_mfma_f32_16x16x32_bf16 v[72:75], v[60:63], v[32:35], v[72:75]
    ds_read_b64_tr_b16 v[58:59], v13 offset:25088
    s_waitcnt lgkmcnt(2)
    v_mfma_f32_16x16x32_bf16 v[96:99], v[16:19], v[48:51], v[96:99]
    ds_read_b64_tr_b16 v[60:61], v13 offset:28672
    v_mfma_f32_16x16x32_bf16 v[96:99], v[32:35], v[52:55], v[96:99]
    ds_read_b64_tr_b16 v[62:63], v13 offset:29184
    v_mfma_f32_16x16x32_bf16 v[104:107], v[20:23], v[48:51], v[104:107]
    v_mfma_f32_16x16x32_bf16 v[104:107], v[36:39], v[52:55], v[104:107]
    v_mfma_f32_16x16x32_bf16 v[112:115], v[24:27], v[48:51], v[112:115]
    v_mfma_f32_16x16x32_bf16 v[112:115], v[40:43], v[52:55], v[112:115]
    v_mfma_f32_16x16x32_bf16 v[120:123], v[28:31], v[48:51], v[120:123]
    ds_read_b64_tr_b16 v[48:49], v10 offset:24576
    v_mfma_f32_16x16x32_bf16 v[120:123], v[44:47], v[52:55], v[120:123]
    ds_read_b64_tr_b16 v[50:51], v10 offset:25088
    s_waitcnt lgkmcnt(2)
    v_mfma_f32_16x16x32_bf16 v[124:127], v[28:31], v[56:59], v[124:127]
    ds_read_b64_tr_b16 v[52:53], v10 offset:28672
    v_mfma_f32_16x16x32_bf16 v[124:127], v[44:47], v[60:63], v[124:127]
    ds_read_b64_tr_b16 v[54:55], v10 offset:29184
    v_mfma_f32_16x16x32_bf16 v[116:119], v[24:27], v[56:59], v[116:119]
    v_mfma_f32_16x16x32_bf16 v[116:119], v[40:43], v[60:63], v[116:119]
    v_mfma_f32_16x16x32_bf16 v[108:111], v[20:23], v[56:59], v[108:111]
    v_mfma_f32_16x16x32_bf16 v[108:111], v[36:39], v[60:63], v[108:111]
    v_mfma_f32_16x16x32_bf16 v[100:103], v[16:19], v[56:59], v[100:103]
    ds_read_b64_tr_b16 v[56:57], v11 offset:24576
    v_mfma_f32_16x16x32_bf16 v[100:103], v[32:35], v[60:63], v[100:103]
    ds_read_b64_tr_b16 v[58:59], v11 offset:25088
    s_waitcnt lgkmcnt(2)
    v_mfma_f32_16x16x32_bf16 v[128:131], v[48:51], v[16:19], v[128:131]
    ds_read_b64_tr_b16 v[60:61], v11 offset:28672
    v_mfma_f32_16x16x32_bf16 v[128:131], v[52:55], v[32:35], v[128:131]
    ds_read_b64_tr_b16 v[62:63], v11 offset:29184
    v_mfma_f32_16x16x32_bf16 v[132:135], v[48:51], v[20:23], v[132:135]
    v_mfma_f32_16x16x32_bf16 v[132:135], v[52:55], v[36:39], v[132:135]
    v_mfma_f32_16x16x32_bf16 v[144:147], v[48:51], v[24:27], v[144:147]
    v_mfma_f32_16x16x32_bf16 v[144:147], v[52:55], v[40:43], v[144:147]
    v_mfma_f32_16x16x32_bf16 v[148:151], v[48:51], v[28:31], v[148:151]
    v_mfma_f32_16x16x32_bf16 v[148:151], v[52:55], v[44:47], v[148:151]
    s_waitcnt lgkmcnt(0)
    s_barrier
    ds_read_b64_tr_b16 v[48:49], v10 offset:57344
    ds_read_b64_tr_b16 v[50:51], v10 offset:57856
    v_mfma_f32_16x16x32_bf16 v[136:139], v[56:59], v[16:19], v[136:139]
    ds_read_b64_tr_b16 v[52:53], v10 offset:61440
    ds_read_b64_tr_b16 v[54:55], v10 offset:61952
    v_mfma_f32_16x16x32_bf16 v[136:139], v[60:63], v[32:35], v[136:139]
    ds_read_b128 v[16:19], v8 offset:32768
    v_mfma_f32_16x16x32_bf16 v[140:143], v[56:59], v[20:23], v[140:143]
    ds_read_b128 v[32:35], v9 offset:32768
    v_mfma_f32_16x16x32_bf16 v[140:143], v[60:63], v[36:39], v[140:143]
    ds_read_b128 v[20:23], v8 offset:34816
    v_mfma_f32_16x16x32_bf16 v[152:155], v[56:59], v[24:27], v[152:155]
    ds_read_b128 v[36:39], v9 offset:34816
    v_mfma_f32_16x16x32_bf16 v[152:155], v[60:63], v[40:43], v[152:155]
    ds_read_b128 v[24:27], v8 offset:36864
    v_mfma_f32_16x16x32_bf16 v[156:159], v[56:59], v[28:31], v[156:159]
    ds_read_b128 v[40:43], v9 offset:36864
    v_mfma_f32_16x16x32_bf16 v[156:159], v[60:63], v[44:47], v[156:159]
    ds_read_b128 v[28:31], v8 offset:38912
    s_waitcnt lgkmcnt(5)
    v_mfma_f32_16x16x32_bf16 v[64:67], v[48:51], v[16:19], v[64:67]
    ds_read_b128 v[44:47], v9 offset:38912
    s_sub_u32 s80, s80, 1
    v_mfma_f32_16x16x32_bf16 v[64:67], v[52:55], v[32:35], v[64:67]
    ds_read_b64_tr_b16 v[56:57], v11 offset:57344
    s_waitcnt lgkmcnt(5)
    v_mfma_f32_16x16x32_bf16 v[68:71], v[48:51], v[20:23], v[68:71]
    ds_read_b64_tr_b16 v[58:59], v11 offset:57856
    v_mfma_f32_16x16x32_bf16 v[68:71], v[52:55], v[36:39], v[68:71]
    ds_read_b64_tr_b16 v[60:61], v11 offset:61440
    s_waitcnt lgkmcnt(5)
    v_mfma_f32_16x16x32_bf16 v[80:83], v[48:51], v[24:27], v[80:83]
    ds_read_b64_tr_b16 v[62:63], v11 offset:61952
    v_mfma_f32_16x16x32_bf16 v[80:83], v[52:55], v[40:43], v[80:83]
    s_waitcnt lgkmcnt(4)
    v_mfma_f32_16x16x32_bf16 v[84:87], v[48:51], v[28:31], v[84:87]
    ds_read_b64_tr_b16 v[48:49], v12 offset:49152
    v_mfma_f32_16x16x32_bf16 v[84:87], v[52:55], v[44:47], v[84:87]
    ds_read_b64_tr_b16 v[50:51], v12 offset:49664
    s_waitcnt lgkmcnt(4)
    v_mfma_f32_16x16x32_bf16 v[92:95], v[56:59], v[28:31], v[92:95]
    ds_read_b64_tr_b16 v[52:53], v12 offset:53248
    s_waitcnt lgkmcnt(3)
    v_mfma_f32_16x16x32_bf16 v[92:95], v[60:63], v[44:47], v[92:95]
    ds_read_b64_tr_b16 v[54:55], v12 offset:53760
    v_mfma_f32_16x16x32_bf16 v[88:91], v[56:59], v[24:27], v[88:91]
    v_mfma_f32_16x16x32_bf16 v[88:91], v[60:63], v[40:43], v[88:91]
    v_mfma_f32_16x16x32_bf16 v[76:79], v[56:59], v[20:23], v[76:79]
    v_mfma_f32_16x16x32_bf16 v[76:79], v[60:63], v[36:39], v[76:79]
    v_mfma_f32_16x16x32_bf16 v[72:75], v[56:59], v[16:19], v[72:75]
    ds_read_b64_tr_b16 v[56:57], v13 offset:49152
    v_mfma_f32_16x16x32_bf16 v[72:75], v[60:63], v[32:35], v[72:75]
    ds_read_b64_tr_b16 v[58:59], v13 offset:49664
    s_waitcnt lgkmcnt(2)
    v_mfma_f32_16x16x32_bf16 v[96:99], v[16:19], v[48:51], v[96:99]
    ds_read_b64_tr_b16 v[60:61], v13 offset:53248
    v_mfma_f32_16x16x32_bf16 v[96:99], v[32:35], v[52:55], v[96:99]
    ds_read_b64_tr_b16 v[62:63], v13 offset:53760
    v_mfma_f32_16x16x32_bf16 v[104:107], v[20:23], v[48:51], v[104:107]
    v_mfma_f32_16x16x32_bf16 v[104:107], v[36:39], v[52:55], v[104:107]
    v_mfma_f32_16x16x32_bf16 v[112:115], v[24:27], v[48:51], v[112:115]
    v_mfma_f32_16x16x32_bf16 v[112:115], v[40:43], v[52:55], v[112:115]
    s_cmp_lg_u32 s80, 0
    v_mfma_f32_16x16x32_bf16 v[120:123], v[28:31], v[48:51], v[120:123]
    ds_read_b64_tr_b16 v[48:49], v10 offset:49152
    v_mfma_f32_16x16x32_bf16 v[120:123], v[44:47], v[52:55], v[120:123]
    ds_read_b64_tr_b16 v[50:51], v10 offset:49664
    s_waitcnt lgkmcnt(2)
    v_mfma_f32_16x16x32_bf16 v[124:127], v[28:31], v[56:59], v[124:127]
    ds_read_b64_tr_b16 v[52:53], v10 offset:53248
    v_mfma_f32_16x16x32_bf16 v[124:127], v[44:47], v[60:63], v[124:127]
    ds_read_b64_tr_b16 v[54:55], v10 offset:53760
    v_mfma_f32_16x16x32_bf16 v[116:119], v[24:27], v[56:59], v[116:119]
    v_mfma_f32_16x16x32_bf16 v[116:119], v[40:43], v[60:63], v[116:119]
    v_mfma_f32_16x16x32_bf16 v[108:111], v[20:23], v[56:59], v[108:111]
    v_mfma_f32_16x16x32_bf16 v[108:111], v[36:39], v[60:63], v[108:111]
    v_mfma_f32_16x16x32_bf16 v[100:103], v[16:19], v[56:59], v[100:103]
    ds_read_b64_tr_b16 v[56:57], v11 offset:49152
    v_mfma_f32_16x16x32_bf16 v[100:103], v[32:35], v[60:63], v[100:103]
    ds_read_b64_tr_b16 v[58:59], v11 offset:49664
    s_waitcnt lgkmcnt(2)
    v_mfma_f32_16x16x32_bf16 v[128:131], v[48:51], v[16:19], v[128:131]
    ds_read_b64_tr_b16 v[60:61], v11 offset:53248
    v_mfma_f32_16x16x32_bf16 v[128:131], v[52:55], v[32:35], v[128:131]
    ds_read_b64_tr_b16 v[62:63], v11 offset:53760
    v_mfma_f32_16x16x32_bf16 v[132:135], v[48:51], v[20:23], v[132:135]
    v_mfma_f32_16x16x32_bf16 v[132:135], v[52:55], v[36:39], v[132:135]
    v_mfma_f32_16x16x32_bf16 v[144:147], v[48:51], v[24:27], v[144:147]
    v_mfma_f32_16x16x32_bf16 v[144:147], v[52:55], v[40:43], v[144:147]
    v_mfma_f32_16x16x32_bf16 v[148:151], v[48:51], v[28:31], v[148:151]
    v_mfma_f32_16x16x32_bf16 v[148:151], v[52:55], v[44:47], v[148:151]
    s_waitcnt lgkmcnt(0)
    s_barrier
    ds_read_b64_tr_b16 v[48:49], v10 offset:8192
    ds_read_b64_tr_b16 v[50:51], v10 offset:8704
    v_mfma_f32_16x16x32_bf16 v[136:139], v[56:59], v[16:19], v[136:139]
    ds_read_b64_tr_b16 v[52:53], v10 offset:12288
    ds_read_b64_tr_b16 v[54:55], v10 offset:12800
    v_mfma_f32_16x16x32_bf16 v[136:139], v[60:63], v[32:35], v[136:139]
    ds_read_b128 v[16:19], v8 offset:0
    v_mfma_f32_16x16x32_bf16 v[140:143], v[56:59], v[20:23], v[140:143]
    ds_read_b128 v[32:35], v9 offset:0
    v_mfma_f32_16x16x32_bf16 v[140:143], v[60:63], v[36:39], v[140:143]
    ds_read_b128 v[20:23], v8 offset:2048
    v_mfma_f32_16x16x32_bf16 v[152:155], v[56:59], v[24:27], v[152:155]
    ds_read_b128 v[36:39], v9 offset:2048
    v_mfma_f32_16x16x32_bf16 v[152:155], v[60:63], v[40:43], v[152:155]
    ds_read_b128 v[24:27], v8 offset:4096
    v_mfma_f32_16x16x32_bf16 v[156:159], v[56:59], v[28:31], v[156:159]
    ds_read_b128 v[40:43], v9 offset:4096
    v_mfma_f32_16x16x32_bf16 v[156:159], v[60:63], v[44:47], v[156:159]
    s_cbranch_scc1 L_p_c4_77
    ds_read_b128 v[28:31], v8 offset:6144
    s_waitcnt lgkmcnt(5)
    v_mfma_f32_16x16x32_bf16 v[64:67], v[48:51], v[16:19], v[64:67]
    ds_read_b128 v[44:47], v9 offset:6144
    v_mfma_f32_16x16x32_bf16 v[64:67], v[52:55], v[32:35], v[64:67]
    ds_read_b64_tr_b16 v[56:57], v11 offset:8192
    s_waitcnt lgkmcnt(5)
    v_mfma_f32_16x16x32_bf16 v[68:71], v[48:51], v[20:23], v[68:71]
    ds_read_b64_tr_b16 v[58:59], v11 offset:8704
    v_mfma_f32_16x16x32_bf16 v[68:71], v[52:55], v[36:39], v[68:71]
    ds_read_b64_tr_b16 v[60:61], v11 offset:12288
    s_waitcnt lgkmcnt(5)
    v_mfma_f32_16x16x32_bf16 v[80:83], v[48:51], v[24:27], v[80:83]
    ds_read_b64_tr_b16 v[62:63], v11 offset:12800
    v_mfma_f32_16x16x32_bf16 v[80:83], v[52:55], v[40:43], v[80:83]
    s_waitcnt lgkmcnt(4)
    v_mfma_f32_16x16x32_bf16 v[84:87], v[48:51], v[28:31], v[84:87]
    ds_read_b64_tr_b16 v[48:49], v12 offset:0
    v_mfma_f32_16x16x32_bf16 v[84:87], v[52:55], v[44:47], v[84:87]
    ds_read_b64_tr_b16 v[50:51], v12 offset:512
    s_waitcnt lgkmcnt(4)
    v_mfma_f32_16x16x32_bf16 v[92:95], v[56:59], v[28:31], v[92:95]
    ds_read_b64_tr_b16 v[52:53], v12 offset:4096
    s_waitcnt lgkmcnt(3)
    v_mfma_f32_16x16x32_bf16 v[92:95], v[60:63], v[44:47], v[92:95]
    ds_read_b64_tr_b16 v[54:55], v12 offset:4608
    v_mfma_f32_16x16x32_bf16 v[88:91], v[56:59], v[24:27], v[88:91]
    v_mfma_f32_16x16x32_bf16 v[88:91], v[60:63], v[40:43], v[88:91]
    v_mfma_f32_16x16x32_bf16 v[76:79], v[56:59], v[20:23], v[76:79]
    v_mfma_f32_16x16x32_bf16 v[76:79], v[60:63], v[36:39], v[76:79]
    v_mfma_f32_16x16x32_bf16 v[72:75], v[56:59], v[16:19], v[72:75]
    ds_read_b64_tr_b16 v[56:57], v13 offset:0
    v_mfma_f32_16x16x32_bf16 v[72:75], v[60:63], v[32:35], v[72:75]
    ds_read_b64_tr_b16 v[58:59], v13 offset:512
    s_waitcnt lgkmcnt(2)
    v_mfma_f32_16x16x32_bf16 v[96:99], v[16:19], v[48:51], v[96:99]
    ds_read_b64_tr_b16 v[60:61], v13 offset:4096
    v_mfma_f32_16x16x32_bf16 v[96:99], v[32:35], v[52:55], v[96:99]
    ds_read_b64_tr_b16 v[62:63], v13 offset:4608
    v_mfma_f32_16x16x32_bf16 v[104:107], v[20:23], v[48:51], v[104:107]
    v_mfma_f32_16x16x32_bf16 v[104:107], v[36:39], v[52:55], v[104:107]
    v_mfma_f32_16x16x32_bf16 v[112:115], v[24:27], v[48:51], v[112:115]
    v_mfma_f32_16x16x32_bf16 v[112:115], v[40:43], v[52:55], v[112:115]
    v_mfma_f32_16x16x32_bf16 v[120:123], v[28:31], v[48:51], v[120:123]
    ds_read_b64_tr_b16 v[48:49], v10 offset:0
    v_mfma_f32_16x16x32_bf16 v[120:123], v[44:47], v[52:55], v[120:123]
    ds_read_b64_tr_b16 v[50:51], v10 offset:512
    s_waitcnt lgkmcnt(2)
    v_mfma_f32_16x16x32_bf16 v[124:127], v[28:31], v[56:59], v[124:127]
    ds_read_b64_tr_b16 v[52:53], v10 offset:4096
    v_mfma_f32_16x16x32_bf16 v[124:127], v[44:47], v[60:63], v[124:127]
    ds_read_b64_tr_b16 v[54:55], v10 offset:4608
    v_mfma_f32_16x16x32_bf16 v[116:119], v[24:27], v[56:59], v[116:119]
    v_mfma_f32_16x16x32_bf16 v[116:119], v[40:43], v[60:63], v[116:119]
    v_mfma_f32_16x16x32_bf16 v[108:111], v[20:23], v[56:59], v[108:111]
    v_mfma_f32_16x16x32_bf16 v[108:111], v[36:39], v[60:63], v[108:111]
    v_mfma_f32_16x16x32_bf16 v[100:103], v[16:19], v[56:59], v[100:103]
    ds_read_b64_tr_b16 v[56:57], v11 offset:0
    v_mfma_f32_16x16x32_bf16 v[100:103], v[32:35], v[60:63], v[100:103]
    ds_read_b64_tr_b16 v[58:59], v11 offset:512
    s_waitcnt lgkmcnt(2)
    v_mfma_f32_16x16x32_bf16 v[128:131], v[48:51], v[16:19], v[128:131]
    ds_read_b64_tr_b16 v[60:61], v11 offset:4096
    v_mfma_f32_16x16x32_bf16 v[128:131], v[52:55], v[32:35], v[128:131]
    ds_read_b64_tr_b16 v[62:63], v11 offset:4608
    v_mfma_f32_16x16x32_bf16 v[132:135], v[48:51], v[20:23], v[132:135]
    v_mfma_f32_16x16x32_bf16 v[132:135], v[52:55], v[36:39], v[132:135]
    v_mfma_f32_16x16x32_bf16 v[144:147], v[48:51], v[24:27], v[144:147]
    v_mfma_f32_16x16x32_bf16 v[144:147], v[52:55], v[40:43], v[144:147]
    v_mfma_f32_16x16x32_bf16 v[148:151], v[48:51], v[28:31], v[148:151]
    v_mfma_f32_16x16x32_bf16 v[148:151], v[52:55], v[44:47], v[148:151]
    s_waitcnt lgkmcnt(0)
    s_barrier
    ds_read2_b32 v[232:233], v241 offset0:0 offset1:128
    ds_read2_b32 v[234:235], v241 offset0:16 offset1:144
    v_mfma_f32_16x16x32_bf16 v[136:139], v[56:59], v[16:19], v[136:139]
    ds_read2_b32 v[236:237], v241 offset0:32 offset1:160
    ds_read2_b32 v[238:239], v241 offset0:48 offset1:176
    v_mfma_f32_16x16x32_bf16 v[136:139], v[60:63], v[32:35], v[136:139]
    ds_read_b128 v[160:163], v242 offset:128
    ds_read_b128 v[164:167], v242 offset:192
    v_mfma_f32_16x16x32_bf16 v[140:143], v[56:59], v[20:23], v[140:143]
    ds_read_b64_tr_b16 v[224:225], v240 offset:0
    ds_read_b64_tr_b16 v[226:227], v240 offset:256
    v_mfma_f32_16x16x32_bf16 v[140:143], v[60:63], v[36:39], v[140:143]
    ds_read_b64_tr_b16 v[228:229], v240 offset:1024
    ds_read_b64_tr_b16 v[230:231], v240 offset:1280
    v_mfma_f32_16x16x32_bf16 v[152:155], v[56:59], v[24:27], v[152:155]
    ds_read2_b32 v[2:3], v243 offset0:64 offset1:80
    v_mfma_f32_16x16x32_bf16 v[152:155], v[60:63], v[40:43], v[152:155]
    v_mfma_f32_16x16x32_bf16 v[156:159], v[56:59], v[28:31], v[156:159]
    v_mfma_f32_16x16x32_bf16 v[156:159], v[60:63], v[44:47], v[156:159]
    s_waitcnt lgkmcnt(5)
    ds_read_b128 v[192:195], v244 offset:0
    ds_read_b128 v[208:211], v244 offset:512
    ds_read_b128 v[196:199], v244 offset:64
    ds_read_b128 v[212:215], v244 offset:576
    ds_read_b128 v[200:203], v244 offset:128
    ds_read_b128 v[216:219], v244 offset:640
    ds_read_b128 v[204:207], v244 offset:192
    ds_read_b128 v[220:223], v244 offset:704
    v_pk_mul_f32 v[16:17], v[160:161], v[232:233] op_sel_hi:[1,0]
    v_pk_mul_f32 v[18:19], v[162:163], v[232:233] op_sel_hi:[1,0]
    v_pk_mul_f32 v[20:21], v[160:161], v[234:235] op_sel_hi:[1,0]
    v_pk_mul_f32 v[22:23], v[162:163], v[234:235] op_sel_hi:[1,0]
    v_pk_fma_f32 v[64:65], v[64:65], v[232:233], v[16:17] op_sel:[0,1,0] op_sel_hi:[1,1,1]
    v_pk_fma_f32 v[66:67], v[66:67], v[232:233], v[18:19] op_sel:[0,1,0] op_sel_hi:[1,1,1]
    v_pk_fma_f32 v[68:69], v[68:69], v[234:235], v[20:21] op_sel:[0,1,0] op_sel_hi:[1,1,1]
    v_pk_fma_f32 v[70:71], v[70:71], v[234:235], v[22:23] op_sel:[0,1,0] op_sel_hi:[1,1,1]
    v_pk_mul_f32 v[16:17], v[164:165], v[232:233] op_sel_hi:[1,0]
    v_pk_mul_f32 v[18:19], v[166:167], v[232:233] op_sel_hi:[1,0]
    v_pk_mul_f32 v[20:21], v[164:165], v[234:235] op_sel_hi:[1,0]
    v_pk_mul_f32 v[22:23], v[166:167], v[234:235] op_sel_hi:[1,0]
    v_pk_fma_f32 v[72:73], v[72:73], v[232:233], v[16:17] op_sel:[0,1,0] op_sel_hi:[1,1,1]
    v_pk_fma_f32 v[74:75], v[74:75], v[232:233], v[18:19] op_sel:[0,1,0] op_sel_hi:[1,1,1]
    v_pk_fma_f32 v[76:77], v[76:77], v[234:235], v[20:21] op_sel:[0,1,0] op_sel_hi:[1,1,1]
    v_pk_fma_f32 v[78:79], v[78:79], v[234:235], v[22:23] op_sel:[0,1,0] op_sel_hi:[1,1,1]
    v_pk_mul_f32 v[16:17], v[160:161], v[236:237] op_sel_hi:[1,0]
    v_pk_mul_f32 v[18:19], v[162:163], v[236:237] op_sel_hi:[1,0]
    v_pk_mul_f32 v[20:21], v[160:161], v[238:239] op_sel_hi:[1,0]
    v_pk_mul_f32 v[22:23], v[162:163], v[238:239] op_sel_hi:[1,0]
    v_pk_fma_f32 v[80:81], v[80:81], v[236:237], v[16:17] op_sel:[0,1,0] op_sel_hi:[1,1,1]
    v_pk_fma_f32 v[82:83], v[82:83], v[236:237], v[18:19] op_sel:[0,1,0] op_sel_hi:[1,1,1]
    v_pk_fma_f32 v[84:85], v[84:85], v[238:239], v[20:21] op_sel:[0,1,0] op_sel_hi:[1,1,1]
L_pad8:
    s_cbranch_execz L_padr8
    v_pk_fma_f32 v[86:87], v[86:87], v[238:239], v[22:23] op_sel:[0,1,0] op_sel_hi:[1,1,1]
    v_pk_mul_f32 v[16:17], v[164:165], v[236:237] op_sel_hi:[1,0]
    v_pk_mul_f32 v[18:19], v[166:167], v[236:237] op_sel_hi:[1,0]
    v_pk_mul_f32 v[20:21], v[164:165], v[238:239] op_sel_hi:[1,0]
    v_pk_mul_f32 v[22:23], v[166:167], v[238:239] op_sel_hi:[1,0]
    v_pk_fma_f32 v[88:89], v[88:89], v[236:237], v[16:17] op_sel:[0,1,0] op_sel_hi:[1,1,1]
    v_pk_fma_f32 v[90:91], v[90:91], v[236:237], v[18:19] op_sel:[0,1,0] op_sel_hi:[1,1,1]
    v_pk_fma_f32 v[92:93], v[92:93], v[238:239], v[20:21] op_sel:[0,1,0] op_sel_hi:[1,1,1]
    v_pk_fma_f32 v[94:95], v[94:95], v[238:239], v[22:23] op_sel:[0,1,0] op_sel_hi:[1,1,1]
    v_cvt_pk_bf16_f32 v24, v64, v65
    v_cvt_pk_bf16_f32 v25, v66, v67
    v_cvt_pk_bf16_f32 v26, v68, v69
    v_cvt_pk_bf16_f32 v27, v70, v71
    v_cvt_pk_bf16_f32 v28, v72, v73
    v_cvt_pk_bf16_f32 v29, v74, v75
    v_cvt_pk_bf16_f32 v30, v76, v77
    v_cvt_pk_bf16_f32 v31, v78, v79
    v_permlane16_swap_b32 v24, v26
    v_permlane16_swap_b32 v25, v27
    v_permlane16_swap_b32 v28, v30
    v_permlane16_swap_b32 v29, v31
    v_cvt_pk_bf16_f32 v32, v80, v81
    v_cvt_pk_bf16_f32 v33, v82, v83
    v_cvt_pk_bf16_f32 v34, v84, v85
    v_cvt_pk_bf16_f32 v35, v86, v87
    v_cvt_pk_bf16_f32 v36, v88, v89
    v_cvt_pk_bf16_f32 v37, v90, v91
    v_cvt_pk_bf16_f32 v38, v92, v93
    v_cvt_pk_bf16_f32 v39, v94, v95
    v_permlane16_swap_b32 v32, v34
    v_permlane16_swap_b32 v33, v35
    v_permlane16_swap_b32 v36, v38
    v_permlane16_swap_b32 v37, v39
    s_waitcnt lgkmcnt(0)
    v_mfma_f32_32x32x16_bf16 v[160:175], v[224:227], v[24:27], 0
    v_mfma_f32_32x32x16_bf16 v[160:175], v[228:231], v[28:31], v[160:175]
    v_mfma_f32_32x32x16_bf16 v[176:191], v[224:227], v[32:35], 0
    v_mfma_f32_32x32x16_bf16 v[176:191], v[228:231], v[36:39], v[176:191]
    v_pk_mul_f32 v[16:17], v[192:193], v[2:3] op_sel:[0,0] op_sel_hi:[1,0]
    v_pk_mul_f32 v[18:19], v[194:195], v[2:3] op_sel:[0,0] op_sel_hi:[1,0]
    v_pk_mul_f32 v[20:21], v[192:193], v[2:3] op_sel:[0,1] op_sel_hi:[1,1]
    v_pk_mul_f32 v[22:23], v[194:195], v[2:3] op_sel:[0,1] op_sel_hi:[1,1]
    v_pk_fma_f32 v[96:97], v[96:97], v[208:209], v[16:17]
    v_pk_fma_f32 v[98:99], v[98:99], v[210:211], v[18:19]
    v_pk_fma_f32 v[100:101], v[100:101], v[208:209], v[20:21]
    v_pk_fma_f32 v[102:103], v[102:103], v[210:211], v[22:23]
    v_pk_mul_f32 v[16:17], v[196:197], v[2:3] op_sel:[0,0] op_sel_hi:[1,0]
    v_pk_mul_f32 v[18:19], v[198:199], v[2:3] op_sel:[0,0] op_sel_hi:[1,0]
    v_pk_mul_f32 v[20:21], v[196:197], v[2:3] op_sel:[0,1] op_sel_hi:[1,1]
    v_pk_mul_f32 v[22:23], v[198:199], v[2:3] op_sel:[0,1] op_sel_hi:[1,1]
    v_pk_fma_f32 v[104:105], v[104:105], v[212:213], v[16:17]
    v_pk_fma_f32 v[106:107], v[106:107], v[214:215], v[18:19]
    v_pk_fma_f32 v[108:109], v[108:109], v[212:213], v[20:21]
    v_pk_fma_f32 v[110:111], v[110:111], v[214:215], v[22:23]
    v_pk_mul_f32 v[16:17], v[200:201], v[2:3] op_sel:[0,0] op_sel_hi:[1,0]
    v_pk_mul_f32 v[18:19], v[202:203], v[2:3] op_sel:[0,0] op_sel_hi:[1,0]
    v_pk_mul_f32 v[20:21], v[200:201], v[2:3] op_sel:[0,1] op_sel_hi:[1,1]
    v_pk_mul_f32 v[22:23], v[202:203], v[2:3] op_sel:[0,1] op_sel_hi:[1,1]
    v_pk_fma_f32 v[112:113], v[112:113], v[216:217], v[16:17]
    v_pk_fma_f32 v[114:115], v[114:115], v[218:219], v[18:19]
    v_pk_fma_f32 v[116:117], v[116:117], v[216:217], v[20:21]
    v_pk_fma_f32 v[118:119], v[118:119], v[218:219], v[22:23]
    v_pk_mul_f32 v[16:17], v[204:205], v[2:3] op_sel:[0,0] op_sel_hi:[1,0]
    v_pk_mul_f32 v[18:19], v[206:207], v[2:3] op_sel:[0,0] op_sel_hi:[1,0]
    v_pk_mul_f32 v[20:21], v[204:205], v[2:3] op_sel:[0,1] op_sel_hi:[1,1]
    v_pk_mul_f32 v[22:23], v[206:207], v[2:3] op_sel:[0,1] op_sel_hi:[1,1]
    v_pk_fma_f32 v[120:121], v[120:121], v[220:221], v[16:17]
    v_pk_fma_f32 v[122:123], v[122:123], v[222:223], v[18:19]
    v_pk_fma_f32 v[124:125], v[124:125], v[220:221], v[20:21]
    v_pk_fma_f32 v[126:127], v[126:127], v[222:223], v[22:23]
    v_cvt_pk_bf16_f32 v40, v96, v97
    v_cvt_pk_bf16_f32 v41, v98, v99
    v_cvt_pk_bf16_f32 v42, v100, v101
    v_cvt_pk_bf16_f32 v43, v102, v103
    v_cvt_pk_bf16_f32 v44, v104, v105
    v_cvt_pk_bf16_f32 v45, v106, v107
    v_cvt_pk_bf16_f32 v46, v108, v109
    v_cvt_pk_bf16_f32 v47, v110, v111
    v_permlane16_swap_b32 v40, v42
    v_permlane16_swap_b32 v41, v43
    v_permlane16_swap_b32 v44, v46
    v_permlane16_swap_b32 v45, v47
    v_cvt_pk_bf16_f32 v48, v112, v113
    v_cvt_pk_bf16_f32 v49, v114, v115
    v_cvt_pk_bf16_f32 v50, v116, v117
    v_cvt_pk_bf16_f32 v51, v118, v119
    v_cvt_pk_bf16_f32 v52, v120, v121
    v_cvt_pk_bf16_f32 v53, v122, v123
    v_cvt_pk_bf16_f32 v54, v124, v125
    v_cvt_pk_bf16_f32 v55, v126, v127
    v_permlane16_swap_b32 v48, v50
    v_permlane16_swap_b32 v49, v51
    v_permlane16_swap_b32 v52, v54
    v_permlane16_swap_b32 v53, v55
    v_max3_f32 v56, v160, v161, v162
    v_max3_f32 v60, v176, v177, v178
    v_min3_f32 v57, v160, v161, v162
    v_min3_f32 v61, v176, v177, v178
    v_max3_f32 v56, v56, v163, v164
    v_max3_f32 v60, v60, v179, v180
    v_min3_f32 v57, v57, v163, v164
    v_min3_f32 v61, v61, v179, v180
    v_max3_f32 v56, v56, v165, v166
    v_max3_f32 v60, v60, v181, v182
    v_min3_f32 v57, v57, v165, v166
    v_min3_f32 v61, v61, v181, v182
    v_max3_f32 v56, v56, v167, v168
    v_max3_f32 v60, v60, v183, v184
    v_min3_f32 v57, v57, v167, v168
    v_min3_f32 v61, v61, v183, v184
    v_max3_f32 v56, v56, v169, v170
    v_max3_f32 v60, v60, v185, v186
    v_min3_f32 v57, v57, v169, v170
    v_min3_f32 v61, v61, v185, v186
    v_max3_f32 v56, v56, v171, v172
    v_max3_f32 v60, v60, v187, v188
    v_min3_f32 v57, v57, v171, v172
    v_min3_f32 v61, v61, v187, v188
    ds_write_b128 v248, v[40:43] offset:0
    v_max3_f32 v56, v56, v173, v174
    v_max3_f32 v60, v60, v189, v190
    v_min3_f32 v57, v57, v173, v174
    v_min3_f32 v61, v61, v189, v190
    v_max_f32 v56, v56, v175
    v_max_f32 v60, v60, v191
    v_max_f32 v57, -v57, -v175
    v_max_f32 v61, -v61, -v191
    s_nop 0
    v_permlane32_swap_b32 v56, v57
    v_permlane32_swap_b32 v60, v61
    v_max_f32 v56, v56, v57
    v_max_f32 v60, v60, v61
    v_mul_f32 v56, 3216550459, v56
    v_mul_f32 v60, 3216550459, v60
    v_mov_b32 v57, v56
    v_mov_b32 v61, v60
    s_nop 0
    v_permlane32_swap_b32 v56, v57
    v_permlane32_swap_b32 v60, v61
    v_pk_fma_f32 v[64:65], v[160:161], s[88:89], v[56:57] op_sel_hi:[1,1,0]
    v_pk_fma_f32 v[96:97], v[176:177], s[88:89], v[60:61] op_sel_hi:[1,1,0]
    v_pk_fma_f32 v[80:81], v[160:161], s[88:89], v[56:57] op_sel:[0,0,1] op_sel_hi:[1,1,1] neg_lo:[0,1,0] neg_hi:[0,1,0]
    v_pk_fma_f32 v[112:113], v[176:177], s[88:89], v[60:61] op_sel:[0,0,1] op_sel_hi:[1,1,1] neg_lo:[0,1,0] neg_hi:[0,1,0]
    ds_write_b128 v248, v[44:47] offset:1024
    v_pk_fma_f32 v[66:67], v[162:163], s[88:89], v[56:57] op_sel_hi:[1,1,0]
    v_pk_fma_f32 v[98:99], v[178:179], s[88:89], v[60:61] op_sel_hi:[1,1,0]
    v_pk_fma_f32 v[82:83], v[162:163], s[88:89], v[56:57] op_sel:[0,0,1] op_sel_hi:[1,1,1] neg_lo:[0,1,0] neg_hi:[0,1,0]
    v_pk_fma_f32 v[114:115], v[178:179], s[88:89], v[60:61] op_sel:[0,0,1] op_sel_hi:[1,1,1] neg_lo:[0,1,0] neg_hi:[0,1,0]
    v_pk_fma_f32 v[68:69], v[164:165], s[88:89], v[56:57] op_sel_hi:[1,1,0]
    v_pk_fma_f32 v[100:101], v[180:181], s[88:89], v[60:61] op_sel_hi:[1,1,0]
    v_pk_fma_f32 v[84:85], v[164:165], s[88:89], v[56:57] op_sel:[0,0,1] op_sel_hi:[1,1,1] neg_lo:[0,1,0] neg_hi:[0,1,0]
    v_pk_fma_f32 v[116:117], v[180:181], s[88:89], v[60:61] op_sel:[0,0,1] op_sel_hi:[1,1,1] neg_lo:[0,1,0] neg_hi:[0,1,0]
    v_pk_fma_f32 v[70:71], v[166:167], s[88:89], v[56:57] op_sel_hi:[1,1,0]
    v_pk_fma_f32 v[102:103], v[182:183], s[88:89], v[60:61] op_sel_hi:[1,1,0]
    v_pk_fma_f32 v[86:87], v[166:167], s[88:89], v[56:57] op_sel:[0,0,1] op_sel_hi:[1,1,1] neg_lo:[0,1,0] neg_hi:[0,1,0]
    v_pk_fma_f32 v[118:119], v[182:183], s[88:89], v[60:61] op_sel:[0,0,1] op_sel_hi:[1,1,1] neg_lo:[0,1,0] neg_hi:[0,1,0]
    v_pk_fma_f32 v[72:73], v[168:169], s[88:89], v[56:57] op_sel_hi:[1,1,0]
    v_pk_fma_f32 v[104:105], v[184:185], s[88:89], v[60:61] op_sel_hi:[1,1,0]
    v_pk_fma_f32 v[88:89], v[168:169], s[88:89], v[56:57] op_sel:[0,0,1] op_sel_hi:[1,1,1] neg_lo:[0,1,0] neg_hi:[0,1,0]
    v_pk_fma_f32 v[120:121], v[184:185], s[88:89], v[60:61] op_sel:[0,0,1] op_sel_hi:[1,1,1] neg_lo:[0,1,0] neg_hi:[0,1,0]
    v_pk_fma_f32 v[74:75], v[170:171], s[88:89], v[56:57] op_sel_hi:[1,1,0]
    v_pk_fma_f32 v[106:107], v[186:187], s[88:89], v[60:61] op_sel_hi:[1,1,0]
    v_pk_fma_f32 v[90:91], v[170:171], s[88:89], v[56:57] op_sel:[0,0,1] op_sel_hi:[1,1,1] neg_lo:[0,1,0] neg_hi:[0,1,0]
    v_pk_fma_f32 v[122:123], v[186:187], s[88:89], v[60:61] op_sel:[0,0,1] op_sel_hi:[1,1,1] neg_lo:[0,1,0] neg_hi:[0,1,0]
    v_pk_fma_f32 v[76:77], v[172:173], s[88:89], v[56:57] op_sel_hi:[1,1,0]
    v_pk_fma_f32 v[108:109], v[188:189], s[88:89], v[60:61] op_sel_hi:[1,1,0]
    v_pk_fma_f32 v[92:93], v[172:173], s[88:89], v[56:57] op_sel:[0,0,1] op_sel_hi:[1,1,1] neg_lo:[0,1,0] neg_hi:[0,1,0]
    v_pk_fma_f32 v[124:125], v[188:189], s[88:89], v[60:61] op_sel:[0,0,1] op_sel_hi:[1,1,1] neg_lo:[0,1,0] neg_hi:[0,1,0]
    ds_write_b128 v248, v[48:51] offset:2048
    v_pk_fma_f32 v[78:79], v[174:175], s[88:89], v[56:57] op_sel_hi:[1,1,0]
    v_pk_fma_f32 v[110:111], v[190:191], s[88:89], v[60:61] op_sel_hi:[1,1,0]
    v_pk_fma_f32 v[94:95], v[174:175], s[88:89], v[56:57] op_sel:[0,0,1] op_sel_hi:[1,1,1] neg_lo:[0,1,0] neg_hi:[0,1,0]
    v_pk_fma_f32 v[126:127], v[190:191], s[88:89], v[60:61] op_sel:[0,0,1] op_sel_hi:[1,1,1] neg_lo:[0,1,0] neg_hi:[0,1,0]
    v_exp_f32 v64, v64
    v_exp_f32 v96, v96
    v_exp_f32 v80, v80
    v_exp_f32 v112, v112
    v_exp_f32 v65, v65
    v_exp_f32 v97, v97
    v_exp_f32 v81, v81
    v_exp_f32 v113, v113
    v_exp_f32 v66, v66
    v_exp_f32 v98, v98
    v_exp_f32 v82, v82
    v_exp_f32 v114, v114
    v_exp_f32 v67, v67
    v_exp_f32 v99, v99
    v_exp_f32 v83, v83
    v_exp_f32 v115, v115
    v_exp_f32 v68, v68
    v_exp_f32 v100, v100
    v_exp_f32 v84, v84
    v_exp_f32 v116, v116
    ds_write_b128 v248, v[52:55] offset:3072
    v_exp_f32 v69, v69
    v_exp_f32 v101, v101
    v_exp_f32 v85, v85
    v_exp_f32 v117, v117
    v_exp_f32 v70, v70
    v_exp_f32 v102, v102
    v_exp_f32 v86, v86
    v_exp_f32 v118, v118
    v_exp_f32 v71, v71
    v_exp_f32 v103, v103
    v_exp_f32 v87, v87
    v_exp_f32 v119, v119
    v_exp_f32 v72, v72
    v_exp_f32 v104, v104
    v_exp_f32 v88, v88
    v_exp_f32 v120, v120
    v_exp_f32 v73, v73
    v_exp_f32 v105, v105
    v_exp_f32 v89, v89
    v_exp_f32 v121, v121
    v_exp_f32 v74, v74
    v_exp_f32 v106, v106
    v_exp_f32 v90, v90
    v_exp_f32 v122, v122
    ds_read_b128 v[192:195], v242 offset:0
    v_exp_f32 v75, v75
    v_exp_f32 v107, v107
    v_exp_f32 v91, v91
    v_exp_f32 v123, v123
    v_exp_f32 v76, v76
    v_exp_f32 v108, v108
    v_exp_f32 v92, v92
    v_exp_f32 v124, v124
    v_exp_f32 v77, v77
    v_exp_f32 v109, v109
    v_exp_f32 v93, v93
    v_exp_f32 v125, v125
    v_exp_f32 v78, v78
    v_exp_f32 v110, v110
    v_exp_f32 v94, v94
    v_exp_f32 v126, v126
    v_exp_f32 v79, v79
    v_exp_f32 v111, v111
    v_exp_f32 v95, v95
    v_exp_f32 v127, v127
    v_pk_add_f32 v[56:57], v[64:65], v[66:67]
    v_pk_add_f32 v[60:61], v[96:97], v[98:99]
    v_pk_add_f32 v[58:59], v[80:81], v[82:83]
    v_pk_add_f32 v[62:63], v[112:113], v[114:115]
    ds_read_b128 v[196:199], v242 offset:64
    v_pk_add_f32 v[56:57], v[56:57], v[68:69]
    v_pk_add_f32 v[60:61], v[60:61], v[100:101]
    v_pk_add_f32 v[58:59], v[58:59], v[84:85]
    v_pk_add_f32 v[62:63], v[62:63], v[116:117]
    v_pk_add_f32 v[56:57], v[56:57], v[70:71]
    v_pk_add_f32 v[60:61], v[60:61], v[102:103]
    v_pk_add_f32 v[58:59], v[58:59], v[86:87]
    v_pk_add_f32 v[62:63], v[62:63], v[118:119]
    v_pk_add_f32 v[56:57], v[56:57], v[72:73]
    v_pk_add_f32 v[60:61], v[60:61], v[104:105]
    v_pk_add_f32 v[58:59], v[58:59], v[88:89]
    v_pk_add_f32 v[62:63], v[62:63], v[120:121]
    v_pk_add_f32 v[56:57], v[56:57], v[74:75]
    v_pk_add_f32 v[60:61], v[60:61], v[106:107]
    v_pk_add_f32 v[58:59], v[58:59], v[90:91]
    v_pk_add_f32 v[62:63], v[62:63], v[122:123]
    v_pk_add_f32 v[56:57], v[56:57], v[76:77]
    v_pk_add_f32 v[60:61], v[60:61], v[108:109]
    v_pk_add_f32 v[58:59], v[58:59], v[92:93]
    v_pk_add_f32 v[62:63], v[62:63], v[124:125]
    v_pk_add_f32 v[56:57], v[56:57], v[78:79]
    v_pk_add_f32 v[60:61], v[60:61], v[110:111]
    v_pk_add_f32 v[58:59], v[58:59], v[94:95]
    v_pk_add_f32 v[62:63], v[62:63], v[126:127]
    v_add_f32 v56, v56, v57
    v_add_f32 v60, v60, v61
    v_add_f32 v57, v58, v59
    v_add_f32 v61, v62, v63
    s_nop 0
    v_permlane32_swap_b32 v56, v57
    v_permlane32_swap_b32 v60, v61
    v_add_f32 v56, v56, v57
    v_add_f32 v60, v60, v61
    v_rcp_f32 v56, v56
    v_rcp_f32 v60, v60
    v_mov_b32 v57, v56
    v_mov_b32 v61, v60
    s_nop 0
    v_permlane32_swap_b32 v56, v57
    v_permlane32_swap_b32 v60, v61
    v_pk_mul_f32 v[64:65], v[64:65], v[56:57] op_sel_hi:[1,0]
    v_pk_mul_f32 v[96:97], v[96:97], v[60:61] op_sel_hi:[1,0]
    v_pk_mul_f32 v[66:67], v[66:67], v[56:57] op_sel_hi:[1,0]
    v_pk_mul_f32 v[98:99], v[98:99], v[60:61] op_sel_hi:[1,0]
    v_pk_mul_f32 v[68:69], v[68:69], v[56:57] op_sel_hi:[1,0]
    v_pk_mul_f32 v[100:101], v[100:101], v[60:61] op_sel_hi:[1,0]
    v_pk_mul_f32 v[70:71], v[70:71], v[56:57] op_sel_hi:[1,0]
    v_pk_mul_f32 v[102:103], v[102:103], v[60:61] op_sel_hi:[1,0]
    v_cvt_pk_bf16_f32 v160, v64, v65
    v_cvt_pk_bf16_f32 v176, v96, v97
    v_cvt_pk_bf16_f32 v161, v66, v67
    v_cvt_pk_bf16_f32 v177, v98, v99
    v_cvt_pk_bf16_f32 v162, v68, v69
    v_cvt_pk_bf16_f32 v178, v100, v101
    v_cvt_pk_bf16_f32 v163, v70, v71
    v_cvt_pk_bf16_f32 v179, v102, v103
    ds_write_b128 v245, v[160:163] offset:0
    ds_write_b128 v245, v[176:179] offset:4096
    v_pk_mul_f32 v[72:73], v[72:73], v[56:57] op_sel_hi:[1,0]
    v_pk_mul_f32 v[104:105], v[104:105], v[60:61] op_sel_hi:[1,0]
    v_pk_mul_f32 v[74:75], v[74:75], v[56:57] op_sel_hi:[1,0]
    v_pk_mul_f32 v[106:107], v[106:107], v[60:61] op_sel_hi:[1,0]
    v_pk_mul_f32 v[76:77], v[76:77], v[56:57] op_sel_hi:[1,0]
    v_pk_mul_f32 v[108:109], v[108:109], v[60:61] op_sel_hi:[1,0]
    v_pk_mul_f32 v[78:79], v[78:79], v[56:57] op_sel_hi:[1,0]
    v_pk_mul_f32 v[110:111], v[110:111], v[60:61] op_sel_hi:[1,0]
    v_cvt_pk_bf16_f32 v164, v72, v73
    v_cvt_pk_bf16_f32 v180, v104, v105
    v_cvt_pk_bf16_f32 v165, v74, v75
    v_cvt_pk_bf16_f32 v181, v106, v107
    v_cvt_pk_bf16_f32 v166, v76, v77
    v_cvt_pk_bf16_f32 v182, v108, v109
    v_cvt_pk_bf16_f32 v167, v78, v79
    v_cvt_pk_bf16_f32 v183, v110, v111
    ds_write_b128 v246, v[164:167] offset:1024
    ds_write_b128 v246, v[180:183] offset:5120
    v_pk_mul_f32 v[80:81], v[80:81], v[56:57] op_sel:[0,1] op_sel_hi:[1,1]
    v_pk_mul_f32 v[112:113], v[112:113], v[60:61] op_sel:[0,1] op_sel_hi:[1,1]
    v_pk_mul_f32 v[82:83], v[82:83], v[56:57] op_sel:[0,1] op_sel_hi:[1,1]
    v_pk_mul_f32 v[114:115], v[114:115], v[60:61] op_sel:[0,1] op_sel_hi:[1,1]
    v_pk_mul_f32 v[84:85], v[84:85], v[56:57] op_sel:[0,1] op_sel_hi:[1,1]
    v_pk_mul_f32 v[116:117], v[116:117], v[60:61] op_sel:[0,1] op_sel_hi:[1,1]
    v_pk_mul_f32 v[86:87], v[86:87], v[56:57] op_sel:[0,1] op_sel_hi:[1,1]
    v_pk_mul_f32 v[118:119], v[118:119], v[60:61] op_sel:[0,1] op_sel_hi:[1,1]
    v_cvt_pk_bf16_f32 v168, v80, v81
    v_cvt_pk_bf16_f32 v184, v112, v113
    v_cvt_pk_bf16_f32 v169, v82, v83
    v_cvt_pk_bf16_f32 v185, v114, v115
    v_cvt_pk_bf16_f32 v170, v84, v85
    v_cvt_pk_bf16_f32 v186, v116, v117
    v_cvt_pk_bf16_f32 v171, v86, v87
    v_cvt_pk_bf16_f32 v187, v118, v119
    ds_write_b128 v245, v[168:171] offset:2048
    ds_write_b128 v245, v[184:187] offset:6144
    v_pk_mul_f32 v[88:89], v[88:89], v[56:57] op_sel:[0,1] op_sel_hi:[1,1]
    v_pk_mul_f32 v[120:121], v[120:121], v[60:61] op_sel:[0,1] op_sel_hi:[1,1]
    v_pk_mul_f32 v[90:91], v[90:91], v[56:57] op_sel:[0,1] op_sel_hi:[1,1]
    v_pk_mul_f32 v[122:123], v[122:123], v[60:61] op_sel:[0,1] op_sel_hi:[1,1]
    v_pk_mul_f32 v[92:93], v[92:93], v[56:57] op_sel:[0,1] op_sel_hi:[1,1]
    v_pk_mul_f32 v[124:125], v[124:125], v[60:61] op_sel:[0,1] op_sel_hi:[1,1]
    v_pk_mul_f32 v[94:95], v[94:95], v[56:57] op_sel:[0,1] op_sel_hi:[1,1]
    v_pk_mul_f32 v[126:127], v[126:127], v[60:61] op_sel:[0,1] op_sel_hi:[1,1]
    v_cvt_pk_bf16_f32 v172, v88, v89
    v_cvt_pk_bf16_f32 v188, v120, v121
    v_cvt_pk_bf16_f32 v173, v90, v91
    v_cvt_pk_bf16_f32 v189, v122, v123
    v_cvt_pk_bf16_f32 v174, v92, v93
    v_cvt_pk_bf16_f32 v190, v124, v125
    v_cvt_pk_bf16_f32 v175, v94, v95
    v_cvt_pk_bf16_f32 v191, v126, v127
    ds_write_b128 v246, v[172:175] offset:3072
    ds_write_b128 v246, v[188:191] offset:7168
    s_waitcnt lgkmcnt(0)
    s_barrier
    ds_read_b64_tr_b16 v[64:65], v249 offset:0
    ds_read_b64_tr_b16 v[66:67], v250 offset:0
    ds_read_b128 v[96:99], v247 offset:0
    ds_read_b64_tr_b16 v[68:69], v249 offset:256
    ds_read_b64_tr_b16 v[70:71], v250 offset:256
    ds_read_b128 v[100:103], v247 offset:1024
    ds_read_b64_tr_b16 v[72:73], v249 offset:4096
    ds_read_b64_tr_b16 v[74:75], v250 offset:4096
    ds_read_b128 v[104:107], v247 offset:2048
    ds_read_b64_tr_b16 v[76:77], v249 offset:4352
    ds_read_b64_tr_b16 v[78:79], v250 offset:4352
    ds_read_b128 v[108:111], v247 offset:3072
    ds_read_b64_tr_b16 v[80:81], v249 offset:8192
    ds_read_b64_tr_b16 v[82:83], v250 offset:8192
    ds_read_b128 v[112:115], v247 offset:4096
    s_waitcnt lgkmcnt(12)
    v_mfma_f32_32x32x16_bf16 v[160:175], v[64:67], v[96:99], 0
    ds_read_b64_tr_b16 v[84:85], v249 offset:8448
    ds_read_b64_tr_b16 v[86:87], v250 offset:8448
    ds_read_b128 v[116:119], v247 offset:5120
    s_waitcnt lgkmcnt(12)
    v_mfma_f32_32x32x16_bf16 v[160:175], v[68:71], v[100:103], v[160:175]
    ds_read_b64_tr_b16 v[88:89], v249 offset:12288
    ds_read_b64_tr_b16 v[90:91], v250 offset:12288
    ds_read_b128 v[120:123], v247 offset:6144
    s_waitcnt lgkmcnt(12)
    v_mfma_f32_32x32x16_bf16 v[160:175], v[72:75], v[104:107], v[160:175]
    ds_read_b64_tr_b16 v[92:93], v249 offset:12544
    ds_read_b64_tr_b16 v[94:95], v250 offset:12544
    ds_read_b128 v[124:127], v247 offset:7168
    s_waitcnt lgkmcnt(12)
    v_mfma_f32_32x32x16_bf16 v[160:175], v[76:79], v[108:111], v[160:175]
    s_waitcnt lgkmcnt(9)
    v_mfma_f32_32x32x16_bf16 v[160:175], v[80:83], v[112:115], v[160:175]
    s_waitcnt lgkmcnt(6)
    v_mfma_f32_32x32x16_bf16 v[160:175], v[84:87], v[116:119], v[160:175]
    s_waitcnt lgkmcnt(3)
    v_mfma_f32_32x32x16_bf16 v[160:175], v[88:91], v[120:123], v[160:175]
    s_waitcnt lgkmcnt(0)
    v_mfma_f32_32x32x16_bf16 v[160:175], v[92:95], v[124:127], v[160:175]
    v_mfma_f32_32x32x16_bf16 v[176:191], v[64:67], v[4:7], 0
    v_mfma_f32_32x32x16_bf16 v[176:191], v[68:71], v[4:7], v[176:191]
    v_mfma_f32_32x32x16_bf16 v[176:191], v[72:75], v[4:7], v[176:191]
    s_nop 7
    s_nop 1
    v_cvt_pk_bf16_f32 v212, v160, v161
    v_cvt_pk_bf16_f32 v213, v162, v163
    v_cvt_pk_bf16_f32 v214, v164, v165
    v_cvt_pk_bf16_f32 v215, v166, v167
    buffer_store_dwordx4 v[212:215], v14, s[24:27], s58 offen sc1
    v_mfma_f32_32x32x16_bf16 v[176:191], v[76:79], v[4:7], v[176:191]
    v_cvt_pk_bf16_f32 v216, v168, v169
    v_cvt_pk_bf16_f32 v217, v170, v171
    v_cvt_pk_bf16_f32 v218, v172, v173
    v_cvt_pk_bf16_f32 v219, v174, v175
    buffer_store_dwordx4 v[216:219], v14, s[24:27], s59 offen sc1
    v_mfma_f32_32x32x16_bf16 v[176:191], v[80:83], v[4:7], v[176:191]
    v_mfma_f32_32x32x16_bf16 v[176:191], v[84:87], v[4:7], v[176:191]
    v_mfma_f32_32x32x16_bf16 v[176:191], v[88:91], v[4:7], v[176:191]
    v_mfma_f32_32x32x16_bf16 v[176:191], v[92:95], v[4:7], v[176:191]
    s_barrier
    s_nop 7
    s_nop 2
    v_cvt_pk_bf16_f32 v16, v176, v177
    v_cvt_pk_bf16_f32 v17, v178, v179
    v_cvt_pk_bf16_f32 v18, v180, v181
    v_cvt_pk_bf16_f32 v19, v182, v183
    v_cvt_pk_bf16_f32 v20, v184, v185
    v_cvt_pk_bf16_f32 v21, v186, v187
    v_cvt_pk_bf16_f32 v22, v188, v189
    v_cvt_pk_bf16_f32 v23, v190, v191
    s_mov_b32 exec_lo, 1
    s_mov_b32 exec_hi, 1
    buffer_store_dwordx4 v[16:19], v251, s[24:27], s60 offen sc1
    buffer_store_dwordx4 v[20:23], v251, s[24:27], s60 offen offset:512 sc1
    s_mov_b64 exec, -1
    v_pk_mul_f32 v[48:49], v[192:193], v[232:233] op_sel_hi:[1,0]
    v_pk_mul_f32 v[50:51], v[194:195], v[232:233] op_sel_hi:[1,0]
    v_pk_mul_f32 v[52:53], v[192:193], v[234:235] op_sel_hi:[1,0]
    v_pk_mul_f32 v[54:55], v[194:195], v[234:235] op_sel_hi:[1,0]
    v_pk_fma_f32 v[128:129], v[128:129], v[232:233], v[48:49] op_sel:[0,1,0] op_sel_hi:[1,1,1]
    v_pk_fma_f32 v[130:131], v[130:131], v[232:233], v[50:51] op_sel:[0,1,0] op_sel_hi:[1,1,1]
    v_pk_fma_f32 v[132:133], v[132:133], v[234:235], v[52:53] op_sel:[0,1,0] op_sel_hi:[1,1,1]
    v_pk_fma_f32 v[134:135], v[134:135], v[234:235], v[54:55] op_sel:[0,1,0] op_sel_hi:[1,1,1]
    v_pk_mul_f32 v[48:49], v[196:197], v[232:233] op_sel_hi:[1,0]
    v_pk_mul_f32 v[50:51], v[198:199], v[232:233] op_sel_hi:[1,0]
    v_pk_mul_f32 v[52:53], v[196:197], v[234:235] op_sel_hi:[1,0]
    v_pk_mul_f32 v[54:55], v[198:199], v[234:235] op_sel_hi:[1,0]
    v_pk_fma_f32 v[136:137], v[136:137], v[232:233], v[48:49] op_sel:[0,1,0] op_sel_hi:[1,1,1]
    v_pk_fma_f32 v[138:139], v[138:139], v[232:233], v[50:51] op_sel:[0,1,0] op_sel_hi:[1,1,1]
    v_pk_fma_f32 v[140:141], v[140:141], v[234:235], v[52:53] op_sel:[0,1,0] op_sel_hi:[1,1,1]
    v_pk_fma_f32 v[142:143], v[142:143], v[234:235], v[54:55] op_sel:[0,1,0] op_sel_hi:[1,1,1]
    v_pk_mul_f32 v[48:49], v[192:193], v[236:237] op_sel_hi:[1,0]
    v_pk_mul_f32 v[50:51], v[194:195], v[236:237] op_sel_hi:[1,0]
    v_pk_mul_f32 v[52:53], v[192:193], v[238:239] op_sel_hi:[1,0]
    v_pk_mul_f32 v[54:55], v[194:195], v[238:239] op_sel_hi:[1,0]
    v_pk_fma_f32 v[144:145], v[144:145], v[236:237], v[48:49] op_sel:[0,1,0] op_sel_hi:[1,1,1]
    v_pk_fma_f32 v[146:147], v[146:147], v[236:237], v[50:51] op_sel:[0,1,0] op_sel_hi:[1,1,1]
    v_pk_fma_f32 v[148:149], v[148:149], v[238:239], v[52:53] op_sel:[0,1,0] op_sel_hi:[1,1,1]
    v_pk_fma_f32 v[150:151], v[150:151], v[238:239], v[54:55] op_sel:[0,1,0] op_sel_hi:[1,1,1]
    v_pk_mul_f32 v[48:49], v[196:197], v[236:237] op_sel_hi:[1,0]
    v_pk_mul_f32 v[50:51], v[198:199], v[236:237] op_sel_hi:[1,0]
    v_pk_mul_f32 v[52:53], v[196:197], v[238:239] op_sel_hi:[1,0]
    v_pk_mul_f32 v[54:55], v[198:199], v[238:239] op_sel_hi:[1,0]
    v_pk_fma_f32 v[152:153], v[152:153], v[236:237], v[48:49] op_sel:[0,1,0] op_sel_hi:[1,1,1]
    v_pk_fma_f32 v[154:155], v[154:155], v[236:237], v[50:51] op_sel:[0,1,0] op_sel_hi:[1,1,1]
    v_pk_fma_f32 v[156:157], v[156:157], v[238:239], v[52:53] op_sel:[0,1,0] op_sel_hi:[1,1,1]
    v_pk_fma_f32 v[158:159], v[158:159], v[238:239], v[54:55] op_sel:[0,1,0] op_sel_hi:[1,1,1]
    v_cvt_pk_bf16_f32 v32, v128, v129
    v_cvt_pk_bf16_f32 v33, v130, v131
    v_cvt_pk_bf16_f32 v34, v132, v133
    v_cvt_pk_bf16_f32 v35, v134, v135
    v_cvt_pk_bf16_f32 v36, v136, v137
    v_cvt_pk_bf16_f32 v37, v138, v139
    v_cvt_pk_bf16_f32 v38, v140, v141
    v_cvt_pk_bf16_f32 v39, v142, v143
    v_permlane16_swap_b32 v32, v34
    v_permlane16_swap_b32 v33, v35
    v_permlane16_swap_b32 v36, v38
    v_permlane16_swap_b32 v37, v39
    v_cvt_pk_bf16_f32 v40, v144, v145
    v_cvt_pk_bf16_f32 v41, v146, v147
    v_cvt_pk_bf16_f32 v42, v148, v149
    v_cvt_pk_bf16_f32 v43, v150, v151
    v_cvt_pk_bf16_f32 v44, v152, v153
    v_cvt_pk_bf16_f32 v45, v154, v155
    v_cvt_pk_bf16_f32 v46, v156, v157
    v_cvt_pk_bf16_f32 v47, v158, v159
    v_permlane16_swap_b32 v40, v42
    v_permlane16_swap_b32 v41, v43
    v_permlane16_swap_b32 v44, v46
    v_permlane16_swap_b32 v45, v47
    v_mfma_f32_32x32x16_bf16 v[160:175], v[224:227], v[32:35], 0
    v_mfma_f32_32x32x16_bf16 v[160:175], v[228:231], v[36:39], v[160:175]
    v_mfma_f32_32x32x16_bf16 v[176:191], v[224:227], v[40:43], 0
    v_mfma_f32_32x32x16_bf16 v[176:191], v[228:231], v[44:47], v[176:191]
    s_and_b32 s56, s2, 7
    s_lshr_b32 s57, s2, 3
    s_and_b32 s58, s57, 3
    s_lshr_b32 s59, s57, 2
    s_lshr_b32 s4, s56, 1
    s_mul_i32 s4, s4, 4
    s_add_u32 s4, s4, s58
    s_and_b32 s5, s56, 1
    s_mul_i32 s5, s5, 8
    s_add_u32 s5, s5, s59
    s_add_u32 s6, s58, s59
    s_lshl_b32 s56, s4, 2
    s_add_u32 s56, s56, s3
    s_lshl_b32 s57, s56, 16
    s_lshl_b32 s58, s5, 7
    s_add_u32 s58, s58, s57
    v_and_b32 v4, 31, v1
    v_lshlrev_b32 v14, 11, v4
    v_lshrrev_b32 v5, 5, v1
    v_lshl_add_u32 v14, v5, 4, v14
    v_add_u32 v14, s58, v14
    buffer_load_dwordx4 v[224:227], v14, s[20:23], 0 offen offset:0
    buffer_load_dwordx4 v[228:231], v14, s[20:23], 0 offen offset:32
    buffer_load_dwordx4 v[232:235], v14, s[20:23], 0 offen offset:64
    buffer_load_dwordx4 v[236:239], v14, s[20:23], 0 offen offset:96
    s_lshl_b32 s58, s5, 12
    s_add_u32 s58, s58, s57
    s_add_u32 s58, s58, 8388608
    v_add_u32 v7, s58, v15
    s_lshl_b32 s56, s56, 8
    s_lshl_b32 s57, s5, 14
    s_add_u32 s56, s56, s57
    s_add_u32 s56, s56, 41943040
    v_lshlrev_b32 v9, 3, v4
    v_add_u32 v9, s56, v9
    s_lshl_b32 s56, s73, 12
    v_add_u32 v2, s56, v15
    s_lshl_b32 s56, s73, 7
    v_add_u32 v3, s56, v252
    s_mov_b32 s16, s46
    s_mov_b32 s17, s47
    s_mov_b32 s18, 4096
    s_mov_b32 s19, 0x20000
    v_and_b32 v4, 15, v1
    v_lshlrev_b32 v4, 1, v4
    s_lshl_b32 s58, s4, 8
    s_lshl_b32 s59, s72, 7
    s_add_u32 s58, s58, s59
    buffer_load_ushort v240, v4, s[16:19], s58 offen offset:0
    buffer_load_ushort v241, v4, s[16:19], s58 offen offset:32
    buffer_load_ushort v242, v4, s[16:19], s58 offen offset:64
    buffer_load_ushort v243, v4, s[16:19], s58 offen offset:96
    v_max3_f32 v56, v160, v161, v162
    v_max3_f32 v60, v176, v177, v178
    v_min3_f32 v57, v160, v161, v162
    v_min3_f32 v61, v176, v177, v178
    v_max3_f32 v56, v56, v163, v164
    v_max3_f32 v60, v60, v179, v180
    v_min3_f32 v57, v57, v163, v164
    v_min3_f32 v61, v61, v179, v180
    v_max3_f32 v56, v56, v165, v166
    v_max3_f32 v60, v60, v181, v182
    v_min3_f32 v57, v57, v165, v166
    v_min3_f32 v61, v61, v181, v182
    v_max3_f32 v56, v56, v167, v168
    v_max3_f32 v60, v60, v183, v184
    v_min3_f32 v57, v57, v167, v168
    v_min3_f32 v61, v61, v183, v184
    v_max3_f32 v56, v56, v169, v170
    v_max3_f32 v60, v60, v185, v186
    v_min3_f32 v57, v57, v169, v170
    v_min3_f32 v61, v61, v185, v186
    v_max3_f32 v56, v56, v171, v172
    v_max3_f32 v60, v60, v187, v188
    v_min3_f32 v57, v57, v171, v172
    v_min3_f32 v61, v61, v187, v188
    v_max3_f32 v56, v56, v173, v174
    v_max3_f32 v60, v60, v189, v190
    v_min3_f32 v57, v57, v173, v174
    v_min3_f32 v61, v61, v189, v190
    v_max_f32 v56, v56, v175
    v_max_f32 v60, v60, v191
    v_max_f32 v57, -v57, -v175
    v_max_f32 v61, -v61, -v191
    s_nop 0
    v_permlane32_swap_b32 v56, v57
    v_permlane32_swap_b32 v60, v61
    v_max_f32 v56, v56, v57
    v_max_f32 v60, v60, v61
    v_mul_f32 v56, 3216550459, v56
    v_mul_f32 v60, 3216550459, v60
    v_mov_b32 v57, v56
    v_mov_b32 v61, v60
    s_nop 0
    v_permlane32_swap_b32 v56, v57
    v_permlane32_swap_b32 v60, v61
    v_pk_fma_f32 v[64:65], v[160:161], s[88:89], v[56:57] op_sel_hi:[1,1,0]
    v_pk_fma_f32 v[96:97], v[176:177], s[88:89], v[60:61] op_sel_hi:[1,1,0]
    v_pk_fma_f32 v[80:81], v[160:161], s[88:89], v[56:57] op_sel:[0,0,1] op_sel_hi:[1,1,1] neg_lo:[0,1,0] neg_hi:[0,1,0]
    v_pk_fma_f32 v[112:113], v[176:177], s[88:89], v[60:61] op_sel:[0,0,1] op_sel_hi:[1,1,1] neg_lo:[0,1,0] neg_hi:[0,1,0]
    v_pk_fma_f32 v[66:67], v[162:163], s[88:89], v[56:57] op_sel_hi:[1,1,0]
    v_pk_fma_f32 v[98:99], v[178:179], s[88:89], v[60:61] op_sel_hi:[1,1,0]
    v_pk_fma_f32 v[82:83], v[162:163], s[88:89], v[56:57] op_sel:[0,0,1] op_sel_hi:[1,1,1] neg_lo:[0,1,0] neg_hi:[0,1,0]
    v_pk_fma_f32 v[114:115], v[178:179], s[88:89], v[60:61] op_sel:[0,0,1] op_sel_hi:[1,1,1] neg_lo:[0,1,0] neg_hi:[0,1,0]
    v_pk_fma_f32 v[68:69], v[164:165], s[88:89], v[56:57] op_sel_hi:[1,1,0]
    v_pk_fma_f32 v[100:101], v[180:181], s[88:89], v[60:61] op_sel_hi:[1,1,0]
    v_pk_fma_f32 v[84:85], v[164:165], s[88:89], v[56:57] op_sel:[0,0,1] op_sel_hi:[1,1,1] neg_lo:[0,1,0] neg_hi:[0,1,0]
    v_pk_fma_f32 v[116:117], v[180:181], s[88:89], v[60:61] op_sel:[0,0,1] op_sel_hi:[1,1,1] neg_lo:[0,1,0] neg_hi:[0,1,0]
    v_pk_fma_f32 v[70:71], v[166:167], s[88:89], v[56:57] op_sel_hi:[1,1,0]
    v_pk_fma_f32 v[102:103], v[182:183], s[88:89], v[60:61] op_sel_hi:[1,1,0]
    v_pk_fma_f32 v[86:87], v[166:167], s[88:89], v[56:57] op_sel:[0,0,1] op_sel_hi:[1,1,1] neg_lo:[0,1,0] neg_hi:[0,1,0]
L_pad9:
    s_cbranch_execz L_padr9
    v_pk_fma_f32 v[118:119], v[182:183], s[88:89], v[60:61] op_sel:[0,0,1] op_sel_hi:[1,1,1] neg_lo:[0,1,0] neg_hi:[0,1,0]
    v_pk_fma_f32 v[72:73], v[168:169], s[88:89], v[56:57] op_sel_hi:[1,1,0]
    v_pk_fma_f32 v[104:105], v[184:185], s[88:89], v[60:61] op_sel_hi:[1,1,0]
    v_pk_fma_f32 v[88:89], v[168:169], s[88:89], v[56:57] op_sel:[0,0,1] op_sel_hi:[1,1,1] neg_lo:[0,1,0] neg_hi:[0,1,0]
    v_pk_fma_f32 v[120:121], v[184:185], s[88:89], v[60:61] op_sel:[0,0,1] op_sel_hi:[1,1,1] neg_lo:[0,1,0] neg_hi:[0,1,0]
    v_pk_fma_f32 v[74:75], v[170:171], s[88:89], v[56:57] op_sel_hi:[1,1,0]
    v_pk_fma_f32 v[106:107], v[186:187], s[88:89], v[60:61] op_sel_hi:[1,1,0]
    v_pk_fma_f32 v[90:91], v[170:171], s[88:89], v[56:57] op_sel:[0,0,1] op_sel_hi:[1,1,1] neg_lo:[0,1,0] neg_hi:[0,1,0]
    v_pk_fma_f32 v[122:123], v[186:187], s[88:89], v[60:61] op_sel:[0,0,1] op_sel_hi:[1,1,1] neg_lo:[0,1,0] neg_hi:[0,1,0]
    v_pk_fma_f32 v[76:77], v[172:173], s[88:89], v[56:57] op_sel_hi:[1,1,0]
    v_pk_fma_f32 v[108:109], v[188:189], s[88:89], v[60:61] op_sel_hi:[1,1,0]
    v_pk_fma_f32 v[92:93], v[172:173], s[88:89], v[56:57] op_sel:[0,0,1] op_sel_hi:[1,1,1] neg_lo:[0,1,0] neg_hi:[0,1,0]
    v_pk_fma_f32 v[124:125], v[188:189], s[88:89], v[60:61] op_sel:[0,0,1] op_sel_hi:[1,1,1] neg_lo:[0,1,0] neg_hi:[0,1,0]
    v_pk_fma_f32 v[78:79], v[174:175], s[88:89], v[56:57] op_sel_hi:[1,1,0]
    v_pk_fma_f32 v[110:111], v[190:191], s[88:89], v[60:61] op_sel_hi:[1,1,0]
    v_pk_fma_f32 v[94:95], v[174:175], s[88:89], v[56:57] op_sel:[0,0,1] op_sel_hi:[1,1,1] neg_lo:[0,1,0] neg_hi:[0,1,0]
    v_pk_fma_f32 v[126:127], v[190:191], s[88:89], v[60:61] op_sel:[0,0,1] op_sel_hi:[1,1,1] neg_lo:[0,1,0] neg_hi:[0,1,0]
    v_exp_f32 v64, v64
    v_exp_f32 v96, v96
    v_exp_f32 v80, v80
    v_exp_f32 v112, v112
    v_exp_f32 v65, v65
    v_exp_f32 v97, v97
    v_exp_f32 v81, v81
    v_exp_f32 v113, v113
    v_exp_f32 v66, v66
    v_exp_f32 v98, v98
    v_exp_f32 v82, v82
    v_exp_f32 v114, v114
    v_exp_f32 v67, v67
    v_exp_f32 v99, v99
    v_exp_f32 v83, v83
    v_exp_f32 v115, v115
    v_exp_f32 v68, v68
    v_exp_f32 v100, v100
    v_exp_f32 v84, v84
    v_exp_f32 v116, v116
    v_exp_f32 v69, v69
    v_exp_f32 v101, v101
    v_exp_f32 v85, v85
    v_exp_f32 v117, v117
    v_exp_f32 v70, v70
    v_exp_f32 v102, v102
    v_exp_f32 v86, v86
    v_exp_f32 v118, v118
    v_exp_f32 v71, v71
    v_exp_f32 v103, v103
    v_exp_f32 v87, v87
    v_exp_f32 v119, v119
    v_exp_f32 v72, v72
    v_exp_f32 v104, v104
    v_exp_f32 v88, v88
    v_exp_f32 v120, v120
    v_exp_f32 v73, v73
    v_exp_f32 v105, v105
    v_exp_f32 v89, v89
    v_exp_f32 v121, v121
    v_exp_f32 v74, v74
    v_exp_f32 v106, v106
    v_exp_f32 v90, v90
    v_exp_f32 v122, v122
    v_exp_f32 v75, v75
    v_exp_f32 v107, v107
    v_exp_f32 v91, v91
    v_exp_f32 v123, v123
    v_exp_f32 v76, v76
    v_exp_f32 v108, v108
    v_exp_f32 v92, v92
    v_exp_f32 v124, v124
    v_exp_f32 v77, v77
    v_exp_f32 v109, v109
    v_exp_f32 v93, v93
    v_exp_f32 v125, v125
    v_exp_f32 v78, v78
    v_exp_f32 v110, v110
    v_exp_f32 v94, v94
    v_exp_f32 v126, v126
    v_exp_f32 v79, v79
    v_exp_f32 v111, v111
    v_exp_f32 v95, v95
    v_exp_f32 v127, v127
    v_pk_add_f32 v[56:57], v[64:65], v[66:67]
    v_pk_add_f32 v[60:61], v[96:97], v[98:99]
    v_pk_add_f32 v[58:59], v[80:81], v[82:83]
    v_pk_add_f32 v[62:63], v[112:113], v[114:115]
    v_pk_add_f32 v[56:57], v[56:57], v[68:69]
    v_pk_add_f32 v[60:61], v[60:61], v[100:101]
    v_pk_add_f32 v[58:59], v[58:59], v[84:85]
    v_pk_add_f32 v[62:63], v[62:63], v[116:117]
    v_pk_add_f32 v[56:57], v[56:57], v[70:71]
    v_pk_add_f32 v[60:61], v[60:61], v[102:103]
    v_pk_add_f32 v[58:59], v[58:59], v[86:87]
    v_pk_add_f32 v[62:63], v[62:63], v[118:119]
    v_pk_add_f32 v[56:57], v[56:57], v[72:73]
    v_pk_add_f32 v[60:61], v[60:61], v[104:105]
    v_pk_add_f32 v[58:59], v[58:59], v[88:89]
    v_pk_add_f32 v[62:63], v[62:63], v[120:121]
    v_pk_add_f32 v[56:57], v[56:57], v[74:75]
    v_pk_add_f32 v[60:61], v[60:61], v[106:107]
    v_pk_add_f32 v[58:59], v[58:59], v[90:91]
    v_pk_add_f32 v[62:63], v[62:63], v[122:123]
    v_pk_add_f32 v[56:57], v[56:57], v[76:77]
    v_pk_add_f32 v[60:61], v[60:61], v[108:109]
    v_pk_add_f32 v[58:59], v[58:59], v[92:93]
    v_pk_add_f32 v[62:63], v[62:63], v[124:125]
    v_pk_add_f32 v[56:57], v[56:57], v[78:79]
    v_pk_add_f32 v[60:61], v[60:61], v[110:111]
    v_pk_add_f32 v[58:59], v[58:59], v[94:95]
    v_pk_add_f32 v[62:63], v[62:63], v[126:127]
    v_add_f32 v56, v56, v57
    v_add_f32 v60, v60, v61
    v_add_f32 v57, v58, v59
    v_add_f32 v61, v62, v63
    s_nop 0
    v_permlane32_swap_b32 v56, v57
    v_permlane32_swap_b32 v60, v61
    v_add_f32 v56, v56, v57
    v_add_f32 v60, v60, v61
    v_rcp_f32 v56, v56
    v_rcp_f32 v60, v60
    v_mov_b32 v57, v56
    v_mov_b32 v61, v60
    s_nop 0
    v_permlane32_swap_b32 v56, v57
    v_permlane32_swap_b32 v60, v61
    v_pk_mul_f32 v[64:65], v[64:65], v[56:57] op_sel_hi:[1,0]
    v_pk_mul_f32 v[96:97], v[96:97], v[60:61] op_sel_hi:[1,0]
    v_pk_mul_f32 v[66:67], v[66:67], v[56:57] op_sel_hi:[1,0]
    v_pk_mul_f32 v[98:99], v[98:99], v[60:61] op_sel_hi:[1,0]
    v_pk_mul_f32 v[68:69], v[68:69], v[56:57] op_sel_hi:[1,0]
    v_pk_mul_f32 v[100:101], v[100:101], v[60:61] op_sel_hi:[1,0]
    v_pk_mul_f32 v[70:71], v[70:71], v[56:57] op_sel_hi:[1,0]
    v_pk_mul_f32 v[102:103], v[102:103], v[60:61] op_sel_hi:[1,0]
    v_cvt_pk_bf16_f32 v128, v64, v65
    v_cvt_pk_bf16_f32 v144, v96, v97
    v_cvt_pk_bf16_f32 v129, v66, v67
    v_cvt_pk_bf16_f32 v145, v98, v99
    v_cvt_pk_bf16_f32 v130, v68, v69
    v_cvt_pk_bf16_f32 v146, v100, v101
    v_cvt_pk_bf16_f32 v131, v70, v71
    v_cvt_pk_bf16_f32 v147, v102, v103
    v_pk_mul_f32 v[72:73], v[72:73], v[56:57] op_sel_hi:[1,0]
    v_pk_mul_f32 v[104:105], v[104:105], v[60:61] op_sel_hi:[1,0]
    v_pk_mul_f32 v[74:75], v[74:75], v[56:57] op_sel_hi:[1,0]
    v_pk_mul_f32 v[106:107], v[106:107], v[60:61] op_sel_hi:[1,0]
    v_pk_mul_f32 v[76:77], v[76:77], v[56:57] op_sel_hi:[1,0]
    v_pk_mul_f32 v[108:109], v[108:109], v[60:61] op_sel_hi:[1,0]
    v_pk_mul_f32 v[78:79], v[78:79], v[56:57] op_sel_hi:[1,0]
    v_pk_mul_f32 v[110:111], v[110:111], v[60:61] op_sel_hi:[1,0]
    v_cvt_pk_bf16_f32 v132, v72, v73
    v_cvt_pk_bf16_f32 v148, v104, v105
    v_cvt_pk_bf16_f32 v133, v74, v75
    v_cvt_pk_bf16_f32 v149, v106, v107
    v_cvt_pk_bf16_f32 v134, v76, v77
    v_cvt_pk_bf16_f32 v150, v108, v109
    v_cvt_pk_bf16_f32 v135, v78, v79
    v_cvt_pk_bf16_f32 v151, v110, v111
    v_pk_mul_f32 v[80:81], v[80:81], v[56:57] op_sel:[0,1] op_sel_hi:[1,1]
    v_pk_mul_f32 v[112:113], v[112:113], v[60:61] op_sel:[0,1] op_sel_hi:[1,1]
    v_pk_mul_f32 v[82:83], v[82:83], v[56:57] op_sel:[0,1] op_sel_hi:[1,1]
    v_pk_mul_f32 v[114:115], v[114:115], v[60:61] op_sel:[0,1] op_sel_hi:[1,1]
    v_pk_mul_f32 v[84:85], v[84:85], v[56:57] op_sel:[0,1] op_sel_hi:[1,1]
    v_pk_mul_f32 v[116:117], v[116:117], v[60:61] op_sel:[0,1] op_sel_hi:[1,1]
    v_pk_mul_f32 v[86:87], v[86:87], v[56:57] op_sel:[0,1] op_sel_hi:[1,1]
    v_pk_mul_f32 v[118:119], v[118:119], v[60:61] op_sel:[0,1] op_sel_hi:[1,1]
    v_cvt_pk_bf16_f32 v136, v80, v81
    v_cvt_pk_bf16_f32 v152, v112, v113
    v_cvt_pk_bf16_f32 v137, v82, v83
    v_cvt_pk_bf16_f32 v153, v114, v115
    v_cvt_pk_bf16_f32 v138, v84, v85
    v_cvt_pk_bf16_f32 v154, v116, v117
    v_cvt_pk_bf16_f32 v139, v86, v87
    v_cvt_pk_bf16_f32 v155, v118, v119
    v_pk_mul_f32 v[88:89], v[88:89], v[56:57] op_sel:[0,1] op_sel_hi:[1,1]
    v_pk_mul_f32 v[120:121], v[120:121], v[60:61] op_sel:[0,1] op_sel_hi:[1,1]
    v_pk_mul_f32 v[90:91], v[90:91], v[56:57] op_sel:[0,1] op_sel_hi:[1,1]
    v_pk_mul_f32 v[122:123], v[122:123], v[60:61] op_sel:[0,1] op_sel_hi:[1,1]
    v_pk_mul_f32 v[92:93], v[92:93], v[56:57] op_sel:[0,1] op_sel_hi:[1,1]
    v_pk_mul_f32 v[124:125], v[124:125], v[60:61] op_sel:[0,1] op_sel_hi:[1,1]
    v_pk_mul_f32 v[94:95], v[94:95], v[56:57] op_sel:[0,1] op_sel_hi:[1,1]
    v_pk_mul_f32 v[126:127], v[126:127], v[60:61] op_sel:[0,1] op_sel_hi:[1,1]
    v_cvt_pk_bf16_f32 v140, v88, v89
    v_cvt_pk_bf16_f32 v156, v120, v121
    v_cvt_pk_bf16_f32 v141, v90, v91
    v_cvt_pk_bf16_f32 v157, v122, v123
    v_cvt_pk_bf16_f32 v142, v92, v93
    v_cvt_pk_bf16_f32 v158, v124, v125
    v_cvt_pk_bf16_f32 v143, v94, v95
    v_cvt_pk_bf16_f32 v159, v126, v127
    s_mov_b32 s81, 0
    s_mov_b32 s84, -49152
    s_mov_b32 s85, -24576
    s_add_u32 s81, s81, 1
    s_and_b32 s81, s81, 3
    s_cselect_b32 s82, 16384, s84
    s_ashr_i32 s83, s82, 1
    s_lshr_b32 s72, s3, 0
    s_and_b32 s73, s3, 0
    s_mul_i32 s62, s72, 4096
    s_add_u32 s62, s62, 0
    v_and_b32 v48, 15, v1
    v_lshrrev_b32 v49, 4, v1
    v_lshlrev_b32 v50, 4, v48
    v_lshl_add_u32 v50, v49, 9, v50
    v_add_u32 v8, s62, v50
    v_bfe_u32 v50, v1, 2, 2
    v_lshlrev_b32 v10, 7, v50
    v_lshl_add_u32 v10, v49, 10, v10
    v_bfe_u32 v50, v1, 3, 1
    v_lshl_add_u32 v10, v50, 6, v10
    v_bfe_u32 v50, v1, 4, 1
    v_lshl_add_u32 v10, v50, 5, v10
    s_mov_b32 s62, 65536
    v_add_u32 v10, s62, v10
    v_and_b32 v50, 3, v1
    v_lshl_add_u32 v10, v50, 3, v10
    v_xor_b32 v11, 32, v10
    v_xor_b32 v12, 64, v10
    v_xor_b32 v13, 96, v10
    s_waitcnt vmcnt(0)
    v_permlane16_swap_b32 v224, v226
    v_permlane16_swap_b32 v225, v227
    v_permlane16_swap_b32 v228, v230
    v_permlane16_swap_b32 v229, v231
    v_permlane16_swap_b32 v232, v234
    v_permlane16_swap_b32 v233, v235
    v_permlane16_swap_b32 v236, v238
    v_permlane16_swap_b32 v237, v239
    v_lshlrev_b32 v64, 16, v224
    v_and_b32 v65, 0xffff0000, v224
    v_lshlrev_b32 v66, 16, v225
    v_and_b32 v67, 0xffff0000, v225
    v_lshlrev_b32 v68, 16, v226
    v_and_b32 v69, 0xffff0000, v226
    v_lshlrev_b32 v70, 16, v227
    v_and_b32 v71, 0xffff0000, v227
    v_lshlrev_b32 v72, 16, v228
    v_and_b32 v73, 0xffff0000, v228
    v_lshlrev_b32 v74, 16, v229
    v_and_b32 v75, 0xffff0000, v229
    v_lshlrev_b32 v76, 16, v230
    v_and_b32 v77, 0xffff0000, v230
    v_lshlrev_b32 v78, 16, v231
    v_and_b32 v79, 0xffff0000, v231
    v_lshlrev_b32 v80, 16, v232
    v_and_b32 v81, 0xffff0000, v232
    v_lshlrev_b32 v82, 16, v233
    v_and_b32 v83, 0xffff0000, v233
    v_lshlrev_b32 v84, 16, v234
    v_and_b32 v85, 0xffff0000, v234
    v_lshlrev_b32 v86, 16, v235
    v_and_b32 v87, 0xffff0000, v235
    v_lshlrev_b32 v88, 16, v236
    v_and_b32 v89, 0xffff0000, v236
    v_lshlrev_b32 v90, 16, v237
    v_and_b32 v91, 0xffff0000, v237
    v_lshlrev_b32 v92, 16, v238
    v_and_b32 v93, 0xffff0000, v238
    v_lshlrev_b32 v94, 16, v239
    v_and_b32 v95, 0xffff0000, v239
    s_mov_b64 exec, 0
    s_cmp_lg_u32 s3, 0
    s_cbranch_scc1 L_padr1
    s_branch L_pad1
L_padr1:
    s_cmp_lg_u32 s3, 1
    s_cbranch_scc1 L_padr2
    s_branch L_pad2
L_padr2:
    s_cmp_lg_u32 s3, 2
    s_cbranch_scc1 L_padr3
    s_branch L_pad3
L_padr3:
    s_cmp_lg_u32 s3, 3
    s_cbranch_scc1 L_padr6
    s_branch L_pad6
L_padr6:
    s_cmp_lg_u32 s3, 0
    s_cbranch_scc1 L_padr10
    s_branch L_pad10
L_padr10:
    s_cmp_lg_u32 s3, 1
    s_cbranch_scc1 L_padr11
    s_branch L_pad11
L_padr11:
    s_cmp_lg_u32 s3, 2
    s_cbranch_scc1 L_padr12
    s_branch L_pad12
L_padr12:
    s_nop 0
    s_nop 0
    s_nop 0
    s_mov_b64 exec, -1
    s_barrier
    ds_read_b128 v[32:35], v3 offset:57344
    ds_read_b128 v[36:39], v3 offset:57376
    ds_read_b128 v[40:43], v3 offset:57408
    ds_read_b128 v[44:47], v3 offset:57440
    ds_read_b128 v[16:19], v2 offset:49152
    ds_read_b128 v[20:23], v2 offset:50176
    ds_read_b128 v[24:27], v2 offset:51200
    ds_read_b128 v[28:31], v2 offset:52224
    s_waitcnt lgkmcnt(4)
    v_mfma_f32_32x32x16_bf16 v[192:207], v[32:35], v[128:131], 0
    v_mfma_f32_32x32x16_bf16 v[192:207], v[36:39], v[132:135], v[192:207]
    v_mfma_f32_32x32x16_bf16 v[192:207], v[40:43], v[136:139], v[192:207]
    v_mfma_f32_32x32x16_bf16 v[192:207], v[44:47], v[140:143], v[192:207]
    s_waitcnt lgkmcnt(0)
    v_mfma_f32_32x32x16_bf16 v[96:111], v[16:19], v[128:131], 0
    v_mfma_f32_32x32x16_bf16 v[96:111], v[20:23], v[132:135], v[96:111]
    v_mfma_f32_32x32x16_bf16 v[96:111], v[24:27], v[136:139], v[96:111]
    v_mfma_f32_32x32x16_bf16 v[96:111], v[28:31], v[140:143], v[96:111]
    v_mfma_f32_32x32x16_bf16 v[208:223], v[32:35], v[144:147], 0
    v_mfma_f32_32x32x16_bf16 v[208:223], v[36:39], v[148:151], v[208:223]
    v_mfma_f32_32x32x16_bf16 v[208:223], v[40:43], v[152:155], v[208:223]
    v_mfma_f32_32x32x16_bf16 v[208:223], v[44:47], v[156:159], v[208:223]
    v_mfma_f32_32x32x16_bf16 v[112:127], v[16:19], v[144:147], 0
    v_mfma_f32_32x32x16_bf16 v[112:127], v[20:23], v[148:151], v[112:127]
    v_mfma_f32_32x32x16_bf16 v[112:127], v[24:27], v[152:155], v[112:127]
    v_mfma_f32_32x32x16_bf16 v[112:127], v[28:31], v[156:159], v[112:127]
    s_nop 0
    v_add_f32 v192, 897988541, v192
    v_rcp_f32 v192, v192
    s_nop 0
    v_pk_mul_f32 v[96:97], v[96:97], v[192:193] op_sel_hi:[1,0]
    v_pk_mul_f32 v[98:99], v[98:99], v[192:193] op_sel_hi:[1,0]
    v_pk_mul_f32 v[100:101], v[100:101], v[192:193] op_sel_hi:[1,0]
    v_pk_mul_f32 v[102:103], v[102:103], v[192:193] op_sel_hi:[1,0]
    v_cvt_pk_bf16_f32 v160, v96, v97
    v_cvt_pk_bf16_f32 v161, v98, v99
    v_cvt_pk_bf16_f32 v162, v100, v101
    v_cvt_pk_bf16_f32 v163, v102, v103
    buffer_store_dwordx4 v[160:163], v15, s[24:27], s68 offen offset:0 sc1
    v_pk_mul_f32 v[104:105], v[104:105], v[192:193] op_sel_hi:[1,0]
    v_pk_mul_f32 v[106:107], v[106:107], v[192:193] op_sel_hi:[1,0]
    v_pk_mul_f32 v[108:109], v[108:109], v[192:193] op_sel_hi:[1,0]
    v_pk_mul_f32 v[110:111], v[110:111], v[192:193] op_sel_hi:[1,0]
    v_cvt_pk_bf16_f32 v164, v104, v105
    v_cvt_pk_bf16_f32 v165, v106, v107
    v_cvt_pk_bf16_f32 v166, v108, v109
    v_cvt_pk_bf16_f32 v167, v110, v111
    buffer_store_dwordx4 v[164:167], v15, s[24:27], s68 offen offset:1024 sc1
    v_add_f32 v208, 897988541, v208
    v_rcp_f32 v208, v208
    s_nop 0
    v_pk_mul_f32 v[112:113], v[112:113], v[208:209] op_sel_hi:[1,0]
    v_pk_mul_f32 v[114:115], v[114:115], v[208:209] op_sel_hi:[1,0]
    v_pk_mul_f32 v[116:117], v[116:117], v[208:209] op_sel_hi:[1,0]
    v_pk_mul_f32 v[118:119], v[118:119], v[208:209] op_sel_hi:[1,0]
    v_cvt_pk_bf16_f32 v168, v112, v113
    v_cvt_pk_bf16_f32 v169, v114, v115
    v_cvt_pk_bf16_f32 v170, v116, v117
    v_cvt_pk_bf16_f32 v171, v118, v119
    buffer_store_dwordx4 v[168:171], v15, s[24:27], s69 offen offset:0 sc1
    v_pk_mul_f32 v[120:121], v[120:121], v[208:209] op_sel_hi:[1,0]
    v_pk_mul_f32 v[122:123], v[122:123], v[208:209] op_sel_hi:[1,0]
    v_pk_mul_f32 v[124:125], v[124:125], v[208:209] op_sel_hi:[1,0]
    v_pk_mul_f32 v[126:127], v[126:127], v[208:209] op_sel_hi:[1,0]
    v_cvt_pk_bf16_f32 v172, v120, v121
    v_cvt_pk_bf16_f32 v173, v122, v123
    v_cvt_pk_bf16_f32 v174, v124, v125
    v_cvt_pk_bf16_f32 v175, v126, v127
    buffer_store_dwordx4 v[172:175], v15, s[24:27], s69 offen offset:1024 sc1
    s_bitcmp1_b32 s101, 0
    s_cbranch_scc1 L_p_par_82
    s_waitcnt vmcnt(0)
L_p_par_82:
    s_barrier
    s_mov_b64 exec, 0
    s_cmp_lg_u32 s3, 0
    s_cbranch_scc1 L_padr13
    s_branch L_pad13
L_padr13:
    s_cmp_lg_u32 s3, 1
    s_cbranch_scc1 L_padr14
    s_branch L_pad14
L_padr14:
    s_cmp_lg_u32 s3, 2
    s_cbranch_scc1 L_padr15
    s_branch L_pad15
L_padr15:
    s_cmp_lg_u32 s3, 3
    s_cbranch_scc1 L_padr16
    s_branch L_pad16
L_padr16:
    s_nop 0
    s_nop 0
    s_nop 0
    s_nop 0
    s_nop 0
    s_nop 0
    s_nop 0
    s_nop 0
    s_nop 0
    s_nop 0
    s_nop 0
    s_nop 0
    s_mov_b64 exec, -1
    s_waitcnt vmcnt(0)
    s_barrier
    s_barrier
    ds_read_b64_tr_b16 v[32:33], v10 offset:0
    ds_read_b64_tr_b16 v[34:35], v10 offset:512
    ds_read_b128 v[16:19], v8 offset:0
    ds_read_b128 v[20:23], v8 offset:256
    ds_read_b64_tr_b16 v[36:37], v11 offset:0
    ds_read_b64_tr_b16 v[38:39], v11 offset:512
    ds_read_b64_tr_b16 v[40:41], v12 offset:0
    ds_read_b64_tr_b16 v[42:43], v12 offset:512
    ds_read_b64_tr_b16 v[44:45], v13 offset:0
    ds_read_b64_tr_b16 v[46:47], v13 offset:512
    ds_read_b64_tr_b16 v[48:49], v10 offset:4096
    ds_read_b64_tr_b16 v[50:51], v10 offset:4608
    s_mov_b32 s80, 5
    .p2align 6
L_p_cu_83:
    ds_read_b128 v[24:27], v8 offset:2048
    ds_read_b128 v[28:31], v8 offset:2304
    s_waitcnt lgkmcnt(11)
    v_mfma_f32_16x16x32_bf16 v[64:67], v[32:35], v[16:19], v[64:67]
    ds_read_b64_tr_b16 v[52:53], v11 offset:4096
    ds_read_b64_tr_b16 v[54:55], v11 offset:4608
    s_waitcnt lgkmcnt(12)
    v_mfma_f32_16x16x32_bf16 v[68:71], v[32:35], v[20:23], v[68:71]
    ds_read_b64_tr_b16 v[56:57], v12 offset:4096
    ds_read_b64_tr_b16 v[58:59], v12 offset:4608
    s_waitcnt lgkmcnt(12)
    v_mfma_f32_16x16x32_bf16 v[76:79], v[36:39], v[20:23], v[76:79]
    ds_read_b64_tr_b16 v[60:61], v13 offset:4096
    ds_read_b64_tr_b16 v[62:63], v13 offset:4608
    v_mfma_f32_16x16x32_bf16 v[72:75], v[36:39], v[16:19], v[72:75]
    s_waitcnt lgkmcnt(12)
    v_add_u32 v8, s82, v8
    v_mfma_f32_16x16x32_bf16 v[80:83], v[40:43], v[16:19], v[80:83]
    v_add_u32 v10, s83, v10
    v_mfma_f32_16x16x32_bf16 v[84:87], v[40:43], v[20:23], v[84:87]
    s_waitcnt lgkmcnt(8)
    v_add_u32 v11, s83, v11
    v_mfma_f32_16x16x32_bf16 v[92:95], v[44:47], v[20:23], v[92:95]
    v_add_u32 v12, s83, v12
    v_mfma_f32_16x16x32_bf16 v[88:91], v[44:47], v[16:19], v[88:91]
    s_waitcnt lgkmcnt(4)
    v_add_u32 v13, s83, v13
    v_mfma_f32_16x16x32_bf16 v[64:67], v[48:51], v[24:27], v[64:67]
    v_mfma_f32_16x16x32_bf16 v[68:71], v[48:51], v[28:31], v[68:71]
    s_waitcnt lgkmcnt(0)
    s_barrier
    ds_read_b64_tr_b16 v[32:33], v10 offset:0
    ds_read_b64_tr_b16 v[34:35], v10 offset:512
    v_mfma_f32_16x16x32_bf16 v[76:79], v[52:55], v[28:31], v[76:79]
    ds_read_b128 v[16:19], v8 offset:0
    ds_read_b128 v[20:23], v8 offset:256
    v_mfma_f32_16x16x32_bf16 v[72:75], v[52:55], v[24:27], v[72:75]
    ds_read_b64_tr_b16 v[36:37], v11 offset:0
    ds_read_b64_tr_b16 v[38:39], v11 offset:512
    v_mfma_f32_16x16x32_bf16 v[80:83], v[56:59], v[24:27], v[80:83]
    s_add_u32 s81, s81, 1
    ds_read_b64_tr_b16 v[40:41], v12 offset:0
    ds_read_b64_tr_b16 v[42:43], v12 offset:512
    v_mfma_f32_16x16x32_bf16 v[84:87], v[56:59], v[28:31], v[84:87]
    s_and_b32 s81, s81, 3
    s_cselect_b32 s82, 16384, s84
    ds_read_b64_tr_b16 v[44:45], v13 offset:0
    ds_read_b64_tr_b16 v[46:47], v13 offset:512
    v_mfma_f32_16x16x32_bf16 v[92:95], v[60:63], v[28:31], v[92:95]
    s_ashr_i32 s83, s82, 1
    ds_read_b64_tr_b16 v[48:49], v10 offset:4096
    ds_read_b64_tr_b16 v[50:51], v10 offset:4608
    v_mfma_f32_16x16x32_bf16 v[88:91], v[60:63], v[24:27], v[88:91]
    ds_read_b128 v[24:27], v8 offset:2048
    ds_read_b128 v[28:31], v8 offset:2304
    s_waitcnt lgkmcnt(11)
    v_mfma_f32_16x16x32_bf16 v[64:67], v[32:35], v[16:19], v[64:67]
    ds_read_b64_tr_b16 v[52:53], v11 offset:4096
    ds_read_b64_tr_b16 v[54:55], v11 offset:4608
    s_waitcnt lgkmcnt(12)
    v_mfma_f32_16x16x32_bf16 v[68:71], v[32:35], v[20:23], v[68:71]
    ds_read_b64_tr_b16 v[56:57], v12 offset:4096
    ds_read_b64_tr_b16 v[58:59], v12 offset:4608
    s_waitcnt lgkmcnt(12)
    v_mfma_f32_16x16x32_bf16 v[76:79], v[36:39], v[20:23], v[76:79]
    ds_read_b64_tr_b16 v[60:61], v13 offset:4096
    ds_read_b64_tr_b16 v[62:63], v13 offset:4608
    v_mfma_f32_16x16x32_bf16 v[72:75], v[36:39], v[16:19], v[72:75]
    s_waitcnt lgkmcnt(12)
    v_add_u32 v8, s82, v8
    v_mfma_f32_16x16x32_bf16 v[80:83], v[40:43], v[16:19], v[80:83]
    v_add_u32 v10, s83, v10
    v_mfma_f32_16x16x32_bf16 v[84:87], v[40:43], v[20:23], v[84:87]
    s_waitcnt lgkmcnt(8)
    v_add_u32 v11, s83, v11
    v_mfma_f32_16x16x32_bf16 v[92:95], v[44:47], v[20:23], v[92:95]
    v_add_u32 v12, s83, v12
    v_mfma_f32_16x16x32_bf16 v[88:91], v[44:47], v[16:19], v[88:91]
    s_waitcnt lgkmcnt(4)
    v_add_u32 v13, s83, v13
    v_mfma_f32_16x16x32_bf16 v[64:67], v[48:51], v[24:27], v[64:67]
    v_mfma_f32_16x16x32_bf16 v[68:71], v[48:51], v[28:31], v[68:71]
    s_waitcnt lgkmcnt(0)
    s_barrier
    ds_read_b64_tr_b16 v[32:33], v10 offset:0
    ds_read_b64_tr_b16 v[34:35], v10 offset:512
    v_mfma_f32_16x16x32_bf16 v[76:79], v[52:55], v[28:31], v[76:79]
    ds_read_b128 v[16:19], v8 offset:0
    ds_read_b128 v[20:23], v8 offset:256
    v_mfma_f32_16x16x32_bf16 v[72:75], v[52:55], v[24:27], v[72:75]
    ds_read_b64_tr_b16 v[36:37], v11 offset:0
    ds_read_b64_tr_b16 v[38:39], v11 offset:512
    v_mfma_f32_16x16x32_bf16 v[80:83], v[56:59], v[24:27], v[80:83]
    s_add_u32 s81, s81, 1
    ds_read_b64_tr_b16 v[40:41], v12 offset:0
    ds_read_b64_tr_b16 v[42:43], v12 offset:512
    v_mfma_f32_16x16x32_bf16 v[84:87], v[56:59], v[28:31], v[84:87]
    s_and_b32 s81, s81, 3
    s_cselect_b32 s82, 16384, s84
    ds_read_b64_tr_b16 v[44:45], v13 offset:0
    ds_read_b64_tr_b16 v[46:47], v13 offset:512
    v_mfma_f32_16x16x32_bf16 v[92:95], v[60:63], v[28:31], v[92:95]
    s_ashr_i32 s83, s82, 1
    ds_read_b64_tr_b16 v[48:49], v10 offset:4096
    ds_read_b64_tr_b16 v[50:51], v10 offset:4608
    v_mfma_f32_16x16x32_bf16 v[88:91], v[60:63], v[24:27], v[88:91]
    ds_read_b128 v[24:27], v8 offset:2048
    ds_read_b128 v[28:31], v8 offset:2304
    s_waitcnt lgkmcnt(11)
    v_mfma_f32_16x16x32_bf16 v[64:67], v[32:35], v[16:19], v[64:67]
    ds_read_b64_tr_b16 v[52:53], v11 offset:4096
    ds_read_b64_tr_b16 v[54:55], v11 offset:4608
    s_waitcnt lgkmcnt(12)
    v_mfma_f32_16x16x32_bf16 v[68:71], v[32:35], v[20:23], v[68:71]
    ds_read_b64_tr_b16 v[56:57], v12 offset:4096
    ds_read_b64_tr_b16 v[58:59], v12 offset:4608
    s_waitcnt lgkmcnt(12)
    v_mfma_f32_16x16x32_bf16 v[76:79], v[36:39], v[20:23], v[76:79]
    ds_read_b64_tr_b16 v[60:61], v13 offset:4096
    ds_read_b64_tr_b16 v[62:63], v13 offset:4608
    v_mfma_f32_16x16x32_bf16 v[72:75], v[36:39], v[16:19], v[72:75]
    s_waitcnt lgkmcnt(12)
    v_add_u32 v8, s82, v8
    v_mfma_f32_16x16x32_bf16 v[80:83], v[40:43], v[16:19], v[80:83]
    v_add_u32 v10, s83, v10
    v_mfma_f32_16x16x32_bf16 v[84:87], v[40:43], v[20:23], v[84:87]
    s_waitcnt lgkmcnt(8)
    v_add_u32 v11, s83, v11
    v_mfma_f32_16x16x32_bf16 v[92:95], v[44:47], v[20:23], v[92:95]
    v_add_u32 v12, s83, v12
    v_mfma_f32_16x16x32_bf16 v[88:91], v[44:47], v[16:19], v[88:91]
    s_waitcnt lgkmcnt(4)
    v_add_u32 v13, s83, v13
    v_mfma_f32_16x16x32_bf16 v[64:67], v[48:51], v[24:27], v[64:67]
    v_mfma_f32_16x16x32_bf16 v[68:71], v[48:51], v[28:31], v[68:71]
    s_waitcnt lgkmcnt(0)
    s_barrier
    ds_read_b64_tr_b16 v[32:33], v10 offset:0
    ds_read_b64_tr_b16 v[34:35], v10 offset:512
    v_mfma_f32_16x16x32_bf16 v[76:79], v[52:55], v[28:31], v[76:79]
    ds_read_b128 v[16:19], v8 offset:0
    ds_read_b128 v[20:23], v8 offset:256
    v_mfma_f32_16x16x32_bf16 v[72:75], v[52:55], v[24:27], v[72:75]
    ds_read_b64_tr_b16 v[36:37], v11 offset:0
    ds_read_b64_tr_b16 v[38:39], v11 offset:512
    v_mfma_f32_16x16x32_bf16 v[80:83], v[56:59], v[24:27], v[80:83]
    s_add_u32 s81, s81, 1
    ds_read_b64_tr_b16 v[40:41], v12 offset:0
    ds_read_b64_tr_b16 v[42:43], v12 offset:512
    v_mfma_f32_16x16x32_bf16 v[84:87], v[56:59], v[28:31], v[84:87]
    s_and_b32 s81, s81, 3
    s_cselect_b32 s82, 16384, s84
    ds_read_b64_tr_b16 v[44:45], v13 offset:0
    ds_read_b64_tr_b16 v[46:47], v13 offset:512
    v_mfma_f32_16x16x32_bf16 v[92:95], v[60:63], v[28:31], v[92:95]
    s_ashr_i32 s83, s82, 1
    ds_read_b64_tr_b16 v[48:49], v10 offset:4096
    ds_read_b64_tr_b16 v[50:51], v10 offset:4608
    v_mfma_f32_16x16x32_bf16 v[88:91], v[60:63], v[24:27], v[88:91]
    s_sub_u32 s80, s80, 1
    s_cmp_lg_u32 s80, 0
    s_cbranch_scc1 L_p_cu_83
    ds_read_b128 v[24:27], v8 offset:2048
    ds_read_b128 v[28:31], v8 offset:2304
    s_waitcnt lgkmcnt(11)
    v_mfma_f32_16x16x32_bf16 v[64:67], v[32:35], v[16:19], v[64:67]
    ds_read_b64_tr_b16 v[52:53], v11 offset:4096
    ds_read_b64_tr_b16 v[54:55], v11 offset:4608
    s_waitcnt lgkmcnt(12)
    v_mfma_f32_16x16x32_bf16 v[68:71], v[32:35], v[20:23], v[68:71]
    ds_read_b64_tr_b16 v[56:57], v12 offset:4096
    ds_read_b64_tr_b16 v[58:59], v12 offset:4608
    s_waitcnt lgkmcnt(12)
    v_mfma_f32_16x16x32_bf16 v[76:79], v[36:39], v[20:23], v[76:79]
    ds_read_b64_tr_b16 v[60:61], v13 offset:4096
    ds_read_b64_tr_b16 v[62:63], v13 offset:4608
    v_mfma_f32_16x16x32_bf16 v[72:75], v[36:39], v[16:19], v[72:75]
    s_waitcnt lgkmcnt(12)
    v_add_u32 v8, s82, v8
    v_mfma_f32_16x16x32_bf16 v[80:83], v[40:43], v[16:19], v[80:83]
    v_add_u32 v10, s83, v10
    v_mfma_f32_16x16x32_bf16 v[84:87], v[40:43], v[20:23], v[84:87]
    s_waitcnt lgkmcnt(8)
    v_add_u32 v11, s83, v11
    v_mfma_f32_16x16x32_bf16 v[92:95], v[44:47], v[20:23], v[92:95]
    v_add_u32 v12, s83, v12
    v_mfma_f32_16x16x32_bf16 v[88:91], v[44:47], v[16:19], v[88:91]
    s_waitcnt lgkmcnt(4)
    v_add_u32 v13, s83, v13
    v_mfma_f32_16x16x32_bf16 v[64:67], v[48:51], v[24:27], v[64:67]
    v_mfma_f32_16x16x32_bf16 v[68:71], v[48:51], v[28:31], v[68:71]
    s_waitcnt lgkmcnt(0)
    s_barrier
    v_mfma_f32_16x16x32_bf16 v[76:79], v[52:55], v[28:31], v[76:79]
    v_mfma_f32_16x16x32_bf16 v[72:75], v[52:55], v[24:27], v[72:75]
    v_mfma_f32_16x16x32_bf16 v[80:83], v[56:59], v[24:27], v[80:83]
    s_add_u32 s81, s81, 1
    v_mfma_f32_16x16x32_bf16 v[84:87], v[56:59], v[28:31], v[84:87]
    s_and_b32 s81, s81, 3
    s_cselect_b32 s82, 16384, s84
    v_mfma_f32_16x16x32_bf16 v[92:95], v[60:63], v[28:31], v[92:95]
    s_ashr_i32 s83, s82, 1
    v_mfma_f32_16x16x32_bf16 v[88:91], v[60:63], v[24:27], v[88:91]
    s_nop 1
    v_cvt_pk_bf16_f32 v224, v64, v65
    v_cvt_pk_bf16_f32 v225, v66, v67
    v_cvt_pk_bf16_f32 v226, v68, v69
    v_cvt_pk_bf16_f32 v227, v70, v71
    v_cvt_pk_bf16_f32 v228, v72, v73
    v_cvt_pk_bf16_f32 v229, v74, v75
    v_cvt_pk_bf16_f32 v230, v76, v77
    v_cvt_pk_bf16_f32 v231, v78, v79
    v_permlane16_swap_b32 v224, v226
    v_permlane16_swap_b32 v225, v227
    buffer_store_dwordx4 v[224:227], v7, s[24:27], 0 offen offset:0 sc1
    v_cvt_pk_bf16_f32 v232, v80, v81
    v_cvt_pk_bf16_f32 v233, v82, v83
    v_cvt_pk_bf16_f32 v234, v84, v85
    v_cvt_pk_bf16_f32 v235, v86, v87
    v_permlane16_swap_b32 v228, v230
    v_permlane16_swap_b32 v229, v231
    buffer_store_dwordx4 v[228:231], v7, s[24:27], 0 offen offset:1024 sc1
    v_cvt_pk_bf16_f32 v236, v88, v89
    v_cvt_pk_bf16_f32 v237, v90, v91
    v_cvt_pk_bf16_f32 v238, v92, v93
    v_cvt_pk_bf16_f32 v239, v94, v95
    v_permlane16_swap_b32 v232, v234
    v_permlane16_swap_b32 v233, v235
    buffer_store_dwordx4 v[232:235], v7, s[24:27], 0 offen offset:2048 sc1
    v_permlane16_swap_b32 v236, v238
    v_permlane16_swap_b32 v237, v239
    buffer_store_dwordx4 v[236:239], v7, s[24:27], 0 offen offset:3072 sc1
    v_lshlrev_b32 v64, 16, v224
    v_and_b32 v65, 0xffff0000, v224
    v_lshlrev_b32 v66, 16, v225
    v_and_b32 v67, 0xffff0000, v225
    v_lshlrev_b32 v68, 16, v226
    v_and_b32 v69, 0xffff0000, v226
    v_lshlrev_b32 v70, 16, v227
    v_and_b32 v71, 0xffff0000, v227
L_pad10:
    s_cbranch_execz L_padr10
    v_lshlrev_b32 v72, 16, v228
    v_and_b32 v73, 0xffff0000, v228
    v_lshlrev_b32 v74, 16, v229
    v_and_b32 v75, 0xffff0000, v229
    v_lshlrev_b32 v76, 16, v230
    v_and_b32 v77, 0xffff0000, v230
    v_lshlrev_b32 v78, 16, v231
    v_and_b32 v79, 0xffff0000, v231
    v_lshlrev_b32 v80, 16, v232
    v_and_b32 v81, 0xffff0000, v232
    v_lshlrev_b32 v82, 16, v233
    v_and_b32 v83, 0xffff0000, v233
    v_lshlrev_b32 v84, 16, v234
    v_and_b32 v85, 0xffff0000, v234
    v_lshlrev_b32 v86, 16, v235
    v_and_b32 v87, 0xffff0000, v235
    v_lshlrev_b32 v88, 16, v236
    v_and_b32 v89, 0xffff0000, v236
    v_lshlrev_b32 v90, 16, v237
    v_and_b32 v91, 0xffff0000, v237
    v_lshlrev_b32 v92, 16, v238
    v_and_b32 v93, 0xffff0000, v238
    v_lshlrev_b32 v94, 16, v239
    v_and_b32 v95, 0xffff0000, v239
    v_pk_add_f32 v[20:21], v[64:65], v[66:67]
    v_pk_add_f32 v[22:23], v[68:69], v[70:71]
    v_pk_add_f32 v[20:21], v[20:21], v[72:73]
    v_pk_add_f32 v[22:23], v[22:23], v[74:75]
    v_pk_add_f32 v[20:21], v[20:21], v[76:77]
    v_pk_add_f32 v[22:23], v[22:23], v[78:79]
    v_pk_add_f32 v[20:21], v[20:21], v[80:81]
    v_pk_add_f32 v[22:23], v[22:23], v[82:83]
    v_pk_add_f32 v[20:21], v[20:21], v[84:85]
    v_pk_add_f32 v[22:23], v[22:23], v[86:87]
    v_pk_add_f32 v[20:21], v[20:21], v[88:89]
    v_pk_add_f32 v[22:23], v[22:23], v[90:91]
    v_pk_add_f32 v[20:21], v[20:21], v[92:93]
    v_pk_add_f32 v[22:23], v[22:23], v[94:95]
    v_pk_add_f32 v[20:21], v[20:21], v[22:23]
    v_add_f32 v20, v20, v21
    v_mov_b32 v21, v20
    s_nop 1
    v_permlane32_swap_b32 v20, v21
    v_add_f32 v20, v20, v21
    v_mul_f32 v20, 1015021568, v20
    v_pk_add_f32 v[64:65], v[64:65], v[20:21] op_sel_hi:[1,0] neg_lo:[0,1] neg_hi:[0,1]
    v_pk_add_f32 v[66:67], v[66:67], v[20:21] op_sel_hi:[1,0] neg_lo:[0,1] neg_hi:[0,1]
    v_pk_add_f32 v[68:69], v[68:69], v[20:21] op_sel_hi:[1,0] neg_lo:[0,1] neg_hi:[0,1]
    v_pk_add_f32 v[70:71], v[70:71], v[20:21] op_sel_hi:[1,0] neg_lo:[0,1] neg_hi:[0,1]
    v_pk_add_f32 v[72:73], v[72:73], v[20:21] op_sel_hi:[1,0] neg_lo:[0,1] neg_hi:[0,1]
    v_pk_add_f32 v[74:75], v[74:75], v[20:21] op_sel_hi:[1,0] neg_lo:[0,1] neg_hi:[0,1]
    v_pk_add_f32 v[76:77], v[76:77], v[20:21] op_sel_hi:[1,0] neg_lo:[0,1] neg_hi:[0,1]
    v_pk_add_f32 v[78:79], v[78:79], v[20:21] op_sel_hi:[1,0] neg_lo:[0,1] neg_hi:[0,1]
    v_pk_add_f32 v[80:81], v[80:81], v[20:21] op_sel_hi:[1,0] neg_lo:[0,1] neg_hi:[0,1]
    v_pk_add_f32 v[82:83], v[82:83], v[20:21] op_sel_hi:[1,0] neg_lo:[0,1] neg_hi:[0,1]
    v_pk_add_f32 v[84:85], v[84:85], v[20:21] op_sel_hi:[1,0] neg_lo:[0,1] neg_hi:[0,1]
    v_pk_add_f32 v[86:87], v[86:87], v[20:21] op_sel_hi:[1,0] neg_lo:[0,1] neg_hi:[0,1]
    v_pk_add_f32 v[88:89], v[88:89], v[20:21] op_sel_hi:[1,0] neg_lo:[0,1] neg_hi:[0,1]
    v_pk_add_f32 v[90:91], v[90:91], v[20:21] op_sel_hi:[1,0] neg_lo:[0,1] neg_hi:[0,1]
    v_pk_add_f32 v[92:93], v[92:93], v[20:21] op_sel_hi:[1,0] neg_lo:[0,1] neg_hi:[0,1]
    v_pk_add_f32 v[94:95], v[94:95], v[20:21] op_sel_hi:[1,0] neg_lo:[0,1] neg_hi:[0,1]
    v_pk_mul_f32 v[22:23], v[64:65], v[64:65]
    v_pk_mul_f32 v[24:25], v[66:67], v[66:67]
    v_pk_fma_f32 v[22:23], v[68:69], v[68:69], v[22:23]
    v_pk_fma_f32 v[24:25], v[70:71], v[70:71], v[24:25]
    v_pk_fma_f32 v[22:23], v[72:73], v[72:73], v[22:23]
    v_pk_fma_f32 v[24:25], v[74:75], v[74:75], v[24:25]
    v_pk_fma_f32 v[22:23], v[76:77], v[76:77], v[22:23]
    v_pk_fma_f32 v[24:25], v[78:79], v[78:79], v[24:25]
    v_pk_fma_f32 v[22:23], v[80:81], v[80:81], v[22:23]
    v_pk_fma_f32 v[24:25], v[82:83], v[82:83], v[24:25]
    v_pk_fma_f32 v[22:23], v[84:85], v[84:85], v[22:23]
    v_pk_fma_f32 v[24:25], v[86:87], v[86:87], v[24:25]
    v_pk_fma_f32 v[22:23], v[88:89], v[88:89], v[22:23]
    v_pk_fma_f32 v[24:25], v[90:91], v[90:91], v[24:25]
    v_pk_fma_f32 v[22:23], v[92:93], v[92:93], v[22:23]
    v_pk_fma_f32 v[24:25], v[94:95], v[94:95], v[24:25]
    v_pk_add_f32 v[22:23], v[22:23], v[24:25]
    v_add_f32 v22, v22, v23
    v_mov_b32 v23, v22
    s_nop 1
    v_permlane32_swap_b32 v22, v23
    v_add_f32 v22, v22, v23
    v_mov_b32 v21, v22
    s_mov_b32 exec_hi, 0
    buffer_store_dwordx2 v[20:21], v9, s[24:27], 0 offen sc1
    s_mov_b32 exec_hi, -1
    s_cmp_ge_u32 s2, 224
    s_cbranch_scc1 L_c_helper
    s_bitcmp1_b32 s2, 0
    s_cbranch_scc1 L_p_par_88
    s_waitcnt vmcnt(1)
L_p_par_88:
    s_barrier
L_c_p3:
    s_and_b32 s56, s2, 7
    s_lshr_b32 s57, s2, 3
    s_and_b32 s58, s57, 3
    s_lshr_b32 s59, s57, 2
    s_lshr_b32 s4, s56, 1
    s_mul_i32 s4, s4, 4
    s_add_u32 s4, s4, s58
    s_and_b32 s5, s56, 1
    s_mul_i32 s5, s5, 7
    s_add_u32 s5, s5, s59
    s_add_u32 s6, s58, s59
    s_mov_b32 s81, 0
    s_mov_b32 s84, -49152
    s_mov_b32 s85, -49152
    s_add_u32 s81, s81, 1
    s_and_b32 s81, s81, 3
    s_cselect_b32 s82, 16384, s84
    s_lshr_b32 s72, s3, 1
    s_and_b32 s73, s3, 1
    s_mul_i32 s62, s72, 8192
    s_add_u32 s62, s62, 0
    v_and_b32 v32, 15, v1
    v_lshrrev_b32 v33, 4, v1
    v_lshlrev_b32 v34, 4, v32
    v_lshl_add_u32 v34, v33, 9, v34
    v_add_u32 v2, s62, v34
    v_bfe_u32 v34, v1, 2, 2
    v_lshlrev_b32 v3, 7, v34
    v_lshl_add_u32 v3, v33, 10, v3
    v_bfe_u32 v34, v1, 3, 1
    v_lshl_add_u32 v3, v34, 6, v3
    v_bfe_u32 v34, v1, 4, 1
    v_lshl_add_u32 v3, v34, 5, v3
    s_mov_b32 s62, 65536
    s_lshl_b32 s63, s73, 13
    s_add_u32 s62, s62, s63
    v_add_u32 v3, s62, v3
    v_and_b32 v34, 3, v1
    v_lshl_add_u32 v3, v34, 3, v3
    v_xor_b32 v4, 32, v3
    v_xor_b32 v5, 64, v3
    v_xor_b32 v6, 96, v3
    s_lshr_b32 s72, s3, 1
    s_and_b32 s73, s3, 1
    s_mul_i32 s62, s72, 8192
    s_add_u32 s62, s62, 0
    v_and_b32 v32, 15, v1
    v_lshrrev_b32 v33, 4, v1
    v_bfe_u32 v34, v1, 1, 3
    v_xor_b32 v34, v34, v33
    v_lshlrev_b32 v34, 4, v34
    v_lshl_add_u32 v34, v32, 7, v34
    v_add_u32 v8, s62, v34
    v_xor_b32 v9, 64, v8
    v_bfe_u32 v34, v1, 2, 2
    v_lshl_add_u32 v34, v33, 3, v34
    v_lshlrev_b32 v10, 4, v34
    v_bfe_u32 v34, v1, 1, 1
    v_lshl_add_u32 v10, v34, 6, v10
    v_lshl_add_u32 v10, v34, 9, v10
    v_and_b32 v34, 1, v1
    v_lshl_add_u32 v10, v34, 3, v10
    s_lshl_b32 s62, s73, 12
    s_add_u32 s62, s62, 65536
    v_add_u32 v10, s62, v10
    v_xor_b32 v11, 64, v10
    v_mov_b64 v[128:129], 0
    v_mov_b64 v[130:131], 0
    v_mov_b64 v[132:133], 0
    v_mov_b64 v[134:135], 0
    v_mov_b64 v[136:137], 0
    v_mov_b64 v[138:139], 0
    v_mov_b64 v[140:141], 0
    v_mov_b64 v[142:143], 0
    v_mov_b64 v[144:145], 0
    v_mov_b64 v[146:147], 0
    v_mov_b64 v[148:149], 0
    v_mov_b64 v[150:151], 0
    v_mov_b64 v[152:153], 0
    v_mov_b64 v[154:155], 0
    v_mov_b64 v[156:157], 0
    v_mov_b64 v[158:159], 0
    v_mov_b64 v[160:161], 0
    v_mov_b64 v[162:163], 0
    v_mov_b64 v[164:165], 0
    v_mov_b64 v[166:167], 0
    v_mov_b64 v[168:169], 0
    v_mov_b64 v[170:171], 0
    v_mov_b64 v[172:173], 0
    v_mov_b64 v[174:175], 0
    v_mov_b64 v[176:177], 0
    v_mov_b64 v[178:179], 0
    v_mov_b64 v[180:181], 0
    v_mov_b64 v[182:183], 0
    v_mov_b64 v[184:185], 0
    v_mov_b64 v[186:187], 0
    v_mov_b64 v[188:189], 0
    v_mov_b64 v[190:191], 0
    v_mov_b64 v[64:65], 0
    v_mov_b64 v[66:67], 0
    v_mov_b64 v[68:69], 0
    v_mov_b64 v[70:71], 0
    v_mov_b64 v[72:73], 0
    v_mov_b64 v[74:75], 0
    v_mov_b64 v[76:77], 0
    v_mov_b64 v[78:79], 0
    v_mov_b64 v[80:81], 0
    v_mov_b64 v[82:83], 0
    v_mov_b64 v[84:85], 0
    v_mov_b64 v[86:87], 0
    v_mov_b64 v[88:89], 0
    v_mov_b64 v[90:91], 0
    v_mov_b64 v[92:93], 0
    v_mov_b64 v[94:95], 0
    v_mov_b64 v[96:97], 0
    v_mov_b64 v[98:99], 0
    v_mov_b64 v[100:101], 0
    v_mov_b64 v[102:103], 0
    v_mov_b64 v[104:105], 0
    v_mov_b64 v[106:107], 0
    v_mov_b64 v[108:109], 0
    v_mov_b64 v[110:111], 0
    v_mov_b64 v[112:113], 0
    v_mov_b64 v[114:115], 0
    v_mov_b64 v[116:117], 0
    v_mov_b64 v[118:119], 0
    v_mov_b64 v[120:121], 0
    v_mov_b64 v[122:123], 0
    v_mov_b64 v[124:125], 0
    v_mov_b64 v[126:127], 0
    v_and_b32 v32, 15, v1
    s_lshl_b32 s56, s72, 6
    v_add_u32 v32, s56, v32
    v_lshlrev_b32 v14, 3, v32
    v_add_u32 v14, 158720, v14
    v_lshlrev_b32 v13, 4, v32
    v_add_u32 v13, 153600, v13
    v_lshrrev_b32 v34, 4, v1
    s_lshl_b32 s56, s73, 8
    s_add_u32 s56, s56, 155648
    v_lshl_add_u32 v7, v34, 4, s56
    v_lshrrev_b32 v34, 5, v1
    v_lshlrev_b32 v34, 6, v34
    v_xor_b32 v12, v34, v15
    s_lshl_b32 s56, s72, 9
    s_lshl_b32 s57, s73, 10
    s_add_u32 s56, s56, s57
    s_add_u32 s56, s56, 156672
    v_lshl_add_u32 v252, v1, 3, s56
    s_lshl_b32 s68, s5, 19
    s_lshl_b32 s57, s4, 15
    s_add_u32 s68, s68, s57
    s_lshl_b32 s57, s72, 14
    s_add_u32 s68, s68, s57
    s_lshl_b32 s57, s73, 12
    s_add_u32 s68, s68, s57
    s_add_u32 s68, s68, 20971520
    s_add_u32 s69, s68, 8192
    s_lshl_b32 s56, s4, 2
    s_lshl_b32 s57, s72, 1
    s_add_u32 s56, s56, s57
    s_mul_i32 s56, s56, 112
    s_lshl_b32 s57, s5, 3
    s_add_u32 s56, s56, s57
    s_lshl_b32 s57, s73, 2
    s_add_u32 s56, s56, s57
    s_lshl_b32 s56, s56, 10
    s_add_u32 s70, s56, 29360128
    s_add_u32 s71, s70, 114688
    s_mov_b64 exec, 0
    s_cmp_lg_u32 s3, 0
    s_cbranch_scc1 L_padr17
    s_branch L_pad17
L_padr17:
    s_cmp_lg_u32 s3, 1
    s_cbranch_scc1 L_padr18
    s_branch L_pad18
L_padr18:
    s_cmp_lg_u32 s3, 2
    s_cbranch_scc1 L_padr19
    s_branch L_pad19
L_padr19:
    s_cmp_lg_u32 s3, 3
    s_cbranch_scc1 L_padr20
    s_branch L_pad20
L_padr20:
    s_mov_b64 exec, -1
    s_waitcnt vmcnt(0)
    s_barrier
    s_barrier
    ds_read_b64_tr_b16 v[48:49], v3 offset:32768
    ds_read_b64_tr_b16 v[50:51], v3 offset:33280
    ds_read_b64_tr_b16 v[52:53], v3 offset:36864
    ds_read_b64_tr_b16 v[54:55], v3 offset:37376
    ds_read_b128 v[16:19], v2 offset:32768
    ds_read_b128 v[32:35], v2 offset:34816
    ds_read_b128 v[20:23], v2 offset:33024
    ds_read_b128 v[36:39], v2 offset:35072
    ds_read_b128 v[24:27], v2 offset:36864
    ds_read_b128 v[40:43], v2 offset:38912
    s_mov_b32 s80, 3
    .p2align 6
L_p_c4_89:
    ds_read_b128 v[28:31], v2 offset:37120
    s_waitcnt lgkmcnt(5)
    v_mfma_f32_16x16x32_bf16 v[128:131], v[48:51], v[16:19], v[128:131]
    ds_read_b128 v[44:47], v2 offset:39168
    v_mfma_f32_16x16x32_bf16 v[128:131], v[52:55], v[32:35], v[128:131]
    ds_read_b64_tr_b16 v[56:57], v4 offset:32768
    s_waitcnt lgkmcnt(5)
    v_mfma_f32_16x16x32_bf16 v[132:135], v[48:51], v[20:23], v[132:135]
    ds_read_b64_tr_b16 v[58:59], v4 offset:33280
    v_mfma_f32_16x16x32_bf16 v[132:135], v[52:55], v[36:39], v[132:135]
    ds_read_b64_tr_b16 v[60:61], v4 offset:36864
    s_waitcnt lgkmcnt(5)
    v_mfma_f32_16x16x32_bf16 v[144:147], v[48:51], v[24:27], v[144:147]
    ds_read_b64_tr_b16 v[62:63], v4 offset:37376
    v_mfma_f32_16x16x32_bf16 v[144:147], v[52:55], v[40:43], v[144:147]
    s_waitcnt lgkmcnt(4)
    v_mfma_f32_16x16x32_bf16 v[148:151], v[48:51], v[28:31], v[148:151]
    ds_read_b64_tr_b16 v[48:49], v5 offset:32768
    v_mfma_f32_16x16x32_bf16 v[148:151], v[52:55], v[44:47], v[148:151]
    ds_read_b64_tr_b16 v[50:51], v5 offset:33280
    s_waitcnt lgkmcnt(4)
    v_mfma_f32_16x16x32_bf16 v[156:159], v[56:59], v[28:31], v[156:159]
    ds_read_b64_tr_b16 v[52:53], v5 offset:36864
    s_waitcnt lgkmcnt(3)
    v_mfma_f32_16x16x32_bf16 v[156:159], v[60:63], v[44:47], v[156:159]
    ds_read_b64_tr_b16 v[54:55], v5 offset:37376
    v_mfma_f32_16x16x32_bf16 v[152:155], v[56:59], v[24:27], v[152:155]
    v_mfma_f32_16x16x32_bf16 v[152:155], v[60:63], v[40:43], v[152:155]
    v_mfma_f32_16x16x32_bf16 v[140:143], v[56:59], v[20:23], v[140:143]
    v_mfma_f32_16x16x32_bf16 v[140:143], v[60:63], v[36:39], v[140:143]
    v_mfma_f32_16x16x32_bf16 v[136:139], v[56:59], v[16:19], v[136:139]
    ds_read_b64_tr_b16 v[56:57], v6 offset:32768
    v_mfma_f32_16x16x32_bf16 v[136:139], v[60:63], v[32:35], v[136:139]
    ds_read_b64_tr_b16 v[58:59], v6 offset:33280
    s_waitcnt lgkmcnt(2)
    v_mfma_f32_16x16x32_bf16 v[160:163], v[48:51], v[16:19], v[160:163]
    ds_read_b64_tr_b16 v[60:61], v6 offset:36864
    v_mfma_f32_16x16x32_bf16 v[160:163], v[52:55], v[32:35], v[160:163]
    ds_read_b64_tr_b16 v[62:63], v6 offset:37376
    v_mfma_f32_16x16x32_bf16 v[164:167], v[48:51], v[20:23], v[164:167]
    v_mfma_f32_16x16x32_bf16 v[164:167], v[52:55], v[36:39], v[164:167]
    v_mfma_f32_16x16x32_bf16 v[176:179], v[48:51], v[24:27], v[176:179]
    v_mfma_f32_16x16x32_bf16 v[176:179], v[52:55], v[40:43], v[176:179]
    v_mfma_f32_16x16x32_bf16 v[180:183], v[48:51], v[28:31], v[180:183]
    v_mfma_f32_16x16x32_bf16 v[180:183], v[52:55], v[44:47], v[180:183]
    s_waitcnt lgkmcnt(0)
    s_barrier
    ds_read_b64_tr_b16 v[48:49], v3 offset:49152
    ds_read_b64_tr_b16 v[50:51], v3 offset:49664
    v_mfma_f32_16x16x32_bf16 v[168:171], v[56:59], v[16:19], v[168:171]
    ds_read_b64_tr_b16 v[52:53], v3 offset:53248
    ds_read_b64_tr_b16 v[54:55], v3 offset:53760
    v_mfma_f32_16x16x32_bf16 v[168:171], v[60:63], v[32:35], v[168:171]
    ds_read_b128 v[16:19], v2 offset:49152
    v_mfma_f32_16x16x32_bf16 v[172:175], v[56:59], v[20:23], v[172:175]
    ds_read_b128 v[32:35], v2 offset:51200
    v_mfma_f32_16x16x32_bf16 v[172:175], v[60:63], v[36:39], v[172:175]
    ds_read_b128 v[20:23], v2 offset:49408
    v_mfma_f32_16x16x32_bf16 v[184:187], v[56:59], v[24:27], v[184:187]
    ds_read_b128 v[36:39], v2 offset:51456
    v_mfma_f32_16x16x32_bf16 v[184:187], v[60:63], v[40:43], v[184:187]
    ds_read_b128 v[24:27], v2 offset:53248
    v_mfma_f32_16x16x32_bf16 v[188:191], v[56:59], v[28:31], v[188:191]
    ds_read_b128 v[40:43], v2 offset:55296
    v_mfma_f32_16x16x32_bf16 v[188:191], v[60:63], v[44:47], v[188:191]
    ds_read_b128 v[28:31], v2 offset:53504
    s_waitcnt lgkmcnt(5)
    v_mfma_f32_16x16x32_bf16 v[128:131], v[48:51], v[16:19], v[128:131]
    ds_read_b128 v[44:47], v2 offset:55552
    v_mfma_f32_16x16x32_bf16 v[128:131], v[52:55], v[32:35], v[128:131]
    ds_read_b64_tr_b16 v[56:57], v4 offset:49152
    s_waitcnt lgkmcnt(5)
    v_mfma_f32_16x16x32_bf16 v[132:135], v[48:51], v[20:23], v[132:135]
    ds_read_b64_tr_b16 v[58:59], v4 offset:49664
    v_mfma_f32_16x16x32_bf16 v[132:135], v[52:55], v[36:39], v[132:135]
    ds_read_b64_tr_b16 v[60:61], v4 offset:53248
    s_waitcnt lgkmcnt(5)
    v_mfma_f32_16x16x32_bf16 v[144:147], v[48:51], v[24:27], v[144:147]
    ds_read_b64_tr_b16 v[62:63], v4 offset:53760
    v_mfma_f32_16x16x32_bf16 v[144:147], v[52:55], v[40:43], v[144:147]
    s_waitcnt lgkmcnt(4)
    v_mfma_f32_16x16x32_bf16 v[148:151], v[48:51], v[28:31], v[148:151]
    ds_read_b64_tr_b16 v[48:49], v5 offset:49152
    v_mfma_f32_16x16x32_bf16 v[148:151], v[52:55], v[44:47], v[148:151]
    ds_read_b64_tr_b16 v[50:51], v5 offset:49664
    s_waitcnt lgkmcnt(4)
    v_mfma_f32_16x16x32_bf16 v[156:159], v[56:59], v[28:31], v[156:159]
    ds_read_b64_tr_b16 v[52:53], v5 offset:53248
    s_waitcnt lgkmcnt(3)
    v_mfma_f32_16x16x32_bf16 v[156:159], v[60:63], v[44:47], v[156:159]
    ds_read_b64_tr_b16 v[54:55], v5 offset:53760
    v_mfma_f32_16x16x32_bf16 v[152:155], v[56:59], v[24:27], v[152:155]
    v_mfma_f32_16x16x32_bf16 v[152:155], v[60:63], v[40:43], v[152:155]
    v_mfma_f32_16x16x32_bf16 v[140:143], v[56:59], v[20:23], v[140:143]
    v_mfma_f32_16x16x32_bf16 v[140:143], v[60:63], v[36:39], v[140:143]
    v_mfma_f32_16x16x32_bf16 v[136:139], v[56:59], v[16:19], v[136:139]
    ds_read_b64_tr_b16 v[56:57], v6 offset:49152
    v_mfma_f32_16x16x32_bf16 v[136:139], v[60:63], v[32:35], v[136:139]
    ds_read_b64_tr_b16 v[58:59], v6 offset:49664
    s_waitcnt lgkmcnt(2)
    v_mfma_f32_16x16x32_bf16 v[160:163], v[48:51], v[16:19], v[160:163]
    ds_read_b64_tr_b16 v[60:61], v6 offset:53248
    v_mfma_f32_16x16x32_bf16 v[160:163], v[52:55], v[32:35], v[160:163]
    ds_read_b64_tr_b16 v[62:63], v6 offset:53760
    v_mfma_f32_16x16x32_bf16 v[164:167], v[48:51], v[20:23], v[164:167]
    v_mfma_f32_16x16x32_bf16 v[164:167], v[52:55], v[36:39], v[164:167]
    v_mfma_f32_16x16x32_bf16 v[176:179], v[48:51], v[24:27], v[176:179]
    v_mfma_f32_16x16x32_bf16 v[176:179], v[52:55], v[40:43], v[176:179]
    v_mfma_f32_16x16x32_bf16 v[180:183], v[48:51], v[28:31], v[180:183]
    v_mfma_f32_16x16x32_bf16 v[180:183], v[52:55], v[44:47], v[180:183]
    s_waitcnt lgkmcnt(0)
    s_barrier
    ds_read_b64_tr_b16 v[48:49], v3 offset:0
    ds_read_b64_tr_b16 v[50:51], v3 offset:512
    v_mfma_f32_16x16x32_bf16 v[168:171], v[56:59], v[16:19], v[168:171]
    ds_read_b64_tr_b16 v[52:53], v3 offset:4096
    ds_read_b64_tr_b16 v[54:55], v3 offset:4608
    v_mfma_f32_16x16x32_bf16 v[168:171], v[60:63], v[32:35], v[168:171]
    ds_read_b128 v[16:19], v2 offset:0
    v_mfma_f32_16x16x32_bf16 v[172:175], v[56:59], v[20:23], v[172:175]
    ds_read_b128 v[32:35], v2 offset:2048
    v_mfma_f32_16x16x32_bf16 v[172:175], v[60:63], v[36:39], v[172:175]
    ds_read_b128 v[20:23], v2 offset:256
    v_mfma_f32_16x16x32_bf16 v[184:187], v[56:59], v[24:27], v[184:187]
    ds_read_b128 v[36:39], v2 offset:2304
    v_mfma_f32_16x16x32_bf16 v[184:187], v[60:63], v[40:43], v[184:187]
    ds_read_b128 v[24:27], v2 offset:4096
    v_mfma_f32_16x16x32_bf16 v[188:191], v[56:59], v[28:31], v[188:191]
    ds_read_b128 v[40:43], v2 offset:6144
    v_mfma_f32_16x16x32_bf16 v[188:191], v[60:63], v[44:47], v[188:191]
    ds_read_b128 v[28:31], v2 offset:4352
    s_waitcnt lgkmcnt(5)
    v_mfma_f32_16x16x32_bf16 v[128:131], v[48:51], v[16:19], v[128:131]
    ds_read_b128 v[44:47], v2 offset:6400
    v_mfma_f32_16x16x32_bf16 v[128:131], v[52:55], v[32:35], v[128:131]
    ds_read_b64_tr_b16 v[56:57], v4 offset:0
    s_waitcnt lgkmcnt(5)
    v_mfma_f32_16x16x32_bf16 v[132:135], v[48:51], v[20:23], v[132:135]
    ds_read_b64_tr_b16 v[58:59], v4 offset:512
    v_mfma_f32_16x16x32_bf16 v[132:135], v[52:55], v[36:39], v[132:135]
    ds_read_b64_tr_b16 v[60:61], v4 offset:4096
    s_waitcnt lgkmcnt(5)
    v_mfma_f32_16x16x32_bf16 v[144:147], v[48:51], v[24:27], v[144:147]
    ds_read_b64_tr_b16 v[62:63], v4 offset:4608
    v_mfma_f32_16x16x32_bf16 v[144:147], v[52:55], v[40:43], v[144:147]
    s_waitcnt lgkmcnt(4)
    v_mfma_f32_16x16x32_bf16 v[148:151], v[48:51], v[28:31], v[148:151]
    ds_read_b64_tr_b16 v[48:49], v5 offset:0
    v_mfma_f32_16x16x32_bf16 v[148:151], v[52:55], v[44:47], v[148:151]
    ds_read_b64_tr_b16 v[50:51], v5 offset:512
    s_waitcnt lgkmcnt(4)
    v_mfma_f32_16x16x32_bf16 v[156:159], v[56:59], v[28:31], v[156:159]
    ds_read_b64_tr_b16 v[52:53], v5 offset:4096
    s_waitcnt lgkmcnt(3)
    v_mfma_f32_16x16x32_bf16 v[156:159], v[60:63], v[44:47], v[156:159]
    ds_read_b64_tr_b16 v[54:55], v5 offset:4608
    v_mfma_f32_16x16x32_bf16 v[152:155], v[56:59], v[24:27], v[152:155]
    v_mfma_f32_16x16x32_bf16 v[152:155], v[60:63], v[40:43], v[152:155]
    v_mfma_f32_16x16x32_bf16 v[140:143], v[56:59], v[20:23], v[140:143]
    v_mfma_f32_16x16x32_bf16 v[140:143], v[60:63], v[36:39], v[140:143]
    v_mfma_f32_16x16x32_bf16 v[136:139], v[56:59], v[16:19], v[136:139]
    ds_read_b64_tr_b16 v[56:57], v6 offset:0
    v_mfma_f32_16x16x32_bf16 v[136:139], v[60:63], v[32:35], v[136:139]
    ds_read_b64_tr_b16 v[58:59], v6 offset:512
    s_waitcnt lgkmcnt(2)
    v_mfma_f32_16x16x32_bf16 v[160:163], v[48:51], v[16:19], v[160:163]
    ds_read_b64_tr_b16 v[60:61], v6 offset:4096
    v_mfma_f32_16x16x32_bf16 v[160:163], v[52:55], v[32:35], v[160:163]
    ds_read_b64_tr_b16 v[62:63], v6 offset:4608
    v_mfma_f32_16x16x32_bf16 v[164:167], v[48:51], v[20:23], v[164:167]
    v_mfma_f32_16x16x32_bf16 v[164:167], v[52:55], v[36:39], v[164:167]
    v_mfma_f32_16x16x32_bf16 v[176:179], v[48:51], v[24:27], v[176:179]
    v_mfma_f32_16x16x32_bf16 v[176:179], v[52:55], v[40:43], v[176:179]
    v_mfma_f32_16x16x32_bf16 v[180:183], v[48:51], v[28:31], v[180:183]
    v_mfma_f32_16x16x32_bf16 v[180:183], v[52:55], v[44:47], v[180:183]
    s_waitcnt lgkmcnt(0)
    s_barrier
    ds_read_b64_tr_b16 v[48:49], v3 offset:16384
    ds_read_b64_tr_b16 v[50:51], v3 offset:16896
    v_mfma_f32_16x16x32_bf16 v[168:171], v[56:59], v[16:19], v[168:171]
    ds_read_b64_tr_b16 v[52:53], v3 offset:20480
    ds_read_b64_tr_b16 v[54:55], v3 offset:20992
    v_mfma_f32_16x16x32_bf16 v[168:171], v[60:63], v[32:35], v[168:171]
    ds_read_b128 v[16:19], v2 offset:16384
    v_mfma_f32_16x16x32_bf16 v[172:175], v[56:59], v[20:23], v[172:175]
    ds_read_b128 v[32:35], v2 offset:18432
    v_mfma_f32_16x16x32_bf16 v[172:175], v[60:63], v[36:39], v[172:175]
    ds_read_b128 v[20:23], v2 offset:16640
    v_mfma_f32_16x16x32_bf16 v[184:187], v[56:59], v[24:27], v[184:187]
    ds_read_b128 v[36:39], v2 offset:18688
    v_mfma_f32_16x16x32_bf16 v[184:187], v[60:63], v[40:43], v[184:187]
    ds_read_b128 v[24:27], v2 offset:20480
    v_mfma_f32_16x16x32_bf16 v[188:191], v[56:59], v[28:31], v[188:191]
    ds_read_b128 v[40:43], v2 offset:22528
    v_mfma_f32_16x16x32_bf16 v[188:191], v[60:63], v[44:47], v[188:191]
    ds_read_b128 v[28:31], v2 offset:20736
    s_waitcnt lgkmcnt(5)
    v_mfma_f32_16x16x32_bf16 v[128:131], v[48:51], v[16:19], v[128:131]
    ds_read_b128 v[44:47], v2 offset:22784
    s_sub_u32 s80, s80, 1
    v_mfma_f32_16x16x32_bf16 v[128:131], v[52:55], v[32:35], v[128:131]
    ds_read_b64_tr_b16 v[56:57], v4 offset:16384
    s_waitcnt lgkmcnt(5)
    v_mfma_f32_16x16x32_bf16 v[132:135], v[48:51], v[20:23], v[132:135]
    ds_read_b64_tr_b16 v[58:59], v4 offset:16896
    v_mfma_f32_16x16x32_bf16 v[132:135], v[52:55], v[36:39], v[132:135]
    ds_read_b64_tr_b16 v[60:61], v4 offset:20480
    s_waitcnt lgkmcnt(5)
    v_mfma_f32_16x16x32_bf16 v[144:147], v[48:51], v[24:27], v[144:147]
    ds_read_b64_tr_b16 v[62:63], v4 offset:20992
    v_mfma_f32_16x16x32_bf16 v[144:147], v[52:55], v[40:43], v[144:147]
    s_waitcnt lgkmcnt(4)
    v_mfma_f32_16x16x32_bf16 v[148:151], v[48:51], v[28:31], v[148:151]
    ds_read_b64_tr_b16 v[48:49], v5 offset:16384
    v_mfma_f32_16x16x32_bf16 v[148:151], v[52:55], v[44:47], v[148:151]
    ds_read_b64_tr_b16 v[50:51], v5 offset:16896
    s_waitcnt lgkmcnt(4)
    v_mfma_f32_16x16x32_bf16 v[156:159], v[56:59], v[28:31], v[156:159]
    ds_read_b64_tr_b16 v[52:53], v5 offset:20480
    s_waitcnt lgkmcnt(3)
    v_mfma_f32_16x16x32_bf16 v[156:159], v[60:63], v[44:47], v[156:159]
    ds_read_b64_tr_b16 v[54:55], v5 offset:20992
    v_mfma_f32_16x16x32_bf16 v[152:155], v[56:59], v[24:27], v[152:155]
    v_mfma_f32_16x16x32_bf16 v[152:155], v[60:63], v[40:43], v[152:155]
    v_mfma_f32_16x16x32_bf16 v[140:143], v[56:59], v[20:23], v[140:143]
    v_mfma_f32_16x16x32_bf16 v[140:143], v[60:63], v[36:39], v[140:143]
    v_mfma_f32_16x16x32_bf16 v[136:139], v[56:59], v[16:19], v[136:139]
    ds_read_b64_tr_b16 v[56:57], v6 offset:16384
    s_cmp_lg_u32 s80, 0
    v_mfma_f32_16x16x32_bf16 v[136:139], v[60:63], v[32:35], v[136:139]
    ds_read_b64_tr_b16 v[58:59], v6 offset:16896
    s_waitcnt lgkmcnt(2)
    v_mfma_f32_16x16x32_bf16 v[160:163], v[48:51], v[16:19], v[160:163]
    ds_read_b64_tr_b16 v[60:61], v6 offset:20480
    v_mfma_f32_16x16x32_bf16 v[160:163], v[52:55], v[32:35], v[160:163]
    ds_read_b64_tr_b16 v[62:63], v6 offset:20992
    v_mfma_f32_16x16x32_bf16 v[164:167], v[48:51], v[20:23], v[164:167]
    v_mfma_f32_16x16x32_bf16 v[164:167], v[52:55], v[36:39], v[164:167]
    v_mfma_f32_16x16x32_bf16 v[176:179], v[48:51], v[24:27], v[176:179]
    v_mfma_f32_16x16x32_bf16 v[176:179], v[52:55], v[40:43], v[176:179]
    v_mfma_f32_16x16x32_bf16 v[180:183], v[48:51], v[28:31], v[180:183]
    v_mfma_f32_16x16x32_bf16 v[180:183], v[52:55], v[44:47], v[180:183]
    s_waitcnt lgkmcnt(0)
    s_barrier
    ds_read_b64_tr_b16 v[48:49], v3 offset:32768
    ds_read_b64_tr_b16 v[50:51], v3 offset:33280
    v_mfma_f32_16x16x32_bf16 v[168:171], v[56:59], v[16:19], v[168:171]
    ds_read_b64_tr_b16 v[52:53], v3 offset:36864
    ds_read_b64_tr_b16 v[54:55], v3 offset:37376
    v_mfma_f32_16x16x32_bf16 v[168:171], v[60:63], v[32:35], v[168:171]
    ds_read_b128 v[16:19], v2 offset:32768
    v_mfma_f32_16x16x32_bf16 v[172:175], v[56:59], v[20:23], v[172:175]
    ds_read_b128 v[32:35], v2 offset:34816
    v_mfma_f32_16x16x32_bf16 v[172:175], v[60:63], v[36:39], v[172:175]
    ds_read_b128 v[20:23], v2 offset:33024
    v_mfma_f32_16x16x32_bf16 v[184:187], v[56:59], v[24:27], v[184:187]
    ds_read_b128 v[36:39], v2 offset:35072
    v_mfma_f32_16x16x32_bf16 v[184:187], v[60:63], v[40:43], v[184:187]
    ds_read_b128 v[24:27], v2 offset:36864
    v_mfma_f32_16x16x32_bf16 v[188:191], v[56:59], v[28:31], v[188:191]
    ds_read_b128 v[40:43], v2 offset:38912
    v_mfma_f32_16x16x32_bf16 v[188:191], v[60:63], v[44:47], v[188:191]
    s_cbranch_scc1 L_p_c4_89
    ds_read_b128 v[28:31], v2 offset:37120
    s_waitcnt lgkmcnt(5)
    v_mfma_f32_16x16x32_bf16 v[128:131], v[48:51], v[16:19], v[128:131]
    ds_read_b128 v[44:47], v2 offset:39168
    v_mfma_f32_16x16x32_bf16 v[128:131], v[52:55], v[32:35], v[128:131]
    ds_read_b64_tr_b16 v[56:57], v4 offset:32768
    s_waitcnt lgkmcnt(5)
    v_mfma_f32_16x16x32_bf16 v[132:135], v[48:51], v[20:23], v[132:135]
    ds_read_b64_tr_b16 v[58:59], v4 offset:33280
    v_mfma_f32_16x16x32_bf16 v[132:135], v[52:55], v[36:39], v[132:135]
    ds_read_b64_tr_b16 v[60:61], v4 offset:36864
    s_waitcnt lgkmcnt(5)
    v_mfma_f32_16x16x32_bf16 v[144:147], v[48:51], v[24:27], v[144:147]
    ds_read_b64_tr_b16 v[62:63], v4 offset:37376
    v_mfma_f32_16x16x32_bf16 v[144:147], v[52:55], v[40:43], v[144:147]
    s_waitcnt lgkmcnt(4)
    v_mfma_f32_16x16x32_bf16 v[148:151], v[48:51], v[28:31], v[148:151]
    ds_read_b64_tr_b16 v[48:49], v5 offset:32768
    v_mfma_f32_16x16x32_bf16 v[148:151], v[52:55], v[44:47], v[148:151]
    ds_read_b64_tr_b16 v[50:51], v5 offset:33280
    s_waitcnt lgkmcnt(4)
    v_mfma_f32_16x16x32_bf16 v[156:159], v[56:59], v[28:31], v[156:159]
    ds_read_b64_tr_b16 v[52:53], v5 offset:36864
    s_waitcnt lgkmcnt(3)
    v_mfma_f32_16x16x32_bf16 v[156:159], v[60:63], v[44:47], v[156:159]
    ds_read_b64_tr_b16 v[54:55], v5 offset:37376
    v_mfma_f32_16x16x32_bf16 v[152:155], v[56:59], v[24:27], v[152:155]
    v_mfma_f32_16x16x32_bf16 v[152:155], v[60:63], v[40:43], v[152:155]
    v_mfma_f32_16x16x32_bf16 v[140:143], v[56:59], v[20:23], v[140:143]
    v_mfma_f32_16x16x32_bf16 v[140:143], v[60:63], v[36:39], v[140:143]
    v_mfma_f32_16x16x32_bf16 v[136:139], v[56:59], v[16:19], v[136:139]
    ds_read_b64_tr_b16 v[56:57], v6 offset:32768
    v_mfma_f32_16x16x32_bf16 v[136:139], v[60:63], v[32:35], v[136:139]
    ds_read_b64_tr_b16 v[58:59], v6 offset:33280
    s_waitcnt lgkmcnt(2)
    v_mfma_f32_16x16x32_bf16 v[160:163], v[48:51], v[16:19], v[160:163]
    ds_read_b64_tr_b16 v[60:61], v6 offset:36864
    v_mfma_f32_16x16x32_bf16 v[160:163], v[52:55], v[32:35], v[160:163]
    ds_read_b64_tr_b16 v[62:63], v6 offset:37376
    v_mfma_f32_16x16x32_bf16 v[164:167], v[48:51], v[20:23], v[164:167]
    v_mfma_f32_16x16x32_bf16 v[164:167], v[52:55], v[36:39], v[164:167]
    v_mfma_f32_16x16x32_bf16 v[176:179], v[48:51], v[24:27], v[176:179]
    v_mfma_f32_16x16x32_bf16 v[176:179], v[52:55], v[40:43], v[176:179]
    v_mfma_f32_16x16x32_bf16 v[180:183], v[48:51], v[28:31], v[180:183]
    v_mfma_f32_16x16x32_bf16 v[180:183], v[52:55], v[44:47], v[180:183]
    s_waitcnt lgkmcnt(0)
    s_barrier
    ds_read_b64_tr_b16 v[48:49], v3 offset:49152
    ds_read_b64_tr_b16 v[50:51], v3 offset:49664
    v_mfma_f32_16x16x32_bf16 v[168:171], v[56:59], v[16:19], v[168:171]
    ds_read_b64_tr_b16 v[52:53], v3 offset:53248
    ds_read_b64_tr_b16 v[54:55], v3 offset:53760
    v_mfma_f32_16x16x32_bf16 v[168:171], v[60:63], v[32:35], v[168:171]
    ds_read_b128 v[16:19], v2 offset:49152
    v_mfma_f32_16x16x32_bf16 v[172:175], v[56:59], v[20:23], v[172:175]
    ds_read_b128 v[32:35], v2 offset:51200
    v_mfma_f32_16x16x32_bf16 v[172:175], v[60:63], v[36:39], v[172:175]
    ds_read_b128 v[20:23], v2 offset:49408
    v_mfma_f32_16x16x32_bf16 v[184:187], v[56:59], v[24:27], v[184:187]
    ds_read_b128 v[36:39], v2 offset:51456
    v_mfma_f32_16x16x32_bf16 v[184:187], v[60:63], v[40:43], v[184:187]
    ds_read_b128 v[24:27], v2 offset:53248
    v_mfma_f32_16x16x32_bf16 v[188:191], v[56:59], v[28:31], v[188:191]
    ds_read_b128 v[40:43], v2 offset:55296
    v_mfma_f32_16x16x32_bf16 v[188:191], v[60:63], v[44:47], v[188:191]
    ds_read_b128 v[28:31], v2 offset:53504
    s_waitcnt lgkmcnt(5)
    v_mfma_f32_16x16x32_bf16 v[128:131], v[48:51], v[16:19], v[128:131]
    ds_read_b128 v[44:47], v2 offset:55552
    v_mfma_f32_16x16x32_bf16 v[128:131], v[52:55], v[32:35], v[128:131]
    ds_read_b64_tr_b16 v[56:57], v4 offset:49152
    s_waitcnt lgkmcnt(5)
    v_mfma_f32_16x16x32_bf16 v[132:135], v[48:51], v[20:23], v[132:135]
    ds_read_b64_tr_b16 v[58:59], v4 offset:49664
L_pad11:
    s_cbranch_execz L_padr11
    v_mfma_f32_16x16x32_bf16 v[132:135], v[52:55], v[36:39], v[132:135]
    ds_read_b64_tr_b16 v[60:61], v4 offset:53248
    s_waitcnt lgkmcnt(5)
    v_mfma_f32_16x16x32_bf16 v[144:147], v[48:51], v[24:27], v[144:147]
    ds_read_b64_tr_b16 v[62:63], v4 offset:53760
    v_mfma_f32_16x16x32_bf16 v[144:147], v[52:55], v[40:43], v[144:147]
    s_waitcnt lgkmcnt(4)
    v_mfma_f32_16x16x32_bf16 v[148:151], v[48:51], v[28:31], v[148:151]
    ds_read_b64_tr_b16 v[48:49], v5 offset:49152
    v_mfma_f32_16x16x32_bf16 v[148:151], v[52:55], v[44:47], v[148:151]
    ds_read_b64_tr_b16 v[50:51], v5 offset:49664
    s_waitcnt lgkmcnt(4)
    v_mfma_f32_16x16x32_bf16 v[156:159], v[56:59], v[28:31], v[156:159]
    ds_read_b64_tr_b16 v[52:53], v5 offset:53248
    s_waitcnt lgkmcnt(3)
    v_mfma_f32_16x16x32_bf16 v[156:159], v[60:63], v[44:47], v[156:159]
    ds_read_b64_tr_b16 v[54:55], v5 offset:53760
    v_mfma_f32_16x16x32_bf16 v[152:155], v[56:59], v[24:27], v[152:155]
    v_mfma_f32_16x16x32_bf16 v[152:155], v[60:63], v[40:43], v[152:155]
    v_mfma_f32_16x16x32_bf16 v[140:143], v[56:59], v[20:23], v[140:143]
    v_mfma_f32_16x16x32_bf16 v[140:143], v[60:63], v[36:39], v[140:143]
    v_mfma_f32_16x16x32_bf16 v[136:139], v[56:59], v[16:19], v[136:139]
    ds_read_b64_tr_b16 v[56:57], v6 offset:49152
    v_mfma_f32_16x16x32_bf16 v[136:139], v[60:63], v[32:35], v[136:139]
    ds_read_b64_tr_b16 v[58:59], v6 offset:49664
    s_waitcnt lgkmcnt(2)
    v_mfma_f32_16x16x32_bf16 v[160:163], v[48:51], v[16:19], v[160:163]
    ds_read_b64_tr_b16 v[60:61], v6 offset:53248
    v_mfma_f32_16x16x32_bf16 v[160:163], v[52:55], v[32:35], v[160:163]
    ds_read_b64_tr_b16 v[62:63], v6 offset:53760
    v_mfma_f32_16x16x32_bf16 v[164:167], v[48:51], v[20:23], v[164:167]
    v_mfma_f32_16x16x32_bf16 v[164:167], v[52:55], v[36:39], v[164:167]
    v_mfma_f32_16x16x32_bf16 v[176:179], v[48:51], v[24:27], v[176:179]
    v_mfma_f32_16x16x32_bf16 v[176:179], v[52:55], v[40:43], v[176:179]
    v_mfma_f32_16x16x32_bf16 v[180:183], v[48:51], v[28:31], v[180:183]
    v_mfma_f32_16x16x32_bf16 v[180:183], v[52:55], v[44:47], v[180:183]
    s_waitcnt lgkmcnt(0)
    s_barrier
    ds_read_b64_tr_b16 v[48:49], v3 offset:0
    ds_read_b64_tr_b16 v[50:51], v3 offset:512
    v_mfma_f32_16x16x32_bf16 v[168:171], v[56:59], v[16:19], v[168:171]
    ds_read_b64_tr_b16 v[52:53], v3 offset:4096
    ds_read_b64_tr_b16 v[54:55], v3 offset:4608
    v_mfma_f32_16x16x32_bf16 v[168:171], v[60:63], v[32:35], v[168:171]
    ds_read_b128 v[16:19], v2 offset:0
    v_mfma_f32_16x16x32_bf16 v[172:175], v[56:59], v[20:23], v[172:175]
    ds_read_b128 v[32:35], v2 offset:2048
    v_mfma_f32_16x16x32_bf16 v[172:175], v[60:63], v[36:39], v[172:175]
    ds_read_b128 v[20:23], v2 offset:256
    v_mfma_f32_16x16x32_bf16 v[184:187], v[56:59], v[24:27], v[184:187]
    ds_read_b128 v[36:39], v2 offset:2304
    v_mfma_f32_16x16x32_bf16 v[184:187], v[60:63], v[40:43], v[184:187]
    ds_read_b128 v[24:27], v2 offset:4096
    v_mfma_f32_16x16x32_bf16 v[188:191], v[56:59], v[28:31], v[188:191]
    ds_read_b128 v[40:43], v2 offset:6144
    v_mfma_f32_16x16x32_bf16 v[188:191], v[60:63], v[44:47], v[188:191]
    ds_read_b128 v[28:31], v2 offset:4352
    s_waitcnt lgkmcnt(5)
    v_mfma_f32_16x16x32_bf16 v[128:131], v[48:51], v[16:19], v[128:131]
    ds_read_b128 v[44:47], v2 offset:6400
    v_mfma_f32_16x16x32_bf16 v[128:131], v[52:55], v[32:35], v[128:131]
    ds_read_b64_tr_b16 v[56:57], v4 offset:0
    s_waitcnt lgkmcnt(5)
    v_mfma_f32_16x16x32_bf16 v[132:135], v[48:51], v[20:23], v[132:135]
    ds_read_b64_tr_b16 v[58:59], v4 offset:512
    v_mfma_f32_16x16x32_bf16 v[132:135], v[52:55], v[36:39], v[132:135]
    ds_read_b64_tr_b16 v[60:61], v4 offset:4096
    s_waitcnt lgkmcnt(5)
    v_mfma_f32_16x16x32_bf16 v[144:147], v[48:51], v[24:27], v[144:147]
    ds_read_b64_tr_b16 v[62:63], v4 offset:4608
    v_mfma_f32_16x16x32_bf16 v[144:147], v[52:55], v[40:43], v[144:147]
    s_waitcnt lgkmcnt(4)
    v_mfma_f32_16x16x32_bf16 v[148:151], v[48:51], v[28:31], v[148:151]
    ds_read_b64_tr_b16 v[48:49], v5 offset:0
    v_mfma_f32_16x16x32_bf16 v[148:151], v[52:55], v[44:47], v[148:151]
    ds_read_b64_tr_b16 v[50:51], v5 offset:512
    s_waitcnt lgkmcnt(4)
    v_mfma_f32_16x16x32_bf16 v[156:159], v[56:59], v[28:31], v[156:159]
    ds_read_b64_tr_b16 v[52:53], v5 offset:4096
    s_waitcnt lgkmcnt(3)
    v_mfma_f32_16x16x32_bf16 v[156:159], v[60:63], v[44:47], v[156:159]
    ds_read_b64_tr_b16 v[54:55], v5 offset:4608
    v_mfma_f32_16x16x32_bf16 v[152:155], v[56:59], v[24:27], v[152:155]
    v_mfma_f32_16x16x32_bf16 v[152:155], v[60:63], v[40:43], v[152:155]
    v_mfma_f32_16x16x32_bf16 v[140:143], v[56:59], v[20:23], v[140:143]
    v_mfma_f32_16x16x32_bf16 v[140:143], v[60:63], v[36:39], v[140:143]
    v_mfma_f32_16x16x32_bf16 v[136:139], v[56:59], v[16:19], v[136:139]
    ds_read_b64_tr_b16 v[56:57], v6 offset:0
    v_mfma_f32_16x16x32_bf16 v[136:139], v[60:63], v[32:35], v[136:139]
    ds_read_b64_tr_b16 v[58:59], v6 offset:512
    s_waitcnt lgkmcnt(2)
    v_mfma_f32_16x16x32_bf16 v[160:163], v[48:51], v[16:19], v[160:163]
    ds_read_b64_tr_b16 v[60:61], v6 offset:4096
    v_mfma_f32_16x16x32_bf16 v[160:163], v[52:55], v[32:35], v[160:163]
    ds_read_b64_tr_b16 v[62:63], v6 offset:4608
    v_mfma_f32_16x16x32_bf16 v[164:167], v[48:51], v[20:23], v[164:167]
    v_mfma_f32_16x16x32_bf16 v[164:167], v[52:55], v[36:39], v[164:167]
    v_mfma_f32_16x16x32_bf16 v[176:179], v[48:51], v[24:27], v[176:179]
    v_mfma_f32_16x16x32_bf16 v[176:179], v[52:55], v[40:43], v[176:179]
    v_mfma_f32_16x16x32_bf16 v[180:183], v[48:51], v[28:31], v[180:183]
    v_mfma_f32_16x16x32_bf16 v[180:183], v[52:55], v[44:47], v[180:183]
    s_waitcnt lgkmcnt(0)
    s_barrier
    ds_read_b64_tr_b16 v[48:49], v3 offset:16384
    ds_read_b64_tr_b16 v[50:51], v3 offset:16896
    v_mfma_f32_16x16x32_bf16 v[168:171], v[56:59], v[16:19], v[168:171]
    ds_read_b64_tr_b16 v[52:53], v3 offset:20480
    ds_read_b64_tr_b16 v[54:55], v3 offset:20992
    v_mfma_f32_16x16x32_bf16 v[168:171], v[60:63], v[32:35], v[168:171]
    ds_read_b128 v[16:19], v2 offset:16384
    v_mfma_f32_16x16x32_bf16 v[172:175], v[56:59], v[20:23], v[172:175]
    ds_read_b128 v[32:35], v2 offset:18432
    v_mfma_f32_16x16x32_bf16 v[172:175], v[60:63], v[36:39], v[172:175]
    ds_read_b128 v[20:23], v2 offset:16640
    v_mfma_f32_16x16x32_bf16 v[184:187], v[56:59], v[24:27], v[184:187]
    ds_read_b128 v[36:39], v2 offset:18688
    v_mfma_f32_16x16x32_bf16 v[184:187], v[60:63], v[40:43], v[184:187]
    ds_read_b128 v[24:27], v2 offset:20480
    v_mfma_f32_16x16x32_bf16 v[188:191], v[56:59], v[28:31], v[188:191]
    ds_read_b128 v[40:43], v2 offset:22528
    v_mfma_f32_16x16x32_bf16 v[188:191], v[60:63], v[44:47], v[188:191]
    ds_read_b128 v[28:31], v2 offset:20736
    s_waitcnt lgkmcnt(5)
    v_mfma_f32_16x16x32_bf16 v[128:131], v[48:51], v[16:19], v[128:131]
    ds_read_b128 v[44:47], v2 offset:22784
    v_mfma_f32_16x16x32_bf16 v[128:131], v[52:55], v[32:35], v[128:131]
    ds_read_b64_tr_b16 v[56:57], v4 offset:16384
    s_waitcnt lgkmcnt(5)
    v_mfma_f32_16x16x32_bf16 v[132:135], v[48:51], v[20:23], v[132:135]
    ds_read_b64_tr_b16 v[58:59], v4 offset:16896
    v_mfma_f32_16x16x32_bf16 v[132:135], v[52:55], v[36:39], v[132:135]
    ds_read_b64_tr_b16 v[60:61], v4 offset:20480
    s_waitcnt lgkmcnt(5)
    v_mfma_f32_16x16x32_bf16 v[144:147], v[48:51], v[24:27], v[144:147]
    ds_read_b64_tr_b16 v[62:63], v4 offset:20992
    v_mfma_f32_16x16x32_bf16 v[144:147], v[52:55], v[40:43], v[144:147]
    s_waitcnt lgkmcnt(4)
    v_mfma_f32_16x16x32_bf16 v[148:151], v[48:51], v[28:31], v[148:151]
    ds_read_b64_tr_b16 v[48:49], v5 offset:16384
    v_mfma_f32_16x16x32_bf16 v[148:151], v[52:55], v[44:47], v[148:151]
    ds_read_b64_tr_b16 v[50:51], v5 offset:16896
    s_waitcnt lgkmcnt(4)
    v_mfma_f32_16x16x32_bf16 v[156:159], v[56:59], v[28:31], v[156:159]
    ds_read_b64_tr_b16 v[52:53], v5 offset:20480
    s_waitcnt lgkmcnt(3)
    v_mfma_f32_16x16x32_bf16 v[156:159], v[60:63], v[44:47], v[156:159]
    ds_read_b64_tr_b16 v[54:55], v5 offset:20992
    v_mfma_f32_16x16x32_bf16 v[152:155], v[56:59], v[24:27], v[152:155]
    v_mfma_f32_16x16x32_bf16 v[152:155], v[60:63], v[40:43], v[152:155]
    v_mfma_f32_16x16x32_bf16 v[140:143], v[56:59], v[20:23], v[140:143]
    v_mfma_f32_16x16x32_bf16 v[140:143], v[60:63], v[36:39], v[140:143]
    v_mfma_f32_16x16x32_bf16 v[136:139], v[56:59], v[16:19], v[136:139]
    ds_read_b64_tr_b16 v[56:57], v6 offset:16384
    v_mfma_f32_16x16x32_bf16 v[136:139], v[60:63], v[32:35], v[136:139]
    ds_read_b64_tr_b16 v[58:59], v6 offset:16896
    s_waitcnt lgkmcnt(2)
    v_mfma_f32_16x16x32_bf16 v[160:163], v[48:51], v[16:19], v[160:163]
    ds_read_b64_tr_b16 v[60:61], v6 offset:20480
    v_mfma_f32_16x16x32_bf16 v[160:163], v[52:55], v[32:35], v[160:163]
    ds_read_b64_tr_b16 v[62:63], v6 offset:20992
    v_mfma_f32_16x16x32_bf16 v[164:167], v[48:51], v[20:23], v[164:167]
    v_mfma_f32_16x16x32_bf16 v[164:167], v[52:55], v[36:39], v[164:167]
    v_mfma_f32_16x16x32_bf16 v[176:179], v[48:51], v[24:27], v[176:179]
    v_mfma_f32_16x16x32_bf16 v[176:179], v[52:55], v[40:43], v[176:179]
    v_mfma_f32_16x16x32_bf16 v[180:183], v[48:51], v[28:31], v[180:183]
    v_mfma_f32_16x16x32_bf16 v[180:183], v[52:55], v[44:47], v[180:183]
    s_waitcnt lgkmcnt(0)
    s_barrier
    ds_read_b128 v[208:211], v13 offset:0
    ds_read_b128 v[212:215], v13 offset:256
    v_mfma_f32_16x16x32_bf16 v[168:171], v[56:59], v[16:19], v[168:171]
    ds_read_b128 v[216:219], v13 offset:512
    ds_read_b128 v[220:223], v13 offset:768
    v_mfma_f32_16x16x32_bf16 v[168:171], v[60:63], v[32:35], v[168:171]
    ds_read_b128 v[192:195], v7 offset:512
    ds_read_b128 v[196:199], v7 offset:576
    v_mfma_f32_16x16x32_bf16 v[172:175], v[56:59], v[20:23], v[172:175]
    ds_read_b128 v[200:203], v7 offset:640
    ds_read_b128 v[204:207], v7 offset:704
    v_mfma_f32_16x16x32_bf16 v[172:175], v[60:63], v[36:39], v[172:175]
    v_mfma_f32_16x16x32_bf16 v[184:187], v[56:59], v[24:27], v[184:187]
    v_mfma_f32_16x16x32_bf16 v[184:187], v[60:63], v[40:43], v[184:187]
    v_mfma_f32_16x16x32_bf16 v[188:191], v[56:59], v[28:31], v[188:191]
    v_mfma_f32_16x16x32_bf16 v[188:191], v[60:63], v[44:47], v[188:191]
    s_waitcnt lgkmcnt(0)
    s_nop 3
    v_pk_fma_f32 v[128:129], v[192:193], v[208:209], v[128:129] op_sel_hi:[1,0,1]
    v_pk_fma_f32 v[130:131], v[194:195], v[208:209], v[130:131] op_sel_hi:[1,0,1]
    v_pk_fma_f32 v[136:137], v[196:197], v[208:209], v[136:137] op_sel_hi:[1,0,1]
    v_pk_fma_f32 v[138:139], v[198:199], v[208:209], v[138:139] op_sel_hi:[1,0,1]
    v_pk_mul_f32 v[32:33], v[128:129], v[128:129]
    v_pk_mul_f32 v[34:35], v[130:131], v[130:131]
    v_pk_mul_f32 v[36:37], v[136:137], v[136:137]
    v_pk_mul_f32 v[38:39], v[138:139], v[138:139]
    v_pk_fma_f32 v[32:33], v[32:33], v[210:211], v[208:209] op_sel:[0,0,1] op_sel_hi:[1,0,1]
    v_pk_fma_f32 v[34:35], v[34:35], v[210:211], v[208:209] op_sel:[0,0,1] op_sel_hi:[1,0,1]
    v_pk_fma_f32 v[36:37], v[36:37], v[210:211], v[208:209] op_sel:[0,0,1] op_sel_hi:[1,0,1]
    v_pk_fma_f32 v[38:39], v[38:39], v[210:211], v[208:209] op_sel:[0,0,1] op_sel_hi:[1,0,1]
    v_pk_mul_f32 v[32:33], v[32:33], v[128:129]
    v_pk_mul_f32 v[34:35], v[34:35], v[130:131]
    v_pk_mul_f32 v[36:37], v[36:37], v[136:137]
    v_pk_mul_f32 v[38:39], v[38:39], v[138:139]
    v_exp_f32 v32, v32
    v_exp_f32 v33, v33
    v_exp_f32 v34, v34
    v_exp_f32 v35, v35
    v_exp_f32 v36, v36
    v_exp_f32 v37, v37
    v_exp_f32 v38, v38
    v_exp_f32 v39, v39
    v_pk_fma_f32 v[160:161], v[200:201], v[208:209], v[160:161] op_sel_hi:[1,0,1]
    v_pk_fma_f32 v[162:163], v[202:203], v[208:209], v[162:163] op_sel_hi:[1,0,1]
    v_pk_fma_f32 v[168:169], v[204:205], v[208:209], v[168:169] op_sel_hi:[1,0,1]
    v_pk_fma_f32 v[170:171], v[206:207], v[208:209], v[170:171] op_sel_hi:[1,0,1]
    v_pk_mul_f32 v[40:41], v[160:161], v[160:161]
    v_pk_mul_f32 v[42:43], v[162:163], v[162:163]
    v_pk_mul_f32 v[44:45], v[168:169], v[168:169]
    v_pk_mul_f32 v[46:47], v[170:171], v[170:171]
    v_pk_fma_f32 v[32:33], v[32:33], v[210:211], v[210:211] op_sel:[0,1,1] op_sel_hi:[1,1,1]
    v_pk_fma_f32 v[34:35], v[34:35], v[210:211], v[210:211] op_sel:[0,1,1] op_sel_hi:[1,1,1]
    v_pk_fma_f32 v[36:37], v[36:37], v[210:211], v[210:211] op_sel:[0,1,1] op_sel_hi:[1,1,1]
    v_pk_fma_f32 v[38:39], v[38:39], v[210:211], v[210:211] op_sel:[0,1,1] op_sel_hi:[1,1,1]
    v_pk_fma_f32 v[40:41], v[40:41], v[210:211], v[208:209] op_sel:[0,0,1] op_sel_hi:[1,0,1]
    v_pk_fma_f32 v[42:43], v[42:43], v[210:211], v[208:209] op_sel:[0,0,1] op_sel_hi:[1,0,1]
    v_pk_fma_f32 v[44:45], v[44:45], v[210:211], v[208:209] op_sel:[0,0,1] op_sel_hi:[1,0,1]
    v_pk_fma_f32 v[46:47], v[46:47], v[210:211], v[208:209] op_sel:[0,0,1] op_sel_hi:[1,0,1]
    v_rcp_f32 v32, v32
    v_rcp_f32 v33, v33
    v_rcp_f32 v34, v34
    v_rcp_f32 v35, v35
    v_rcp_f32 v36, v36
    v_rcp_f32 v37, v37
    v_rcp_f32 v38, v38
    v_rcp_f32 v39, v39
    v_pk_mul_f32 v[40:41], v[40:41], v[160:161]
    v_pk_mul_f32 v[42:43], v[42:43], v[162:163]
    v_pk_mul_f32 v[44:45], v[44:45], v[168:169]
    v_pk_mul_f32 v[46:47], v[46:47], v[170:171]
    v_pk_mul_f32 v[128:129], v[128:129], v[32:33]
    v_pk_mul_f32 v[130:131], v[130:131], v[34:35]
    v_pk_mul_f32 v[136:137], v[136:137], v[36:37]
    v_pk_mul_f32 v[138:139], v[138:139], v[38:39]
    v_exp_f32 v40, v40
    v_exp_f32 v41, v41
    v_exp_f32 v42, v42
    v_exp_f32 v43, v43
    v_exp_f32 v44, v44
    v_exp_f32 v45, v45
    v_exp_f32 v46, v46
    v_exp_f32 v47, v47
    v_pk_fma_f32 v[132:133], v[192:193], v[212:213], v[132:133] op_sel_hi:[1,0,1]
    v_pk_fma_f32 v[134:135], v[194:195], v[212:213], v[134:135] op_sel_hi:[1,0,1]
    v_pk_fma_f32 v[140:141], v[196:197], v[212:213], v[140:141] op_sel_hi:[1,0,1]
    v_pk_fma_f32 v[142:143], v[198:199], v[212:213], v[142:143] op_sel_hi:[1,0,1]
    v_pk_mul_f32 v[32:33], v[132:133], v[132:133]
    v_pk_mul_f32 v[34:35], v[134:135], v[134:135]
    v_pk_mul_f32 v[36:37], v[140:141], v[140:141]
    v_pk_mul_f32 v[38:39], v[142:143], v[142:143]
    v_pk_mul_f32 v[62:63], v[128:129], v[128:129]
    v_pk_add_f32 v[60:61], v[128:129], v[130:131]
    v_pk_fma_f32 v[62:63], v[130:131], v[130:131], v[62:63]
    v_pk_add_f32 v[60:61], v[60:61], v[136:137]
    v_pk_fma_f32 v[40:41], v[40:41], v[210:211], v[210:211] op_sel:[0,1,1] op_sel_hi:[1,1,1]
    v_pk_fma_f32 v[42:43], v[42:43], v[210:211], v[210:211] op_sel:[0,1,1] op_sel_hi:[1,1,1]
    v_pk_fma_f32 v[44:45], v[44:45], v[210:211], v[210:211] op_sel:[0,1,1] op_sel_hi:[1,1,1]
    v_pk_fma_f32 v[46:47], v[46:47], v[210:211], v[210:211] op_sel:[0,1,1] op_sel_hi:[1,1,1]
    v_pk_fma_f32 v[32:33], v[32:33], v[214:215], v[212:213] op_sel:[0,0,1] op_sel_hi:[1,0,1]
    v_pk_fma_f32 v[34:35], v[34:35], v[214:215], v[212:213] op_sel:[0,0,1] op_sel_hi:[1,0,1]
    v_pk_fma_f32 v[36:37], v[36:37], v[214:215], v[212:213] op_sel:[0,0,1] op_sel_hi:[1,0,1]
    v_pk_fma_f32 v[38:39], v[38:39], v[214:215], v[212:213] op_sel:[0,0,1] op_sel_hi:[1,0,1]
    v_rcp_f32 v40, v40
    v_rcp_f32 v41, v41
    v_rcp_f32 v42, v42
    v_rcp_f32 v43, v43
    v_rcp_f32 v44, v44
    v_rcp_f32 v45, v45
    v_rcp_f32 v46, v46
    v_rcp_f32 v47, v47
    v_pk_mul_f32 v[32:33], v[32:33], v[132:133]
    v_pk_mul_f32 v[34:35], v[34:35], v[134:135]
    v_pk_mul_f32 v[36:37], v[36:37], v[140:141]
    v_pk_mul_f32 v[38:39], v[38:39], v[142:143]
    v_pk_fma_f32 v[62:63], v[136:137], v[136:137], v[62:63]
    v_pk_add_f32 v[60:61], v[60:61], v[138:139]
    v_pk_fma_f32 v[62:63], v[138:139], v[138:139], v[62:63]
    v_pk_mul_f32 v[160:161], v[160:161], v[40:41]
    v_pk_mul_f32 v[162:163], v[162:163], v[42:43]
    v_pk_mul_f32 v[168:169], v[168:169], v[44:45]
    v_pk_mul_f32 v[170:171], v[170:171], v[46:47]
    v_exp_f32 v32, v32
    v_exp_f32 v33, v33
    v_exp_f32 v34, v34
    v_exp_f32 v35, v35
    v_exp_f32 v36, v36
    v_exp_f32 v37, v37
    v_exp_f32 v38, v38
    v_exp_f32 v39, v39
    v_pk_fma_f32 v[164:165], v[200:201], v[212:213], v[164:165] op_sel_hi:[1,0,1]
    v_pk_fma_f32 v[166:167], v[202:203], v[212:213], v[166:167] op_sel_hi:[1,0,1]
    v_pk_fma_f32 v[172:173], v[204:205], v[212:213], v[172:173] op_sel_hi:[1,0,1]
    v_pk_fma_f32 v[174:175], v[206:207], v[212:213], v[174:175] op_sel_hi:[1,0,1]
    v_pk_mul_f32 v[40:41], v[164:165], v[164:165]
    v_pk_mul_f32 v[42:43], v[166:167], v[166:167]
    v_pk_mul_f32 v[44:45], v[172:173], v[172:173]
    v_pk_mul_f32 v[46:47], v[174:175], v[174:175]
    v_pk_add_f32 v[60:61], v[60:61], v[160:161]
    v_pk_fma_f32 v[62:63], v[160:161], v[160:161], v[62:63]
    v_pk_add_f32 v[60:61], v[60:61], v[162:163]
    v_pk_fma_f32 v[62:63], v[162:163], v[162:163], v[62:63]
    v_pk_fma_f32 v[32:33], v[32:33], v[214:215], v[214:215] op_sel:[0,1,1] op_sel_hi:[1,1,1]
    v_pk_fma_f32 v[34:35], v[34:35], v[214:215], v[214:215] op_sel:[0,1,1] op_sel_hi:[1,1,1]
    v_pk_fma_f32 v[36:37], v[36:37], v[214:215], v[214:215] op_sel:[0,1,1] op_sel_hi:[1,1,1]
    v_pk_fma_f32 v[38:39], v[38:39], v[214:215], v[214:215] op_sel:[0,1,1] op_sel_hi:[1,1,1]
    v_pk_fma_f32 v[40:41], v[40:41], v[214:215], v[212:213] op_sel:[0,0,1] op_sel_hi:[1,0,1]
    v_pk_fma_f32 v[42:43], v[42:43], v[214:215], v[212:213] op_sel:[0,0,1] op_sel_hi:[1,0,1]
    v_pk_fma_f32 v[44:45], v[44:45], v[214:215], v[212:213] op_sel:[0,0,1] op_sel_hi:[1,0,1]
    v_pk_fma_f32 v[46:47], v[46:47], v[214:215], v[212:213] op_sel:[0,0,1] op_sel_hi:[1,0,1]
    v_rcp_f32 v32, v32
    v_rcp_f32 v33, v33
    v_rcp_f32 v34, v34
    v_rcp_f32 v35, v35
    v_rcp_f32 v36, v36
    v_rcp_f32 v37, v37
    v_rcp_f32 v38, v38
    v_rcp_f32 v39, v39
    v_pk_mul_f32 v[40:41], v[40:41], v[164:165]
    v_pk_mul_f32 v[42:43], v[42:43], v[166:167]
    v_pk_mul_f32 v[44:45], v[44:45], v[172:173]
    v_pk_mul_f32 v[46:47], v[46:47], v[174:175]
    v_pk_add_f32 v[60:61], v[60:61], v[168:169]
    v_pk_fma_f32 v[62:63], v[168:169], v[168:169], v[62:63]
    v_pk_add_f32 v[60:61], v[60:61], v[170:171]
    v_pk_fma_f32 v[62:63], v[170:171], v[170:171], v[62:63]
    v_add_f32 v244, v60, v61
    v_add_f32 v248, v62, v63
    v_pk_mul_f32 v[132:133], v[132:133], v[32:33]
    v_pk_mul_f32 v[134:135], v[134:135], v[34:35]
    v_pk_mul_f32 v[140:141], v[140:141], v[36:37]
    v_pk_mul_f32 v[142:143], v[142:143], v[38:39]
    v_exp_f32 v40, v40
    v_exp_f32 v41, v41
    v_exp_f32 v42, v42
    v_exp_f32 v43, v43
    v_exp_f32 v44, v44
    v_exp_f32 v45, v45
    v_exp_f32 v46, v46
    v_exp_f32 v47, v47
    v_pk_fma_f32 v[144:145], v[192:193], v[216:217], v[144:145] op_sel_hi:[1,0,1]
    v_pk_fma_f32 v[146:147], v[194:195], v[216:217], v[146:147] op_sel_hi:[1,0,1]
    v_pk_fma_f32 v[152:153], v[196:197], v[216:217], v[152:153] op_sel_hi:[1,0,1]
    v_pk_fma_f32 v[154:155], v[198:199], v[216:217], v[154:155] op_sel_hi:[1,0,1]
    v_pk_mul_f32 v[32:33], v[144:145], v[144:145]
    v_pk_mul_f32 v[34:35], v[146:147], v[146:147]
    v_pk_mul_f32 v[36:37], v[152:153], v[152:153]
    v_pk_mul_f32 v[38:39], v[154:155], v[154:155]
    v_pk_mul_f32 v[62:63], v[132:133], v[132:133]
    v_pk_add_f32 v[60:61], v[132:133], v[134:135]
    v_pk_fma_f32 v[62:63], v[134:135], v[134:135], v[62:63]
    v_pk_add_f32 v[60:61], v[60:61], v[140:141]
    v_pk_fma_f32 v[40:41], v[40:41], v[214:215], v[214:215] op_sel:[0,1,1] op_sel_hi:[1,1,1]
    v_pk_fma_f32 v[42:43], v[42:43], v[214:215], v[214:215] op_sel:[0,1,1] op_sel_hi:[1,1,1]
    v_pk_fma_f32 v[44:45], v[44:45], v[214:215], v[214:215] op_sel:[0,1,1] op_sel_hi:[1,1,1]
    v_pk_fma_f32 v[46:47], v[46:47], v[214:215], v[214:215] op_sel:[0,1,1] op_sel_hi:[1,1,1]
    v_pk_fma_f32 v[32:33], v[32:33], v[218:219], v[216:217] op_sel:[0,0,1] op_sel_hi:[1,0,1]
    v_pk_fma_f32 v[34:35], v[34:35], v[218:219], v[216:217] op_sel:[0,0,1] op_sel_hi:[1,0,1]
    v_pk_fma_f32 v[36:37], v[36:37], v[218:219], v[216:217] op_sel:[0,0,1] op_sel_hi:[1,0,1]
    v_pk_fma_f32 v[38:39], v[38:39], v[218:219], v[216:217] op_sel:[0,0,1] op_sel_hi:[1,0,1]
    v_rcp_f32 v40, v40
    v_rcp_f32 v41, v41
    v_rcp_f32 v42, v42
    v_rcp_f32 v43, v43
    v_rcp_f32 v44, v44
    v_rcp_f32 v45, v45
    v_rcp_f32 v46, v46
    v_rcp_f32 v47, v47
    v_pk_mul_f32 v[32:33], v[32:33], v[144:145]
    v_pk_mul_f32 v[34:35], v[34:35], v[146:147]
    v_pk_mul_f32 v[36:37], v[36:37], v[152:153]
    v_pk_mul_f32 v[38:39], v[38:39], v[154:155]
    v_pk_fma_f32 v[62:63], v[140:141], v[140:141], v[62:63]
    v_pk_add_f32 v[60:61], v[60:61], v[142:143]
    v_pk_fma_f32 v[62:63], v[142:143], v[142:143], v[62:63]
    v_pk_mul_f32 v[164:165], v[164:165], v[40:41]
    v_pk_mul_f32 v[166:167], v[166:167], v[42:43]
    v_pk_mul_f32 v[172:173], v[172:173], v[44:45]
    v_pk_mul_f32 v[174:175], v[174:175], v[46:47]
    v_exp_f32 v32, v32
    v_exp_f32 v33, v33
    v_exp_f32 v34, v34
    v_exp_f32 v35, v35
    v_exp_f32 v36, v36
    v_exp_f32 v37, v37
    v_exp_f32 v38, v38
    v_exp_f32 v39, v39
    v_pk_fma_f32 v[176:177], v[200:201], v[216:217], v[176:177] op_sel_hi:[1,0,1]
    v_pk_fma_f32 v[178:179], v[202:203], v[216:217], v[178:179] op_sel_hi:[1,0,1]
    v_pk_fma_f32 v[184:185], v[204:205], v[216:217], v[184:185] op_sel_hi:[1,0,1]
    v_pk_fma_f32 v[186:187], v[206:207], v[216:217], v[186:187] op_sel_hi:[1,0,1]
    v_pk_mul_f32 v[40:41], v[176:177], v[176:177]
    v_pk_mul_f32 v[42:43], v[178:179], v[178:179]
    v_pk_mul_f32 v[44:45], v[184:185], v[184:185]
    v_pk_mul_f32 v[46:47], v[186:187], v[186:187]
    v_pk_add_f32 v[60:61], v[60:61], v[164:165]
    v_pk_fma_f32 v[62:63], v[164:165], v[164:165], v[62:63]
    v_pk_add_f32 v[60:61], v[60:61], v[166:167]
    v_pk_fma_f32 v[62:63], v[166:167], v[166:167], v[62:63]
    v_pk_fma_f32 v[32:33], v[32:33], v[218:219], v[218:219] op_sel:[0,1,1] op_sel_hi:[1,1,1]
    v_pk_fma_f32 v[34:35], v[34:35], v[218:219], v[218:219] op_sel:[0,1,1] op_sel_hi:[1,1,1]
    v_pk_fma_f32 v[36:37], v[36:37], v[218:219], v[218:219] op_sel:[0,1,1] op_sel_hi:[1,1,1]
    v_pk_fma_f32 v[38:39], v[38:39], v[218:219], v[218:219] op_sel:[0,1,1] op_sel_hi:[1,1,1]
    v_pk_fma_f32 v[40:41], v[40:41], v[218:219], v[216:217] op_sel:[0,0,1] op_sel_hi:[1,0,1]
    v_pk_fma_f32 v[42:43], v[42:43], v[218:219], v[216:217] op_sel:[0,0,1] op_sel_hi:[1,0,1]
    v_pk_fma_f32 v[44:45], v[44:45], v[218:219], v[216:217] op_sel:[0,0,1] op_sel_hi:[1,0,1]
    v_pk_fma_f32 v[46:47], v[46:47], v[218:219], v[216:217] op_sel:[0,0,1] op_sel_hi:[1,0,1]
    v_rcp_f32 v32, v32
    v_rcp_f32 v33, v33
    v_rcp_f32 v34, v34
    v_rcp_f32 v35, v35
    v_rcp_f32 v36, v36
    v_rcp_f32 v37, v37
    v_rcp_f32 v38, v38
    v_rcp_f32 v39, v39
    v_pk_mul_f32 v[40:41], v[40:41], v[176:177]
    v_pk_mul_f32 v[42:43], v[42:43], v[178:179]
    v_pk_mul_f32 v[44:45], v[44:45], v[184:185]
    v_pk_mul_f32 v[46:47], v[46:47], v[186:187]
    v_pk_add_f32 v[60:61], v[60:61], v[172:173]
    v_pk_fma_f32 v[62:63], v[172:173], v[172:173], v[62:63]
    v_pk_add_f32 v[60:61], v[60:61], v[174:175]
    v_pk_fma_f32 v[62:63], v[174:175], v[174:175], v[62:63]
    v_add_f32 v245, v60, v61
    v_add_f32 v249, v62, v63
    v_pk_mul_f32 v[144:145], v[144:145], v[32:33]
    v_pk_mul_f32 v[146:147], v[146:147], v[34:35]
    v_pk_mul_f32 v[152:153], v[152:153], v[36:37]
    v_pk_mul_f32 v[154:155], v[154:155], v[38:39]
    v_exp_f32 v40, v40
    v_exp_f32 v41, v41
    v_exp_f32 v42, v42
    v_exp_f32 v43, v43
    v_exp_f32 v44, v44
    v_exp_f32 v45, v45
    v_exp_f32 v46, v46
    v_exp_f32 v47, v47
    v_pk_fma_f32 v[148:149], v[192:193], v[220:221], v[148:149] op_sel_hi:[1,0,1]
    v_pk_fma_f32 v[150:151], v[194:195], v[220:221], v[150:151] op_sel_hi:[1,0,1]
    v_pk_fma_f32 v[156:157], v[196:197], v[220:221], v[156:157] op_sel_hi:[1,0,1]
    v_pk_fma_f32 v[158:159], v[198:199], v[220:221], v[158:159] op_sel_hi:[1,0,1]
    v_pk_mul_f32 v[32:33], v[148:149], v[148:149]
    v_pk_mul_f32 v[34:35], v[150:151], v[150:151]
    v_pk_mul_f32 v[36:37], v[156:157], v[156:157]
    v_pk_mul_f32 v[38:39], v[158:159], v[158:159]
    v_pk_mul_f32 v[62:63], v[144:145], v[144:145]
    v_pk_add_f32 v[60:61], v[144:145], v[146:147]
    v_pk_fma_f32 v[62:63], v[146:147], v[146:147], v[62:63]
    v_pk_add_f32 v[60:61], v[60:61], v[152:153]
    v_pk_fma_f32 v[40:41], v[40:41], v[218:219], v[218:219] op_sel:[0,1,1] op_sel_hi:[1,1,1]
    v_pk_fma_f32 v[42:43], v[42:43], v[218:219], v[218:219] op_sel:[0,1,1] op_sel_hi:[1,1,1]
    v_pk_fma_f32 v[44:45], v[44:45], v[218:219], v[218:219] op_sel:[0,1,1] op_sel_hi:[1,1,1]
    v_pk_fma_f32 v[46:47], v[46:47], v[218:219], v[218:219] op_sel:[0,1,1] op_sel_hi:[1,1,1]
    v_pk_fma_f32 v[32:33], v[32:33], v[222:223], v[220:221] op_sel:[0,0,1] op_sel_hi:[1,0,1]
    v_pk_fma_f32 v[34:35], v[34:35], v[222:223], v[220:221] op_sel:[0,0,1] op_sel_hi:[1,0,1]
    v_pk_fma_f32 v[36:37], v[36:37], v[222:223], v[220:221] op_sel:[0,0,1] op_sel_hi:[1,0,1]
    v_pk_fma_f32 v[38:39], v[38:39], v[222:223], v[220:221] op_sel:[0,0,1] op_sel_hi:[1,0,1]
    v_rcp_f32 v40, v40
    v_rcp_f32 v41, v41
    v_rcp_f32 v42, v42
    v_rcp_f32 v43, v43
    v_rcp_f32 v44, v44
    v_rcp_f32 v45, v45
    v_rcp_f32 v46, v46
    v_rcp_f32 v47, v47
    v_pk_mul_f32 v[32:33], v[32:33], v[148:149]
    v_pk_mul_f32 v[34:35], v[34:35], v[150:151]
    v_pk_mul_f32 v[36:37], v[36:37], v[156:157]
    v_pk_mul_f32 v[38:39], v[38:39], v[158:159]
    v_pk_fma_f32 v[62:63], v[152:153], v[152:153], v[62:63]
    v_pk_add_f32 v[60:61], v[60:61], v[154:155]
    v_pk_fma_f32 v[62:63], v[154:155], v[154:155], v[62:63]
    v_pk_mul_f32 v[176:177], v[176:177], v[40:41]
    v_pk_mul_f32 v[178:179], v[178:179], v[42:43]
    v_pk_mul_f32 v[184:185], v[184:185], v[44:45]
    v_pk_mul_f32 v[186:187], v[186:187], v[46:47]
    v_exp_f32 v32, v32
    v_exp_f32 v33, v33
    v_exp_f32 v34, v34
    v_exp_f32 v35, v35
    v_exp_f32 v36, v36
    v_exp_f32 v37, v37
    v_exp_f32 v38, v38
    v_exp_f32 v39, v39
    v_pk_fma_f32 v[180:181], v[200:201], v[220:221], v[180:181] op_sel_hi:[1,0,1]
    v_pk_fma_f32 v[182:183], v[202:203], v[220:221], v[182:183] op_sel_hi:[1,0,1]
    v_pk_fma_f32 v[188:189], v[204:205], v[220:221], v[188:189] op_sel_hi:[1,0,1]
    v_pk_fma_f32 v[190:191], v[206:207], v[220:221], v[190:191] op_sel_hi:[1,0,1]
    v_pk_mul_f32 v[40:41], v[180:181], v[180:181]
    v_pk_mul_f32 v[42:43], v[182:183], v[182:183]
    v_pk_mul_f32 v[44:45], v[188:189], v[188:189]
    v_pk_mul_f32 v[46:47], v[190:191], v[190:191]
    v_pk_add_f32 v[60:61], v[60:61], v[176:177]
    v_pk_fma_f32 v[62:63], v[176:177], v[176:177], v[62:63]
    v_pk_add_f32 v[60:61], v[60:61], v[178:179]
    v_pk_fma_f32 v[62:63], v[178:179], v[178:179], v[62:63]
    v_pk_fma_f32 v[32:33], v[32:33], v[222:223], v[222:223] op_sel:[0,1,1] op_sel_hi:[1,1,1]
    v_pk_fma_f32 v[34:35], v[34:35], v[222:223], v[222:223] op_sel:[0,1,1] op_sel_hi:[1,1,1]
    v_pk_fma_f32 v[36:37], v[36:37], v[222:223], v[222:223] op_sel:[0,1,1] op_sel_hi:[1,1,1]
    v_pk_fma_f32 v[38:39], v[38:39], v[222:223], v[222:223] op_sel:[0,1,1] op_sel_hi:[1,1,1]
    v_pk_fma_f32 v[40:41], v[40:41], v[222:223], v[220:221] op_sel:[0,0,1] op_sel_hi:[1,0,1]
    v_pk_fma_f32 v[42:43], v[42:43], v[222:223], v[220:221] op_sel:[0,0,1] op_sel_hi:[1,0,1]
    v_pk_fma_f32 v[44:45], v[44:45], v[222:223], v[220:221] op_sel:[0,0,1] op_sel_hi:[1,0,1]
    v_pk_fma_f32 v[46:47], v[46:47], v[222:223], v[220:221] op_sel:[0,0,1] op_sel_hi:[1,0,1]
    v_rcp_f32 v32, v32
    v_rcp_f32 v33, v33
    v_rcp_f32 v34, v34
    v_rcp_f32 v35, v35
    v_rcp_f32 v36, v36
    v_rcp_f32 v37, v37
    v_rcp_f32 v38, v38
    v_rcp_f32 v39, v39
    v_pk_mul_f32 v[40:41], v[40:41], v[180:181]
    v_pk_mul_f32 v[42:43], v[42:43], v[182:183]
    v_pk_mul_f32 v[44:45], v[44:45], v[188:189]
    v_pk_mul_f32 v[46:47], v[46:47], v[190:191]
    v_pk_add_f32 v[60:61], v[60:61], v[184:185]
    v_pk_fma_f32 v[62:63], v[184:185], v[184:185], v[62:63]
    v_pk_add_f32 v[60:61], v[60:61], v[186:187]
    v_pk_fma_f32 v[62:63], v[186:187], v[186:187], v[62:63]
    v_add_f32 v246, v60, v61
    v_add_f32 v250, v62, v63
    v_pk_mul_f32 v[148:149], v[148:149], v[32:33]
    v_pk_mul_f32 v[150:151], v[150:151], v[34:35]
    v_pk_mul_f32 v[156:157], v[156:157], v[36:37]
    v_pk_mul_f32 v[158:159], v[158:159], v[38:39]
    v_exp_f32 v40, v40
    v_exp_f32 v41, v41
    v_exp_f32 v42, v42
    v_exp_f32 v43, v43
    v_exp_f32 v44, v44
    v_exp_f32 v45, v45
    v_exp_f32 v46, v46
    v_exp_f32 v47, v47
    v_pk_mul_f32 v[62:63], v[148:149], v[148:149]
    v_pk_add_f32 v[60:61], v[148:149], v[150:151]
    v_pk_fma_f32 v[62:63], v[150:151], v[150:151], v[62:63]
    v_pk_add_f32 v[60:61], v[60:61], v[156:157]
    v_pk_fma_f32 v[40:41], v[40:41], v[222:223], v[222:223] op_sel:[0,1,1] op_sel_hi:[1,1,1]
    v_pk_fma_f32 v[42:43], v[42:43], v[222:223], v[222:223] op_sel:[0,1,1] op_sel_hi:[1,1,1]
    v_pk_fma_f32 v[44:45], v[44:45], v[222:223], v[222:223] op_sel:[0,1,1] op_sel_hi:[1,1,1]
    v_pk_fma_f32 v[46:47], v[46:47], v[222:223], v[222:223] op_sel:[0,1,1] op_sel_hi:[1,1,1]
    v_rcp_f32 v40, v40
    v_rcp_f32 v41, v41
    v_rcp_f32 v42, v42
    v_rcp_f32 v43, v43
    v_rcp_f32 v44, v44
    v_rcp_f32 v45, v45
    v_rcp_f32 v46, v46
    v_rcp_f32 v47, v47
    v_pk_fma_f32 v[62:63], v[156:157], v[156:157], v[62:63]
    v_pk_add_f32 v[60:61], v[60:61], v[158:159]
    v_pk_fma_f32 v[62:63], v[158:159], v[158:159], v[62:63]
    v_pk_mul_f32 v[180:181], v[180:181], v[40:41]
    v_pk_mul_f32 v[182:183], v[182:183], v[42:43]
    v_pk_mul_f32 v[188:189], v[188:189], v[44:45]
    v_pk_mul_f32 v[190:191], v[190:191], v[46:47]
    v_pk_add_f32 v[60:61], v[60:61], v[180:181]
    v_pk_fma_f32 v[62:63], v[180:181], v[180:181], v[62:63]
    v_pk_add_f32 v[60:61], v[60:61], v[182:183]
    v_pk_fma_f32 v[62:63], v[182:183], v[182:183], v[62:63]
    v_pk_add_f32 v[60:61], v[60:61], v[188:189]
    v_pk_fma_f32 v[62:63], v[188:189], v[188:189], v[62:63]
    v_pk_add_f32 v[60:61], v[60:61], v[190:191]
    v_pk_fma_f32 v[62:63], v[190:191], v[190:191], v[62:63]
    v_add_f32 v247, v60, v61
    v_add_f32 v251, v62, v63
    ds_read_b64_tr_b16 v[48:49], v3 offset:32768
    ds_read_b64_tr_b16 v[50:51], v3 offset:33280
    ds_read_b64_tr_b16 v[52:53], v3 offset:36864
    ds_read_b64_tr_b16 v[54:55], v3 offset:37376
    ds_read_b128 v[16:19], v2 offset:32768
    ds_read_b128 v[32:35], v2 offset:34816
    ds_read_b128 v[20:23], v2 offset:33024
    ds_read_b128 v[36:39], v2 offset:35072
    ds_read_b128 v[24:27], v2 offset:36864
    ds_read_b128 v[40:43], v2 offset:38912
    ds_read_b128 v[192:195], v7 offset:0
    ds_read_b128 v[196:199], v7 offset:64
    ds_read_b128 v[200:203], v7 offset:128
    ds_read_b128 v[204:207], v7 offset:192
    v_permlane32_swap_b32 v244, v246
    v_permlane32_swap_b32 v245, v247
    v_permlane32_swap_b32 v248, v250
    v_permlane32_swap_b32 v249, v251
    v_pk_add_f32 v[244:245], v[244:245], v[246:247]
    v_pk_add_f32 v[248:249], v[248:249], v[250:251]
    s_nop 0
    v_permlane16_swap_b32 v244, v245
L_pad12:
    s_cbranch_execz L_padr12
    v_permlane16_swap_b32 v248, v249
    v_add_f32 v246, v244, v245
    v_add_f32 v248, v248, v249
    v_mul_f32 v244, 1015021568, v246
    v_fma_f32 v245, -v244, v246, v248
    v_max_f32 v245, 0, v245
    ds_write_b64 v252, v[244:245]
    s_waitcnt lgkmcnt(0)
    s_barrier
    ds_read_b128 v[28:31], v2 offset:37120
    s_waitcnt lgkmcnt(5)
    v_mfma_f32_16x16x32_bf16 v[64:67], v[48:51], v[16:19], v[64:67]
    ds_read_b128 v[44:47], v2 offset:39168
    v_mfma_f32_16x16x32_bf16 v[64:67], v[52:55], v[32:35], v[64:67]
    ds_read_b64_tr_b16 v[56:57], v4 offset:32768
    s_waitcnt lgkmcnt(5)
    v_mfma_f32_16x16x32_bf16 v[68:71], v[48:51], v[20:23], v[68:71]
    ds_read_b64_tr_b16 v[58:59], v4 offset:33280
    v_mfma_f32_16x16x32_bf16 v[68:71], v[52:55], v[36:39], v[68:71]
    ds_read_b64_tr_b16 v[60:61], v4 offset:36864
    s_waitcnt lgkmcnt(5)
    v_mfma_f32_16x16x32_bf16 v[80:83], v[48:51], v[24:27], v[80:83]
    ds_read_b64_tr_b16 v[62:63], v4 offset:37376
    v_mfma_f32_16x16x32_bf16 v[80:83], v[52:55], v[40:43], v[80:83]
    s_waitcnt lgkmcnt(4)
    v_mfma_f32_16x16x32_bf16 v[84:87], v[48:51], v[28:31], v[84:87]
    ds_read_b64_tr_b16 v[48:49], v5 offset:32768
    v_mfma_f32_16x16x32_bf16 v[84:87], v[52:55], v[44:47], v[84:87]
    ds_read_b64_tr_b16 v[50:51], v5 offset:33280
    s_waitcnt lgkmcnt(4)
    v_mfma_f32_16x16x32_bf16 v[92:95], v[56:59], v[28:31], v[92:95]
    ds_read_b64_tr_b16 v[52:53], v5 offset:36864
    s_waitcnt lgkmcnt(3)
    v_mfma_f32_16x16x32_bf16 v[92:95], v[60:63], v[44:47], v[92:95]
    ds_read_b64_tr_b16 v[54:55], v5 offset:37376
    v_mfma_f32_16x16x32_bf16 v[88:91], v[56:59], v[24:27], v[88:91]
    v_mfma_f32_16x16x32_bf16 v[88:91], v[60:63], v[40:43], v[88:91]
    v_mfma_f32_16x16x32_bf16 v[76:79], v[56:59], v[20:23], v[76:79]
    v_mfma_f32_16x16x32_bf16 v[76:79], v[60:63], v[36:39], v[76:79]
    v_mfma_f32_16x16x32_bf16 v[72:75], v[56:59], v[16:19], v[72:75]
    ds_read_b64_tr_b16 v[56:57], v6 offset:32768
    v_mfma_f32_16x16x32_bf16 v[72:75], v[60:63], v[32:35], v[72:75]
    ds_read_b64_tr_b16 v[58:59], v6 offset:33280
    s_waitcnt lgkmcnt(2)
    v_mfma_f32_16x16x32_bf16 v[96:99], v[48:51], v[16:19], v[96:99]
    ds_read_b64_tr_b16 v[60:61], v6 offset:36864
    v_mfma_f32_16x16x32_bf16 v[96:99], v[52:55], v[32:35], v[96:99]
    ds_read_b64_tr_b16 v[62:63], v6 offset:37376
    v_mfma_f32_16x16x32_bf16 v[100:103], v[48:51], v[20:23], v[100:103]
    v_mfma_f32_16x16x32_bf16 v[100:103], v[52:55], v[36:39], v[100:103]
    v_mfma_f32_16x16x32_bf16 v[112:115], v[48:51], v[24:27], v[112:115]
    v_mfma_f32_16x16x32_bf16 v[112:115], v[52:55], v[40:43], v[112:115]
    v_mfma_f32_16x16x32_bf16 v[116:119], v[48:51], v[28:31], v[116:119]
    v_mfma_f32_16x16x32_bf16 v[116:119], v[52:55], v[44:47], v[116:119]
    s_waitcnt lgkmcnt(0)
    s_barrier
    ds_read_b64_tr_b16 v[48:49], v3 offset:49152
    ds_read_b64_tr_b16 v[50:51], v3 offset:49664
    v_mfma_f32_16x16x32_bf16 v[104:107], v[56:59], v[16:19], v[104:107]
    ds_read_b64_tr_b16 v[52:53], v3 offset:53248
    ds_read_b64_tr_b16 v[54:55], v3 offset:53760
    v_mfma_f32_16x16x32_bf16 v[104:107], v[60:63], v[32:35], v[104:107]
    ds_read_b128 v[16:19], v2 offset:49152
    v_mfma_f32_16x16x32_bf16 v[108:111], v[56:59], v[20:23], v[108:111]
    ds_read_b128 v[32:35], v2 offset:51200
    v_mfma_f32_16x16x32_bf16 v[108:111], v[60:63], v[36:39], v[108:111]
    ds_read_b128 v[20:23], v2 offset:49408
    v_mfma_f32_16x16x32_bf16 v[120:123], v[56:59], v[24:27], v[120:123]
    ds_read_b128 v[36:39], v2 offset:51456
    v_mfma_f32_16x16x32_bf16 v[120:123], v[60:63], v[40:43], v[120:123]
    ds_read_b128 v[24:27], v2 offset:53248
    v_mfma_f32_16x16x32_bf16 v[124:127], v[56:59], v[28:31], v[124:127]
    ds_read_b128 v[40:43], v2 offset:55296
    v_mfma_f32_16x16x32_bf16 v[124:127], v[60:63], v[44:47], v[124:127]
    ds_read_b128 v[28:31], v2 offset:53504
    s_waitcnt lgkmcnt(5)
    v_mfma_f32_16x16x32_bf16 v[64:67], v[48:51], v[16:19], v[64:67]
    ds_read_b128 v[44:47], v2 offset:55552
    v_mfma_f32_16x16x32_bf16 v[64:67], v[52:55], v[32:35], v[64:67]
    ds_read_b64_tr_b16 v[56:57], v4 offset:49152
    s_waitcnt lgkmcnt(5)
    v_mfma_f32_16x16x32_bf16 v[68:71], v[48:51], v[20:23], v[68:71]
    ds_read_b64_tr_b16 v[58:59], v4 offset:49664
    v_mfma_f32_16x16x32_bf16 v[68:71], v[52:55], v[36:39], v[68:71]
    ds_read_b64_tr_b16 v[60:61], v4 offset:53248
    s_waitcnt lgkmcnt(5)
    v_mfma_f32_16x16x32_bf16 v[80:83], v[48:51], v[24:27], v[80:83]
    ds_read_b64_tr_b16 v[62:63], v4 offset:53760
    v_mfma_f32_16x16x32_bf16 v[80:83], v[52:55], v[40:43], v[80:83]
    s_waitcnt lgkmcnt(4)
    v_mfma_f32_16x16x32_bf16 v[84:87], v[48:51], v[28:31], v[84:87]
    ds_read_b64_tr_b16 v[48:49], v5 offset:49152
    v_mfma_f32_16x16x32_bf16 v[84:87], v[52:55], v[44:47], v[84:87]
    ds_read_b64_tr_b16 v[50:51], v5 offset:49664
    s_waitcnt lgkmcnt(4)
    v_mfma_f32_16x16x32_bf16 v[92:95], v[56:59], v[28:31], v[92:95]
    ds_read_b64_tr_b16 v[52:53], v5 offset:53248
    s_waitcnt lgkmcnt(3)
    v_mfma_f32_16x16x32_bf16 v[92:95], v[60:63], v[44:47], v[92:95]
    ds_read_b64_tr_b16 v[54:55], v5 offset:53760
    v_mfma_f32_16x16x32_bf16 v[88:91], v[56:59], v[24:27], v[88:91]
    v_mfma_f32_16x16x32_bf16 v[88:91], v[60:63], v[40:43], v[88:91]
    v_mfma_f32_16x16x32_bf16 v[76:79], v[56:59], v[20:23], v[76:79]
    v_mfma_f32_16x16x32_bf16 v[76:79], v[60:63], v[36:39], v[76:79]
    v_mfma_f32_16x16x32_bf16 v[72:75], v[56:59], v[16:19], v[72:75]
    ds_read_b64_tr_b16 v[56:57], v6 offset:49152
    v_mfma_f32_16x16x32_bf16 v[72:75], v[60:63], v[32:35], v[72:75]
    ds_read_b64_tr_b16 v[58:59], v6 offset:49664
    s_waitcnt lgkmcnt(2)
    v_mfma_f32_16x16x32_bf16 v[96:99], v[48:51], v[16:19], v[96:99]
    ds_read_b64_tr_b16 v[60:61], v6 offset:53248
    v_mfma_f32_16x16x32_bf16 v[96:99], v[52:55], v[32:35], v[96:99]
    ds_read_b64_tr_b16 v[62:63], v6 offset:53760
    v_mfma_f32_16x16x32_bf16 v[100:103], v[48:51], v[20:23], v[100:103]
    v_mfma_f32_16x16x32_bf16 v[100:103], v[52:55], v[36:39], v[100:103]
    v_mfma_f32_16x16x32_bf16 v[112:115], v[48:51], v[24:27], v[112:115]
    v_mfma_f32_16x16x32_bf16 v[112:115], v[52:55], v[40:43], v[112:115]
    v_mfma_f32_16x16x32_bf16 v[116:119], v[48:51], v[28:31], v[116:119]
    v_mfma_f32_16x16x32_bf16 v[116:119], v[52:55], v[44:47], v[116:119]
    s_waitcnt lgkmcnt(0)
    s_barrier
    ds_read_b64_tr_b16 v[48:49], v3 offset:0
    ds_read_b64_tr_b16 v[50:51], v3 offset:512
    v_mfma_f32_16x16x32_bf16 v[104:107], v[56:59], v[16:19], v[104:107]
    ds_read_b64_tr_b16 v[52:53], v3 offset:4096
    ds_read_b64_tr_b16 v[54:55], v3 offset:4608
    v_mfma_f32_16x16x32_bf16 v[104:107], v[60:63], v[32:35], v[104:107]
    ds_read_b128 v[16:19], v2 offset:0
    v_mfma_f32_16x16x32_bf16 v[108:111], v[56:59], v[20:23], v[108:111]
    ds_read_b128 v[32:35], v2 offset:2048
    v_mfma_f32_16x16x32_bf16 v[108:111], v[60:63], v[36:39], v[108:111]
    ds_read_b128 v[20:23], v2 offset:256
    v_mfma_f32_16x16x32_bf16 v[120:123], v[56:59], v[24:27], v[120:123]
    ds_read_b128 v[36:39], v2 offset:2304
    v_mfma_f32_16x16x32_bf16 v[120:123], v[60:63], v[40:43], v[120:123]
    ds_read_b128 v[24:27], v2 offset:4096
    v_mfma_f32_16x16x32_bf16 v[124:127], v[56:59], v[28:31], v[124:127]
    ds_read_b128 v[40:43], v2 offset:6144
    v_mfma_f32_16x16x32_bf16 v[124:127], v[60:63], v[44:47], v[124:127]
    ds_read_b128 v[28:31], v2 offset:4352
    s_waitcnt lgkmcnt(5)
    v_mfma_f32_16x16x32_bf16 v[64:67], v[48:51], v[16:19], v[64:67]
    ds_read_b128 v[44:47], v2 offset:6400
    v_mfma_f32_16x16x32_bf16 v[64:67], v[52:55], v[32:35], v[64:67]
    ds_read_b64_tr_b16 v[56:57], v4 offset:0
    s_waitcnt lgkmcnt(5)
    v_mfma_f32_16x16x32_bf16 v[68:71], v[48:51], v[20:23], v[68:71]
    ds_read_b64_tr_b16 v[58:59], v4 offset:512
    v_mfma_f32_16x16x32_bf16 v[68:71], v[52:55], v[36:39], v[68:71]
    ds_read_b64_tr_b16 v[60:61], v4 offset:4096
    s_waitcnt lgkmcnt(5)
    v_mfma_f32_16x16x32_bf16 v[80:83], v[48:51], v[24:27], v[80:83]
    ds_read_b64_tr_b16 v[62:63], v4 offset:4608
    v_mfma_f32_16x16x32_bf16 v[80:83], v[52:55], v[40:43], v[80:83]
    s_waitcnt lgkmcnt(4)
    v_mfma_f32_16x16x32_bf16 v[84:87], v[48:51], v[28:31], v[84:87]
    ds_read_b64_tr_b16 v[48:49], v5 offset:0
    v_mfma_f32_16x16x32_bf16 v[84:87], v[52:55], v[44:47], v[84:87]
    ds_read_b64_tr_b16 v[50:51], v5 offset:512
    s_waitcnt lgkmcnt(4)
    v_mfma_f32_16x16x32_bf16 v[92:95], v[56:59], v[28:31], v[92:95]
    ds_read_b64_tr_b16 v[52:53], v5 offset:4096
    s_waitcnt lgkmcnt(3)
    v_mfma_f32_16x16x32_bf16 v[92:95], v[60:63], v[44:47], v[92:95]
    ds_read_b64_tr_b16 v[54:55], v5 offset:4608
    v_mfma_f32_16x16x32_bf16 v[88:91], v[56:59], v[24:27], v[88:91]
    v_mfma_f32_16x16x32_bf16 v[88:91], v[60:63], v[40:43], v[88:91]
    v_mfma_f32_16x16x32_bf16 v[76:79], v[56:59], v[20:23], v[76:79]
    v_mfma_f32_16x16x32_bf16 v[76:79], v[60:63], v[36:39], v[76:79]
    v_mfma_f32_16x16x32_bf16 v[72:75], v[56:59], v[16:19], v[72:75]
    ds_read_b64_tr_b16 v[56:57], v6 offset:0
    v_mfma_f32_16x16x32_bf16 v[72:75], v[60:63], v[32:35], v[72:75]
    ds_read_b64_tr_b16 v[58:59], v6 offset:512
    s_waitcnt lgkmcnt(2)
    v_mfma_f32_16x16x32_bf16 v[96:99], v[48:51], v[16:19], v[96:99]
    ds_read_b64_tr_b16 v[60:61], v6 offset:4096
    v_mfma_f32_16x16x32_bf16 v[96:99], v[52:55], v[32:35], v[96:99]
    ds_read_b64_tr_b16 v[62:63], v6 offset:4608
    v_mfma_f32_16x16x32_bf16 v[100:103], v[48:51], v[20:23], v[100:103]
    v_mfma_f32_16x16x32_bf16 v[100:103], v[52:55], v[36:39], v[100:103]
    v_mfma_f32_16x16x32_bf16 v[112:115], v[48:51], v[24:27], v[112:115]
    v_mfma_f32_16x16x32_bf16 v[112:115], v[52:55], v[40:43], v[112:115]
    v_mfma_f32_16x16x32_bf16 v[116:119], v[48:51], v[28:31], v[116:119]
    v_mfma_f32_16x16x32_bf16 v[116:119], v[52:55], v[44:47], v[116:119]
    s_waitcnt lgkmcnt(0)
    s_barrier
    ds_read_b64_tr_b16 v[48:49], v3 offset:16384
    ds_read_b64_tr_b16 v[50:51], v3 offset:16896
    v_mfma_f32_16x16x32_bf16 v[104:107], v[56:59], v[16:19], v[104:107]
    ds_read_b64_tr_b16 v[52:53], v3 offset:20480
    ds_read_b64_tr_b16 v[54:55], v3 offset:20992
    v_mfma_f32_16x16x32_bf16 v[104:107], v[60:63], v[32:35], v[104:107]
    ds_read_b128 v[16:19], v2 offset:16384
    v_mfma_f32_16x16x32_bf16 v[108:111], v[56:59], v[20:23], v[108:111]
    ds_read_b128 v[32:35], v2 offset:18432
    v_mfma_f32_16x16x32_bf16 v[108:111], v[60:63], v[36:39], v[108:111]
    ds_read_b128 v[20:23], v2 offset:16640
    v_mfma_f32_16x16x32_bf16 v[120:123], v[56:59], v[24:27], v[120:123]
    ds_read_b128 v[36:39], v2 offset:18688
    v_mfma_f32_16x16x32_bf16 v[120:123], v[60:63], v[40:43], v[120:123]
    ds_read_b128 v[24:27], v2 offset:20480
    v_mfma_f32_16x16x32_bf16 v[124:127], v[56:59], v[28:31], v[124:127]
    ds_read_b128 v[40:43], v2 offset:22528
    v_mfma_f32_16x16x32_bf16 v[124:127], v[60:63], v[44:47], v[124:127]
    ds_read_b128 v[28:31], v2 offset:20736
    s_waitcnt lgkmcnt(5)
    v_mfma_f32_16x16x32_bf16 v[64:67], v[48:51], v[16:19], v[64:67]
    ds_read_b128 v[44:47], v2 offset:22784
    v_mfma_f32_16x16x32_bf16 v[64:67], v[52:55], v[32:35], v[64:67]
    ds_read_b64_tr_b16 v[56:57], v4 offset:16384
    s_waitcnt lgkmcnt(5)
    v_mfma_f32_16x16x32_bf16 v[68:71], v[48:51], v[20:23], v[68:71]
    ds_read_b64_tr_b16 v[58:59], v4 offset:16896
    v_mfma_f32_16x16x32_bf16 v[68:71], v[52:55], v[36:39], v[68:71]
    ds_read_b64_tr_b16 v[60:61], v4 offset:20480
    s_waitcnt lgkmcnt(5)
    v_mfma_f32_16x16x32_bf16 v[80:83], v[48:51], v[24:27], v[80:83]
    ds_read_b64_tr_b16 v[62:63], v4 offset:20992
    v_mfma_f32_16x16x32_bf16 v[80:83], v[52:55], v[40:43], v[80:83]
    s_waitcnt lgkmcnt(4)
    v_mfma_f32_16x16x32_bf16 v[84:87], v[48:51], v[28:31], v[84:87]
    ds_read_b64_tr_b16 v[48:49], v5 offset:16384
    v_mfma_f32_16x16x32_bf16 v[84:87], v[52:55], v[44:47], v[84:87]
    ds_read_b64_tr_b16 v[50:51], v5 offset:16896
    s_waitcnt lgkmcnt(4)
    v_mfma_f32_16x16x32_bf16 v[92:95], v[56:59], v[28:31], v[92:95]
    ds_read_b64_tr_b16 v[52:53], v5 offset:20480
    s_waitcnt lgkmcnt(3)
    v_mfma_f32_16x16x32_bf16 v[92:95], v[60:63], v[44:47], v[92:95]
    ds_read_b64_tr_b16 v[54:55], v5 offset:20992
    v_mfma_f32_16x16x32_bf16 v[88:91], v[56:59], v[24:27], v[88:91]
    v_mfma_f32_16x16x32_bf16 v[88:91], v[60:63], v[40:43], v[88:91]
    v_mfma_f32_16x16x32_bf16 v[76:79], v[56:59], v[20:23], v[76:79]
    v_mfma_f32_16x16x32_bf16 v[76:79], v[60:63], v[36:39], v[76:79]
    v_mfma_f32_16x16x32_bf16 v[72:75], v[56:59], v[16:19], v[72:75]
    ds_read_b64_tr_b16 v[56:57], v6 offset:16384
    v_mfma_f32_16x16x32_bf16 v[72:75], v[60:63], v[32:35], v[72:75]
    ds_read_b64_tr_b16 v[58:59], v6 offset:16896
    s_waitcnt lgkmcnt(2)
    v_mfma_f32_16x16x32_bf16 v[96:99], v[48:51], v[16:19], v[96:99]
    ds_read_b64_tr_b16 v[60:61], v6 offset:20480
    v_mfma_f32_16x16x32_bf16 v[96:99], v[52:55], v[32:35], v[96:99]
    ds_read_b64_tr_b16 v[62:63], v6 offset:20992
    v_mfma_f32_16x16x32_bf16 v[100:103], v[48:51], v[20:23], v[100:103]
    v_mfma_f32_16x16x32_bf16 v[100:103], v[52:55], v[36:39], v[100:103]
    v_mfma_f32_16x16x32_bf16 v[112:115], v[48:51], v[24:27], v[112:115]
    v_mfma_f32_16x16x32_bf16 v[112:115], v[52:55], v[40:43], v[112:115]
    v_mfma_f32_16x16x32_bf16 v[116:119], v[48:51], v[28:31], v[116:119]
    v_mfma_f32_16x16x32_bf16 v[116:119], v[52:55], v[44:47], v[116:119]
    s_waitcnt lgkmcnt(0)
    s_barrier
    ds_read_b64_tr_b16 v[48:49], v3 offset:32768
    ds_read_b64_tr_b16 v[50:51], v3 offset:33280
    v_mfma_f32_16x16x32_bf16 v[104:107], v[56:59], v[16:19], v[104:107]
    ds_read_b64_tr_b16 v[52:53], v3 offset:36864
    ds_read_b64_tr_b16 v[54:55], v3 offset:37376
    v_mfma_f32_16x16x32_bf16 v[104:107], v[60:63], v[32:35], v[104:107]
    ds_read_b128 v[16:19], v2 offset:32768
    v_mfma_f32_16x16x32_bf16 v[108:111], v[56:59], v[20:23], v[108:111]
    ds_read_b128 v[32:35], v2 offset:34816
    v_mfma_f32_16x16x32_bf16 v[108:111], v[60:63], v[36:39], v[108:111]
    ds_read_b128 v[20:23], v2 offset:33024
    v_mfma_f32_16x16x32_bf16 v[120:123], v[56:59], v[24:27], v[120:123]
    ds_read_b128 v[36:39], v2 offset:35072
    v_mfma_f32_16x16x32_bf16 v[120:123], v[60:63], v[40:43], v[120:123]
    ds_read_b128 v[24:27], v2 offset:36864
    v_mfma_f32_16x16x32_bf16 v[124:127], v[56:59], v[28:31], v[124:127]
    ds_read_b128 v[40:43], v2 offset:38912
    v_mfma_f32_16x16x32_bf16 v[124:127], v[60:63], v[44:47], v[124:127]
    ds_read_b128 v[28:31], v2 offset:37120
    s_waitcnt lgkmcnt(5)
    v_mfma_f32_16x16x32_bf16 v[64:67], v[48:51], v[16:19], v[64:67]
    ds_read_b128 v[44:47], v2 offset:39168
    v_mfma_f32_16x16x32_bf16 v[64:67], v[52:55], v[32:35], v[64:67]
    ds_read_b64_tr_b16 v[56:57], v4 offset:32768
    s_waitcnt lgkmcnt(5)
    v_mfma_f32_16x16x32_bf16 v[68:71], v[48:51], v[20:23], v[68:71]
    ds_read_b64_tr_b16 v[58:59], v4 offset:33280
    v_mfma_f32_16x16x32_bf16 v[68:71], v[52:55], v[36:39], v[68:71]
    ds_read_b64_tr_b16 v[60:61], v4 offset:36864
    s_waitcnt lgkmcnt(5)
    v_mfma_f32_16x16x32_bf16 v[80:83], v[48:51], v[24:27], v[80:83]
    ds_read_b64_tr_b16 v[62:63], v4 offset:37376
    v_mfma_f32_16x16x32_bf16 v[80:83], v[52:55], v[40:43], v[80:83]
    s_waitcnt lgkmcnt(4)
    v_mfma_f32_16x16x32_bf16 v[84:87], v[48:51], v[28:31], v[84:87]
    ds_read_b64_tr_b16 v[48:49], v5 offset:32768
    v_mfma_f32_16x16x32_bf16 v[84:87], v[52:55], v[44:47], v[84:87]
    ds_read_b64_tr_b16 v[50:51], v5 offset:33280
    s_waitcnt lgkmcnt(4)
    v_mfma_f32_16x16x32_bf16 v[92:95], v[56:59], v[28:31], v[92:95]
    ds_read_b64_tr_b16 v[52:53], v5 offset:36864
    s_waitcnt lgkmcnt(3)
    v_mfma_f32_16x16x32_bf16 v[92:95], v[60:63], v[44:47], v[92:95]
    ds_read_b64_tr_b16 v[54:55], v5 offset:37376
    v_mfma_f32_16x16x32_bf16 v[88:91], v[56:59], v[24:27], v[88:91]
    v_mfma_f32_16x16x32_bf16 v[88:91], v[60:63], v[40:43], v[88:91]
    v_mfma_f32_16x16x32_bf16 v[76:79], v[56:59], v[20:23], v[76:79]
    v_mfma_f32_16x16x32_bf16 v[76:79], v[60:63], v[36:39], v[76:79]
    v_mfma_f32_16x16x32_bf16 v[72:75], v[56:59], v[16:19], v[72:75]
    ds_read_b64_tr_b16 v[56:57], v6 offset:32768
    v_mfma_f32_16x16x32_bf16 v[72:75], v[60:63], v[32:35], v[72:75]
    ds_read_b64_tr_b16 v[58:59], v6 offset:33280
    s_waitcnt lgkmcnt(2)
    v_mfma_f32_16x16x32_bf16 v[96:99], v[48:51], v[16:19], v[96:99]
    ds_read_b64_tr_b16 v[60:61], v6 offset:36864
    v_mfma_f32_16x16x32_bf16 v[96:99], v[52:55], v[32:35], v[96:99]
    ds_read_b64_tr_b16 v[62:63], v6 offset:37376
    v_mfma_f32_16x16x32_bf16 v[100:103], v[48:51], v[20:23], v[100:103]
    v_mfma_f32_16x16x32_bf16 v[100:103], v[52:55], v[36:39], v[100:103]
    v_mfma_f32_16x16x32_bf16 v[112:115], v[48:51], v[24:27], v[112:115]
    v_mfma_f32_16x16x32_bf16 v[112:115], v[52:55], v[40:43], v[112:115]
    v_mfma_f32_16x16x32_bf16 v[116:119], v[48:51], v[28:31], v[116:119]
    v_mfma_f32_16x16x32_bf16 v[116:119], v[52:55], v[44:47], v[116:119]
    s_waitcnt lgkmcnt(0)
    s_barrier
    ds_read_b64_tr_b16 v[48:49], v3 offset:49152
    ds_read_b64_tr_b16 v[50:51], v3 offset:49664
    v_mfma_f32_16x16x32_bf16 v[104:107], v[56:59], v[16:19], v[104:107]
    ds_read_b64_tr_b16 v[52:53], v3 offset:53248
    ds_read_b64_tr_b16 v[54:55], v3 offset:53760
    v_mfma_f32_16x16x32_bf16 v[104:107], v[60:63], v[32:35], v[104:107]
    ds_read_b128 v[16:19], v2 offset:49152
    v_mfma_f32_16x16x32_bf16 v[108:111], v[56:59], v[20:23], v[108:111]
    ds_read_b128 v[32:35], v2 offset:51200
    v_mfma_f32_16x16x32_bf16 v[108:111], v[60:63], v[36:39], v[108:111]
    ds_read_b128 v[20:23], v2 offset:49408
    v_mfma_f32_16x16x32_bf16 v[120:123], v[56:59], v[24:27], v[120:123]
    ds_read_b128 v[36:39], v2 offset:51456
    v_mfma_f32_16x16x32_bf16 v[120:123], v[60:63], v[40:43], v[120:123]
    ds_read_b128 v[24:27], v2 offset:53248
    v_mfma_f32_16x16x32_bf16 v[124:127], v[56:59], v[28:31], v[124:127]
    ds_read_b128 v[40:43], v2 offset:55296
    v_mfma_f32_16x16x32_bf16 v[124:127], v[60:63], v[44:47], v[124:127]
    ds_read_b128 v[28:31], v2 offset:53504
    s_waitcnt lgkmcnt(5)
    v_mfma_f32_16x16x32_bf16 v[64:67], v[48:51], v[16:19], v[64:67]
    ds_read_b128 v[44:47], v2 offset:55552
    v_mfma_f32_16x16x32_bf16 v[64:67], v[52:55], v[32:35], v[64:67]
    ds_read_b64_tr_b16 v[56:57], v4 offset:49152
    s_waitcnt lgkmcnt(5)
    v_mfma_f32_16x16x32_bf16 v[68:71], v[48:51], v[20:23], v[68:71]
    ds_read_b64_tr_b16 v[58:59], v4 offset:49664
    v_mfma_f32_16x16x32_bf16 v[68:71], v[52:55], v[36:39], v[68:71]
    ds_read_b64_tr_b16 v[60:61], v4 offset:53248
    s_waitcnt lgkmcnt(5)
    v_mfma_f32_16x16x32_bf16 v[80:83], v[48:51], v[24:27], v[80:83]
    ds_read_b64_tr_b16 v[62:63], v4 offset:53760
    v_mfma_f32_16x16x32_bf16 v[80:83], v[52:55], v[40:43], v[80:83]
    s_waitcnt lgkmcnt(4)
    v_mfma_f32_16x16x32_bf16 v[84:87], v[48:51], v[28:31], v[84:87]
    ds_read_b64_tr_b16 v[48:49], v5 offset:49152
    v_mfma_f32_16x16x32_bf16 v[84:87], v[52:55], v[44:47], v[84:87]
    ds_read_b64_tr_b16 v[50:51], v5 offset:49664
    s_waitcnt lgkmcnt(4)
    v_mfma_f32_16x16x32_bf16 v[92:95], v[56:59], v[28:31], v[92:95]
    ds_read_b64_tr_b16 v[52:53], v5 offset:53248
    s_waitcnt lgkmcnt(3)
    v_mfma_f32_16x16x32_bf16 v[92:95], v[60:63], v[44:47], v[92:95]
    ds_read_b64_tr_b16 v[54:55], v5 offset:53760
    v_mfma_f32_16x16x32_bf16 v[88:91], v[56:59], v[24:27], v[88:91]
    v_mfma_f32_16x16x32_bf16 v[88:91], v[60:63], v[40:43], v[88:91]
    v_mfma_f32_16x16x32_bf16 v[76:79], v[56:59], v[20:23], v[76:79]
    v_mfma_f32_16x16x32_bf16 v[76:79], v[60:63], v[36:39], v[76:79]
    v_mfma_f32_16x16x32_bf16 v[72:75], v[56:59], v[16:19], v[72:75]
    ds_read_b64_tr_b16 v[56:57], v6 offset:49152
    v_mfma_f32_16x16x32_bf16 v[72:75], v[60:63], v[32:35], v[72:75]
    ds_read_b64_tr_b16 v[58:59], v6 offset:49664
    s_waitcnt lgkmcnt(2)
    v_mfma_f32_16x16x32_bf16 v[96:99], v[48:51], v[16:19], v[96:99]
    ds_read_b64_tr_b16 v[60:61], v6 offset:53248
    v_mfma_f32_16x16x32_bf16 v[96:99], v[52:55], v[32:35], v[96:99]
    ds_read_b64_tr_b16 v[62:63], v6 offset:53760
    v_mfma_f32_16x16x32_bf16 v[100:103], v[48:51], v[20:23], v[100:103]
    v_mfma_f32_16x16x32_bf16 v[100:103], v[52:55], v[36:39], v[100:103]
    v_mfma_f32_16x16x32_bf16 v[112:115], v[48:51], v[24:27], v[112:115]
    v_mfma_f32_16x16x32_bf16 v[112:115], v[52:55], v[40:43], v[112:115]
    v_mfma_f32_16x16x32_bf16 v[116:119], v[48:51], v[28:31], v[116:119]
    v_mfma_f32_16x16x32_bf16 v[116:119], v[52:55], v[44:47], v[116:119]
    s_waitcnt lgkmcnt(0)
    s_barrier
    ds_read_b64_tr_b16 v[48:49], v3 offset:0
    ds_read_b64_tr_b16 v[50:51], v3 offset:512
    v_mfma_f32_16x16x32_bf16 v[104:107], v[56:59], v[16:19], v[104:107]
    ds_read_b64_tr_b16 v[52:53], v3 offset:4096
    ds_read_b64_tr_b16 v[54:55], v3 offset:4608
    v_mfma_f32_16x16x32_bf16 v[104:107], v[60:63], v[32:35], v[104:107]
    ds_read_b128 v[16:19], v2 offset:0
    v_mfma_f32_16x16x32_bf16 v[108:111], v[56:59], v[20:23], v[108:111]
    ds_read_b128 v[32:35], v2 offset:2048
    v_mfma_f32_16x16x32_bf16 v[108:111], v[60:63], v[36:39], v[108:111]
    ds_read_b128 v[20:23], v2 offset:256
    v_mfma_f32_16x16x32_bf16 v[120:123], v[56:59], v[24:27], v[120:123]
    ds_read_b128 v[36:39], v2 offset:2304
    v_mfma_f32_16x16x32_bf16 v[120:123], v[60:63], v[40:43], v[120:123]
    ds_read_b128 v[24:27], v2 offset:4096
    v_mfma_f32_16x16x32_bf16 v[124:127], v[56:59], v[28:31], v[124:127]
    ds_read_b128 v[40:43], v2 offset:6144
    v_mfma_f32_16x16x32_bf16 v[124:127], v[60:63], v[44:47], v[124:127]
    ds_read_b128 v[28:31], v2 offset:4352
    s_waitcnt lgkmcnt(5)
    v_mfma_f32_16x16x32_bf16 v[64:67], v[48:51], v[16:19], v[64:67]
    ds_read_b128 v[44:47], v2 offset:6400
    v_mfma_f32_16x16x32_bf16 v[64:67], v[52:55], v[32:35], v[64:67]
    ds_read_b64_tr_b16 v[56:57], v4 offset:0
    s_waitcnt lgkmcnt(5)
    v_mfma_f32_16x16x32_bf16 v[68:71], v[48:51], v[20:23], v[68:71]
    ds_read_b64_tr_b16 v[58:59], v4 offset:512
    v_mfma_f32_16x16x32_bf16 v[68:71], v[52:55], v[36:39], v[68:71]
    ds_read_b64_tr_b16 v[60:61], v4 offset:4096
    s_waitcnt lgkmcnt(5)
    v_mfma_f32_16x16x32_bf16 v[80:83], v[48:51], v[24:27], v[80:83]
    ds_read_b64_tr_b16 v[62:63], v4 offset:4608
    v_mfma_f32_16x16x32_bf16 v[80:83], v[52:55], v[40:43], v[80:83]
    s_waitcnt lgkmcnt(4)
    v_mfma_f32_16x16x32_bf16 v[84:87], v[48:51], v[28:31], v[84:87]
    ds_read_b64_tr_b16 v[48:49], v5 offset:0
    v_mfma_f32_16x16x32_bf16 v[84:87], v[52:55], v[44:47], v[84:87]
    ds_read_b64_tr_b16 v[50:51], v5 offset:512
    s_waitcnt lgkmcnt(4)
    v_mfma_f32_16x16x32_bf16 v[92:95], v[56:59], v[28:31], v[92:95]
    ds_read_b64_tr_b16 v[52:53], v5 offset:4096
    s_waitcnt lgkmcnt(3)
    v_mfma_f32_16x16x32_bf16 v[92:95], v[60:63], v[44:47], v[92:95]
    ds_read_b64_tr_b16 v[54:55], v5 offset:4608
    v_mfma_f32_16x16x32_bf16 v[88:91], v[56:59], v[24:27], v[88:91]
    v_mfma_f32_16x16x32_bf16 v[88:91], v[60:63], v[40:43], v[88:91]
    v_mfma_f32_16x16x32_bf16 v[76:79], v[56:59], v[20:23], v[76:79]
    v_mfma_f32_16x16x32_bf16 v[76:79], v[60:63], v[36:39], v[76:79]
    v_mfma_f32_16x16x32_bf16 v[72:75], v[56:59], v[16:19], v[72:75]
    ds_read_b64_tr_b16 v[56:57], v6 offset:0
    v_mfma_f32_16x16x32_bf16 v[72:75], v[60:63], v[32:35], v[72:75]
    ds_read_b64_tr_b16 v[58:59], v6 offset:512
    s_waitcnt lgkmcnt(2)
    v_mfma_f32_16x16x32_bf16 v[96:99], v[48:51], v[16:19], v[96:99]
    ds_read_b64_tr_b16 v[60:61], v6 offset:4096
    v_mfma_f32_16x16x32_bf16 v[96:99], v[52:55], v[32:35], v[96:99]
    ds_read_b64_tr_b16 v[62:63], v6 offset:4608
    v_mfma_f32_16x16x32_bf16 v[100:103], v[48:51], v[20:23], v[100:103]
    v_mfma_f32_16x16x32_bf16 v[100:103], v[52:55], v[36:39], v[100:103]
    v_mfma_f32_16x16x32_bf16 v[112:115], v[48:51], v[24:27], v[112:115]
    v_mfma_f32_16x16x32_bf16 v[112:115], v[52:55], v[40:43], v[112:115]
    v_mfma_f32_16x16x32_bf16 v[116:119], v[48:51], v[28:31], v[116:119]
    v_mfma_f32_16x16x32_bf16 v[116:119], v[52:55], v[44:47], v[116:119]
    s_waitcnt lgkmcnt(0)
    s_barrier
    ds_read_b64_tr_b16 v[48:49], v3 offset:16384
    ds_read_b64_tr_b16 v[50:51], v3 offset:16896
    v_mfma_f32_16x16x32_bf16 v[104:107], v[56:59], v[16:19], v[104:107]
    ds_read_b64_tr_b16 v[52:53], v3 offset:20480
    ds_read_b64_tr_b16 v[54:55], v3 offset:20992
    v_mfma_f32_16x16x32_bf16 v[104:107], v[60:63], v[32:35], v[104:107]
    ds_read_b128 v[16:19], v2 offset:16384
    v_mfma_f32_16x16x32_bf16 v[108:111], v[56:59], v[20:23], v[108:111]
    ds_read_b128 v[32:35], v2 offset:18432
    v_mfma_f32_16x16x32_bf16 v[108:111], v[60:63], v[36:39], v[108:111]
    ds_read_b128 v[20:23], v2 offset:16640
    v_mfma_f32_16x16x32_bf16 v[120:123], v[56:59], v[24:27], v[120:123]
    ds_read_b128 v[36:39], v2 offset:18688
    v_mfma_f32_16x16x32_bf16 v[120:123], v[60:63], v[40:43], v[120:123]
    ds_read_b128 v[24:27], v2 offset:20480
    v_mfma_f32_16x16x32_bf16 v[124:127], v[56:59], v[28:31], v[124:127]
    ds_read_b128 v[40:43], v2 offset:22528
    v_mfma_f32_16x16x32_bf16 v[124:127], v[60:63], v[44:47], v[124:127]
    ds_read_b128 v[28:31], v2 offset:20736
    s_waitcnt lgkmcnt(5)
    v_mfma_f32_16x16x32_bf16 v[64:67], v[48:51], v[16:19], v[64:67]
    ds_read_b128 v[44:47], v2 offset:22784
    v_mfma_f32_16x16x32_bf16 v[64:67], v[52:55], v[32:35], v[64:67]
    ds_read_b64_tr_b16 v[56:57], v4 offset:16384
    s_waitcnt lgkmcnt(5)
    v_mfma_f32_16x16x32_bf16 v[68:71], v[48:51], v[20:23], v[68:71]
    ds_read_b64_tr_b16 v[58:59], v4 offset:16896
    v_mfma_f32_16x16x32_bf16 v[68:71], v[52:55], v[36:39], v[68:71]
    ds_read_b64_tr_b16 v[60:61], v4 offset:20480
    s_waitcnt lgkmcnt(5)
    v_mfma_f32_16x16x32_bf16 v[80:83], v[48:51], v[24:27], v[80:83]
    ds_read_b64_tr_b16 v[62:63], v4 offset:20992
    v_mfma_f32_16x16x32_bf16 v[80:83], v[52:55], v[40:43], v[80:83]
    s_waitcnt lgkmcnt(4)
    v_mfma_f32_16x16x32_bf16 v[84:87], v[48:51], v[28:31], v[84:87]
    ds_read_b64_tr_b16 v[48:49], v5 offset:16384
    v_mfma_f32_16x16x32_bf16 v[84:87], v[52:55], v[44:47], v[84:87]
    ds_read_b64_tr_b16 v[50:51], v5 offset:16896
    s_waitcnt lgkmcnt(4)
    v_mfma_f32_16x16x32_bf16 v[92:95], v[56:59], v[28:31], v[92:95]
    ds_read_b64_tr_b16 v[52:53], v5 offset:20480
    s_waitcnt lgkmcnt(3)
    v_mfma_f32_16x16x32_bf16 v[92:95], v[60:63], v[44:47], v[92:95]
    ds_read_b64_tr_b16 v[54:55], v5 offset:20992
    v_mfma_f32_16x16x32_bf16 v[88:91], v[56:59], v[24:27], v[88:91]
    v_mfma_f32_16x16x32_bf16 v[88:91], v[60:63], v[40:43], v[88:91]
    v_mfma_f32_16x16x32_bf16 v[76:79], v[56:59], v[20:23], v[76:79]
    v_mfma_f32_16x16x32_bf16 v[76:79], v[60:63], v[36:39], v[76:79]
    v_mfma_f32_16x16x32_bf16 v[72:75], v[56:59], v[16:19], v[72:75]
    ds_read_b64_tr_b16 v[56:57], v6 offset:16384
    v_mfma_f32_16x16x32_bf16 v[72:75], v[60:63], v[32:35], v[72:75]
    ds_read_b64_tr_b16 v[58:59], v6 offset:16896
    s_waitcnt lgkmcnt(2)
    v_mfma_f32_16x16x32_bf16 v[96:99], v[48:51], v[16:19], v[96:99]
    ds_read_b64_tr_b16 v[60:61], v6 offset:20480
    v_mfma_f32_16x16x32_bf16 v[96:99], v[52:55], v[32:35], v[96:99]
    ds_read_b64_tr_b16 v[62:63], v6 offset:20992
    v_mfma_f32_16x16x32_bf16 v[100:103], v[48:51], v[20:23], v[100:103]
    v_mfma_f32_16x16x32_bf16 v[100:103], v[52:55], v[36:39], v[100:103]
    v_mfma_f32_16x16x32_bf16 v[112:115], v[48:51], v[24:27], v[112:115]
    v_mfma_f32_16x16x32_bf16 v[112:115], v[52:55], v[40:43], v[112:115]
    v_mfma_f32_16x16x32_bf16 v[116:119], v[48:51], v[28:31], v[116:119]
    v_mfma_f32_16x16x32_bf16 v[116:119], v[52:55], v[44:47], v[116:119]
    s_waitcnt lgkmcnt(0)
    s_barrier
    ds_read_b64_tr_b16 v[48:49], v3 offset:32768
    ds_read_b64_tr_b16 v[50:51], v3 offset:33280
    ds_read_b64 v[244:245], v14 offset:0
    ds_read_b64 v[246:247], v14 offset:128
    v_mfma_f32_16x16x32_bf16 v[104:107], v[56:59], v[16:19], v[104:107]
    ds_read_b64_tr_b16 v[52:53], v3 offset:36864
    ds_read_b64_tr_b16 v[54:55], v3 offset:37376
    ds_read_b64 v[248:249], v14 offset:256
    ds_read_b64 v[250:251], v14 offset:384
    v_mfma_f32_16x16x32_bf16 v[104:107], v[60:63], v[32:35], v[104:107]
    ds_read_b128 v[16:19], v2 offset:32768
    v_mfma_f32_16x16x32_bf16 v[108:111], v[56:59], v[20:23], v[108:111]
    ds_read_b128 v[32:35], v2 offset:34816
    v_mfma_f32_16x16x32_bf16 v[108:111], v[60:63], v[36:39], v[108:111]
    ds_read_b128 v[20:23], v2 offset:33024
    v_mfma_f32_16x16x32_bf16 v[120:123], v[56:59], v[24:27], v[120:123]
    ds_read_b128 v[36:39], v2 offset:35072
    v_mfma_f32_16x16x32_bf16 v[120:123], v[60:63], v[40:43], v[120:123]
    ds_read_b128 v[24:27], v2 offset:36864
    v_mfma_f32_16x16x32_bf16 v[124:127], v[56:59], v[28:31], v[124:127]
    ds_read_b128 v[40:43], v2 offset:38912
    v_mfma_f32_16x16x32_bf16 v[124:127], v[60:63], v[44:47], v[124:127]
    s_waitcnt lgkmcnt(4)
    s_setprio 3
    v_pk_fma_f32 v[128:129], v[128:129], v[244:245], v[244:245] op_sel:[0,1,0] op_sel_hi:[1,1,0]
    v_pk_fma_f32 v[130:131], v[130:131], v[244:245], v[244:245] op_sel:[0,1,0] op_sel_hi:[1,1,0]
    v_pk_fma_f32 v[132:133], v[132:133], v[246:247], v[246:247] op_sel:[0,1,0] op_sel_hi:[1,1,0]
    v_pk_fma_f32 v[134:135], v[134:135], v[246:247], v[246:247] op_sel:[0,1,0] op_sel_hi:[1,1,0]
    v_cvt_pk_bf16_f32 v128, v128, v129
    v_cvt_pk_bf16_f32 v129, v130, v131
    v_cvt_pk_bf16_f32 v130, v132, v133
    v_cvt_pk_bf16_f32 v131, v134, v135
    v_pk_fma_f32 v[136:137], v[136:137], v[244:245], v[244:245] op_sel:[0,1,0] op_sel_hi:[1,1,0]
    v_pk_fma_f32 v[138:139], v[138:139], v[244:245], v[244:245] op_sel:[0,1,0] op_sel_hi:[1,1,0]
    v_pk_fma_f32 v[140:141], v[140:141], v[246:247], v[246:247] op_sel:[0,1,0] op_sel_hi:[1,1,0]
    v_pk_fma_f32 v[142:143], v[142:143], v[246:247], v[246:247] op_sel:[0,1,0] op_sel_hi:[1,1,0]
    v_permlane16_swap_b32 v128, v130
    v_permlane16_swap_b32 v129, v131
    buffer_store_dwordx4 v[128:131], v12, s[24:27], s68 offen offset:0 sc1
    v_cvt_pk_bf16_f32 v136, v136, v137
    v_cvt_pk_bf16_f32 v137, v138, v139
    v_cvt_pk_bf16_f32 v138, v140, v141
L_pad13:
    s_cbranch_execz L_padr13
    v_cvt_pk_bf16_f32 v139, v142, v143
    v_pk_fma_f32 v[160:161], v[160:161], v[244:245], v[244:245] op_sel:[0,1,0] op_sel_hi:[1,1,0]
    v_pk_fma_f32 v[162:163], v[162:163], v[244:245], v[244:245] op_sel:[0,1,0] op_sel_hi:[1,1,0]
    v_pk_fma_f32 v[164:165], v[164:165], v[246:247], v[246:247] op_sel:[0,1,0] op_sel_hi:[1,1,0]
    v_pk_fma_f32 v[166:167], v[166:167], v[246:247], v[246:247] op_sel:[0,1,0] op_sel_hi:[1,1,0]
    v_permlane16_swap_b32 v136, v138
    v_permlane16_swap_b32 v137, v139
    buffer_store_dwordx4 v[136:139], v12, s[24:27], s68 offen offset:1024 sc1
    v_cvt_pk_bf16_f32 v160, v160, v161
    v_cvt_pk_bf16_f32 v161, v162, v163
    v_cvt_pk_bf16_f32 v162, v164, v165
    v_cvt_pk_bf16_f32 v163, v166, v167
    v_pk_fma_f32 v[168:169], v[168:169], v[244:245], v[244:245] op_sel:[0,1,0] op_sel_hi:[1,1,0]
    v_pk_fma_f32 v[170:171], v[170:171], v[244:245], v[244:245] op_sel:[0,1,0] op_sel_hi:[1,1,0]
    v_pk_fma_f32 v[172:173], v[172:173], v[246:247], v[246:247] op_sel:[0,1,0] op_sel_hi:[1,1,0]
    v_pk_fma_f32 v[174:175], v[174:175], v[246:247], v[246:247] op_sel:[0,1,0] op_sel_hi:[1,1,0]
    v_permlane16_swap_b32 v160, v162
    v_permlane16_swap_b32 v161, v163
    buffer_store_dwordx4 v[160:163], v12, s[24:27], s68 offen offset:2048 sc1
    v_cvt_pk_bf16_f32 v168, v168, v169
    v_cvt_pk_bf16_f32 v169, v170, v171
    v_cvt_pk_bf16_f32 v170, v172, v173
    v_cvt_pk_bf16_f32 v171, v174, v175
    v_pk_fma_f32 v[144:145], v[144:145], v[248:249], v[248:249] op_sel:[0,1,0] op_sel_hi:[1,1,0]
    v_pk_fma_f32 v[146:147], v[146:147], v[248:249], v[248:249] op_sel:[0,1,0] op_sel_hi:[1,1,0]
    v_pk_fma_f32 v[148:149], v[148:149], v[250:251], v[250:251] op_sel:[0,1,0] op_sel_hi:[1,1,0]
    v_pk_fma_f32 v[150:151], v[150:151], v[250:251], v[250:251] op_sel:[0,1,0] op_sel_hi:[1,1,0]
    v_permlane16_swap_b32 v168, v170
    v_permlane16_swap_b32 v169, v171
    buffer_store_dwordx4 v[168:171], v12, s[24:27], s68 offen offset:3072 sc1
    v_cvt_pk_bf16_f32 v144, v144, v145
    v_cvt_pk_bf16_f32 v145, v146, v147
    v_cvt_pk_bf16_f32 v146, v148, v149
    v_cvt_pk_bf16_f32 v147, v150, v151
    v_pk_fma_f32 v[152:153], v[152:153], v[248:249], v[248:249] op_sel:[0,1,0] op_sel_hi:[1,1,0]
    v_pk_fma_f32 v[154:155], v[154:155], v[248:249], v[248:249] op_sel:[0,1,0] op_sel_hi:[1,1,0]
    v_pk_fma_f32 v[156:157], v[156:157], v[250:251], v[250:251] op_sel:[0,1,0] op_sel_hi:[1,1,0]
    v_pk_fma_f32 v[158:159], v[158:159], v[250:251], v[250:251] op_sel:[0,1,0] op_sel_hi:[1,1,0]
    v_permlane16_swap_b32 v144, v146
    v_permlane16_swap_b32 v145, v147
    buffer_store_dwordx4 v[144:147], v12, s[24:27], s69 offen offset:0 sc1
    v_cvt_pk_bf16_f32 v152, v152, v153
    v_cvt_pk_bf16_f32 v153, v154, v155
    v_cvt_pk_bf16_f32 v154, v156, v157
    v_cvt_pk_bf16_f32 v155, v158, v159
    v_pk_fma_f32 v[176:177], v[176:177], v[248:249], v[248:249] op_sel:[0,1,0] op_sel_hi:[1,1,0]
    v_pk_fma_f32 v[178:179], v[178:179], v[248:249], v[248:249] op_sel:[0,1,0] op_sel_hi:[1,1,0]
    v_pk_fma_f32 v[180:181], v[180:181], v[250:251], v[250:251] op_sel:[0,1,0] op_sel_hi:[1,1,0]
    v_pk_fma_f32 v[182:183], v[182:183], v[250:251], v[250:251] op_sel:[0,1,0] op_sel_hi:[1,1,0]
    v_permlane16_swap_b32 v152, v154
    v_permlane16_swap_b32 v153, v155
    buffer_store_dwordx4 v[152:155], v12, s[24:27], s69 offen offset:1024 sc1
    v_cvt_pk_bf16_f32 v176, v176, v177
    v_cvt_pk_bf16_f32 v177, v178, v179
    v_cvt_pk_bf16_f32 v178, v180, v181
    v_cvt_pk_bf16_f32 v179, v182, v183
    v_pk_fma_f32 v[184:185], v[184:185], v[248:249], v[248:249] op_sel:[0,1,0] op_sel_hi:[1,1,0]
    v_pk_fma_f32 v[186:187], v[186:187], v[248:249], v[248:249] op_sel:[0,1,0] op_sel_hi:[1,1,0]
    v_pk_fma_f32 v[188:189], v[188:189], v[250:251], v[250:251] op_sel:[0,1,0] op_sel_hi:[1,1,0]
    v_pk_fma_f32 v[190:191], v[190:191], v[250:251], v[250:251] op_sel:[0,1,0] op_sel_hi:[1,1,0]
    v_permlane16_swap_b32 v176, v178
    v_permlane16_swap_b32 v177, v179
    buffer_store_dwordx4 v[176:179], v12, s[24:27], s69 offen offset:2048 sc1
    v_cvt_pk_bf16_f32 v184, v184, v185
    v_cvt_pk_bf16_f32 v185, v186, v187
    v_cvt_pk_bf16_f32 v186, v188, v189
    v_cvt_pk_bf16_f32 v187, v190, v191
    s_nop 0
    v_permlane16_swap_b32 v184, v186
    v_permlane16_swap_b32 v185, v187
    buffer_store_dwordx4 v[184:187], v12, s[24:27], s69 offen offset:3072 sc1
    s_setprio 1
    ds_read_b128 v[28:31], v2 offset:37120
    s_waitcnt lgkmcnt(5)
    v_mfma_f32_16x16x32_bf16 v[64:67], v[48:51], v[16:19], v[64:67]
    ds_read_b128 v[44:47], v2 offset:39168
    v_mfma_f32_16x16x32_bf16 v[64:67], v[52:55], v[32:35], v[64:67]
    ds_read_b64_tr_b16 v[56:57], v4 offset:32768
    s_waitcnt lgkmcnt(5)
    v_mfma_f32_16x16x32_bf16 v[68:71], v[48:51], v[20:23], v[68:71]
    ds_read_b64_tr_b16 v[58:59], v4 offset:33280
    v_mfma_f32_16x16x32_bf16 v[68:71], v[52:55], v[36:39], v[68:71]
    ds_read_b64_tr_b16 v[60:61], v4 offset:36864
    s_waitcnt lgkmcnt(5)
    v_mfma_f32_16x16x32_bf16 v[80:83], v[48:51], v[24:27], v[80:83]
    ds_read_b64_tr_b16 v[62:63], v4 offset:37376
    v_mfma_f32_16x16x32_bf16 v[80:83], v[52:55], v[40:43], v[80:83]
    s_waitcnt lgkmcnt(4)
    v_mfma_f32_16x16x32_bf16 v[84:87], v[48:51], v[28:31], v[84:87]
    ds_read_b64_tr_b16 v[48:49], v5 offset:32768
    v_mfma_f32_16x16x32_bf16 v[84:87], v[52:55], v[44:47], v[84:87]
    ds_read_b64_tr_b16 v[50:51], v5 offset:33280
    s_waitcnt lgkmcnt(4)
    v_mfma_f32_16x16x32_bf16 v[92:95], v[56:59], v[28:31], v[92:95]
    ds_read_b64_tr_b16 v[52:53], v5 offset:36864
    s_waitcnt lgkmcnt(3)
    v_mfma_f32_16x16x32_bf16 v[92:95], v[60:63], v[44:47], v[92:95]
    ds_read_b64_tr_b16 v[54:55], v5 offset:37376
    v_mfma_f32_16x16x32_bf16 v[88:91], v[56:59], v[24:27], v[88:91]
    v_mfma_f32_16x16x32_bf16 v[88:91], v[60:63], v[40:43], v[88:91]
    v_mfma_f32_16x16x32_bf16 v[76:79], v[56:59], v[20:23], v[76:79]
    v_mfma_f32_16x16x32_bf16 v[76:79], v[60:63], v[36:39], v[76:79]
    v_mfma_f32_16x16x32_bf16 v[72:75], v[56:59], v[16:19], v[72:75]
    ds_read_b64_tr_b16 v[56:57], v6 offset:32768
    v_mfma_f32_16x16x32_bf16 v[72:75], v[60:63], v[32:35], v[72:75]
    ds_read_b64_tr_b16 v[58:59], v6 offset:33280
    s_waitcnt lgkmcnt(2)
    v_mfma_f32_16x16x32_bf16 v[96:99], v[48:51], v[16:19], v[96:99]
    ds_read_b64_tr_b16 v[60:61], v6 offset:36864
    v_mfma_f32_16x16x32_bf16 v[96:99], v[52:55], v[32:35], v[96:99]
    ds_read_b64_tr_b16 v[62:63], v6 offset:37376
    v_mfma_f32_16x16x32_bf16 v[100:103], v[48:51], v[20:23], v[100:103]
    v_mfma_f32_16x16x32_bf16 v[100:103], v[52:55], v[36:39], v[100:103]
    v_mfma_f32_16x16x32_bf16 v[112:115], v[48:51], v[24:27], v[112:115]
    v_mfma_f32_16x16x32_bf16 v[112:115], v[52:55], v[40:43], v[112:115]
    v_mfma_f32_16x16x32_bf16 v[116:119], v[48:51], v[28:31], v[116:119]
    v_mfma_f32_16x16x32_bf16 v[116:119], v[52:55], v[44:47], v[116:119]
    s_waitcnt lgkmcnt(0)
    s_barrier
    ds_read_b64_tr_b16 v[48:49], v3 offset:49152
    ds_read_b64_tr_b16 v[50:51], v3 offset:49664
    v_mfma_f32_16x16x32_bf16 v[104:107], v[56:59], v[16:19], v[104:107]
    ds_read_b64_tr_b16 v[52:53], v3 offset:53248
    ds_read_b64_tr_b16 v[54:55], v3 offset:53760
    v_mfma_f32_16x16x32_bf16 v[104:107], v[60:63], v[32:35], v[104:107]
    ds_read_b128 v[16:19], v2 offset:49152
    v_mfma_f32_16x16x32_bf16 v[108:111], v[56:59], v[20:23], v[108:111]
    ds_read_b128 v[32:35], v2 offset:51200
    v_mfma_f32_16x16x32_bf16 v[108:111], v[60:63], v[36:39], v[108:111]
    ds_read_b128 v[20:23], v2 offset:49408
    v_mfma_f32_16x16x32_bf16 v[120:123], v[56:59], v[24:27], v[120:123]
    ds_read_b128 v[36:39], v2 offset:51456
    v_mfma_f32_16x16x32_bf16 v[120:123], v[60:63], v[40:43], v[120:123]
    ds_read_b128 v[24:27], v2 offset:53248
    v_mfma_f32_16x16x32_bf16 v[124:127], v[56:59], v[28:31], v[124:127]
    ds_read_b128 v[40:43], v2 offset:55296
    v_mfma_f32_16x16x32_bf16 v[124:127], v[60:63], v[44:47], v[124:127]
    ds_read_b128 v[28:31], v2 offset:53504
    s_waitcnt lgkmcnt(5)
    v_mfma_f32_16x16x32_bf16 v[64:67], v[48:51], v[16:19], v[64:67]
    ds_read_b128 v[44:47], v2 offset:55552
    v_mfma_f32_16x16x32_bf16 v[64:67], v[52:55], v[32:35], v[64:67]
    ds_read_b64_tr_b16 v[56:57], v4 offset:49152
    s_waitcnt lgkmcnt(5)
    v_mfma_f32_16x16x32_bf16 v[68:71], v[48:51], v[20:23], v[68:71]
    ds_read_b64_tr_b16 v[58:59], v4 offset:49664
    v_mfma_f32_16x16x32_bf16 v[68:71], v[52:55], v[36:39], v[68:71]
    ds_read_b64_tr_b16 v[60:61], v4 offset:53248
    s_waitcnt lgkmcnt(5)
    v_mfma_f32_16x16x32_bf16 v[80:83], v[48:51], v[24:27], v[80:83]
    ds_read_b64_tr_b16 v[62:63], v4 offset:53760
    v_mfma_f32_16x16x32_bf16 v[80:83], v[52:55], v[40:43], v[80:83]
    s_waitcnt lgkmcnt(4)
    v_mfma_f32_16x16x32_bf16 v[84:87], v[48:51], v[28:31], v[84:87]
    ds_read_b64_tr_b16 v[48:49], v5 offset:49152
    v_mfma_f32_16x16x32_bf16 v[84:87], v[52:55], v[44:47], v[84:87]
    ds_read_b64_tr_b16 v[50:51], v5 offset:49664
    s_waitcnt lgkmcnt(4)
    v_mfma_f32_16x16x32_bf16 v[92:95], v[56:59], v[28:31], v[92:95]
    ds_read_b64_tr_b16 v[52:53], v5 offset:53248
    s_waitcnt lgkmcnt(3)
    v_mfma_f32_16x16x32_bf16 v[92:95], v[60:63], v[44:47], v[92:95]
    ds_read_b64_tr_b16 v[54:55], v5 offset:53760
    v_mfma_f32_16x16x32_bf16 v[88:91], v[56:59], v[24:27], v[88:91]
    v_mfma_f32_16x16x32_bf16 v[88:91], v[60:63], v[40:43], v[88:91]
    v_mfma_f32_16x16x32_bf16 v[76:79], v[56:59], v[20:23], v[76:79]
    v_mfma_f32_16x16x32_bf16 v[76:79], v[60:63], v[36:39], v[76:79]
    v_mfma_f32_16x16x32_bf16 v[72:75], v[56:59], v[16:19], v[72:75]
    ds_read_b64_tr_b16 v[56:57], v6 offset:49152
    v_mfma_f32_16x16x32_bf16 v[72:75], v[60:63], v[32:35], v[72:75]
    ds_read_b64_tr_b16 v[58:59], v6 offset:49664
    s_waitcnt lgkmcnt(2)
    v_mfma_f32_16x16x32_bf16 v[96:99], v[48:51], v[16:19], v[96:99]
    ds_read_b64_tr_b16 v[60:61], v6 offset:53248
    v_mfma_f32_16x16x32_bf16 v[96:99], v[52:55], v[32:35], v[96:99]
    ds_read_b64_tr_b16 v[62:63], v6 offset:53760
    v_mfma_f32_16x16x32_bf16 v[100:103], v[48:51], v[20:23], v[100:103]
    v_mfma_f32_16x16x32_bf16 v[100:103], v[52:55], v[36:39], v[100:103]
    v_mfma_f32_16x16x32_bf16 v[112:115], v[48:51], v[24:27], v[112:115]
    v_mfma_f32_16x16x32_bf16 v[112:115], v[52:55], v[40:43], v[112:115]
    v_mfma_f32_16x16x32_bf16 v[116:119], v[48:51], v[28:31], v[116:119]
    v_mfma_f32_16x16x32_bf16 v[116:119], v[52:55], v[44:47], v[116:119]
    s_waitcnt lgkmcnt(0) vmcnt(0)
    s_barrier
    ds_read_b64_tr_b16 v[48:49], v3 offset:0
    ds_read_b64_tr_b16 v[50:51], v3 offset:512
    v_mfma_f32_16x16x32_bf16 v[104:107], v[56:59], v[16:19], v[104:107]
    ds_read_b64_tr_b16 v[52:53], v3 offset:4096
    ds_read_b64_tr_b16 v[54:55], v3 offset:4608
    v_mfma_f32_16x16x32_bf16 v[104:107], v[60:63], v[32:35], v[104:107]
    ds_read_b128 v[16:19], v2 offset:0
    v_mfma_f32_16x16x32_bf16 v[108:111], v[56:59], v[20:23], v[108:111]
    ds_read_b128 v[32:35], v2 offset:2048
    v_mfma_f32_16x16x32_bf16 v[108:111], v[60:63], v[36:39], v[108:111]
    ds_read_b128 v[20:23], v2 offset:256
    v_mfma_f32_16x16x32_bf16 v[120:123], v[56:59], v[24:27], v[120:123]
    ds_read_b128 v[36:39], v2 offset:2304
    v_mfma_f32_16x16x32_bf16 v[120:123], v[60:63], v[40:43], v[120:123]
    ds_read_b128 v[24:27], v2 offset:4096
    v_mfma_f32_16x16x32_bf16 v[124:127], v[56:59], v[28:31], v[124:127]
    ds_read_b128 v[40:43], v2 offset:6144
    v_mfma_f32_16x16x32_bf16 v[124:127], v[60:63], v[44:47], v[124:127]
    ds_read_b128 v[28:31], v2 offset:4352
    s_waitcnt lgkmcnt(5)
    v_mfma_f32_16x16x32_bf16 v[64:67], v[48:51], v[16:19], v[64:67]
    ds_read_b128 v[44:47], v2 offset:6400
    v_lshlrev_b32 v128, 16, v240
    v_mfma_f32_16x16x32_bf16 v[64:67], v[52:55], v[32:35], v[64:67]
    ds_read_b64_tr_b16 v[56:57], v4 offset:0
    s_waitcnt lgkmcnt(5)
    v_mfma_f32_16x16x32_bf16 v[68:71], v[48:51], v[20:23], v[68:71]
    ds_read_b64_tr_b16 v[58:59], v4 offset:512
    v_mfma_f32_16x16x32_bf16 v[68:71], v[52:55], v[36:39], v[68:71]
    ds_read_b64_tr_b16 v[60:61], v4 offset:4096
    s_waitcnt lgkmcnt(5)
    v_mfma_f32_16x16x32_bf16 v[80:83], v[48:51], v[24:27], v[80:83]
    ds_read_b64_tr_b16 v[62:63], v4 offset:4608
    v_lshlrev_b32 v129, 16, v240
    v_mfma_f32_16x16x32_bf16 v[80:83], v[52:55], v[40:43], v[80:83]
    s_waitcnt lgkmcnt(4)
    v_mfma_f32_16x16x32_bf16 v[84:87], v[48:51], v[28:31], v[84:87]
    ds_read_b64_tr_b16 v[48:49], v5 offset:0
    v_mfma_f32_16x16x32_bf16 v[84:87], v[52:55], v[44:47], v[84:87]
    ds_read_b64_tr_b16 v[50:51], v5 offset:512
    s_waitcnt lgkmcnt(4)
    v_mfma_f32_16x16x32_bf16 v[92:95], v[56:59], v[28:31], v[92:95]
    ds_read_b64_tr_b16 v[52:53], v5 offset:4096
    s_waitcnt lgkmcnt(3)
    v_mfma_f32_16x16x32_bf16 v[92:95], v[60:63], v[44:47], v[92:95]
    ds_read_b64_tr_b16 v[54:55], v5 offset:4608
    v_lshlrev_b32 v130, 16, v240
    v_mfma_f32_16x16x32_bf16 v[88:91], v[56:59], v[24:27], v[88:91]
    v_mfma_f32_16x16x32_bf16 v[88:91], v[60:63], v[40:43], v[88:91]
    v_lshlrev_b32 v131, 16, v240
    v_mfma_f32_16x16x32_bf16 v[76:79], v[56:59], v[20:23], v[76:79]
    v_lshlrev_b32 v132, 16, v241
    v_mfma_f32_16x16x32_bf16 v[76:79], v[60:63], v[36:39], v[76:79]
    v_mfma_f32_16x16x32_bf16 v[72:75], v[56:59], v[16:19], v[72:75]
    ds_read_b64_tr_b16 v[56:57], v6 offset:0
    v_lshlrev_b32 v133, 16, v241
    v_mfma_f32_16x16x32_bf16 v[72:75], v[60:63], v[32:35], v[72:75]
    ds_read_b64_tr_b16 v[58:59], v6 offset:512
    s_waitcnt lgkmcnt(2)
    v_mfma_f32_16x16x32_bf16 v[96:99], v[48:51], v[16:19], v[96:99]
    ds_read_b64_tr_b16 v[60:61], v6 offset:4096
    v_mfma_f32_16x16x32_bf16 v[96:99], v[52:55], v[32:35], v[96:99]
    ds_read_b64_tr_b16 v[62:63], v6 offset:4608
    v_mfma_f32_16x16x32_bf16 v[100:103], v[48:51], v[20:23], v[100:103]
    v_lshlrev_b32 v134, 16, v241
    v_mfma_f32_16x16x32_bf16 v[100:103], v[52:55], v[36:39], v[100:103]
    v_lshlrev_b32 v135, 16, v241
    v_mfma_f32_16x16x32_bf16 v[112:115], v[48:51], v[24:27], v[112:115]
    v_mfma_f32_16x16x32_bf16 v[112:115], v[52:55], v[40:43], v[112:115]
    v_lshlrev_b32 v144, 16, v242
    v_mfma_f32_16x16x32_bf16 v[116:119], v[48:51], v[28:31], v[116:119]
    v_lshlrev_b32 v145, 16, v242
    v_mfma_f32_16x16x32_bf16 v[116:119], v[52:55], v[44:47], v[116:119]
    s_waitcnt lgkmcnt(0)
    s_barrier
    ds_read_b64_tr_b16 v[48:49], v3 offset:16384
    ds_read_b64_tr_b16 v[50:51], v3 offset:16896
    v_mfma_f32_16x16x32_bf16 v[104:107], v[56:59], v[16:19], v[104:107]
    ds_read_b64_tr_b16 v[52:53], v3 offset:20480
    ds_read_b64_tr_b16 v[54:55], v3 offset:20992
    v_mfma_f32_16x16x32_bf16 v[104:107], v[60:63], v[32:35], v[104:107]
    ds_read_b128 v[16:19], v2 offset:16384
    v_mfma_f32_16x16x32_bf16 v[108:111], v[56:59], v[20:23], v[108:111]
    ds_read_b128 v[32:35], v2 offset:18432
    v_mfma_f32_16x16x32_bf16 v[108:111], v[60:63], v[36:39], v[108:111]
    ds_read_b128 v[20:23], v2 offset:16640
    v_mfma_f32_16x16x32_bf16 v[120:123], v[56:59], v[24:27], v[120:123]
    ds_read_b128 v[36:39], v2 offset:18688
    v_mfma_f32_16x16x32_bf16 v[120:123], v[60:63], v[40:43], v[120:123]
    ds_read_b128 v[24:27], v2 offset:20480
    v_mfma_f32_16x16x32_bf16 v[124:127], v[56:59], v[28:31], v[124:127]
    ds_read_b128 v[40:43], v2 offset:22528
    v_mfma_f32_16x16x32_bf16 v[124:127], v[60:63], v[44:47], v[124:127]
    ds_read_b128 v[28:31], v2 offset:20736
    s_waitcnt lgkmcnt(5)
    v_mfma_f32_16x16x32_bf16 v[64:67], v[48:51], v[16:19], v[64:67]
    ds_read_b128 v[44:47], v2 offset:22784
    v_lshlrev_b32 v146, 16, v242
    v_mfma_f32_16x16x32_bf16 v[64:67], v[52:55], v[32:35], v[64:67]
    ds_read_b64_tr_b16 v[56:57], v4 offset:16384
    s_waitcnt lgkmcnt(5)
    v_mfma_f32_16x16x32_bf16 v[68:71], v[48:51], v[20:23], v[68:71]
    ds_read_b64_tr_b16 v[58:59], v4 offset:16896
    v_mfma_f32_16x16x32_bf16 v[68:71], v[52:55], v[36:39], v[68:71]
    ds_read_b64_tr_b16 v[60:61], v4 offset:20480
    s_waitcnt lgkmcnt(5)
    v_mfma_f32_16x16x32_bf16 v[80:83], v[48:51], v[24:27], v[80:83]
    ds_read_b64_tr_b16 v[62:63], v4 offset:20992
    v_lshlrev_b32 v147, 16, v242
    v_mfma_f32_16x16x32_bf16 v[80:83], v[52:55], v[40:43], v[80:83]
    s_waitcnt lgkmcnt(4)
    v_mfma_f32_16x16x32_bf16 v[84:87], v[48:51], v[28:31], v[84:87]
    ds_read_b64_tr_b16 v[48:49], v5 offset:16384
    v_mfma_f32_16x16x32_bf16 v[84:87], v[52:55], v[44:47], v[84:87]
    ds_read_b64_tr_b16 v[50:51], v5 offset:16896
    s_waitcnt lgkmcnt(4)
    v_mfma_f32_16x16x32_bf16 v[92:95], v[56:59], v[28:31], v[92:95]
    ds_read_b64_tr_b16 v[52:53], v5 offset:20480
    s_waitcnt lgkmcnt(3)
    v_mfma_f32_16x16x32_bf16 v[92:95], v[60:63], v[44:47], v[92:95]
    ds_read_b64_tr_b16 v[54:55], v5 offset:20992
    v_lshlrev_b32 v148, 16, v243
    v_mfma_f32_16x16x32_bf16 v[88:91], v[56:59], v[24:27], v[88:91]
    v_mfma_f32_16x16x32_bf16 v[88:91], v[60:63], v[40:43], v[88:91]
    v_lshlrev_b32 v149, 16, v243
    v_mfma_f32_16x16x32_bf16 v[76:79], v[56:59], v[20:23], v[76:79]
    v_lshlrev_b32 v150, 16, v243
    v_mfma_f32_16x16x32_bf16 v[76:79], v[60:63], v[36:39], v[76:79]
    v_lshlrev_b32 v151, 16, v243
    v_mfma_f32_16x16x32_bf16 v[72:75], v[56:59], v[16:19], v[72:75]
    ds_read_b64_tr_b16 v[56:57], v6 offset:16384
    v_mfma_f32_16x16x32_bf16 v[72:75], v[60:63], v[32:35], v[72:75]
    ds_read_b64_tr_b16 v[58:59], v6 offset:16896
    s_waitcnt lgkmcnt(2)
    v_mfma_f32_16x16x32_bf16 v[96:99], v[48:51], v[16:19], v[96:99]
    ds_read_b64_tr_b16 v[60:61], v6 offset:20480
    v_mfma_f32_16x16x32_bf16 v[96:99], v[52:55], v[32:35], v[96:99]
    ds_read_b64_tr_b16 v[62:63], v6 offset:20992
    v_lshlrev_b32 v136, 16, v240
    v_mfma_f32_16x16x32_bf16 v[100:103], v[48:51], v[20:23], v[100:103]
    v_lshlrev_b32 v137, 16, v240
    v_mfma_f32_16x16x32_bf16 v[100:103], v[52:55], v[36:39], v[100:103]
    v_mfma_f32_16x16x32_bf16 v[112:115], v[48:51], v[24:27], v[112:115]
    v_lshlrev_b32 v138, 16, v240
    v_mfma_f32_16x16x32_bf16 v[112:115], v[52:55], v[40:43], v[112:115]
    v_lshlrev_b32 v139, 16, v240
    v_mfma_f32_16x16x32_bf16 v[116:119], v[48:51], v[28:31], v[116:119]
    v_lshlrev_b32 v140, 16, v241
    v_mfma_f32_16x16x32_bf16 v[116:119], v[52:55], v[44:47], v[116:119]
    s_waitcnt lgkmcnt(0)
    s_barrier
    ds_read_b64_tr_b16 v[48:49], v3 offset:32768
    ds_read_b64_tr_b16 v[50:51], v3 offset:33280
    v_mfma_f32_16x16x32_bf16 v[104:107], v[56:59], v[16:19], v[104:107]
    ds_read_b64_tr_b16 v[52:53], v3 offset:36864
    ds_read_b64_tr_b16 v[54:55], v3 offset:37376
    v_mfma_f32_16x16x32_bf16 v[104:107], v[60:63], v[32:35], v[104:107]
    ds_read_b128 v[16:19], v2 offset:32768
    v_mfma_f32_16x16x32_bf16 v[108:111], v[56:59], v[20:23], v[108:111]
    ds_read_b128 v[32:35], v2 offset:34816
    v_mfma_f32_16x16x32_bf16 v[108:111], v[60:63], v[36:39], v[108:111]
    ds_read_b128 v[20:23], v2 offset:33024
    v_mfma_f32_16x16x32_bf16 v[120:123], v[56:59], v[24:27], v[120:123]
    ds_read_b128 v[36:39], v2 offset:35072
    v_mfma_f32_16x16x32_bf16 v[120:123], v[60:63], v[40:43], v[120:123]
    ds_read_b128 v[24:27], v2 offset:36864
    v_mfma_f32_16x16x32_bf16 v[124:127], v[56:59], v[28:31], v[124:127]
    ds_read_b128 v[40:43], v2 offset:38912
    v_mfma_f32_16x16x32_bf16 v[124:127], v[60:63], v[44:47], v[124:127]
    ds_read_b128 v[28:31], v2 offset:37120
    s_waitcnt lgkmcnt(5)
    v_mfma_f32_16x16x32_bf16 v[64:67], v[48:51], v[16:19], v[64:67]
    ds_read_b128 v[44:47], v2 offset:39168
    v_lshlrev_b32 v141, 16, v241
    v_mfma_f32_16x16x32_bf16 v[64:67], v[52:55], v[32:35], v[64:67]
    ds_read_b64_tr_b16 v[56:57], v4 offset:32768
    s_waitcnt lgkmcnt(5)
    v_mfma_f32_16x16x32_bf16 v[68:71], v[48:51], v[20:23], v[68:71]
    ds_read_b64_tr_b16 v[58:59], v4 offset:33280
    v_mfma_f32_16x16x32_bf16 v[68:71], v[52:55], v[36:39], v[68:71]
    ds_read_b64_tr_b16 v[60:61], v4 offset:36864
    s_waitcnt lgkmcnt(5)
    v_mfma_f32_16x16x32_bf16 v[80:83], v[48:51], v[24:27], v[80:83]
    ds_read_b64_tr_b16 v[62:63], v4 offset:37376
    v_lshlrev_b32 v142, 16, v241
    v_mfma_f32_16x16x32_bf16 v[80:83], v[52:55], v[40:43], v[80:83]
    s_waitcnt lgkmcnt(4)
    v_mfma_f32_16x16x32_bf16 v[84:87], v[48:51], v[28:31], v[84:87]
    ds_read_b64_tr_b16 v[48:49], v5 offset:32768
    v_mfma_f32_16x16x32_bf16 v[84:87], v[52:55], v[44:47], v[84:87]
    ds_read_b64_tr_b16 v[50:51], v5 offset:33280
    s_waitcnt lgkmcnt(4)
    v_mfma_f32_16x16x32_bf16 v[92:95], v[56:59], v[28:31], v[92:95]
    ds_read_b64_tr_b16 v[52:53], v5 offset:36864
    s_waitcnt lgkmcnt(3)
    v_mfma_f32_16x16x32_bf16 v[92:95], v[60:63], v[44:47], v[92:95]
    ds_read_b64_tr_b16 v[54:55], v5 offset:37376
    v_lshlrev_b32 v143, 16, v241
    v_mfma_f32_16x16x32_bf16 v[88:91], v[56:59], v[24:27], v[88:91]
    v_mfma_f32_16x16x32_bf16 v[88:91], v[60:63], v[40:43], v[88:91]
    v_lshlrev_b32 v152, 16, v242
    v_mfma_f32_16x16x32_bf16 v[76:79], v[56:59], v[20:23], v[76:79]
    v_lshlrev_b32 v153, 16, v242
    v_mfma_f32_16x16x32_bf16 v[76:79], v[60:63], v[36:39], v[76:79]
    v_lshlrev_b32 v154, 16, v242
    v_mfma_f32_16x16x32_bf16 v[72:75], v[56:59], v[16:19], v[72:75]
    ds_read_b64_tr_b16 v[56:57], v6 offset:32768
    v_mfma_f32_16x16x32_bf16 v[72:75], v[60:63], v[32:35], v[72:75]
    ds_read_b64_tr_b16 v[58:59], v6 offset:33280
    s_waitcnt lgkmcnt(2)
    v_mfma_f32_16x16x32_bf16 v[96:99], v[48:51], v[16:19], v[96:99]
    ds_read_b64_tr_b16 v[60:61], v6 offset:36864
    v_mfma_f32_16x16x32_bf16 v[96:99], v[52:55], v[32:35], v[96:99]
    ds_read_b64_tr_b16 v[62:63], v6 offset:37376
    v_lshlrev_b32 v155, 16, v242
    v_mfma_f32_16x16x32_bf16 v[100:103], v[48:51], v[20:23], v[100:103]
    v_lshlrev_b32 v156, 16, v243
    v_mfma_f32_16x16x32_bf16 v[100:103], v[52:55], v[36:39], v[100:103]
    v_mfma_f32_16x16x32_bf16 v[112:115], v[48:51], v[24:27], v[112:115]
    v_lshlrev_b32 v157, 16, v243
    v_mfma_f32_16x16x32_bf16 v[112:115], v[52:55], v[40:43], v[112:115]
    v_lshlrev_b32 v158, 16, v243
    v_mfma_f32_16x16x32_bf16 v[116:119], v[48:51], v[28:31], v[116:119]
    v_lshlrev_b32 v159, 16, v243
    v_mfma_f32_16x16x32_bf16 v[116:119], v[52:55], v[44:47], v[116:119]
    s_waitcnt lgkmcnt(0)
    s_barrier
    ds_read_b64_tr_b16 v[48:49], v3 offset:49152
    ds_read_b64_tr_b16 v[50:51], v3 offset:49664
    v_mfma_f32_16x16x32_bf16 v[104:107], v[56:59], v[16:19], v[104:107]
    ds_read_b64_tr_b16 v[52:53], v3 offset:53248
    ds_read_b64_tr_b16 v[54:55], v3 offset:53760
    v_mfma_f32_16x16x32_bf16 v[104:107], v[60:63], v[32:35], v[104:107]
    ds_read_b128 v[16:19], v2 offset:49152
    v_mfma_f32_16x16x32_bf16 v[108:111], v[56:59], v[20:23], v[108:111]
    ds_read_b128 v[32:35], v2 offset:51200
    v_mfma_f32_16x16x32_bf16 v[108:111], v[60:63], v[36:39], v[108:111]
    ds_read_b128 v[20:23], v2 offset:49408
    v_mfma_f32_16x16x32_bf16 v[120:123], v[56:59], v[24:27], v[120:123]
    ds_read_b128 v[36:39], v2 offset:51456
    v_mfma_f32_16x16x32_bf16 v[120:123], v[60:63], v[40:43], v[120:123]
    ds_read_b128 v[24:27], v2 offset:53248
    v_mfma_f32_16x16x32_bf16 v[124:127], v[56:59], v[28:31], v[124:127]
    ds_read_b128 v[40:43], v2 offset:55296
    v_mfma_f32_16x16x32_bf16 v[124:127], v[60:63], v[44:47], v[124:127]
    ds_read_b128 v[28:31], v2 offset:53504
    s_waitcnt lgkmcnt(5)
    v_mfma_f32_16x16x32_bf16 v[64:67], v[48:51], v[16:19], v[64:67]
    ds_read_b128 v[44:47], v2 offset:55552
    v_lshlrev_b32 v160, 16, v240
    v_mfma_f32_16x16x32_bf16 v[64:67], v[52:55], v[32:35], v[64:67]
    ds_read_b64_tr_b16 v[56:57], v4 offset:49152
    s_waitcnt lgkmcnt(5)
    v_mfma_f32_16x16x32_bf16 v[68:71], v[48:51], v[20:23], v[68:71]
    ds_read_b64_tr_b16 v[58:59], v4 offset:49664
    v_mfma_f32_16x16x32_bf16 v[68:71], v[52:55], v[36:39], v[68:71]
    ds_read_b64_tr_b16 v[60:61], v4 offset:53248
    s_waitcnt lgkmcnt(5)
    v_mfma_f32_16x16x32_bf16 v[80:83], v[48:51], v[24:27], v[80:83]
    ds_read_b64_tr_b16 v[62:63], v4 offset:53760
    v_lshlrev_b32 v161, 16, v240
    v_mfma_f32_16x16x32_bf16 v[80:83], v[52:55], v[40:43], v[80:83]
    s_waitcnt lgkmcnt(4)
    v_mfma_f32_16x16x32_bf16 v[84:87], v[48:51], v[28:31], v[84:87]
    ds_read_b64_tr_b16 v[48:49], v5 offset:49152
    v_mfma_f32_16x16x32_bf16 v[84:87], v[52:55], v[44:47], v[84:87]
    ds_read_b64_tr_b16 v[50:51], v5 offset:49664
    s_waitcnt lgkmcnt(4)
    v_mfma_f32_16x16x32_bf16 v[92:95], v[56:59], v[28:31], v[92:95]
    ds_read_b64_tr_b16 v[52:53], v5 offset:53248
    s_waitcnt lgkmcnt(3)
    v_mfma_f32_16x16x32_bf16 v[92:95], v[60:63], v[44:47], v[92:95]
    ds_read_b64_tr_b16 v[54:55], v5 offset:53760
    v_lshlrev_b32 v162, 16, v240
    v_mfma_f32_16x16x32_bf16 v[88:91], v[56:59], v[24:27], v[88:91]
    v_mfma_f32_16x16x32_bf16 v[88:91], v[60:63], v[40:43], v[88:91]
    v_lshlrev_b32 v163, 16, v240
    v_mfma_f32_16x16x32_bf16 v[76:79], v[56:59], v[20:23], v[76:79]
    v_lshlrev_b32 v164, 16, v241
    v_mfma_f32_16x16x32_bf16 v[76:79], v[60:63], v[36:39], v[76:79]
    v_mfma_f32_16x16x32_bf16 v[72:75], v[56:59], v[16:19], v[72:75]
    ds_read_b64_tr_b16 v[56:57], v6 offset:49152
    v_lshlrev_b32 v165, 16, v241
    v_mfma_f32_16x16x32_bf16 v[72:75], v[60:63], v[32:35], v[72:75]
    ds_read_b64_tr_b16 v[58:59], v6 offset:49664
    s_waitcnt lgkmcnt(2)
    v_mfma_f32_16x16x32_bf16 v[96:99], v[48:51], v[16:19], v[96:99]
    ds_read_b64_tr_b16 v[60:61], v6 offset:53248
    v_mfma_f32_16x16x32_bf16 v[96:99], v[52:55], v[32:35], v[96:99]
    ds_read_b64_tr_b16 v[62:63], v6 offset:53760
    v_mfma_f32_16x16x32_bf16 v[100:103], v[48:51], v[20:23], v[100:103]
    v_lshlrev_b32 v166, 16, v241
    v_mfma_f32_16x16x32_bf16 v[100:103], v[52:55], v[36:39], v[100:103]
    v_lshlrev_b32 v167, 16, v241
    v_mfma_f32_16x16x32_bf16 v[112:115], v[48:51], v[24:27], v[112:115]
    v_mfma_f32_16x16x32_bf16 v[112:115], v[52:55], v[40:43], v[112:115]
    v_lshlrev_b32 v176, 16, v242
    v_mfma_f32_16x16x32_bf16 v[116:119], v[48:51], v[28:31], v[116:119]
    v_lshlrev_b32 v177, 16, v242
    v_mfma_f32_16x16x32_bf16 v[116:119], v[52:55], v[44:47], v[116:119]
    s_waitcnt lgkmcnt(0)
    s_barrier
    ds_read_b64_tr_b16 v[48:49], v3 offset:0
    ds_read_b64_tr_b16 v[50:51], v3 offset:512
    v_mfma_f32_16x16x32_bf16 v[104:107], v[56:59], v[16:19], v[104:107]
    ds_read_b64_tr_b16 v[52:53], v3 offset:4096
    ds_read_b64_tr_b16 v[54:55], v3 offset:4608
    v_mfma_f32_16x16x32_bf16 v[104:107], v[60:63], v[32:35], v[104:107]
    ds_read_b128 v[16:19], v2 offset:0
    v_mfma_f32_16x16x32_bf16 v[108:111], v[56:59], v[20:23], v[108:111]
    ds_read_b128 v[32:35], v2 offset:2048
    v_mfma_f32_16x16x32_bf16 v[108:111], v[60:63], v[36:39], v[108:111]
    ds_read_b128 v[20:23], v2 offset:256
    v_mfma_f32_16x16x32_bf16 v[120:123], v[56:59], v[24:27], v[120:123]
    ds_read_b128 v[36:39], v2 offset:2304
    v_mfma_f32_16x16x32_bf16 v[120:123], v[60:63], v[40:43], v[120:123]
    ds_read_b128 v[24:27], v2 offset:4096
    v_mfma_f32_16x16x32_bf16 v[124:127], v[56:59], v[28:31], v[124:127]
    ds_read_b128 v[40:43], v2 offset:6144
    v_mfma_f32_16x16x32_bf16 v[124:127], v[60:63], v[44:47], v[124:127]
    ds_read_b128 v[28:31], v2 offset:4352
    s_waitcnt lgkmcnt(5)
    v_mfma_f32_16x16x32_bf16 v[64:67], v[48:51], v[16:19], v[64:67]
    ds_read_b128 v[44:47], v2 offset:6400
    v_lshlrev_b32 v178, 16, v242
    v_mfma_f32_16x16x32_bf16 v[64:67], v[52:55], v[32:35], v[64:67]
    ds_read_b64_tr_b16 v[56:57], v4 offset:0
    s_waitcnt lgkmcnt(5)
    v_mfma_f32_16x16x32_bf16 v[68:71], v[48:51], v[20:23], v[68:71]
    ds_read_b64_tr_b16 v[58:59], v4 offset:512
    v_mfma_f32_16x16x32_bf16 v[68:71], v[52:55], v[36:39], v[68:71]
    ds_read_b64_tr_b16 v[60:61], v4 offset:4096
    s_waitcnt lgkmcnt(5)
    v_mfma_f32_16x16x32_bf16 v[80:83], v[48:51], v[24:27], v[80:83]
    ds_read_b64_tr_b16 v[62:63], v4 offset:4608
    v_lshlrev_b32 v179, 16, v242
    v_mfma_f32_16x16x32_bf16 v[80:83], v[52:55], v[40:43], v[80:83]
    s_waitcnt lgkmcnt(4)
    v_mfma_f32_16x16x32_bf16 v[84:87], v[48:51], v[28:31], v[84:87]
    ds_read_b64_tr_b16 v[48:49], v5 offset:0
    v_mfma_f32_16x16x32_bf16 v[84:87], v[52:55], v[44:47], v[84:87]
    ds_read_b64_tr_b16 v[50:51], v5 offset:512
    s_waitcnt lgkmcnt(4)
    v_mfma_f32_16x16x32_bf16 v[92:95], v[56:59], v[28:31], v[92:95]
    ds_read_b64_tr_b16 v[52:53], v5 offset:4096
    s_waitcnt lgkmcnt(3)
    v_mfma_f32_16x16x32_bf16 v[92:95], v[60:63], v[44:47], v[92:95]
    ds_read_b64_tr_b16 v[54:55], v5 offset:4608
    v_lshlrev_b32 v180, 16, v243
    v_mfma_f32_16x16x32_bf16 v[88:91], v[56:59], v[24:27], v[88:91]
    v_mfma_f32_16x16x32_bf16 v[88:91], v[60:63], v[40:43], v[88:91]
    v_lshlrev_b32 v181, 16, v243
    v_mfma_f32_16x16x32_bf16 v[76:79], v[56:59], v[20:23], v[76:79]
    v_lshlrev_b32 v182, 16, v243
    v_mfma_f32_16x16x32_bf16 v[76:79], v[60:63], v[36:39], v[76:79]
    v_lshlrev_b32 v183, 16, v243
    v_mfma_f32_16x16x32_bf16 v[72:75], v[56:59], v[16:19], v[72:75]
    ds_read_b64_tr_b16 v[56:57], v6 offset:0
    v_mfma_f32_16x16x32_bf16 v[72:75], v[60:63], v[32:35], v[72:75]
    ds_read_b64_tr_b16 v[58:59], v6 offset:512
    s_waitcnt lgkmcnt(2)
    v_mfma_f32_16x16x32_bf16 v[96:99], v[48:51], v[16:19], v[96:99]
    ds_read_b64_tr_b16 v[60:61], v6 offset:4096
    v_mfma_f32_16x16x32_bf16 v[96:99], v[52:55], v[32:35], v[96:99]
    ds_read_b64_tr_b16 v[62:63], v6 offset:4608
    v_lshlrev_b32 v168, 16, v240
    v_mfma_f32_16x16x32_bf16 v[100:103], v[48:51], v[20:23], v[100:103]
    v_lshlrev_b32 v169, 16, v240
    v_mfma_f32_16x16x32_bf16 v[100:103], v[52:55], v[36:39], v[100:103]
    v_mfma_f32_16x16x32_bf16 v[112:115], v[48:51], v[24:27], v[112:115]
    v_lshlrev_b32 v170, 16, v240
    v_mfma_f32_16x16x32_bf16 v[112:115], v[52:55], v[40:43], v[112:115]
    v_lshlrev_b32 v171, 16, v240
    v_mfma_f32_16x16x32_bf16 v[116:119], v[48:51], v[28:31], v[116:119]
    v_lshlrev_b32 v172, 16, v241
    v_mfma_f32_16x16x32_bf16 v[116:119], v[52:55], v[44:47], v[116:119]
    s_waitcnt lgkmcnt(0)
    s_barrier
    ds_read_b64_tr_b16 v[48:49], v3 offset:16384
    ds_read_b64_tr_b16 v[50:51], v3 offset:16896
    v_mfma_f32_16x16x32_bf16 v[104:107], v[56:59], v[16:19], v[104:107]
    ds_read_b64_tr_b16 v[52:53], v3 offset:20480
    ds_read_b64_tr_b16 v[54:55], v3 offset:20992
    v_mfma_f32_16x16x32_bf16 v[104:107], v[60:63], v[32:35], v[104:107]
    ds_read_b128 v[16:19], v2 offset:16384
    v_mfma_f32_16x16x32_bf16 v[108:111], v[56:59], v[20:23], v[108:111]
    ds_read_b128 v[32:35], v2 offset:18432
    v_mfma_f32_16x16x32_bf16 v[108:111], v[60:63], v[36:39], v[108:111]
    ds_read_b128 v[20:23], v2 offset:16640
    v_mfma_f32_16x16x32_bf16 v[120:123], v[56:59], v[24:27], v[120:123]
    ds_read_b128 v[36:39], v2 offset:18688
    v_mfma_f32_16x16x32_bf16 v[120:123], v[60:63], v[40:43], v[120:123]
    ds_read_b128 v[24:27], v2 offset:20480
L_pad14:
    s_cbranch_execz L_padr14
    v_mfma_f32_16x16x32_bf16 v[124:127], v[56:59], v[28:31], v[124:127]
    ds_read_b128 v[40:43], v2 offset:22528
    v_mfma_f32_16x16x32_bf16 v[124:127], v[60:63], v[44:47], v[124:127]
    ds_read_b128 v[28:31], v2 offset:20736
    s_waitcnt lgkmcnt(5)
    v_mfma_f32_16x16x32_bf16 v[64:67], v[48:51], v[16:19], v[64:67]
    ds_read_b128 v[44:47], v2 offset:22784
    v_lshlrev_b32 v173, 16, v241
    v_mfma_f32_16x16x32_bf16 v[64:67], v[52:55], v[32:35], v[64:67]
    ds_read_b64_tr_b16 v[56:57], v4 offset:16384
    s_waitcnt lgkmcnt(5)
    v_mfma_f32_16x16x32_bf16 v[68:71], v[48:51], v[20:23], v[68:71]
    ds_read_b64_tr_b16 v[58:59], v4 offset:16896
    v_mfma_f32_16x16x32_bf16 v[68:71], v[52:55], v[36:39], v[68:71]
    ds_read_b64_tr_b16 v[60:61], v4 offset:20480
    s_waitcnt lgkmcnt(5)
    v_mfma_f32_16x16x32_bf16 v[80:83], v[48:51], v[24:27], v[80:83]
    ds_read_b64_tr_b16 v[62:63], v4 offset:20992
    v_lshlrev_b32 v174, 16, v241
    v_mfma_f32_16x16x32_bf16 v[80:83], v[52:55], v[40:43], v[80:83]
    s_waitcnt lgkmcnt(4)
    v_mfma_f32_16x16x32_bf16 v[84:87], v[48:51], v[28:31], v[84:87]
    ds_read_b64_tr_b16 v[48:49], v5 offset:16384
    v_mfma_f32_16x16x32_bf16 v[84:87], v[52:55], v[44:47], v[84:87]
    ds_read_b64_tr_b16 v[50:51], v5 offset:16896
    s_waitcnt lgkmcnt(4)
    v_mfma_f32_16x16x32_bf16 v[92:95], v[56:59], v[28:31], v[92:95]
    ds_read_b64_tr_b16 v[52:53], v5 offset:20480
    s_waitcnt lgkmcnt(3)
    v_mfma_f32_16x16x32_bf16 v[92:95], v[60:63], v[44:47], v[92:95]
    ds_read_b64_tr_b16 v[54:55], v5 offset:20992
    v_lshlrev_b32 v175, 16, v241
    v_mfma_f32_16x16x32_bf16 v[88:91], v[56:59], v[24:27], v[88:91]
    v_mfma_f32_16x16x32_bf16 v[88:91], v[60:63], v[40:43], v[88:91]
    v_lshlrev_b32 v184, 16, v242
    v_mfma_f32_16x16x32_bf16 v[76:79], v[56:59], v[20:23], v[76:79]
    v_lshlrev_b32 v185, 16, v242
    v_mfma_f32_16x16x32_bf16 v[76:79], v[60:63], v[36:39], v[76:79]
    v_lshlrev_b32 v186, 16, v242
    v_mfma_f32_16x16x32_bf16 v[72:75], v[56:59], v[16:19], v[72:75]
    ds_read_b64_tr_b16 v[56:57], v6 offset:16384
    v_mfma_f32_16x16x32_bf16 v[72:75], v[60:63], v[32:35], v[72:75]
    ds_read_b64_tr_b16 v[58:59], v6 offset:16896
    s_waitcnt lgkmcnt(2)
    v_mfma_f32_16x16x32_bf16 v[96:99], v[48:51], v[16:19], v[96:99]
    ds_read_b64_tr_b16 v[60:61], v6 offset:20480
    v_mfma_f32_16x16x32_bf16 v[96:99], v[52:55], v[32:35], v[96:99]
    ds_read_b64_tr_b16 v[62:63], v6 offset:20992
    v_lshlrev_b32 v187, 16, v242
    v_mfma_f32_16x16x32_bf16 v[100:103], v[48:51], v[20:23], v[100:103]
    v_lshlrev_b32 v188, 16, v243
    v_mfma_f32_16x16x32_bf16 v[100:103], v[52:55], v[36:39], v[100:103]
    v_mfma_f32_16x16x32_bf16 v[112:115], v[48:51], v[24:27], v[112:115]
    v_lshlrev_b32 v189, 16, v243
    v_mfma_f32_16x16x32_bf16 v[112:115], v[52:55], v[40:43], v[112:115]
    v_lshlrev_b32 v190, 16, v243
    v_mfma_f32_16x16x32_bf16 v[116:119], v[48:51], v[28:31], v[116:119]
    v_lshlrev_b32 v191, 16, v243
    v_mfma_f32_16x16x32_bf16 v[116:119], v[52:55], v[44:47], v[116:119]
    s_waitcnt lgkmcnt(0)
    s_barrier
    ds_read_b64_tr_b16 v[48:49], v10 offset:32768
    ds_read_b64_tr_b16 v[50:51], v11 offset:32768
    v_mfma_f32_16x16x32_bf16 v[104:107], v[56:59], v[16:19], v[104:107]
    ds_read_b64_tr_b16 v[52:53], v10 offset:40960
    ds_read_b64_tr_b16 v[54:55], v11 offset:40960
    v_mfma_f32_16x16x32_bf16 v[104:107], v[60:63], v[32:35], v[104:107]
    ds_read_b128 v[16:19], v8 offset:32768
    v_mfma_f32_16x16x32_bf16 v[108:111], v[56:59], v[20:23], v[108:111]
    ds_read_b128 v[32:35], v9 offset:32768
    v_mfma_f32_16x16x32_bf16 v[108:111], v[60:63], v[36:39], v[108:111]
    ds_read_b128 v[20:23], v8 offset:34816
    v_mfma_f32_16x16x32_bf16 v[120:123], v[56:59], v[24:27], v[120:123]
    ds_read_b128 v[36:39], v9 offset:34816
    v_mfma_f32_16x16x32_bf16 v[120:123], v[60:63], v[40:43], v[120:123]
    ds_read_b128 v[24:27], v8 offset:36864
    v_mfma_f32_16x16x32_bf16 v[124:127], v[56:59], v[28:31], v[124:127]
    ds_read_b128 v[40:43], v9 offset:36864
    v_mfma_f32_16x16x32_bf16 v[124:127], v[60:63], v[44:47], v[124:127]
    ds_read_b128 v[28:31], v8 offset:38912
    s_waitcnt lgkmcnt(5)
    v_mfma_f32_16x16x32_bf16 v[128:131], v[48:51], v[16:19], v[128:131]
    ds_read_b128 v[44:47], v9 offset:38912
    v_fmac_f32 v64, v192, v208
    v_mfma_f32_16x16x32_bf16 v[128:131], v[52:55], v[32:35], v[128:131]
    ds_read_b64_tr_b16 v[56:57], v10 offset:33792
    s_waitcnt lgkmcnt(5)
    v_mfma_f32_16x16x32_bf16 v[132:135], v[48:51], v[20:23], v[132:135]
    ds_read_b64_tr_b16 v[58:59], v11 offset:33792
    v_fmac_f32 v65, v193, v208
    v_mfma_f32_16x16x32_bf16 v[132:135], v[52:55], v[36:39], v[132:135]
    ds_read_b64_tr_b16 v[60:61], v10 offset:41984
    s_waitcnt lgkmcnt(5)
    v_mfma_f32_16x16x32_bf16 v[144:147], v[48:51], v[24:27], v[144:147]
    ds_read_b64_tr_b16 v[62:63], v11 offset:41984
    v_mul_f32 v244, v64, v64
    v_mfma_f32_16x16x32_bf16 v[144:147], v[52:55], v[40:43], v[144:147]
    s_waitcnt lgkmcnt(4)
    v_mfma_f32_16x16x32_bf16 v[148:151], v[48:51], v[28:31], v[148:151]
    ds_read_b64_tr_b16 v[48:49], v10 offset:34816
    v_mul_f32 v245, v65, v65
    v_mfma_f32_16x16x32_bf16 v[148:151], v[52:55], v[44:47], v[148:151]
    ds_read_b64_tr_b16 v[50:51], v11 offset:34816
    s_waitcnt lgkmcnt(4)
    v_mfma_f32_16x16x32_bf16 v[156:159], v[56:59], v[28:31], v[156:159]
    ds_read_b64_tr_b16 v[52:53], v10 offset:43008
    s_waitcnt lgkmcnt(3)
    v_mfma_f32_16x16x32_bf16 v[156:159], v[60:63], v[44:47], v[156:159]
    ds_read_b64_tr_b16 v[54:55], v11 offset:43008
    v_fma_f32 v244, v244, v210, v209
    v_mfma_f32_16x16x32_bf16 v[152:155], v[56:59], v[24:27], v[152:155]
    v_fma_f32 v245, v245, v210, v209
    v_mfma_f32_16x16x32_bf16 v[152:155], v[60:63], v[40:43], v[152:155]
    v_mul_f32 v244, v244, v64
    v_mfma_f32_16x16x32_bf16 v[140:143], v[56:59], v[20:23], v[140:143]
    v_mul_f32 v245, v245, v65
    v_mfma_f32_16x16x32_bf16 v[140:143], v[60:63], v[36:39], v[140:143]
    v_exp_f32 v244, v244
    v_mfma_f32_16x16x32_bf16 v[136:139], v[56:59], v[16:19], v[136:139]
    ds_read_b64_tr_b16 v[56:57], v10 offset:35840
    v_mfma_f32_16x16x32_bf16 v[136:139], v[60:63], v[32:35], v[136:139]
    ds_read_b64_tr_b16 v[58:59], v11 offset:35840
    s_waitcnt lgkmcnt(2)
    v_mfma_f32_16x16x32_bf16 v[160:163], v[48:51], v[16:19], v[160:163]
    ds_read_b64_tr_b16 v[60:61], v10 offset:44032
    v_mfma_f32_16x16x32_bf16 v[160:163], v[52:55], v[32:35], v[160:163]
    ds_read_b64_tr_b16 v[62:63], v11 offset:44032
    v_mfma_f32_16x16x32_bf16 v[164:167], v[48:51], v[20:23], v[164:167]
    v_exp_f32 v245, v245
    v_mfma_f32_16x16x32_bf16 v[164:167], v[52:55], v[36:39], v[164:167]
    v_fma_f32 v244, v244, v211, v211
    v_fma_f32 v245, v245, v211, v211
    v_mfma_f32_16x16x32_bf16 v[176:179], v[48:51], v[24:27], v[176:179]
    v_rcp_f32 v244, v244
    v_mfma_f32_16x16x32_bf16 v[176:179], v[52:55], v[40:43], v[176:179]
    v_rcp_f32 v245, v245
    v_mfma_f32_16x16x32_bf16 v[180:183], v[48:51], v[28:31], v[180:183]
    v_mul_f32 v64, v244, v64
    v_mfma_f32_16x16x32_bf16 v[180:183], v[52:55], v[44:47], v[180:183]
    s_waitcnt lgkmcnt(0)
    s_barrier
    ds_read_b64_tr_b16 v[48:49], v10 offset:49152
    ds_read_b64_tr_b16 v[50:51], v11 offset:49152
    v_mfma_f32_16x16x32_bf16 v[168:171], v[56:59], v[16:19], v[168:171]
    ds_read_b64_tr_b16 v[52:53], v10 offset:57344
    ds_read_b64_tr_b16 v[54:55], v11 offset:57344
    v_mfma_f32_16x16x32_bf16 v[168:171], v[60:63], v[32:35], v[168:171]
    ds_read_b128 v[16:19], v8 offset:49152
    v_mul_f32 v65, v245, v65
    v_mfma_f32_16x16x32_bf16 v[172:175], v[56:59], v[20:23], v[172:175]
    ds_read_b128 v[32:35], v9 offset:49152
    v_mfma_f32_16x16x32_bf16 v[172:175], v[60:63], v[36:39], v[172:175]
    ds_read_b128 v[20:23], v8 offset:51200
    v_mfma_f32_16x16x32_bf16 v[184:187], v[56:59], v[24:27], v[184:187]
    ds_read_b128 v[36:39], v9 offset:51200
    v_mfma_f32_16x16x32_bf16 v[184:187], v[60:63], v[40:43], v[184:187]
    ds_read_b128 v[24:27], v8 offset:53248
    v_mfma_f32_16x16x32_bf16 v[188:191], v[56:59], v[28:31], v[188:191]
    ds_read_b128 v[40:43], v9 offset:53248
    v_mfma_f32_16x16x32_bf16 v[188:191], v[60:63], v[44:47], v[188:191]
    ds_read_b128 v[28:31], v8 offset:55296
    s_waitcnt lgkmcnt(5)
    v_mfma_f32_16x16x32_bf16 v[128:131], v[48:51], v[16:19], v[128:131]
    ds_read_b128 v[44:47], v9 offset:55296
    v_fmac_f32 v66, v194, v208
    v_mfma_f32_16x16x32_bf16 v[128:131], v[52:55], v[32:35], v[128:131]
    ds_read_b64_tr_b16 v[56:57], v10 offset:50176
    s_waitcnt lgkmcnt(5)
    v_mfma_f32_16x16x32_bf16 v[132:135], v[48:51], v[20:23], v[132:135]
    ds_read_b64_tr_b16 v[58:59], v11 offset:50176
    v_fmac_f32 v67, v195, v208
    v_mfma_f32_16x16x32_bf16 v[132:135], v[52:55], v[36:39], v[132:135]
    ds_read_b64_tr_b16 v[60:61], v10 offset:58368
    s_waitcnt lgkmcnt(5)
    v_mfma_f32_16x16x32_bf16 v[144:147], v[48:51], v[24:27], v[144:147]
    ds_read_b64_tr_b16 v[62:63], v11 offset:58368
    v_mul_f32 v244, v66, v66
    v_mfma_f32_16x16x32_bf16 v[144:147], v[52:55], v[40:43], v[144:147]
    s_waitcnt lgkmcnt(4)
    v_mfma_f32_16x16x32_bf16 v[148:151], v[48:51], v[28:31], v[148:151]
    ds_read_b64_tr_b16 v[48:49], v10 offset:51200
    v_mul_f32 v245, v67, v67
    v_mfma_f32_16x16x32_bf16 v[148:151], v[52:55], v[44:47], v[148:151]
    ds_read_b64_tr_b16 v[50:51], v11 offset:51200
    s_waitcnt lgkmcnt(4)
    v_mfma_f32_16x16x32_bf16 v[156:159], v[56:59], v[28:31], v[156:159]
    ds_read_b64_tr_b16 v[52:53], v10 offset:59392
    s_waitcnt lgkmcnt(3)
    v_mfma_f32_16x16x32_bf16 v[156:159], v[60:63], v[44:47], v[156:159]
    ds_read_b64_tr_b16 v[54:55], v11 offset:59392
    v_fma_f32 v244, v244, v210, v209
    v_mfma_f32_16x16x32_bf16 v[152:155], v[56:59], v[24:27], v[152:155]
    v_fma_f32 v245, v245, v210, v209
    v_mfma_f32_16x16x32_bf16 v[152:155], v[60:63], v[40:43], v[152:155]
    v_mul_f32 v244, v244, v66
    v_mfma_f32_16x16x32_bf16 v[140:143], v[56:59], v[20:23], v[140:143]
    v_mul_f32 v245, v245, v67
    v_mfma_f32_16x16x32_bf16 v[140:143], v[60:63], v[36:39], v[140:143]
    v_exp_f32 v244, v244
    v_mfma_f32_16x16x32_bf16 v[136:139], v[56:59], v[16:19], v[136:139]
    ds_read_b64_tr_b16 v[56:57], v10 offset:52224
    v_mfma_f32_16x16x32_bf16 v[136:139], v[60:63], v[32:35], v[136:139]
    ds_read_b64_tr_b16 v[58:59], v11 offset:52224
    s_waitcnt lgkmcnt(2)
    v_mfma_f32_16x16x32_bf16 v[160:163], v[48:51], v[16:19], v[160:163]
    ds_read_b64_tr_b16 v[60:61], v10 offset:60416
    v_mfma_f32_16x16x32_bf16 v[160:163], v[52:55], v[32:35], v[160:163]
    ds_read_b64_tr_b16 v[62:63], v11 offset:60416
    v_mfma_f32_16x16x32_bf16 v[164:167], v[48:51], v[20:23], v[164:167]
    v_exp_f32 v245, v245
    v_mfma_f32_16x16x32_bf16 v[164:167], v[52:55], v[36:39], v[164:167]
    v_fma_f32 v244, v244, v211, v211
    v_fma_f32 v245, v245, v211, v211
    v_mfma_f32_16x16x32_bf16 v[176:179], v[48:51], v[24:27], v[176:179]
    v_rcp_f32 v244, v244
    v_mfma_f32_16x16x32_bf16 v[176:179], v[52:55], v[40:43], v[176:179]
    v_rcp_f32 v245, v245
    v_mfma_f32_16x16x32_bf16 v[180:183], v[48:51], v[28:31], v[180:183]
    v_mul_f32 v66, v244, v66
    v_mfma_f32_16x16x32_bf16 v[180:183], v[52:55], v[44:47], v[180:183]
    s_waitcnt lgkmcnt(0)
    s_barrier
    ds_read_b64_tr_b16 v[48:49], v10 offset:0
    ds_read_b64_tr_b16 v[50:51], v11 offset:0
    v_mfma_f32_16x16x32_bf16 v[168:171], v[56:59], v[16:19], v[168:171]
    ds_read_b64_tr_b16 v[52:53], v10 offset:8192
    ds_read_b64_tr_b16 v[54:55], v11 offset:8192
    v_mfma_f32_16x16x32_bf16 v[168:171], v[60:63], v[32:35], v[168:171]
    ds_read_b128 v[16:19], v8 offset:0
    v_mul_f32 v67, v245, v67
    v_mfma_f32_16x16x32_bf16 v[172:175], v[56:59], v[20:23], v[172:175]
    ds_read_b128 v[32:35], v9 offset:0
    v_mfma_f32_16x16x32_bf16 v[172:175], v[60:63], v[36:39], v[172:175]
    ds_read_b128 v[20:23], v8 offset:2048
    v_mfma_f32_16x16x32_bf16 v[184:187], v[56:59], v[24:27], v[184:187]
    ds_read_b128 v[36:39], v9 offset:2048
    v_mfma_f32_16x16x32_bf16 v[184:187], v[60:63], v[40:43], v[184:187]
    ds_read_b128 v[24:27], v8 offset:4096
    v_mfma_f32_16x16x32_bf16 v[188:191], v[56:59], v[28:31], v[188:191]
    ds_read_b128 v[40:43], v9 offset:4096
    v_mfma_f32_16x16x32_bf16 v[188:191], v[60:63], v[44:47], v[188:191]
    ds_read_b128 v[28:31], v8 offset:6144
    s_waitcnt lgkmcnt(5)
    v_mfma_f32_16x16x32_bf16 v[128:131], v[48:51], v[16:19], v[128:131]
    ds_read_b128 v[44:47], v9 offset:6144
    v_fmac_f32 v68, v192, v212
    v_mfma_f32_16x16x32_bf16 v[128:131], v[52:55], v[32:35], v[128:131]
    ds_read_b64_tr_b16 v[56:57], v10 offset:1024
    s_waitcnt lgkmcnt(5)
    v_mfma_f32_16x16x32_bf16 v[132:135], v[48:51], v[20:23], v[132:135]
    ds_read_b64_tr_b16 v[58:59], v11 offset:1024
    v_fmac_f32 v69, v193, v212
    v_mfma_f32_16x16x32_bf16 v[132:135], v[52:55], v[36:39], v[132:135]
    ds_read_b64_tr_b16 v[60:61], v10 offset:9216
    s_waitcnt lgkmcnt(5)
    v_mfma_f32_16x16x32_bf16 v[144:147], v[48:51], v[24:27], v[144:147]
    ds_read_b64_tr_b16 v[62:63], v11 offset:9216
    v_mul_f32 v244, v68, v68
    v_mfma_f32_16x16x32_bf16 v[144:147], v[52:55], v[40:43], v[144:147]
    s_waitcnt lgkmcnt(4)
    v_mfma_f32_16x16x32_bf16 v[148:151], v[48:51], v[28:31], v[148:151]
    ds_read_b64_tr_b16 v[48:49], v10 offset:2048
    v_mul_f32 v245, v69, v69
    v_mfma_f32_16x16x32_bf16 v[148:151], v[52:55], v[44:47], v[148:151]
    ds_read_b64_tr_b16 v[50:51], v11 offset:2048
    s_waitcnt lgkmcnt(4)
    v_mfma_f32_16x16x32_bf16 v[156:159], v[56:59], v[28:31], v[156:159]
    ds_read_b64_tr_b16 v[52:53], v10 offset:10240
    s_waitcnt lgkmcnt(3)
    v_mfma_f32_16x16x32_bf16 v[156:159], v[60:63], v[44:47], v[156:159]
    ds_read_b64_tr_b16 v[54:55], v11 offset:10240
    v_fma_f32 v244, v244, v214, v213
    v_mfma_f32_16x16x32_bf16 v[152:155], v[56:59], v[24:27], v[152:155]
    v_fma_f32 v245, v245, v214, v213
    v_mfma_f32_16x16x32_bf16 v[152:155], v[60:63], v[40:43], v[152:155]
    v_mul_f32 v244, v244, v68
    v_mfma_f32_16x16x32_bf16 v[140:143], v[56:59], v[20:23], v[140:143]
    v_mul_f32 v245, v245, v69
    v_mfma_f32_16x16x32_bf16 v[140:143], v[60:63], v[36:39], v[140:143]
    v_exp_f32 v244, v244
    v_mfma_f32_16x16x32_bf16 v[136:139], v[56:59], v[16:19], v[136:139]
    ds_read_b64_tr_b16 v[56:57], v10 offset:3072
    v_mfma_f32_16x16x32_bf16 v[136:139], v[60:63], v[32:35], v[136:139]
    ds_read_b64_tr_b16 v[58:59], v11 offset:3072
    s_waitcnt lgkmcnt(2)
    v_mfma_f32_16x16x32_bf16 v[160:163], v[48:51], v[16:19], v[160:163]
    ds_read_b64_tr_b16 v[60:61], v10 offset:11264
    v_mfma_f32_16x16x32_bf16 v[160:163], v[52:55], v[32:35], v[160:163]
    ds_read_b64_tr_b16 v[62:63], v11 offset:11264
    v_mfma_f32_16x16x32_bf16 v[164:167], v[48:51], v[20:23], v[164:167]
    v_exp_f32 v245, v245
    v_mfma_f32_16x16x32_bf16 v[164:167], v[52:55], v[36:39], v[164:167]
    v_fma_f32 v244, v244, v215, v215
    v_fma_f32 v245, v245, v215, v215
    v_mfma_f32_16x16x32_bf16 v[176:179], v[48:51], v[24:27], v[176:179]
    v_rcp_f32 v244, v244
    v_mfma_f32_16x16x32_bf16 v[176:179], v[52:55], v[40:43], v[176:179]
    v_rcp_f32 v245, v245
    v_mfma_f32_16x16x32_bf16 v[180:183], v[48:51], v[28:31], v[180:183]
    v_mul_f32 v68, v244, v68
    v_mfma_f32_16x16x32_bf16 v[180:183], v[52:55], v[44:47], v[180:183]
    s_waitcnt lgkmcnt(0)
    s_barrier
    ds_read_b64_tr_b16 v[48:49], v10 offset:16384
    ds_read_b64_tr_b16 v[50:51], v11 offset:16384
    v_mfma_f32_16x16x32_bf16 v[168:171], v[56:59], v[16:19], v[168:171]
    ds_read_b64_tr_b16 v[52:53], v10 offset:24576
    ds_read_b64_tr_b16 v[54:55], v11 offset:24576
    v_mfma_f32_16x16x32_bf16 v[168:171], v[60:63], v[32:35], v[168:171]
    ds_read_b128 v[16:19], v8 offset:16384
    v_mul_f32 v69, v245, v69
    v_mfma_f32_16x16x32_bf16 v[172:175], v[56:59], v[20:23], v[172:175]
    ds_read_b128 v[32:35], v9 offset:16384
    v_mfma_f32_16x16x32_bf16 v[172:175], v[60:63], v[36:39], v[172:175]
    ds_read_b128 v[20:23], v8 offset:18432
    v_mfma_f32_16x16x32_bf16 v[184:187], v[56:59], v[24:27], v[184:187]
    ds_read_b128 v[36:39], v9 offset:18432
    v_mfma_f32_16x16x32_bf16 v[184:187], v[60:63], v[40:43], v[184:187]
    ds_read_b128 v[24:27], v8 offset:20480
    v_mfma_f32_16x16x32_bf16 v[188:191], v[56:59], v[28:31], v[188:191]
    ds_read_b128 v[40:43], v9 offset:20480
    v_mfma_f32_16x16x32_bf16 v[188:191], v[60:63], v[44:47], v[188:191]
    ds_read_b128 v[28:31], v8 offset:22528
    s_waitcnt lgkmcnt(5)
    v_mfma_f32_16x16x32_bf16 v[128:131], v[48:51], v[16:19], v[128:131]
    ds_read_b128 v[44:47], v9 offset:22528
    v_fmac_f32 v70, v194, v212
    v_mfma_f32_16x16x32_bf16 v[128:131], v[52:55], v[32:35], v[128:131]
    ds_read_b64_tr_b16 v[56:57], v10 offset:17408
    s_waitcnt lgkmcnt(5)
    v_mfma_f32_16x16x32_bf16 v[132:135], v[48:51], v[20:23], v[132:135]
    ds_read_b64_tr_b16 v[58:59], v11 offset:17408
    v_fmac_f32 v71, v195, v212
    v_mfma_f32_16x16x32_bf16 v[132:135], v[52:55], v[36:39], v[132:135]
    ds_read_b64_tr_b16 v[60:61], v10 offset:25600
    s_waitcnt lgkmcnt(5)
    v_mfma_f32_16x16x32_bf16 v[144:147], v[48:51], v[24:27], v[144:147]
    ds_read_b64_tr_b16 v[62:63], v11 offset:25600
    v_mul_f32 v244, v70, v70
    v_mfma_f32_16x16x32_bf16 v[144:147], v[52:55], v[40:43], v[144:147]
    s_waitcnt lgkmcnt(4)
    v_mfma_f32_16x16x32_bf16 v[148:151], v[48:51], v[28:31], v[148:151]
    ds_read_b64_tr_b16 v[48:49], v10 offset:18432
    v_mul_f32 v245, v71, v71
    v_mfma_f32_16x16x32_bf16 v[148:151], v[52:55], v[44:47], v[148:151]
    ds_read_b64_tr_b16 v[50:51], v11 offset:18432
    s_waitcnt lgkmcnt(4)
    v_mfma_f32_16x16x32_bf16 v[156:159], v[56:59], v[28:31], v[156:159]
    ds_read_b64_tr_b16 v[52:53], v10 offset:26624
    s_waitcnt lgkmcnt(3)
    v_mfma_f32_16x16x32_bf16 v[156:159], v[60:63], v[44:47], v[156:159]
    ds_read_b64_tr_b16 v[54:55], v11 offset:26624
    v_fma_f32 v244, v244, v214, v213
    v_mfma_f32_16x16x32_bf16 v[152:155], v[56:59], v[24:27], v[152:155]
    v_fma_f32 v245, v245, v214, v213
    v_mfma_f32_16x16x32_bf16 v[152:155], v[60:63], v[40:43], v[152:155]
    v_mul_f32 v244, v244, v70
    v_mfma_f32_16x16x32_bf16 v[140:143], v[56:59], v[20:23], v[140:143]
    v_mul_f32 v245, v245, v71
    v_mfma_f32_16x16x32_bf16 v[140:143], v[60:63], v[36:39], v[140:143]
    v_exp_f32 v244, v244
    v_mfma_f32_16x16x32_bf16 v[136:139], v[56:59], v[16:19], v[136:139]
    ds_read_b64_tr_b16 v[56:57], v10 offset:19456
    v_mfma_f32_16x16x32_bf16 v[136:139], v[60:63], v[32:35], v[136:139]
    ds_read_b64_tr_b16 v[58:59], v11 offset:19456
    s_waitcnt lgkmcnt(2)
    v_mfma_f32_16x16x32_bf16 v[160:163], v[48:51], v[16:19], v[160:163]
    ds_read_b64_tr_b16 v[60:61], v10 offset:27648
    v_mfma_f32_16x16x32_bf16 v[160:163], v[52:55], v[32:35], v[160:163]
    ds_read_b64_tr_b16 v[62:63], v11 offset:27648
    v_mfma_f32_16x16x32_bf16 v[164:167], v[48:51], v[20:23], v[164:167]
    v_exp_f32 v245, v245
    v_mfma_f32_16x16x32_bf16 v[164:167], v[52:55], v[36:39], v[164:167]
    v_fma_f32 v244, v244, v215, v215
    v_fma_f32 v245, v245, v215, v215
    v_mfma_f32_16x16x32_bf16 v[176:179], v[48:51], v[24:27], v[176:179]
    v_rcp_f32 v244, v244
    v_mfma_f32_16x16x32_bf16 v[176:179], v[52:55], v[40:43], v[176:179]
    v_rcp_f32 v245, v245
    v_mfma_f32_16x16x32_bf16 v[180:183], v[48:51], v[28:31], v[180:183]
    v_mul_f32 v70, v244, v70
    v_mfma_f32_16x16x32_bf16 v[180:183], v[52:55], v[44:47], v[180:183]
    s_waitcnt lgkmcnt(0)
    s_barrier
    ds_read_b64_tr_b16 v[48:49], v10 offset:32768
    ds_read_b64_tr_b16 v[50:51], v11 offset:32768
    v_mfma_f32_16x16x32_bf16 v[168:171], v[56:59], v[16:19], v[168:171]
    ds_read_b64_tr_b16 v[52:53], v10 offset:40960
    ds_read_b64_tr_b16 v[54:55], v11 offset:40960
    v_mfma_f32_16x16x32_bf16 v[168:171], v[60:63], v[32:35], v[168:171]
    ds_read_b128 v[16:19], v8 offset:32768
    v_mul_f32 v71, v245, v71
    v_mfma_f32_16x16x32_bf16 v[172:175], v[56:59], v[20:23], v[172:175]
    ds_read_b128 v[32:35], v9 offset:32768
    v_mfma_f32_16x16x32_bf16 v[172:175], v[60:63], v[36:39], v[172:175]
    ds_read_b128 v[20:23], v8 offset:34816
    v_mfma_f32_16x16x32_bf16 v[184:187], v[56:59], v[24:27], v[184:187]
    ds_read_b128 v[36:39], v9 offset:34816
    v_mfma_f32_16x16x32_bf16 v[184:187], v[60:63], v[40:43], v[184:187]
    ds_read_b128 v[24:27], v8 offset:36864
    v_mfma_f32_16x16x32_bf16 v[188:191], v[56:59], v[28:31], v[188:191]
    ds_read_b128 v[40:43], v9 offset:36864
    v_mfma_f32_16x16x32_bf16 v[188:191], v[60:63], v[44:47], v[188:191]
    ds_read_b128 v[28:31], v8 offset:38912
    s_waitcnt lgkmcnt(5)
    v_mfma_f32_16x16x32_bf16 v[128:131], v[48:51], v[16:19], v[128:131]
    ds_read_b128 v[44:47], v9 offset:38912
    v_fmac_f32 v80, v192, v216
    v_mfma_f32_16x16x32_bf16 v[128:131], v[52:55], v[32:35], v[128:131]
    ds_read_b64_tr_b16 v[56:57], v10 offset:33792
    s_waitcnt lgkmcnt(5)
    v_mfma_f32_16x16x32_bf16 v[132:135], v[48:51], v[20:23], v[132:135]
    ds_read_b64_tr_b16 v[58:59], v11 offset:33792
    v_fmac_f32 v81, v193, v216
    v_mfma_f32_16x16x32_bf16 v[132:135], v[52:55], v[36:39], v[132:135]
    ds_read_b64_tr_b16 v[60:61], v10 offset:41984
    s_waitcnt lgkmcnt(5)
    v_mfma_f32_16x16x32_bf16 v[144:147], v[48:51], v[24:27], v[144:147]
    ds_read_b64_tr_b16 v[62:63], v11 offset:41984
    v_mul_f32 v244, v80, v80
    v_mfma_f32_16x16x32_bf16 v[144:147], v[52:55], v[40:43], v[144:147]
    s_waitcnt lgkmcnt(4)
    v_mfma_f32_16x16x32_bf16 v[148:151], v[48:51], v[28:31], v[148:151]
    ds_read_b64_tr_b16 v[48:49], v10 offset:34816
    v_mul_f32 v245, v81, v81
    v_mfma_f32_16x16x32_bf16 v[148:151], v[52:55], v[44:47], v[148:151]
    ds_read_b64_tr_b16 v[50:51], v11 offset:34816
    s_waitcnt lgkmcnt(4)
    v_mfma_f32_16x16x32_bf16 v[156:159], v[56:59], v[28:31], v[156:159]
    ds_read_b64_tr_b16 v[52:53], v10 offset:43008
    s_waitcnt lgkmcnt(3)
    v_mfma_f32_16x16x32_bf16 v[156:159], v[60:63], v[44:47], v[156:159]
    ds_read_b64_tr_b16 v[54:55], v11 offset:43008
    v_fma_f32 v244, v244, v218, v217
    v_mfma_f32_16x16x32_bf16 v[152:155], v[56:59], v[24:27], v[152:155]
    v_fma_f32 v245, v245, v218, v217
    v_mfma_f32_16x16x32_bf16 v[152:155], v[60:63], v[40:43], v[152:155]
    v_mul_f32 v244, v244, v80
    v_mfma_f32_16x16x32_bf16 v[140:143], v[56:59], v[20:23], v[140:143]
    v_mul_f32 v245, v245, v81
    v_mfma_f32_16x16x32_bf16 v[140:143], v[60:63], v[36:39], v[140:143]
    v_exp_f32 v244, v244
    v_mfma_f32_16x16x32_bf16 v[136:139], v[56:59], v[16:19], v[136:139]
    ds_read_b64_tr_b16 v[56:57], v10 offset:35840
    v_mfma_f32_16x16x32_bf16 v[136:139], v[60:63], v[32:35], v[136:139]
    ds_read_b64_tr_b16 v[58:59], v11 offset:35840
    s_waitcnt lgkmcnt(2)
    v_mfma_f32_16x16x32_bf16 v[160:163], v[48:51], v[16:19], v[160:163]
    ds_read_b64_tr_b16 v[60:61], v10 offset:44032
    v_mfma_f32_16x16x32_bf16 v[160:163], v[52:55], v[32:35], v[160:163]
    ds_read_b64_tr_b16 v[62:63], v11 offset:44032
    v_mfma_f32_16x16x32_bf16 v[164:167], v[48:51], v[20:23], v[164:167]
    v_exp_f32 v245, v245
    v_mfma_f32_16x16x32_bf16 v[164:167], v[52:55], v[36:39], v[164:167]
    v_fma_f32 v244, v244, v219, v219
    v_fma_f32 v245, v245, v219, v219
    v_mfma_f32_16x16x32_bf16 v[176:179], v[48:51], v[24:27], v[176:179]
    v_rcp_f32 v244, v244
    v_mfma_f32_16x16x32_bf16 v[176:179], v[52:55], v[40:43], v[176:179]
    v_rcp_f32 v245, v245
    v_mfma_f32_16x16x32_bf16 v[180:183], v[48:51], v[28:31], v[180:183]
    v_mul_f32 v80, v244, v80
    v_mfma_f32_16x16x32_bf16 v[180:183], v[52:55], v[44:47], v[180:183]
    s_waitcnt lgkmcnt(0)
    s_barrier
    ds_read_b64_tr_b16 v[48:49], v10 offset:49152
    ds_read_b64_tr_b16 v[50:51], v11 offset:49152
    v_mfma_f32_16x16x32_bf16 v[168:171], v[56:59], v[16:19], v[168:171]
    ds_read_b64_tr_b16 v[52:53], v10 offset:57344
    ds_read_b64_tr_b16 v[54:55], v11 offset:57344
    v_mfma_f32_16x16x32_bf16 v[168:171], v[60:63], v[32:35], v[168:171]
    ds_read_b128 v[16:19], v8 offset:49152
    v_mul_f32 v81, v245, v81
    v_mfma_f32_16x16x32_bf16 v[172:175], v[56:59], v[20:23], v[172:175]
    ds_read_b128 v[32:35], v9 offset:49152
    v_mfma_f32_16x16x32_bf16 v[172:175], v[60:63], v[36:39], v[172:175]
    ds_read_b128 v[20:23], v8 offset:51200
    v_mfma_f32_16x16x32_bf16 v[184:187], v[56:59], v[24:27], v[184:187]
    ds_read_b128 v[36:39], v9 offset:51200
    v_mfma_f32_16x16x32_bf16 v[184:187], v[60:63], v[40:43], v[184:187]
    ds_read_b128 v[24:27], v8 offset:53248
    v_mfma_f32_16x16x32_bf16 v[188:191], v[56:59], v[28:31], v[188:191]
    ds_read_b128 v[40:43], v9 offset:53248
    v_mfma_f32_16x16x32_bf16 v[188:191], v[60:63], v[44:47], v[188:191]
    ds_read_b128 v[28:31], v8 offset:55296
    s_waitcnt lgkmcnt(5)
    v_mfma_f32_16x16x32_bf16 v[128:131], v[48:51], v[16:19], v[128:131]
    ds_read_b128 v[44:47], v9 offset:55296
    v_fmac_f32 v82, v194, v216
    v_mfma_f32_16x16x32_bf16 v[128:131], v[52:55], v[32:35], v[128:131]
    ds_read_b64_tr_b16 v[56:57], v10 offset:50176
    s_waitcnt lgkmcnt(5)
    v_mfma_f32_16x16x32_bf16 v[132:135], v[48:51], v[20:23], v[132:135]
    ds_read_b64_tr_b16 v[58:59], v11 offset:50176
    v_fmac_f32 v83, v195, v216
    v_mfma_f32_16x16x32_bf16 v[132:135], v[52:55], v[36:39], v[132:135]
    ds_read_b64_tr_b16 v[60:61], v10 offset:58368
    s_waitcnt lgkmcnt(5)
    v_mfma_f32_16x16x32_bf16 v[144:147], v[48:51], v[24:27], v[144:147]
    ds_read_b64_tr_b16 v[62:63], v11 offset:58368
    v_mul_f32 v244, v82, v82
    v_mfma_f32_16x16x32_bf16 v[144:147], v[52:55], v[40:43], v[144:147]
    s_waitcnt lgkmcnt(4)
    v_mfma_f32_16x16x32_bf16 v[148:151], v[48:51], v[28:31], v[148:151]
    ds_read_b64_tr_b16 v[48:49], v10 offset:51200
    v_mul_f32 v245, v83, v83
    v_mfma_f32_16x16x32_bf16 v[148:151], v[52:55], v[44:47], v[148:151]
    ds_read_b64_tr_b16 v[50:51], v11 offset:51200
    s_waitcnt lgkmcnt(4)
    v_mfma_f32_16x16x32_bf16 v[156:159], v[56:59], v[28:31], v[156:159]
    ds_read_b64_tr_b16 v[52:53], v10 offset:59392
    s_waitcnt lgkmcnt(3)
    v_mfma_f32_16x16x32_bf16 v[156:159], v[60:63], v[44:47], v[156:159]
    ds_read_b64_tr_b16 v[54:55], v11 offset:59392
    v_fma_f32 v244, v244, v218, v217
    v_mfma_f32_16x16x32_bf16 v[152:155], v[56:59], v[24:27], v[152:155]
    v_fma_f32 v245, v245, v218, v217
    v_mfma_f32_16x16x32_bf16 v[152:155], v[60:63], v[40:43], v[152:155]
    v_mul_f32 v244, v244, v82
    v_mfma_f32_16x16x32_bf16 v[140:143], v[56:59], v[20:23], v[140:143]
    v_mul_f32 v245, v245, v83
    v_mfma_f32_16x16x32_bf16 v[140:143], v[60:63], v[36:39], v[140:143]
    v_exp_f32 v244, v244
    v_mfma_f32_16x16x32_bf16 v[136:139], v[56:59], v[16:19], v[136:139]
    ds_read_b64_tr_b16 v[56:57], v10 offset:52224
    v_mfma_f32_16x16x32_bf16 v[136:139], v[60:63], v[32:35], v[136:139]
    ds_read_b64_tr_b16 v[58:59], v11 offset:52224
    s_waitcnt lgkmcnt(2)
    v_mfma_f32_16x16x32_bf16 v[160:163], v[48:51], v[16:19], v[160:163]
    ds_read_b64_tr_b16 v[60:61], v10 offset:60416
    v_mfma_f32_16x16x32_bf16 v[160:163], v[52:55], v[32:35], v[160:163]
    ds_read_b64_tr_b16 v[62:63], v11 offset:60416
    v_mfma_f32_16x16x32_bf16 v[164:167], v[48:51], v[20:23], v[164:167]
    v_exp_f32 v245, v245
    v_mfma_f32_16x16x32_bf16 v[164:167], v[52:55], v[36:39], v[164:167]
    v_fma_f32 v244, v244, v219, v219
    v_fma_f32 v245, v245, v219, v219
    v_mfma_f32_16x16x32_bf16 v[176:179], v[48:51], v[24:27], v[176:179]
    v_rcp_f32 v244, v244
    v_mfma_f32_16x16x32_bf16 v[176:179], v[52:55], v[40:43], v[176:179]
    v_rcp_f32 v245, v245
    v_mfma_f32_16x16x32_bf16 v[180:183], v[48:51], v[28:31], v[180:183]
    v_mul_f32 v82, v244, v82
    v_mfma_f32_16x16x32_bf16 v[180:183], v[52:55], v[44:47], v[180:183]
    s_waitcnt lgkmcnt(0)
    s_barrier
    ds_read_b64_tr_b16 v[48:49], v10 offset:0
    ds_read_b64_tr_b16 v[50:51], v11 offset:0
    v_mfma_f32_16x16x32_bf16 v[168:171], v[56:59], v[16:19], v[168:171]
    ds_read_b64_tr_b16 v[52:53], v10 offset:8192
    ds_read_b64_tr_b16 v[54:55], v11 offset:8192
    v_mfma_f32_16x16x32_bf16 v[168:171], v[60:63], v[32:35], v[168:171]
    ds_read_b128 v[16:19], v8 offset:0
    v_mul_f32 v83, v245, v83
    v_mfma_f32_16x16x32_bf16 v[172:175], v[56:59], v[20:23], v[172:175]
    ds_read_b128 v[32:35], v9 offset:0
    v_mfma_f32_16x16x32_bf16 v[172:175], v[60:63], v[36:39], v[172:175]
    ds_read_b128 v[20:23], v8 offset:2048
    v_mfma_f32_16x16x32_bf16 v[184:187], v[56:59], v[24:27], v[184:187]
    ds_read_b128 v[36:39], v9 offset:2048
    v_mfma_f32_16x16x32_bf16 v[184:187], v[60:63], v[40:43], v[184:187]
    ds_read_b128 v[24:27], v8 offset:4096
    v_mfma_f32_16x16x32_bf16 v[188:191], v[56:59], v[28:31], v[188:191]
    ds_read_b128 v[40:43], v9 offset:4096
    v_mfma_f32_16x16x32_bf16 v[188:191], v[60:63], v[44:47], v[188:191]
    ds_read_b128 v[28:31], v8 offset:6144
    s_waitcnt lgkmcnt(5)
    v_mfma_f32_16x16x32_bf16 v[128:131], v[48:51], v[16:19], v[128:131]
    ds_read_b128 v[44:47], v9 offset:6144
    v_fmac_f32 v84, v192, v220
    v_mfma_f32_16x16x32_bf16 v[128:131], v[52:55], v[32:35], v[128:131]
    ds_read_b64_tr_b16 v[56:57], v10 offset:1024
    s_waitcnt lgkmcnt(5)
    v_mfma_f32_16x16x32_bf16 v[132:135], v[48:51], v[20:23], v[132:135]
    ds_read_b64_tr_b16 v[58:59], v11 offset:1024
    v_fmac_f32 v85, v193, v220
    v_mfma_f32_16x16x32_bf16 v[132:135], v[52:55], v[36:39], v[132:135]
    ds_read_b64_tr_b16 v[60:61], v10 offset:9216
    s_waitcnt lgkmcnt(5)
    v_mfma_f32_16x16x32_bf16 v[144:147], v[48:51], v[24:27], v[144:147]
    ds_read_b64_tr_b16 v[62:63], v11 offset:9216
    v_mul_f32 v244, v84, v84
    v_mfma_f32_16x16x32_bf16 v[144:147], v[52:55], v[40:43], v[144:147]
    s_waitcnt lgkmcnt(4)
    v_mfma_f32_16x16x32_bf16 v[148:151], v[48:51], v[28:31], v[148:151]
    ds_read_b64_tr_b16 v[48:49], v10 offset:2048
    v_mul_f32 v245, v85, v85
    v_mfma_f32_16x16x32_bf16 v[148:151], v[52:55], v[44:47], v[148:151]
    ds_read_b64_tr_b16 v[50:51], v11 offset:2048
L_pad15:
    s_cbranch_execz L_padr15
    s_waitcnt lgkmcnt(4)
    v_mfma_f32_16x16x32_bf16 v[156:159], v[56:59], v[28:31], v[156:159]
    ds_read_b64_tr_b16 v[52:53], v10 offset:10240
    s_waitcnt lgkmcnt(3)
    v_mfma_f32_16x16x32_bf16 v[156:159], v[60:63], v[44:47], v[156:159]
    ds_read_b64_tr_b16 v[54:55], v11 offset:10240
    v_fma_f32 v244, v244, v222, v221
    v_mfma_f32_16x16x32_bf16 v[152:155], v[56:59], v[24:27], v[152:155]
    v_fma_f32 v245, v245, v222, v221
    v_mfma_f32_16x16x32_bf16 v[152:155], v[60:63], v[40:43], v[152:155]
    v_mul_f32 v244, v244, v84
    v_mfma_f32_16x16x32_bf16 v[140:143], v[56:59], v[20:23], v[140:143]
    v_mul_f32 v245, v245, v85
    v_mfma_f32_16x16x32_bf16 v[140:143], v[60:63], v[36:39], v[140:143]
    v_exp_f32 v244, v244
    v_mfma_f32_16x16x32_bf16 v[136:139], v[56:59], v[16:19], v[136:139]
    ds_read_b64_tr_b16 v[56:57], v10 offset:3072
    v_mfma_f32_16x16x32_bf16 v[136:139], v[60:63], v[32:35], v[136:139]
    ds_read_b64_tr_b16 v[58:59], v11 offset:3072
    s_waitcnt lgkmcnt(2)
    v_mfma_f32_16x16x32_bf16 v[160:163], v[48:51], v[16:19], v[160:163]
    ds_read_b64_tr_b16 v[60:61], v10 offset:11264
    v_mfma_f32_16x16x32_bf16 v[160:163], v[52:55], v[32:35], v[160:163]
    ds_read_b64_tr_b16 v[62:63], v11 offset:11264
    v_mfma_f32_16x16x32_bf16 v[164:167], v[48:51], v[20:23], v[164:167]
    v_exp_f32 v245, v245
    v_mfma_f32_16x16x32_bf16 v[164:167], v[52:55], v[36:39], v[164:167]
    v_fma_f32 v244, v244, v223, v223
    v_fma_f32 v245, v245, v223, v223
    v_mfma_f32_16x16x32_bf16 v[176:179], v[48:51], v[24:27], v[176:179]
    v_rcp_f32 v244, v244
    v_mfma_f32_16x16x32_bf16 v[176:179], v[52:55], v[40:43], v[176:179]
    v_rcp_f32 v245, v245
    v_mfma_f32_16x16x32_bf16 v[180:183], v[48:51], v[28:31], v[180:183]
    v_mul_f32 v84, v244, v84
    v_mfma_f32_16x16x32_bf16 v[180:183], v[52:55], v[44:47], v[180:183]
    s_waitcnt lgkmcnt(0)
    s_barrier
    ds_read_b64_tr_b16 v[48:49], v10 offset:16384
    ds_read_b64_tr_b16 v[50:51], v11 offset:16384
    v_mfma_f32_16x16x32_bf16 v[168:171], v[56:59], v[16:19], v[168:171]
    ds_read_b64_tr_b16 v[52:53], v10 offset:24576
    ds_read_b64_tr_b16 v[54:55], v11 offset:24576
    v_mfma_f32_16x16x32_bf16 v[168:171], v[60:63], v[32:35], v[168:171]
    ds_read_b128 v[16:19], v8 offset:16384
    v_mul_f32 v85, v245, v85
    v_mfma_f32_16x16x32_bf16 v[172:175], v[56:59], v[20:23], v[172:175]
    ds_read_b128 v[32:35], v9 offset:16384
    v_mfma_f32_16x16x32_bf16 v[172:175], v[60:63], v[36:39], v[172:175]
    ds_read_b128 v[20:23], v8 offset:18432
    v_mfma_f32_16x16x32_bf16 v[184:187], v[56:59], v[24:27], v[184:187]
    ds_read_b128 v[36:39], v9 offset:18432
    v_mfma_f32_16x16x32_bf16 v[184:187], v[60:63], v[40:43], v[184:187]
    ds_read_b128 v[24:27], v8 offset:20480
    v_mfma_f32_16x16x32_bf16 v[188:191], v[56:59], v[28:31], v[188:191]
    ds_read_b128 v[40:43], v9 offset:20480
    v_mfma_f32_16x16x32_bf16 v[188:191], v[60:63], v[44:47], v[188:191]
    ds_read_b128 v[28:31], v8 offset:22528
    s_waitcnt lgkmcnt(5)
    v_mfma_f32_16x16x32_bf16 v[128:131], v[48:51], v[16:19], v[128:131]
    ds_read_b128 v[44:47], v9 offset:22528
    v_fmac_f32 v86, v194, v220
    v_mfma_f32_16x16x32_bf16 v[128:131], v[52:55], v[32:35], v[128:131]
    ds_read_b64_tr_b16 v[56:57], v10 offset:17408
    s_waitcnt lgkmcnt(5)
    v_mfma_f32_16x16x32_bf16 v[132:135], v[48:51], v[20:23], v[132:135]
    ds_read_b64_tr_b16 v[58:59], v11 offset:17408
    v_fmac_f32 v87, v195, v220
    v_mfma_f32_16x16x32_bf16 v[132:135], v[52:55], v[36:39], v[132:135]
    ds_read_b64_tr_b16 v[60:61], v10 offset:25600
    s_waitcnt lgkmcnt(5)
    v_mfma_f32_16x16x32_bf16 v[144:147], v[48:51], v[24:27], v[144:147]
    ds_read_b64_tr_b16 v[62:63], v11 offset:25600
    v_mul_f32 v244, v86, v86
    v_mfma_f32_16x16x32_bf16 v[144:147], v[52:55], v[40:43], v[144:147]
    s_waitcnt lgkmcnt(4)
    v_mfma_f32_16x16x32_bf16 v[148:151], v[48:51], v[28:31], v[148:151]
    ds_read_b64_tr_b16 v[48:49], v10 offset:18432
    v_mul_f32 v245, v87, v87
    v_mfma_f32_16x16x32_bf16 v[148:151], v[52:55], v[44:47], v[148:151]
    ds_read_b64_tr_b16 v[50:51], v11 offset:18432
    s_waitcnt lgkmcnt(4)
    v_mfma_f32_16x16x32_bf16 v[156:159], v[56:59], v[28:31], v[156:159]
    ds_read_b64_tr_b16 v[52:53], v10 offset:26624
    s_waitcnt lgkmcnt(3)
    v_mfma_f32_16x16x32_bf16 v[156:159], v[60:63], v[44:47], v[156:159]
    ds_read_b64_tr_b16 v[54:55], v11 offset:26624
    v_fma_f32 v244, v244, v222, v221
    v_mfma_f32_16x16x32_bf16 v[152:155], v[56:59], v[24:27], v[152:155]
    v_fma_f32 v245, v245, v222, v221
    v_mfma_f32_16x16x32_bf16 v[152:155], v[60:63], v[40:43], v[152:155]
    v_mul_f32 v244, v244, v86
    v_mfma_f32_16x16x32_bf16 v[140:143], v[56:59], v[20:23], v[140:143]
    v_mul_f32 v245, v245, v87
    v_mfma_f32_16x16x32_bf16 v[140:143], v[60:63], v[36:39], v[140:143]
    v_exp_f32 v244, v244
    v_mfma_f32_16x16x32_bf16 v[136:139], v[56:59], v[16:19], v[136:139]
    ds_read_b64_tr_b16 v[56:57], v10 offset:19456
    v_mfma_f32_16x16x32_bf16 v[136:139], v[60:63], v[32:35], v[136:139]
    ds_read_b64_tr_b16 v[58:59], v11 offset:19456
    s_waitcnt lgkmcnt(2)
    v_mfma_f32_16x16x32_bf16 v[160:163], v[48:51], v[16:19], v[160:163]
    ds_read_b64_tr_b16 v[60:61], v10 offset:27648
    v_mfma_f32_16x16x32_bf16 v[160:163], v[52:55], v[32:35], v[160:163]
    ds_read_b64_tr_b16 v[62:63], v11 offset:27648
    v_mfma_f32_16x16x32_bf16 v[164:167], v[48:51], v[20:23], v[164:167]
    v_exp_f32 v245, v245
    v_mfma_f32_16x16x32_bf16 v[164:167], v[52:55], v[36:39], v[164:167]
    v_fma_f32 v244, v244, v223, v223
    v_fma_f32 v245, v245, v223, v223
    v_mfma_f32_16x16x32_bf16 v[176:179], v[48:51], v[24:27], v[176:179]
    v_rcp_f32 v244, v244
    v_mfma_f32_16x16x32_bf16 v[176:179], v[52:55], v[40:43], v[176:179]
    v_rcp_f32 v245, v245
    v_mfma_f32_16x16x32_bf16 v[180:183], v[48:51], v[28:31], v[180:183]
    v_mul_f32 v86, v244, v86
    v_mfma_f32_16x16x32_bf16 v[180:183], v[52:55], v[44:47], v[180:183]
    s_waitcnt lgkmcnt(0)
    s_barrier
    ds_read_b64_tr_b16 v[48:49], v10 offset:32768
    ds_read_b64_tr_b16 v[50:51], v11 offset:32768
    v_mfma_f32_16x16x32_bf16 v[168:171], v[56:59], v[16:19], v[168:171]
    ds_read_b64_tr_b16 v[52:53], v10 offset:40960
    ds_read_b64_tr_b16 v[54:55], v11 offset:40960
    v_mfma_f32_16x16x32_bf16 v[168:171], v[60:63], v[32:35], v[168:171]
    ds_read_b128 v[16:19], v8 offset:32768
    v_mul_f32 v87, v245, v87
    v_mfma_f32_16x16x32_bf16 v[172:175], v[56:59], v[20:23], v[172:175]
    ds_read_b128 v[32:35], v9 offset:32768
    v_mfma_f32_16x16x32_bf16 v[172:175], v[60:63], v[36:39], v[172:175]
    ds_read_b128 v[20:23], v8 offset:34816
    v_mfma_f32_16x16x32_bf16 v[184:187], v[56:59], v[24:27], v[184:187]
    ds_read_b128 v[36:39], v9 offset:34816
    v_mfma_f32_16x16x32_bf16 v[184:187], v[60:63], v[40:43], v[184:187]
    ds_read_b128 v[24:27], v8 offset:36864
    v_mfma_f32_16x16x32_bf16 v[188:191], v[56:59], v[28:31], v[188:191]
    ds_read_b128 v[40:43], v9 offset:36864
    v_mfma_f32_16x16x32_bf16 v[188:191], v[60:63], v[44:47], v[188:191]
    ds_read_b128 v[28:31], v8 offset:38912
    s_waitcnt lgkmcnt(5)
    v_mfma_f32_16x16x32_bf16 v[128:131], v[48:51], v[16:19], v[128:131]
    ds_read_b128 v[44:47], v9 offset:38912
    v_fmac_f32 v92, v196, v220
    v_mfma_f32_16x16x32_bf16 v[128:131], v[52:55], v[32:35], v[128:131]
    ds_read_b64_tr_b16 v[56:57], v10 offset:33792
    s_waitcnt lgkmcnt(5)
    v_mfma_f32_16x16x32_bf16 v[132:135], v[48:51], v[20:23], v[132:135]
    ds_read_b64_tr_b16 v[58:59], v11 offset:33792
    v_fmac_f32 v93, v197, v220
    v_mfma_f32_16x16x32_bf16 v[132:135], v[52:55], v[36:39], v[132:135]
    ds_read_b64_tr_b16 v[60:61], v10 offset:41984
    s_waitcnt lgkmcnt(5)
    v_mfma_f32_16x16x32_bf16 v[144:147], v[48:51], v[24:27], v[144:147]
    ds_read_b64_tr_b16 v[62:63], v11 offset:41984
    v_mul_f32 v244, v92, v92
    v_mfma_f32_16x16x32_bf16 v[144:147], v[52:55], v[40:43], v[144:147]
    s_waitcnt lgkmcnt(4)
    v_mfma_f32_16x16x32_bf16 v[148:151], v[48:51], v[28:31], v[148:151]
    ds_read_b64_tr_b16 v[48:49], v10 offset:34816
    v_mul_f32 v245, v93, v93
    v_mfma_f32_16x16x32_bf16 v[148:151], v[52:55], v[44:47], v[148:151]
    ds_read_b64_tr_b16 v[50:51], v11 offset:34816
    s_waitcnt lgkmcnt(4)
    v_mfma_f32_16x16x32_bf16 v[156:159], v[56:59], v[28:31], v[156:159]
    ds_read_b64_tr_b16 v[52:53], v10 offset:43008
    s_waitcnt lgkmcnt(3)
    v_mfma_f32_16x16x32_bf16 v[156:159], v[60:63], v[44:47], v[156:159]
    ds_read_b64_tr_b16 v[54:55], v11 offset:43008
    v_fma_f32 v244, v244, v222, v221
    v_mfma_f32_16x16x32_bf16 v[152:155], v[56:59], v[24:27], v[152:155]
    v_fma_f32 v245, v245, v222, v221
    v_mfma_f32_16x16x32_bf16 v[152:155], v[60:63], v[40:43], v[152:155]
    v_mul_f32 v244, v244, v92
    v_mfma_f32_16x16x32_bf16 v[140:143], v[56:59], v[20:23], v[140:143]
    v_mul_f32 v245, v245, v93
    v_mfma_f32_16x16x32_bf16 v[140:143], v[60:63], v[36:39], v[140:143]
    v_exp_f32 v244, v244
    v_mfma_f32_16x16x32_bf16 v[136:139], v[56:59], v[16:19], v[136:139]
    ds_read_b64_tr_b16 v[56:57], v10 offset:35840
    v_mfma_f32_16x16x32_bf16 v[136:139], v[60:63], v[32:35], v[136:139]
    ds_read_b64_tr_b16 v[58:59], v11 offset:35840
    s_waitcnt lgkmcnt(2)
    v_mfma_f32_16x16x32_bf16 v[160:163], v[48:51], v[16:19], v[160:163]
    ds_read_b64_tr_b16 v[60:61], v10 offset:44032
    v_mfma_f32_16x16x32_bf16 v[160:163], v[52:55], v[32:35], v[160:163]
    ds_read_b64_tr_b16 v[62:63], v11 offset:44032
    v_mfma_f32_16x16x32_bf16 v[164:167], v[48:51], v[20:23], v[164:167]
    v_exp_f32 v245, v245
    v_mfma_f32_16x16x32_bf16 v[164:167], v[52:55], v[36:39], v[164:167]
    v_fma_f32 v244, v244, v223, v223
    v_fma_f32 v245, v245, v223, v223
    v_mfma_f32_16x16x32_bf16 v[176:179], v[48:51], v[24:27], v[176:179]
    v_rcp_f32 v244, v244
    v_mfma_f32_16x16x32_bf16 v[176:179], v[52:55], v[40:43], v[176:179]
    v_rcp_f32 v245, v245
    v_mfma_f32_16x16x32_bf16 v[180:183], v[48:51], v[28:31], v[180:183]
    v_mul_f32 v92, v244, v92
    v_mfma_f32_16x16x32_bf16 v[180:183], v[52:55], v[44:47], v[180:183]
    s_waitcnt lgkmcnt(0)
    s_barrier
    ds_read_b64_tr_b16 v[48:49], v10 offset:49152
    ds_read_b64_tr_b16 v[50:51], v11 offset:49152
    v_mfma_f32_16x16x32_bf16 v[168:171], v[56:59], v[16:19], v[168:171]
    ds_read_b64_tr_b16 v[52:53], v10 offset:57344
    ds_read_b64_tr_b16 v[54:55], v11 offset:57344
    v_mfma_f32_16x16x32_bf16 v[168:171], v[60:63], v[32:35], v[168:171]
    ds_read_b128 v[16:19], v8 offset:49152
    v_mul_f32 v93, v245, v93
    v_mfma_f32_16x16x32_bf16 v[172:175], v[56:59], v[20:23], v[172:175]
    ds_read_b128 v[32:35], v9 offset:49152
    v_mfma_f32_16x16x32_bf16 v[172:175], v[60:63], v[36:39], v[172:175]
    ds_read_b128 v[20:23], v8 offset:51200
    v_mfma_f32_16x16x32_bf16 v[184:187], v[56:59], v[24:27], v[184:187]
    ds_read_b128 v[36:39], v9 offset:51200
    v_mfma_f32_16x16x32_bf16 v[184:187], v[60:63], v[40:43], v[184:187]
    ds_read_b128 v[24:27], v8 offset:53248
    v_mfma_f32_16x16x32_bf16 v[188:191], v[56:59], v[28:31], v[188:191]
    ds_read_b128 v[40:43], v9 offset:53248
    v_mfma_f32_16x16x32_bf16 v[188:191], v[60:63], v[44:47], v[188:191]
    ds_read_b128 v[28:31], v8 offset:55296
    s_waitcnt lgkmcnt(5)
    v_mfma_f32_16x16x32_bf16 v[128:131], v[48:51], v[16:19], v[128:131]
    ds_read_b128 v[44:47], v9 offset:55296
    v_fmac_f32 v94, v198, v220
    v_mfma_f32_16x16x32_bf16 v[128:131], v[52:55], v[32:35], v[128:131]
    ds_read_b64_tr_b16 v[56:57], v10 offset:50176
    s_waitcnt lgkmcnt(5)
    v_mfma_f32_16x16x32_bf16 v[132:135], v[48:51], v[20:23], v[132:135]
    ds_read_b64_tr_b16 v[58:59], v11 offset:50176
    v_fmac_f32 v95, v199, v220
    v_mfma_f32_16x16x32_bf16 v[132:135], v[52:55], v[36:39], v[132:135]
    ds_read_b64_tr_b16 v[60:61], v10 offset:58368
    s_waitcnt lgkmcnt(5)
    v_mfma_f32_16x16x32_bf16 v[144:147], v[48:51], v[24:27], v[144:147]
    ds_read_b64_tr_b16 v[62:63], v11 offset:58368
    v_mul_f32 v244, v94, v94
    v_mfma_f32_16x16x32_bf16 v[144:147], v[52:55], v[40:43], v[144:147]
    s_waitcnt lgkmcnt(4)
    v_mfma_f32_16x16x32_bf16 v[148:151], v[48:51], v[28:31], v[148:151]
    ds_read_b64_tr_b16 v[48:49], v10 offset:51200
    v_mul_f32 v245, v95, v95
    v_mfma_f32_16x16x32_bf16 v[148:151], v[52:55], v[44:47], v[148:151]
    ds_read_b64_tr_b16 v[50:51], v11 offset:51200
    s_waitcnt lgkmcnt(4)
    v_mfma_f32_16x16x32_bf16 v[156:159], v[56:59], v[28:31], v[156:159]
    ds_read_b64_tr_b16 v[52:53], v10 offset:59392
    s_waitcnt lgkmcnt(3)
    v_mfma_f32_16x16x32_bf16 v[156:159], v[60:63], v[44:47], v[156:159]
    ds_read_b64_tr_b16 v[54:55], v11 offset:59392
    v_fma_f32 v244, v244, v222, v221
    v_mfma_f32_16x16x32_bf16 v[152:155], v[56:59], v[24:27], v[152:155]
    v_fma_f32 v245, v245, v222, v221
    v_mfma_f32_16x16x32_bf16 v[152:155], v[60:63], v[40:43], v[152:155]
    v_mul_f32 v244, v244, v94
    v_mfma_f32_16x16x32_bf16 v[140:143], v[56:59], v[20:23], v[140:143]
    v_mul_f32 v245, v245, v95
    v_mfma_f32_16x16x32_bf16 v[140:143], v[60:63], v[36:39], v[140:143]
    v_exp_f32 v244, v244
    v_mfma_f32_16x16x32_bf16 v[136:139], v[56:59], v[16:19], v[136:139]
    ds_read_b64_tr_b16 v[56:57], v10 offset:52224
    v_mfma_f32_16x16x32_bf16 v[136:139], v[60:63], v[32:35], v[136:139]
    ds_read_b64_tr_b16 v[58:59], v11 offset:52224
    s_waitcnt lgkmcnt(2)
    v_mfma_f32_16x16x32_bf16 v[160:163], v[48:51], v[16:19], v[160:163]
    ds_read_b64_tr_b16 v[60:61], v10 offset:60416
    v_mfma_f32_16x16x32_bf16 v[160:163], v[52:55], v[32:35], v[160:163]
    ds_read_b64_tr_b16 v[62:63], v11 offset:60416
    v_mfma_f32_16x16x32_bf16 v[164:167], v[48:51], v[20:23], v[164:167]
    v_exp_f32 v245, v245
    v_mfma_f32_16x16x32_bf16 v[164:167], v[52:55], v[36:39], v[164:167]
    v_fma_f32 v244, v244, v223, v223
    v_fma_f32 v245, v245, v223, v223
    v_mfma_f32_16x16x32_bf16 v[176:179], v[48:51], v[24:27], v[176:179]
    v_rcp_f32 v244, v244
    v_mfma_f32_16x16x32_bf16 v[176:179], v[52:55], v[40:43], v[176:179]
    v_rcp_f32 v245, v245
    v_mfma_f32_16x16x32_bf16 v[180:183], v[48:51], v[28:31], v[180:183]
    v_mul_f32 v94, v244, v94
    v_mfma_f32_16x16x32_bf16 v[180:183], v[52:55], v[44:47], v[180:183]
    s_waitcnt lgkmcnt(0)
    s_barrier
    ds_read_b64_tr_b16 v[48:49], v10 offset:0
    ds_read_b64_tr_b16 v[50:51], v11 offset:0
    v_mfma_f32_16x16x32_bf16 v[168:171], v[56:59], v[16:19], v[168:171]
    ds_read_b64_tr_b16 v[52:53], v10 offset:8192
    ds_read_b64_tr_b16 v[54:55], v11 offset:8192
    v_mfma_f32_16x16x32_bf16 v[168:171], v[60:63], v[32:35], v[168:171]
    ds_read_b128 v[16:19], v8 offset:0
    v_mul_f32 v95, v245, v95
    v_mfma_f32_16x16x32_bf16 v[172:175], v[56:59], v[20:23], v[172:175]
    ds_read_b128 v[32:35], v9 offset:0
    v_mfma_f32_16x16x32_bf16 v[172:175], v[60:63], v[36:39], v[172:175]
    ds_read_b128 v[20:23], v8 offset:2048
    v_mfma_f32_16x16x32_bf16 v[184:187], v[56:59], v[24:27], v[184:187]
    ds_read_b128 v[36:39], v9 offset:2048
    v_mfma_f32_16x16x32_bf16 v[184:187], v[60:63], v[40:43], v[184:187]
    ds_read_b128 v[24:27], v8 offset:4096
    v_mfma_f32_16x16x32_bf16 v[188:191], v[56:59], v[28:31], v[188:191]
    ds_read_b128 v[40:43], v9 offset:4096
    v_mfma_f32_16x16x32_bf16 v[188:191], v[60:63], v[44:47], v[188:191]
    ds_read_b128 v[28:31], v8 offset:6144
    s_waitcnt lgkmcnt(5)
    v_mfma_f32_16x16x32_bf16 v[128:131], v[48:51], v[16:19], v[128:131]
    ds_read_b128 v[44:47], v9 offset:6144
    v_fmac_f32 v88, v196, v216
    v_mfma_f32_16x16x32_bf16 v[128:131], v[52:55], v[32:35], v[128:131]
    ds_read_b64_tr_b16 v[56:57], v10 offset:1024
    s_waitcnt lgkmcnt(5)
    v_mfma_f32_16x16x32_bf16 v[132:135], v[48:51], v[20:23], v[132:135]
    ds_read_b64_tr_b16 v[58:59], v11 offset:1024
    v_fmac_f32 v89, v197, v216
    v_mfma_f32_16x16x32_bf16 v[132:135], v[52:55], v[36:39], v[132:135]
    ds_read_b64_tr_b16 v[60:61], v10 offset:9216
    s_waitcnt lgkmcnt(5)
    v_mfma_f32_16x16x32_bf16 v[144:147], v[48:51], v[24:27], v[144:147]
    ds_read_b64_tr_b16 v[62:63], v11 offset:9216
    v_mul_f32 v244, v88, v88
    v_mfma_f32_16x16x32_bf16 v[144:147], v[52:55], v[40:43], v[144:147]
    s_waitcnt lgkmcnt(4)
    v_mfma_f32_16x16x32_bf16 v[148:151], v[48:51], v[28:31], v[148:151]
    ds_read_b64_tr_b16 v[48:49], v10 offset:2048
    v_mul_f32 v245, v89, v89
    v_mfma_f32_16x16x32_bf16 v[148:151], v[52:55], v[44:47], v[148:151]
    ds_read_b64_tr_b16 v[50:51], v11 offset:2048
    s_waitcnt lgkmcnt(4)
    v_mfma_f32_16x16x32_bf16 v[156:159], v[56:59], v[28:31], v[156:159]
    ds_read_b64_tr_b16 v[52:53], v10 offset:10240
    s_waitcnt lgkmcnt(3)
    v_mfma_f32_16x16x32_bf16 v[156:159], v[60:63], v[44:47], v[156:159]
    ds_read_b64_tr_b16 v[54:55], v11 offset:10240
    v_fma_f32 v244, v244, v218, v217
    v_mfma_f32_16x16x32_bf16 v[152:155], v[56:59], v[24:27], v[152:155]
    v_fma_f32 v245, v245, v218, v217
    v_mfma_f32_16x16x32_bf16 v[152:155], v[60:63], v[40:43], v[152:155]
    v_mul_f32 v244, v244, v88
    v_mfma_f32_16x16x32_bf16 v[140:143], v[56:59], v[20:23], v[140:143]
    v_mul_f32 v245, v245, v89
    v_mfma_f32_16x16x32_bf16 v[140:143], v[60:63], v[36:39], v[140:143]
    v_exp_f32 v244, v244
    v_mfma_f32_16x16x32_bf16 v[136:139], v[56:59], v[16:19], v[136:139]
    ds_read_b64_tr_b16 v[56:57], v10 offset:3072
    v_mfma_f32_16x16x32_bf16 v[136:139], v[60:63], v[32:35], v[136:139]
    ds_read_b64_tr_b16 v[58:59], v11 offset:3072
    s_waitcnt lgkmcnt(2)
    v_mfma_f32_16x16x32_bf16 v[160:163], v[48:51], v[16:19], v[160:163]
    ds_read_b64_tr_b16 v[60:61], v10 offset:11264
    v_mfma_f32_16x16x32_bf16 v[160:163], v[52:55], v[32:35], v[160:163]
    ds_read_b64_tr_b16 v[62:63], v11 offset:11264
    v_mfma_f32_16x16x32_bf16 v[164:167], v[48:51], v[20:23], v[164:167]
    v_exp_f32 v245, v245
    v_mfma_f32_16x16x32_bf16 v[164:167], v[52:55], v[36:39], v[164:167]
    v_fma_f32 v244, v244, v219, v219
    v_fma_f32 v245, v245, v219, v219
    v_mfma_f32_16x16x32_bf16 v[176:179], v[48:51], v[24:27], v[176:179]
    v_rcp_f32 v244, v244
    v_mfma_f32_16x16x32_bf16 v[176:179], v[52:55], v[40:43], v[176:179]
    v_rcp_f32 v245, v245
    v_mfma_f32_16x16x32_bf16 v[180:183], v[48:51], v[28:31], v[180:183]
    v_mul_f32 v88, v244, v88
    v_mfma_f32_16x16x32_bf16 v[180:183], v[52:55], v[44:47], v[180:183]
    s_waitcnt lgkmcnt(0)
    s_barrier
    ds_read_b64_tr_b16 v[48:49], v10 offset:16384
    ds_read_b64_tr_b16 v[50:51], v11 offset:16384
    v_mfma_f32_16x16x32_bf16 v[168:171], v[56:59], v[16:19], v[168:171]
    ds_read_b64_tr_b16 v[52:53], v10 offset:24576
    ds_read_b64_tr_b16 v[54:55], v11 offset:24576
    v_mfma_f32_16x16x32_bf16 v[168:171], v[60:63], v[32:35], v[168:171]
    ds_read_b128 v[16:19], v8 offset:16384
    v_mul_f32 v89, v245, v89
    v_mfma_f32_16x16x32_bf16 v[172:175], v[56:59], v[20:23], v[172:175]
    ds_read_b128 v[32:35], v9 offset:16384
    v_mfma_f32_16x16x32_bf16 v[172:175], v[60:63], v[36:39], v[172:175]
    ds_read_b128 v[20:23], v8 offset:18432
    v_mfma_f32_16x16x32_bf16 v[184:187], v[56:59], v[24:27], v[184:187]
    ds_read_b128 v[36:39], v9 offset:18432
    v_mfma_f32_16x16x32_bf16 v[184:187], v[60:63], v[40:43], v[184:187]
    ds_read_b128 v[24:27], v8 offset:20480
    v_mfma_f32_16x16x32_bf16 v[188:191], v[56:59], v[28:31], v[188:191]
    ds_read_b128 v[40:43], v9 offset:20480
    v_mfma_f32_16x16x32_bf16 v[188:191], v[60:63], v[44:47], v[188:191]
    ds_read_b128 v[28:31], v8 offset:22528
    s_waitcnt lgkmcnt(5)
    v_mfma_f32_16x16x32_bf16 v[128:131], v[48:51], v[16:19], v[128:131]
    ds_read_b128 v[44:47], v9 offset:22528
    v_fmac_f32 v90, v198, v216
    v_mfma_f32_16x16x32_bf16 v[128:131], v[52:55], v[32:35], v[128:131]
    ds_read_b64_tr_b16 v[56:57], v10 offset:17408
    s_waitcnt lgkmcnt(5)
    v_mfma_f32_16x16x32_bf16 v[132:135], v[48:51], v[20:23], v[132:135]
    ds_read_b64_tr_b16 v[58:59], v11 offset:17408
    v_fmac_f32 v91, v199, v216
    v_mfma_f32_16x16x32_bf16 v[132:135], v[52:55], v[36:39], v[132:135]
    ds_read_b64_tr_b16 v[60:61], v10 offset:25600
    s_waitcnt lgkmcnt(5)
    v_mfma_f32_16x16x32_bf16 v[144:147], v[48:51], v[24:27], v[144:147]
    ds_read_b64_tr_b16 v[62:63], v11 offset:25600
    v_mul_f32 v244, v90, v90
    v_mfma_f32_16x16x32_bf16 v[144:147], v[52:55], v[40:43], v[144:147]
    s_waitcnt lgkmcnt(4)
    v_mfma_f32_16x16x32_bf16 v[148:151], v[48:51], v[28:31], v[148:151]
    ds_read_b64_tr_b16 v[48:49], v10 offset:18432
    v_mul_f32 v245, v91, v91
    v_mfma_f32_16x16x32_bf16 v[148:151], v[52:55], v[44:47], v[148:151]
    ds_read_b64_tr_b16 v[50:51], v11 offset:18432
    s_waitcnt lgkmcnt(4)
    v_mfma_f32_16x16x32_bf16 v[156:159], v[56:59], v[28:31], v[156:159]
    ds_read_b64_tr_b16 v[52:53], v10 offset:26624
    s_waitcnt lgkmcnt(3)
    v_mfma_f32_16x16x32_bf16 v[156:159], v[60:63], v[44:47], v[156:159]
    ds_read_b64_tr_b16 v[54:55], v11 offset:26624
    v_fma_f32 v244, v244, v218, v217
    v_mfma_f32_16x16x32_bf16 v[152:155], v[56:59], v[24:27], v[152:155]
    v_fma_f32 v245, v245, v218, v217
    v_mfma_f32_16x16x32_bf16 v[152:155], v[60:63], v[40:43], v[152:155]
    v_mul_f32 v244, v244, v90
    v_mfma_f32_16x16x32_bf16 v[140:143], v[56:59], v[20:23], v[140:143]
    v_mul_f32 v245, v245, v91
    v_mfma_f32_16x16x32_bf16 v[140:143], v[60:63], v[36:39], v[140:143]
    v_exp_f32 v244, v244
    v_mfma_f32_16x16x32_bf16 v[136:139], v[56:59], v[16:19], v[136:139]
    ds_read_b64_tr_b16 v[56:57], v10 offset:19456
    v_mfma_f32_16x16x32_bf16 v[136:139], v[60:63], v[32:35], v[136:139]
    ds_read_b64_tr_b16 v[58:59], v11 offset:19456
    s_waitcnt lgkmcnt(2)
    v_mfma_f32_16x16x32_bf16 v[160:163], v[48:51], v[16:19], v[160:163]
    ds_read_b64_tr_b16 v[60:61], v10 offset:27648
    v_mfma_f32_16x16x32_bf16 v[160:163], v[52:55], v[32:35], v[160:163]
    ds_read_b64_tr_b16 v[62:63], v11 offset:27648
    v_mfma_f32_16x16x32_bf16 v[164:167], v[48:51], v[20:23], v[164:167]
    v_exp_f32 v245, v245
    v_mfma_f32_16x16x32_bf16 v[164:167], v[52:55], v[36:39], v[164:167]
    v_fma_f32 v244, v244, v219, v219
    v_fma_f32 v245, v245, v219, v219
    v_mfma_f32_16x16x32_bf16 v[176:179], v[48:51], v[24:27], v[176:179]
    v_rcp_f32 v244, v244
    v_mfma_f32_16x16x32_bf16 v[176:179], v[52:55], v[40:43], v[176:179]
    v_rcp_f32 v245, v245
    v_mfma_f32_16x16x32_bf16 v[180:183], v[48:51], v[28:31], v[180:183]
    v_mul_f32 v90, v244, v90
    v_mfma_f32_16x16x32_bf16 v[180:183], v[52:55], v[44:47], v[180:183]
    s_waitcnt lgkmcnt(0)
    s_barrier
    ds_read_b64_tr_b16 v[48:49], v10 offset:32768
    ds_read_b64_tr_b16 v[50:51], v11 offset:32768
    v_mfma_f32_16x16x32_bf16 v[168:171], v[56:59], v[16:19], v[168:171]
    ds_read_b64_tr_b16 v[52:53], v10 offset:40960
    ds_read_b64_tr_b16 v[54:55], v11 offset:40960
    v_mfma_f32_16x16x32_bf16 v[168:171], v[60:63], v[32:35], v[168:171]
    ds_read_b128 v[16:19], v8 offset:32768
    v_mul_f32 v91, v245, v91
    v_mfma_f32_16x16x32_bf16 v[172:175], v[56:59], v[20:23], v[172:175]
    ds_read_b128 v[32:35], v9 offset:32768
    v_mfma_f32_16x16x32_bf16 v[172:175], v[60:63], v[36:39], v[172:175]
    ds_read_b128 v[20:23], v8 offset:34816
    v_mfma_f32_16x16x32_bf16 v[184:187], v[56:59], v[24:27], v[184:187]
    ds_read_b128 v[36:39], v9 offset:34816
    v_mfma_f32_16x16x32_bf16 v[184:187], v[60:63], v[40:43], v[184:187]
    ds_read_b128 v[24:27], v8 offset:36864
    v_mfma_f32_16x16x32_bf16 v[188:191], v[56:59], v[28:31], v[188:191]
    ds_read_b128 v[40:43], v9 offset:36864
    v_mfma_f32_16x16x32_bf16 v[188:191], v[60:63], v[44:47], v[188:191]
    ds_read_b128 v[28:31], v8 offset:38912
    s_waitcnt lgkmcnt(5)
    v_mfma_f32_16x16x32_bf16 v[128:131], v[48:51], v[16:19], v[128:131]
    ds_read_b128 v[44:47], v9 offset:38912
    v_fmac_f32 v76, v196, v212
    v_mfma_f32_16x16x32_bf16 v[128:131], v[52:55], v[32:35], v[128:131]
    ds_read_b64_tr_b16 v[56:57], v10 offset:33792
    s_waitcnt lgkmcnt(5)
    v_mfma_f32_16x16x32_bf16 v[132:135], v[48:51], v[20:23], v[132:135]
    ds_read_b64_tr_b16 v[58:59], v11 offset:33792
    v_fmac_f32 v77, v197, v212
    v_mfma_f32_16x16x32_bf16 v[132:135], v[52:55], v[36:39], v[132:135]
    ds_read_b64_tr_b16 v[60:61], v10 offset:41984
    s_waitcnt lgkmcnt(5)
    v_mfma_f32_16x16x32_bf16 v[144:147], v[48:51], v[24:27], v[144:147]
    ds_read_b64_tr_b16 v[62:63], v11 offset:41984
    v_mul_f32 v244, v76, v76
    v_mfma_f32_16x16x32_bf16 v[144:147], v[52:55], v[40:43], v[144:147]
    s_waitcnt lgkmcnt(4)
    v_mfma_f32_16x16x32_bf16 v[148:151], v[48:51], v[28:31], v[148:151]
    ds_read_b64_tr_b16 v[48:49], v10 offset:34816
    v_mul_f32 v245, v77, v77
    v_mfma_f32_16x16x32_bf16 v[148:151], v[52:55], v[44:47], v[148:151]
    ds_read_b64_tr_b16 v[50:51], v11 offset:34816
    s_waitcnt lgkmcnt(4)
    v_mfma_f32_16x16x32_bf16 v[156:159], v[56:59], v[28:31], v[156:159]
    ds_read_b64_tr_b16 v[52:53], v10 offset:43008
    s_waitcnt lgkmcnt(3)
    v_mfma_f32_16x16x32_bf16 v[156:159], v[60:63], v[44:47], v[156:159]
    ds_read_b64_tr_b16 v[54:55], v11 offset:43008
    v_fma_f32 v244, v244, v214, v213
    v_mfma_f32_16x16x32_bf16 v[152:155], v[56:59], v[24:27], v[152:155]
    v_fma_f32 v245, v245, v214, v213
    v_mfma_f32_16x16x32_bf16 v[152:155], v[60:63], v[40:43], v[152:155]
    v_mul_f32 v244, v244, v76
    v_mfma_f32_16x16x32_bf16 v[140:143], v[56:59], v[20:23], v[140:143]
    v_mul_f32 v245, v245, v77
    v_mfma_f32_16x16x32_bf16 v[140:143], v[60:63], v[36:39], v[140:143]
    v_exp_f32 v244, v244
    v_mfma_f32_16x16x32_bf16 v[136:139], v[56:59], v[16:19], v[136:139]
    ds_read_b64_tr_b16 v[56:57], v10 offset:35840
    v_mfma_f32_16x16x32_bf16 v[136:139], v[60:63], v[32:35], v[136:139]
    ds_read_b64_tr_b16 v[58:59], v11 offset:35840
    s_waitcnt lgkmcnt(2)
    v_mfma_f32_16x16x32_bf16 v[160:163], v[48:51], v[16:19], v[160:163]
    ds_read_b64_tr_b16 v[60:61], v10 offset:44032
    v_mfma_f32_16x16x32_bf16 v[160:163], v[52:55], v[32:35], v[160:163]
    ds_read_b64_tr_b16 v[62:63], v11 offset:44032
    v_mfma_f32_16x16x32_bf16 v[164:167], v[48:51], v[20:23], v[164:167]
    v_exp_f32 v245, v245
    v_mfma_f32_16x16x32_bf16 v[164:167], v[52:55], v[36:39], v[164:167]
    v_fma_f32 v244, v244, v215, v215
    v_fma_f32 v245, v245, v215, v215
    v_mfma_f32_16x16x32_bf16 v[176:179], v[48:51], v[24:27], v[176:179]
    v_rcp_f32 v244, v244
    v_mfma_f32_16x16x32_bf16 v[176:179], v[52:55], v[40:43], v[176:179]
    v_rcp_f32 v245, v245
    v_mfma_f32_16x16x32_bf16 v[180:183], v[48:51], v[28:31], v[180:183]
    v_mul_f32 v76, v244, v76
    v_mfma_f32_16x16x32_bf16 v[180:183], v[52:55], v[44:47], v[180:183]
    s_waitcnt lgkmcnt(0)
    s_barrier
    ds_read_b64_tr_b16 v[48:49], v10 offset:49152
    ds_read_b64_tr_b16 v[50:51], v11 offset:49152
    v_mfma_f32_16x16x32_bf16 v[168:171], v[56:59], v[16:19], v[168:171]
    ds_read_b64_tr_b16 v[52:53], v10 offset:57344
    ds_read_b64_tr_b16 v[54:55], v11 offset:57344
    v_mfma_f32_16x16x32_bf16 v[168:171], v[60:63], v[32:35], v[168:171]
    ds_read_b128 v[16:19], v8 offset:49152
    v_mul_f32 v77, v245, v77
    v_mfma_f32_16x16x32_bf16 v[172:175], v[56:59], v[20:23], v[172:175]
    ds_read_b128 v[32:35], v9 offset:49152
    v_mfma_f32_16x16x32_bf16 v[172:175], v[60:63], v[36:39], v[172:175]
    ds_read_b128 v[20:23], v8 offset:51200
    v_mfma_f32_16x16x32_bf16 v[184:187], v[56:59], v[24:27], v[184:187]
    ds_read_b128 v[36:39], v9 offset:51200
    v_mfma_f32_16x16x32_bf16 v[184:187], v[60:63], v[40:43], v[184:187]
    ds_read_b128 v[24:27], v8 offset:53248
    v_mfma_f32_16x16x32_bf16 v[188:191], v[56:59], v[28:31], v[188:191]
    ds_read_b128 v[40:43], v9 offset:53248
    v_mfma_f32_16x16x32_bf16 v[188:191], v[60:63], v[44:47], v[188:191]
    ds_read_b128 v[28:31], v8 offset:55296
    s_waitcnt lgkmcnt(5)
    v_mfma_f32_16x16x32_bf16 v[128:131], v[48:51], v[16:19], v[128:131]
    ds_read_b128 v[44:47], v9 offset:55296
    v_fmac_f32 v78, v198, v212
    v_mfma_f32_16x16x32_bf16 v[128:131], v[52:55], v[32:35], v[128:131]
    ds_read_b64_tr_b16 v[56:57], v10 offset:50176
    s_waitcnt lgkmcnt(5)
    v_mfma_f32_16x16x32_bf16 v[132:135], v[48:51], v[20:23], v[132:135]
    ds_read_b64_tr_b16 v[58:59], v11 offset:50176
    v_fmac_f32 v79, v199, v212
    v_mfma_f32_16x16x32_bf16 v[132:135], v[52:55], v[36:39], v[132:135]
    ds_read_b64_tr_b16 v[60:61], v10 offset:58368
    s_waitcnt lgkmcnt(5)
    v_mfma_f32_16x16x32_bf16 v[144:147], v[48:51], v[24:27], v[144:147]
    ds_read_b64_tr_b16 v[62:63], v11 offset:58368
    v_mul_f32 v244, v78, v78
    v_mfma_f32_16x16x32_bf16 v[144:147], v[52:55], v[40:43], v[144:147]
    s_waitcnt lgkmcnt(4)
    v_mfma_f32_16x16x32_bf16 v[148:151], v[48:51], v[28:31], v[148:151]
    ds_read_b64_tr_b16 v[48:49], v10 offset:51200
    v_mul_f32 v245, v79, v79
    v_mfma_f32_16x16x32_bf16 v[148:151], v[52:55], v[44:47], v[148:151]
    ds_read_b64_tr_b16 v[50:51], v11 offset:51200
    s_waitcnt lgkmcnt(4)
    v_mfma_f32_16x16x32_bf16 v[156:159], v[56:59], v[28:31], v[156:159]
    ds_read_b64_tr_b16 v[52:53], v10 offset:59392
    s_waitcnt lgkmcnt(3)
    v_mfma_f32_16x16x32_bf16 v[156:159], v[60:63], v[44:47], v[156:159]
    ds_read_b64_tr_b16 v[54:55], v11 offset:59392
    v_fma_f32 v244, v244, v214, v213
    v_mfma_f32_16x16x32_bf16 v[152:155], v[56:59], v[24:27], v[152:155]
    v_fma_f32 v245, v245, v214, v213
    v_mfma_f32_16x16x32_bf16 v[152:155], v[60:63], v[40:43], v[152:155]
    v_mul_f32 v244, v244, v78
    v_mfma_f32_16x16x32_bf16 v[140:143], v[56:59], v[20:23], v[140:143]
    v_mul_f32 v245, v245, v79
    v_mfma_f32_16x16x32_bf16 v[140:143], v[60:63], v[36:39], v[140:143]
    v_exp_f32 v244, v244
    v_mfma_f32_16x16x32_bf16 v[136:139], v[56:59], v[16:19], v[136:139]
    ds_read_b64_tr_b16 v[56:57], v10 offset:52224
    v_mfma_f32_16x16x32_bf16 v[136:139], v[60:63], v[32:35], v[136:139]
    ds_read_b64_tr_b16 v[58:59], v11 offset:52224
    s_waitcnt lgkmcnt(2)
    v_mfma_f32_16x16x32_bf16 v[160:163], v[48:51], v[16:19], v[160:163]
L_pad16:
    s_cbranch_execz L_padr16
    ds_read_b64_tr_b16 v[60:61], v10 offset:60416
    v_mfma_f32_16x16x32_bf16 v[160:163], v[52:55], v[32:35], v[160:163]
    ds_read_b64_tr_b16 v[62:63], v11 offset:60416
    v_mfma_f32_16x16x32_bf16 v[164:167], v[48:51], v[20:23], v[164:167]
    v_exp_f32 v245, v245
    v_mfma_f32_16x16x32_bf16 v[164:167], v[52:55], v[36:39], v[164:167]
    v_fma_f32 v244, v244, v215, v215
    v_fma_f32 v245, v245, v215, v215
    v_mfma_f32_16x16x32_bf16 v[176:179], v[48:51], v[24:27], v[176:179]
    v_rcp_f32 v244, v244
    v_mfma_f32_16x16x32_bf16 v[176:179], v[52:55], v[40:43], v[176:179]
    v_rcp_f32 v245, v245
    v_mfma_f32_16x16x32_bf16 v[180:183], v[48:51], v[28:31], v[180:183]
    v_mul_f32 v78, v244, v78
    v_mfma_f32_16x16x32_bf16 v[180:183], v[52:55], v[44:47], v[180:183]
    s_waitcnt lgkmcnt(0)
    s_barrier
    ds_read_b64_tr_b16 v[48:49], v10 offset:0
    ds_read_b64_tr_b16 v[50:51], v11 offset:0
    v_mfma_f32_16x16x32_bf16 v[168:171], v[56:59], v[16:19], v[168:171]
    ds_read_b64_tr_b16 v[52:53], v10 offset:8192
    ds_read_b64_tr_b16 v[54:55], v11 offset:8192
    v_mfma_f32_16x16x32_bf16 v[168:171], v[60:63], v[32:35], v[168:171]
    ds_read_b128 v[16:19], v8 offset:0
    v_mul_f32 v79, v245, v79
    v_mfma_f32_16x16x32_bf16 v[172:175], v[56:59], v[20:23], v[172:175]
    ds_read_b128 v[32:35], v9 offset:0
    v_mfma_f32_16x16x32_bf16 v[172:175], v[60:63], v[36:39], v[172:175]
    ds_read_b128 v[20:23], v8 offset:2048
    v_mfma_f32_16x16x32_bf16 v[184:187], v[56:59], v[24:27], v[184:187]
    ds_read_b128 v[36:39], v9 offset:2048
    v_mfma_f32_16x16x32_bf16 v[184:187], v[60:63], v[40:43], v[184:187]
    ds_read_b128 v[24:27], v8 offset:4096
    v_mfma_f32_16x16x32_bf16 v[188:191], v[56:59], v[28:31], v[188:191]
    ds_read_b128 v[40:43], v9 offset:4096
    v_mfma_f32_16x16x32_bf16 v[188:191], v[60:63], v[44:47], v[188:191]
    ds_read_b128 v[28:31], v8 offset:6144
    s_waitcnt lgkmcnt(5)
    v_mfma_f32_16x16x32_bf16 v[128:131], v[48:51], v[16:19], v[128:131]
    ds_read_b128 v[44:47], v9 offset:6144
    v_fmac_f32 v72, v196, v208
    v_mfma_f32_16x16x32_bf16 v[128:131], v[52:55], v[32:35], v[128:131]
    ds_read_b64_tr_b16 v[56:57], v10 offset:1024
    s_waitcnt lgkmcnt(5)
    v_mfma_f32_16x16x32_bf16 v[132:135], v[48:51], v[20:23], v[132:135]
    ds_read_b64_tr_b16 v[58:59], v11 offset:1024
    v_fmac_f32 v73, v197, v208
    v_mfma_f32_16x16x32_bf16 v[132:135], v[52:55], v[36:39], v[132:135]
    ds_read_b64_tr_b16 v[60:61], v10 offset:9216
    s_waitcnt lgkmcnt(5)
    v_mfma_f32_16x16x32_bf16 v[144:147], v[48:51], v[24:27], v[144:147]
    ds_read_b64_tr_b16 v[62:63], v11 offset:9216
    v_mul_f32 v244, v72, v72
    v_mfma_f32_16x16x32_bf16 v[144:147], v[52:55], v[40:43], v[144:147]
    s_waitcnt lgkmcnt(4)
    v_mfma_f32_16x16x32_bf16 v[148:151], v[48:51], v[28:31], v[148:151]
    ds_read_b64_tr_b16 v[48:49], v10 offset:2048
    v_mul_f32 v245, v73, v73
    v_mfma_f32_16x16x32_bf16 v[148:151], v[52:55], v[44:47], v[148:151]
    ds_read_b64_tr_b16 v[50:51], v11 offset:2048
    s_waitcnt lgkmcnt(4)
    v_mfma_f32_16x16x32_bf16 v[156:159], v[56:59], v[28:31], v[156:159]
    ds_read_b64_tr_b16 v[52:53], v10 offset:10240
    s_waitcnt lgkmcnt(3)
    v_mfma_f32_16x16x32_bf16 v[156:159], v[60:63], v[44:47], v[156:159]
    ds_read_b64_tr_b16 v[54:55], v11 offset:10240
    v_fma_f32 v244, v244, v210, v209
    v_mfma_f32_16x16x32_bf16 v[152:155], v[56:59], v[24:27], v[152:155]
    v_fma_f32 v245, v245, v210, v209
    v_mfma_f32_16x16x32_bf16 v[152:155], v[60:63], v[40:43], v[152:155]
    v_mul_f32 v244, v244, v72
    v_mfma_f32_16x16x32_bf16 v[140:143], v[56:59], v[20:23], v[140:143]
    v_mul_f32 v245, v245, v73
    v_mfma_f32_16x16x32_bf16 v[140:143], v[60:63], v[36:39], v[140:143]
    v_exp_f32 v244, v244
    v_mfma_f32_16x16x32_bf16 v[136:139], v[56:59], v[16:19], v[136:139]
    ds_read_b64_tr_b16 v[56:57], v10 offset:3072
    v_mfma_f32_16x16x32_bf16 v[136:139], v[60:63], v[32:35], v[136:139]
    ds_read_b64_tr_b16 v[58:59], v11 offset:3072
    s_waitcnt lgkmcnt(2)
    v_mfma_f32_16x16x32_bf16 v[160:163], v[48:51], v[16:19], v[160:163]
    ds_read_b64_tr_b16 v[60:61], v10 offset:11264
    v_mfma_f32_16x16x32_bf16 v[160:163], v[52:55], v[32:35], v[160:163]
    ds_read_b64_tr_b16 v[62:63], v11 offset:11264
    v_mfma_f32_16x16x32_bf16 v[164:167], v[48:51], v[20:23], v[164:167]
    v_exp_f32 v245, v245
    v_mfma_f32_16x16x32_bf16 v[164:167], v[52:55], v[36:39], v[164:167]
    v_fma_f32 v244, v244, v211, v211
    v_fma_f32 v245, v245, v211, v211
    v_mfma_f32_16x16x32_bf16 v[176:179], v[48:51], v[24:27], v[176:179]
    v_rcp_f32 v244, v244
    v_mfma_f32_16x16x32_bf16 v[176:179], v[52:55], v[40:43], v[176:179]
    v_rcp_f32 v245, v245
    v_mfma_f32_16x16x32_bf16 v[180:183], v[48:51], v[28:31], v[180:183]
    v_mul_f32 v72, v244, v72
    v_mfma_f32_16x16x32_bf16 v[180:183], v[52:55], v[44:47], v[180:183]
    s_waitcnt lgkmcnt(0)
    s_barrier
    ds_read_b64_tr_b16 v[48:49], v10 offset:16384
    ds_read_b64_tr_b16 v[50:51], v11 offset:16384
    v_mfma_f32_16x16x32_bf16 v[168:171], v[56:59], v[16:19], v[168:171]
    ds_read_b64_tr_b16 v[52:53], v10 offset:24576
    ds_read_b64_tr_b16 v[54:55], v11 offset:24576
    v_mfma_f32_16x16x32_bf16 v[168:171], v[60:63], v[32:35], v[168:171]
    ds_read_b128 v[16:19], v8 offset:16384
    v_mul_f32 v73, v245, v73
    v_mfma_f32_16x16x32_bf16 v[172:175], v[56:59], v[20:23], v[172:175]
    ds_read_b128 v[32:35], v9 offset:16384
    v_mfma_f32_16x16x32_bf16 v[172:175], v[60:63], v[36:39], v[172:175]
    ds_read_b128 v[20:23], v8 offset:18432
    v_mfma_f32_16x16x32_bf16 v[184:187], v[56:59], v[24:27], v[184:187]
    ds_read_b128 v[36:39], v9 offset:18432
    v_mfma_f32_16x16x32_bf16 v[184:187], v[60:63], v[40:43], v[184:187]
    ds_read_b128 v[24:27], v8 offset:20480
    v_mfma_f32_16x16x32_bf16 v[188:191], v[56:59], v[28:31], v[188:191]
    ds_read_b128 v[40:43], v9 offset:20480
    v_mfma_f32_16x16x32_bf16 v[188:191], v[60:63], v[44:47], v[188:191]
    ds_read_b128 v[28:31], v8 offset:22528
    s_waitcnt lgkmcnt(5)
    v_mfma_f32_16x16x32_bf16 v[128:131], v[48:51], v[16:19], v[128:131]
    ds_read_b128 v[44:47], v9 offset:22528
    v_fmac_f32 v74, v198, v208
    v_mfma_f32_16x16x32_bf16 v[128:131], v[52:55], v[32:35], v[128:131]
    ds_read_b64_tr_b16 v[56:57], v10 offset:17408
    s_waitcnt lgkmcnt(5)
    v_mfma_f32_16x16x32_bf16 v[132:135], v[48:51], v[20:23], v[132:135]
    ds_read_b64_tr_b16 v[58:59], v11 offset:17408
    v_fmac_f32 v75, v199, v208
    v_mfma_f32_16x16x32_bf16 v[132:135], v[52:55], v[36:39], v[132:135]
    ds_read_b64_tr_b16 v[60:61], v10 offset:25600
    s_waitcnt lgkmcnt(5)
    v_mfma_f32_16x16x32_bf16 v[144:147], v[48:51], v[24:27], v[144:147]
    ds_read_b64_tr_b16 v[62:63], v11 offset:25600
    v_mul_f32 v244, v74, v74
    v_mfma_f32_16x16x32_bf16 v[144:147], v[52:55], v[40:43], v[144:147]
    s_waitcnt lgkmcnt(4)
    v_mfma_f32_16x16x32_bf16 v[148:151], v[48:51], v[28:31], v[148:151]
    ds_read_b64_tr_b16 v[48:49], v10 offset:18432
    v_mul_f32 v245, v75, v75
    v_mfma_f32_16x16x32_bf16 v[148:151], v[52:55], v[44:47], v[148:151]
    ds_read_b64_tr_b16 v[50:51], v11 offset:18432
    s_waitcnt lgkmcnt(4)
    v_mfma_f32_16x16x32_bf16 v[156:159], v[56:59], v[28:31], v[156:159]
    ds_read_b64_tr_b16 v[52:53], v10 offset:26624
    s_waitcnt lgkmcnt(3)
    v_mfma_f32_16x16x32_bf16 v[156:159], v[60:63], v[44:47], v[156:159]
    ds_read_b64_tr_b16 v[54:55], v11 offset:26624
    v_fma_f32 v244, v244, v210, v209
    v_mfma_f32_16x16x32_bf16 v[152:155], v[56:59], v[24:27], v[152:155]
    v_fma_f32 v245, v245, v210, v209
    v_mfma_f32_16x16x32_bf16 v[152:155], v[60:63], v[40:43], v[152:155]
    v_mul_f32 v244, v244, v74
    v_mfma_f32_16x16x32_bf16 v[140:143], v[56:59], v[20:23], v[140:143]
    v_mul_f32 v245, v245, v75
    v_mfma_f32_16x16x32_bf16 v[140:143], v[60:63], v[36:39], v[140:143]
    v_exp_f32 v244, v244
    v_mfma_f32_16x16x32_bf16 v[136:139], v[56:59], v[16:19], v[136:139]
    ds_read_b64_tr_b16 v[56:57], v10 offset:19456
    v_mfma_f32_16x16x32_bf16 v[136:139], v[60:63], v[32:35], v[136:139]
    ds_read_b64_tr_b16 v[58:59], v11 offset:19456
    s_waitcnt lgkmcnt(2)
    v_mfma_f32_16x16x32_bf16 v[160:163], v[48:51], v[16:19], v[160:163]
    ds_read_b64_tr_b16 v[60:61], v10 offset:27648
    v_mfma_f32_16x16x32_bf16 v[160:163], v[52:55], v[32:35], v[160:163]
    ds_read_b64_tr_b16 v[62:63], v11 offset:27648
    v_mfma_f32_16x16x32_bf16 v[164:167], v[48:51], v[20:23], v[164:167]
    v_exp_f32 v245, v245
    v_mfma_f32_16x16x32_bf16 v[164:167], v[52:55], v[36:39], v[164:167]
    v_fma_f32 v244, v244, v211, v211
    v_fma_f32 v245, v245, v211, v211
    v_mfma_f32_16x16x32_bf16 v[176:179], v[48:51], v[24:27], v[176:179]
    v_rcp_f32 v244, v244
    v_mfma_f32_16x16x32_bf16 v[176:179], v[52:55], v[40:43], v[176:179]
    v_rcp_f32 v245, v245
    v_mfma_f32_16x16x32_bf16 v[180:183], v[48:51], v[28:31], v[180:183]
    v_mul_f32 v74, v244, v74
    v_mfma_f32_16x16x32_bf16 v[180:183], v[52:55], v[44:47], v[180:183]
    s_waitcnt lgkmcnt(0)
    s_barrier
    ds_read_b64_tr_b16 v[48:49], v10 offset:32768
    ds_read_b64_tr_b16 v[50:51], v11 offset:32768
    v_mfma_f32_16x16x32_bf16 v[168:171], v[56:59], v[16:19], v[168:171]
    ds_read_b64_tr_b16 v[52:53], v10 offset:40960
    ds_read_b64_tr_b16 v[54:55], v11 offset:40960
    v_mfma_f32_16x16x32_bf16 v[168:171], v[60:63], v[32:35], v[168:171]
    ds_read_b128 v[16:19], v8 offset:32768
    v_mul_f32 v75, v245, v75
    v_mfma_f32_16x16x32_bf16 v[172:175], v[56:59], v[20:23], v[172:175]
    ds_read_b128 v[32:35], v9 offset:32768
    v_mfma_f32_16x16x32_bf16 v[172:175], v[60:63], v[36:39], v[172:175]
    ds_read_b128 v[20:23], v8 offset:34816
    v_mfma_f32_16x16x32_bf16 v[184:187], v[56:59], v[24:27], v[184:187]
    ds_read_b128 v[36:39], v9 offset:34816
    v_mfma_f32_16x16x32_bf16 v[184:187], v[60:63], v[40:43], v[184:187]
    ds_read_b128 v[24:27], v8 offset:36864
    v_mfma_f32_16x16x32_bf16 v[188:191], v[56:59], v[28:31], v[188:191]
    ds_read_b128 v[40:43], v9 offset:36864
    v_mfma_f32_16x16x32_bf16 v[188:191], v[60:63], v[44:47], v[188:191]
    ds_read_b128 v[28:31], v8 offset:38912
    s_waitcnt lgkmcnt(5)
    v_mfma_f32_16x16x32_bf16 v[128:131], v[48:51], v[16:19], v[128:131]
    ds_read_b128 v[44:47], v9 offset:38912
    v_fmac_f32 v96, v200, v208
    v_mfma_f32_16x16x32_bf16 v[128:131], v[52:55], v[32:35], v[128:131]
    ds_read_b64_tr_b16 v[56:57], v10 offset:33792
    s_waitcnt lgkmcnt(5)
    v_mfma_f32_16x16x32_bf16 v[132:135], v[48:51], v[20:23], v[132:135]
    ds_read_b64_tr_b16 v[58:59], v11 offset:33792
    v_fmac_f32 v97, v201, v208
    v_mfma_f32_16x16x32_bf16 v[132:135], v[52:55], v[36:39], v[132:135]
    ds_read_b64_tr_b16 v[60:61], v10 offset:41984
    s_waitcnt lgkmcnt(5)
    v_mfma_f32_16x16x32_bf16 v[144:147], v[48:51], v[24:27], v[144:147]
    ds_read_b64_tr_b16 v[62:63], v11 offset:41984
    v_mul_f32 v244, v96, v96
    v_mfma_f32_16x16x32_bf16 v[144:147], v[52:55], v[40:43], v[144:147]
    s_waitcnt lgkmcnt(4)
    v_mfma_f32_16x16x32_bf16 v[148:151], v[48:51], v[28:31], v[148:151]
    ds_read_b64_tr_b16 v[48:49], v10 offset:34816
    v_mul_f32 v245, v97, v97
    v_mfma_f32_16x16x32_bf16 v[148:151], v[52:55], v[44:47], v[148:151]
    ds_read_b64_tr_b16 v[50:51], v11 offset:34816
    s_waitcnt lgkmcnt(4)
    v_mfma_f32_16x16x32_bf16 v[156:159], v[56:59], v[28:31], v[156:159]
    ds_read_b64_tr_b16 v[52:53], v10 offset:43008
    s_waitcnt lgkmcnt(3)
    v_mfma_f32_16x16x32_bf16 v[156:159], v[60:63], v[44:47], v[156:159]
    ds_read_b64_tr_b16 v[54:55], v11 offset:43008
    v_fma_f32 v244, v244, v210, v209
    v_mfma_f32_16x16x32_bf16 v[152:155], v[56:59], v[24:27], v[152:155]
    v_fma_f32 v245, v245, v210, v209
    v_mfma_f32_16x16x32_bf16 v[152:155], v[60:63], v[40:43], v[152:155]
    v_mul_f32 v244, v244, v96
    v_mfma_f32_16x16x32_bf16 v[140:143], v[56:59], v[20:23], v[140:143]
    v_mul_f32 v245, v245, v97
    v_mfma_f32_16x16x32_bf16 v[140:143], v[60:63], v[36:39], v[140:143]
    v_exp_f32 v244, v244
    v_mfma_f32_16x16x32_bf16 v[136:139], v[56:59], v[16:19], v[136:139]
    ds_read_b64_tr_b16 v[56:57], v10 offset:35840
    v_mfma_f32_16x16x32_bf16 v[136:139], v[60:63], v[32:35], v[136:139]
    ds_read_b64_tr_b16 v[58:59], v11 offset:35840
    s_waitcnt lgkmcnt(2)
    v_mfma_f32_16x16x32_bf16 v[160:163], v[48:51], v[16:19], v[160:163]
    ds_read_b64_tr_b16 v[60:61], v10 offset:44032
    v_mfma_f32_16x16x32_bf16 v[160:163], v[52:55], v[32:35], v[160:163]
    ds_read_b64_tr_b16 v[62:63], v11 offset:44032
    v_mfma_f32_16x16x32_bf16 v[164:167], v[48:51], v[20:23], v[164:167]
    v_exp_f32 v245, v245
    v_mfma_f32_16x16x32_bf16 v[164:167], v[52:55], v[36:39], v[164:167]
    v_fma_f32 v244, v244, v211, v211
    v_fma_f32 v245, v245, v211, v211
    v_mfma_f32_16x16x32_bf16 v[176:179], v[48:51], v[24:27], v[176:179]
    v_rcp_f32 v244, v244
    v_mfma_f32_16x16x32_bf16 v[176:179], v[52:55], v[40:43], v[176:179]
    v_rcp_f32 v245, v245
    v_mfma_f32_16x16x32_bf16 v[180:183], v[48:51], v[28:31], v[180:183]
    v_mul_f32 v96, v244, v96
    v_mfma_f32_16x16x32_bf16 v[180:183], v[52:55], v[44:47], v[180:183]
    s_waitcnt lgkmcnt(0)
    s_barrier
    ds_read_b64_tr_b16 v[48:49], v10 offset:49152
    ds_read_b64_tr_b16 v[50:51], v11 offset:49152
    v_mfma_f32_16x16x32_bf16 v[168:171], v[56:59], v[16:19], v[168:171]
    ds_read_b64_tr_b16 v[52:53], v10 offset:57344
    ds_read_b64_tr_b16 v[54:55], v11 offset:57344
    v_mfma_f32_16x16x32_bf16 v[168:171], v[60:63], v[32:35], v[168:171]
    ds_read_b128 v[16:19], v8 offset:49152
    v_mul_f32 v97, v245, v97
    v_mfma_f32_16x16x32_bf16 v[172:175], v[56:59], v[20:23], v[172:175]
    ds_read_b128 v[32:35], v9 offset:49152
    v_mfma_f32_16x16x32_bf16 v[172:175], v[60:63], v[36:39], v[172:175]
    ds_read_b128 v[20:23], v8 offset:51200
    v_mfma_f32_16x16x32_bf16 v[184:187], v[56:59], v[24:27], v[184:187]
    ds_read_b128 v[36:39], v9 offset:51200
    v_mfma_f32_16x16x32_bf16 v[184:187], v[60:63], v[40:43], v[184:187]
    ds_read_b128 v[24:27], v8 offset:53248
    v_mfma_f32_16x16x32_bf16 v[188:191], v[56:59], v[28:31], v[188:191]
    ds_read_b128 v[40:43], v9 offset:53248
    v_mfma_f32_16x16x32_bf16 v[188:191], v[60:63], v[44:47], v[188:191]
    ds_read_b128 v[28:31], v8 offset:55296
    s_waitcnt lgkmcnt(5)
    v_mfma_f32_16x16x32_bf16 v[128:131], v[48:51], v[16:19], v[128:131]
    ds_read_b128 v[44:47], v9 offset:55296
    v_fmac_f32 v98, v202, v208
    v_mfma_f32_16x16x32_bf16 v[128:131], v[52:55], v[32:35], v[128:131]
    ds_read_b64_tr_b16 v[56:57], v10 offset:50176
    s_waitcnt lgkmcnt(5)
    v_mfma_f32_16x16x32_bf16 v[132:135], v[48:51], v[20:23], v[132:135]
    ds_read_b64_tr_b16 v[58:59], v11 offset:50176
    v_fmac_f32 v99, v203, v208
    v_mfma_f32_16x16x32_bf16 v[132:135], v[52:55], v[36:39], v[132:135]
    ds_read_b64_tr_b16 v[60:61], v10 offset:58368
    s_waitcnt lgkmcnt(5)
    v_mfma_f32_16x16x32_bf16 v[144:147], v[48:51], v[24:27], v[144:147]
    ds_read_b64_tr_b16 v[62:63], v11 offset:58368
    v_mul_f32 v244, v98, v98
    v_mfma_f32_16x16x32_bf16 v[144:147], v[52:55], v[40:43], v[144:147]
    s_waitcnt lgkmcnt(4)
    v_mfma_f32_16x16x32_bf16 v[148:151], v[48:51], v[28:31], v[148:151]
    ds_read_b64_tr_b16 v[48:49], v10 offset:51200
    v_mul_f32 v245, v99, v99
    v_mfma_f32_16x16x32_bf16 v[148:151], v[52:55], v[44:47], v[148:151]
    ds_read_b64_tr_b16 v[50:51], v11 offset:51200
    s_waitcnt lgkmcnt(4)
    v_mfma_f32_16x16x32_bf16 v[156:159], v[56:59], v[28:31], v[156:159]
    ds_read_b64_tr_b16 v[52:53], v10 offset:59392
    s_waitcnt lgkmcnt(3)
    v_mfma_f32_16x16x32_bf16 v[156:159], v[60:63], v[44:47], v[156:159]
    ds_read_b64_tr_b16 v[54:55], v11 offset:59392
    v_fma_f32 v244, v244, v210, v209
    v_mfma_f32_16x16x32_bf16 v[152:155], v[56:59], v[24:27], v[152:155]
    v_fma_f32 v245, v245, v210, v209
    v_mfma_f32_16x16x32_bf16 v[152:155], v[60:63], v[40:43], v[152:155]
    v_mul_f32 v244, v244, v98
    v_mfma_f32_16x16x32_bf16 v[140:143], v[56:59], v[20:23], v[140:143]
    v_mul_f32 v245, v245, v99
    v_mfma_f32_16x16x32_bf16 v[140:143], v[60:63], v[36:39], v[140:143]
    v_exp_f32 v244, v244
    v_mfma_f32_16x16x32_bf16 v[136:139], v[56:59], v[16:19], v[136:139]
    ds_read_b64_tr_b16 v[56:57], v10 offset:52224
    v_mfma_f32_16x16x32_bf16 v[136:139], v[60:63], v[32:35], v[136:139]
    ds_read_b64_tr_b16 v[58:59], v11 offset:52224
    s_waitcnt lgkmcnt(2)
    v_mfma_f32_16x16x32_bf16 v[160:163], v[48:51], v[16:19], v[160:163]
    ds_read_b64_tr_b16 v[60:61], v10 offset:60416
    v_mfma_f32_16x16x32_bf16 v[160:163], v[52:55], v[32:35], v[160:163]
    ds_read_b64_tr_b16 v[62:63], v11 offset:60416
    v_mfma_f32_16x16x32_bf16 v[164:167], v[48:51], v[20:23], v[164:167]
    v_exp_f32 v245, v245
    v_mfma_f32_16x16x32_bf16 v[164:167], v[52:55], v[36:39], v[164:167]
    v_fma_f32 v244, v244, v211, v211
    v_fma_f32 v245, v245, v211, v211
    v_mfma_f32_16x16x32_bf16 v[176:179], v[48:51], v[24:27], v[176:179]
    v_rcp_f32 v244, v244
    v_mfma_f32_16x16x32_bf16 v[176:179], v[52:55], v[40:43], v[176:179]
    v_rcp_f32 v245, v245
    v_mfma_f32_16x16x32_bf16 v[180:183], v[48:51], v[28:31], v[180:183]
    v_mul_f32 v98, v244, v98
    v_mfma_f32_16x16x32_bf16 v[180:183], v[52:55], v[44:47], v[180:183]
    s_waitcnt lgkmcnt(0)
    s_barrier
    ds_read_b64_tr_b16 v[48:49], v10 offset:0
    ds_read_b64_tr_b16 v[50:51], v11 offset:0
    v_mfma_f32_16x16x32_bf16 v[168:171], v[56:59], v[16:19], v[168:171]
    ds_read_b64_tr_b16 v[52:53], v10 offset:8192
    ds_read_b64_tr_b16 v[54:55], v11 offset:8192
    v_mfma_f32_16x16x32_bf16 v[168:171], v[60:63], v[32:35], v[168:171]
    ds_read_b128 v[16:19], v8 offset:0
    v_mul_f32 v99, v245, v99
    v_mfma_f32_16x16x32_bf16 v[172:175], v[56:59], v[20:23], v[172:175]
    ds_read_b128 v[32:35], v9 offset:0
    v_mfma_f32_16x16x32_bf16 v[172:175], v[60:63], v[36:39], v[172:175]
    ds_read_b128 v[20:23], v8 offset:2048
    v_mfma_f32_16x16x32_bf16 v[184:187], v[56:59], v[24:27], v[184:187]
    ds_read_b128 v[36:39], v9 offset:2048
    v_mfma_f32_16x16x32_bf16 v[184:187], v[60:63], v[40:43], v[184:187]
    ds_read_b128 v[24:27], v8 offset:4096
    v_mfma_f32_16x16x32_bf16 v[188:191], v[56:59], v[28:31], v[188:191]
    ds_read_b128 v[40:43], v9 offset:4096
    v_mfma_f32_16x16x32_bf16 v[188:191], v[60:63], v[44:47], v[188:191]
    ds_read_b128 v[28:31], v8 offset:6144
    s_waitcnt lgkmcnt(5)
    v_mfma_f32_16x16x32_bf16 v[128:131], v[48:51], v[16:19], v[128:131]
    ds_read_b128 v[44:47], v9 offset:6144
    v_fmac_f32 v100, v200, v212
    v_mfma_f32_16x16x32_bf16 v[128:131], v[52:55], v[32:35], v[128:131]
    ds_read_b64_tr_b16 v[56:57], v10 offset:1024
    s_waitcnt lgkmcnt(5)
    v_mfma_f32_16x16x32_bf16 v[132:135], v[48:51], v[20:23], v[132:135]
    ds_read_b64_tr_b16 v[58:59], v11 offset:1024
    v_fmac_f32 v101, v201, v212
    v_mfma_f32_16x16x32_bf16 v[132:135], v[52:55], v[36:39], v[132:135]
    ds_read_b64_tr_b16 v[60:61], v10 offset:9216
    s_waitcnt lgkmcnt(5)
    v_mfma_f32_16x16x32_bf16 v[144:147], v[48:51], v[24:27], v[144:147]
    ds_read_b64_tr_b16 v[62:63], v11 offset:9216
    v_mul_f32 v244, v100, v100
    v_mfma_f32_16x16x32_bf16 v[144:147], v[52:55], v[40:43], v[144:147]
    s_waitcnt lgkmcnt(4)
    v_mfma_f32_16x16x32_bf16 v[148:151], v[48:51], v[28:31], v[148:151]
    ds_read_b64_tr_b16 v[48:49], v10 offset:2048
    v_mul_f32 v245, v101, v101
    v_mfma_f32_16x16x32_bf16 v[148:151], v[52:55], v[44:47], v[148:151]
    ds_read_b64_tr_b16 v[50:51], v11 offset:2048
    s_waitcnt lgkmcnt(4)
    v_mfma_f32_16x16x32_bf16 v[156:159], v[56:59], v[28:31], v[156:159]
    ds_read_b64_tr_b16 v[52:53], v10 offset:10240
    s_waitcnt lgkmcnt(3)
    v_mfma_f32_16x16x32_bf16 v[156:159], v[60:63], v[44:47], v[156:159]
    ds_read_b64_tr_b16 v[54:55], v11 offset:10240
    v_fma_f32 v244, v244, v214, v213
    v_mfma_f32_16x16x32_bf16 v[152:155], v[56:59], v[24:27], v[152:155]
    v_fma_f32 v245, v245, v214, v213
    v_mfma_f32_16x16x32_bf16 v[152:155], v[60:63], v[40:43], v[152:155]
    v_mul_f32 v244, v244, v100
    v_mfma_f32_16x16x32_bf16 v[140:143], v[56:59], v[20:23], v[140:143]
    v_mul_f32 v245, v245, v101
    v_mfma_f32_16x16x32_bf16 v[140:143], v[60:63], v[36:39], v[140:143]
    v_exp_f32 v244, v244
    v_mfma_f32_16x16x32_bf16 v[136:139], v[56:59], v[16:19], v[136:139]
    ds_read_b64_tr_b16 v[56:57], v10 offset:3072
    v_mfma_f32_16x16x32_bf16 v[136:139], v[60:63], v[32:35], v[136:139]
    ds_read_b64_tr_b16 v[58:59], v11 offset:3072
    s_waitcnt lgkmcnt(2)
    v_mfma_f32_16x16x32_bf16 v[160:163], v[48:51], v[16:19], v[160:163]
    ds_read_b64_tr_b16 v[60:61], v10 offset:11264
    v_mfma_f32_16x16x32_bf16 v[160:163], v[52:55], v[32:35], v[160:163]
    ds_read_b64_tr_b16 v[62:63], v11 offset:11264
    v_mfma_f32_16x16x32_bf16 v[164:167], v[48:51], v[20:23], v[164:167]
    v_exp_f32 v245, v245
    v_mfma_f32_16x16x32_bf16 v[164:167], v[52:55], v[36:39], v[164:167]
    v_fma_f32 v244, v244, v215, v215
    v_fma_f32 v245, v245, v215, v215
    v_mfma_f32_16x16x32_bf16 v[176:179], v[48:51], v[24:27], v[176:179]
    v_rcp_f32 v244, v244
    v_mfma_f32_16x16x32_bf16 v[176:179], v[52:55], v[40:43], v[176:179]
    v_rcp_f32 v245, v245
    v_mfma_f32_16x16x32_bf16 v[180:183], v[48:51], v[28:31], v[180:183]
    v_mul_f32 v100, v244, v100
    v_mfma_f32_16x16x32_bf16 v[180:183], v[52:55], v[44:47], v[180:183]
    s_waitcnt lgkmcnt(0)
    s_barrier
    ds_read_b64_tr_b16 v[48:49], v10 offset:16384
    ds_read_b64_tr_b16 v[50:51], v11 offset:16384
    v_mfma_f32_16x16x32_bf16 v[168:171], v[56:59], v[16:19], v[168:171]
    ds_read_b64_tr_b16 v[52:53], v10 offset:24576
    ds_read_b64_tr_b16 v[54:55], v11 offset:24576
    v_mfma_f32_16x16x32_bf16 v[168:171], v[60:63], v[32:35], v[168:171]
    ds_read_b128 v[16:19], v8 offset:16384
    v_mul_f32 v101, v245, v101
    v_mfma_f32_16x16x32_bf16 v[172:175], v[56:59], v[20:23], v[172:175]
    ds_read_b128 v[32:35], v9 offset:16384
    v_mfma_f32_16x16x32_bf16 v[172:175], v[60:63], v[36:39], v[172:175]
    ds_read_b128 v[20:23], v8 offset:18432
    v_mfma_f32_16x16x32_bf16 v[184:187], v[56:59], v[24:27], v[184:187]
    ds_read_b128 v[36:39], v9 offset:18432
    v_mfma_f32_16x16x32_bf16 v[184:187], v[60:63], v[40:43], v[184:187]
    ds_read_b128 v[24:27], v8 offset:20480
    v_mfma_f32_16x16x32_bf16 v[188:191], v[56:59], v[28:31], v[188:191]
    ds_read_b128 v[40:43], v9 offset:20480
    v_mfma_f32_16x16x32_bf16 v[188:191], v[60:63], v[44:47], v[188:191]
    ds_read_b128 v[28:31], v8 offset:22528
    s_waitcnt lgkmcnt(5)
    v_mfma_f32_16x16x32_bf16 v[128:131], v[48:51], v[16:19], v[128:131]
    ds_read_b128 v[44:47], v9 offset:22528
    v_fmac_f32 v102, v202, v212
    v_mfma_f32_16x16x32_bf16 v[128:131], v[52:55], v[32:35], v[128:131]
    ds_read_b64_tr_b16 v[56:57], v10 offset:17408
    s_waitcnt lgkmcnt(5)
    v_mfma_f32_16x16x32_bf16 v[132:135], v[48:51], v[20:23], v[132:135]
    ds_read_b64_tr_b16 v[58:59], v11 offset:17408
    v_fmac_f32 v103, v203, v212
    v_mfma_f32_16x16x32_bf16 v[132:135], v[52:55], v[36:39], v[132:135]
    ds_read_b64_tr_b16 v[60:61], v10 offset:25600
    s_waitcnt lgkmcnt(5)
    v_mfma_f32_16x16x32_bf16 v[144:147], v[48:51], v[24:27], v[144:147]
    ds_read_b64_tr_b16 v[62:63], v11 offset:25600
    v_mul_f32 v244, v102, v102
    v_mfma_f32_16x16x32_bf16 v[144:147], v[52:55], v[40:43], v[144:147]
    s_waitcnt lgkmcnt(4)
    v_mfma_f32_16x16x32_bf16 v[148:151], v[48:51], v[28:31], v[148:151]
    ds_read_b64_tr_b16 v[48:49], v10 offset:18432
    v_mul_f32 v245, v103, v103
    v_mfma_f32_16x16x32_bf16 v[148:151], v[52:55], v[44:47], v[148:151]
    ds_read_b64_tr_b16 v[50:51], v11 offset:18432
    s_waitcnt lgkmcnt(4)
    v_mfma_f32_16x16x32_bf16 v[156:159], v[56:59], v[28:31], v[156:159]
    ds_read_b64_tr_b16 v[52:53], v10 offset:26624
    s_waitcnt lgkmcnt(3)
    v_mfma_f32_16x16x32_bf16 v[156:159], v[60:63], v[44:47], v[156:159]
    ds_read_b64_tr_b16 v[54:55], v11 offset:26624
    v_fma_f32 v244, v244, v214, v213
    v_mfma_f32_16x16x32_bf16 v[152:155], v[56:59], v[24:27], v[152:155]
    v_fma_f32 v245, v245, v214, v213
    v_mfma_f32_16x16x32_bf16 v[152:155], v[60:63], v[40:43], v[152:155]
    v_mul_f32 v244, v244, v102
    v_mfma_f32_16x16x32_bf16 v[140:143], v[56:59], v[20:23], v[140:143]
    v_mul_f32 v245, v245, v103
    v_mfma_f32_16x16x32_bf16 v[140:143], v[60:63], v[36:39], v[140:143]
    v_exp_f32 v244, v244
    v_mfma_f32_16x16x32_bf16 v[136:139], v[56:59], v[16:19], v[136:139]
    ds_read_b64_tr_b16 v[56:57], v10 offset:19456
    v_mfma_f32_16x16x32_bf16 v[136:139], v[60:63], v[32:35], v[136:139]
    ds_read_b64_tr_b16 v[58:59], v11 offset:19456
    s_waitcnt lgkmcnt(2)
    v_mfma_f32_16x16x32_bf16 v[160:163], v[48:51], v[16:19], v[160:163]
    ds_read_b64_tr_b16 v[60:61], v10 offset:27648
    v_mfma_f32_16x16x32_bf16 v[160:163], v[52:55], v[32:35], v[160:163]
    ds_read_b64_tr_b16 v[62:63], v11 offset:27648
    v_mfma_f32_16x16x32_bf16 v[164:167], v[48:51], v[20:23], v[164:167]
    v_exp_f32 v245, v245
    v_mfma_f32_16x16x32_bf16 v[164:167], v[52:55], v[36:39], v[164:167]
    v_fma_f32 v244, v244, v215, v215
    v_fma_f32 v245, v245, v215, v215
    v_mfma_f32_16x16x32_bf16 v[176:179], v[48:51], v[24:27], v[176:179]
    v_rcp_f32 v244, v244
    v_mfma_f32_16x16x32_bf16 v[176:179], v[52:55], v[40:43], v[176:179]
    v_rcp_f32 v245, v245
    v_mfma_f32_16x16x32_bf16 v[180:183], v[48:51], v[28:31], v[180:183]
    v_mul_f32 v102, v244, v102
    v_mfma_f32_16x16x32_bf16 v[180:183], v[52:55], v[44:47], v[180:183]
    s_waitcnt lgkmcnt(0)
    s_barrier
    ds_read_b64_tr_b16 v[48:49], v10 offset:32768
    ds_read_b64_tr_b16 v[50:51], v11 offset:32768
    v_mfma_f32_16x16x32_bf16 v[168:171], v[56:59], v[16:19], v[168:171]
    ds_read_b64_tr_b16 v[52:53], v10 offset:40960
    ds_read_b64_tr_b16 v[54:55], v11 offset:40960
    v_mfma_f32_16x16x32_bf16 v[168:171], v[60:63], v[32:35], v[168:171]
    ds_read_b128 v[16:19], v8 offset:32768
    v_mul_f32 v103, v245, v103
    v_mfma_f32_16x16x32_bf16 v[172:175], v[56:59], v[20:23], v[172:175]
    ds_read_b128 v[32:35], v9 offset:32768
    v_mfma_f32_16x16x32_bf16 v[172:175], v[60:63], v[36:39], v[172:175]
    ds_read_b128 v[20:23], v8 offset:34816
    v_mfma_f32_16x16x32_bf16 v[184:187], v[56:59], v[24:27], v[184:187]
    ds_read_b128 v[36:39], v9 offset:34816
    v_mfma_f32_16x16x32_bf16 v[184:187], v[60:63], v[40:43], v[184:187]
    ds_read_b128 v[24:27], v8 offset:36864
    v_mfma_f32_16x16x32_bf16 v[188:191], v[56:59], v[28:31], v[188:191]
    ds_read_b128 v[40:43], v9 offset:36864
    v_mfma_f32_16x16x32_bf16 v[188:191], v[60:63], v[44:47], v[188:191]
    ds_read_b128 v[28:31], v8 offset:38912
    s_waitcnt lgkmcnt(5)
    v_mfma_f32_16x16x32_bf16 v[128:131], v[48:51], v[16:19], v[128:131]
    ds_read_b128 v[44:47], v9 offset:38912
    v_fmac_f32 v112, v200, v216
    v_mfma_f32_16x16x32_bf16 v[128:131], v[52:55], v[32:35], v[128:131]
    ds_read_b64_tr_b16 v[56:57], v10 offset:33792
    s_waitcnt lgkmcnt(5)
    v_mfma_f32_16x16x32_bf16 v[132:135], v[48:51], v[20:23], v[132:135]
    ds_read_b64_tr_b16 v[58:59], v11 offset:33792
    v_fmac_f32 v113, v201, v216
    v_mfma_f32_16x16x32_bf16 v[132:135], v[52:55], v[36:39], v[132:135]
    ds_read_b64_tr_b16 v[60:61], v10 offset:41984
    s_waitcnt lgkmcnt(5)
    v_mfma_f32_16x16x32_bf16 v[144:147], v[48:51], v[24:27], v[144:147]
    ds_read_b64_tr_b16 v[62:63], v11 offset:41984
    v_mul_f32 v244, v112, v112
    v_mfma_f32_16x16x32_bf16 v[144:147], v[52:55], v[40:43], v[144:147]
    s_waitcnt lgkmcnt(4)
    v_mfma_f32_16x16x32_bf16 v[148:151], v[48:51], v[28:31], v[148:151]
    ds_read_b64_tr_b16 v[48:49], v10 offset:34816
    v_mul_f32 v245, v113, v113
    v_mfma_f32_16x16x32_bf16 v[148:151], v[52:55], v[44:47], v[148:151]
    ds_read_b64_tr_b16 v[50:51], v11 offset:34816
    s_waitcnt lgkmcnt(4)
    v_mfma_f32_16x16x32_bf16 v[156:159], v[56:59], v[28:31], v[156:159]
    ds_read_b64_tr_b16 v[52:53], v10 offset:43008
    s_waitcnt lgkmcnt(3)
    v_mfma_f32_16x16x32_bf16 v[156:159], v[60:63], v[44:47], v[156:159]
    ds_read_b64_tr_b16 v[54:55], v11 offset:43008
    v_fma_f32 v244, v244, v218, v217
    v_mfma_f32_16x16x32_bf16 v[152:155], v[56:59], v[24:27], v[152:155]
    v_fma_f32 v245, v245, v218, v217
    v_mfma_f32_16x16x32_bf16 v[152:155], v[60:63], v[40:43], v[152:155]
    v_mul_f32 v244, v244, v112
    v_mfma_f32_16x16x32_bf16 v[140:143], v[56:59], v[20:23], v[140:143]
    v_mul_f32 v245, v245, v113
    v_mfma_f32_16x16x32_bf16 v[140:143], v[60:63], v[36:39], v[140:143]
    v_exp_f32 v244, v244
    v_mfma_f32_16x16x32_bf16 v[136:139], v[56:59], v[16:19], v[136:139]
    ds_read_b64_tr_b16 v[56:57], v10 offset:35840
    v_mfma_f32_16x16x32_bf16 v[136:139], v[60:63], v[32:35], v[136:139]
    ds_read_b64_tr_b16 v[58:59], v11 offset:35840
    s_waitcnt lgkmcnt(2)
    v_mfma_f32_16x16x32_bf16 v[160:163], v[48:51], v[16:19], v[160:163]
    ds_read_b64_tr_b16 v[60:61], v10 offset:44032
    v_mfma_f32_16x16x32_bf16 v[160:163], v[52:55], v[32:35], v[160:163]
    ds_read_b64_tr_b16 v[62:63], v11 offset:44032
    v_mfma_f32_16x16x32_bf16 v[164:167], v[48:51], v[20:23], v[164:167]
    v_exp_f32 v245, v245
    v_mfma_f32_16x16x32_bf16 v[164:167], v[52:55], v[36:39], v[164:167]
    v_fma_f32 v244, v244, v219, v219
    v_fma_f32 v245, v245, v219, v219
    v_mfma_f32_16x16x32_bf16 v[176:179], v[48:51], v[24:27], v[176:179]
    v_rcp_f32 v244, v244
    v_mfma_f32_16x16x32_bf16 v[176:179], v[52:55], v[40:43], v[176:179]
    v_rcp_f32 v245, v245
    v_mfma_f32_16x16x32_bf16 v[180:183], v[48:51], v[28:31], v[180:183]
    v_mul_f32 v112, v244, v112
    v_mfma_f32_16x16x32_bf16 v[180:183], v[52:55], v[44:47], v[180:183]
    s_waitcnt lgkmcnt(0)
    s_barrier
    ds_read_b64_tr_b16 v[48:49], v10 offset:49152
    ds_read_b64_tr_b16 v[50:51], v11 offset:49152
    v_mfma_f32_16x16x32_bf16 v[168:171], v[56:59], v[16:19], v[168:171]
    ds_read_b64_tr_b16 v[52:53], v10 offset:57344
L_pad17:
    s_cbranch_execz L_padr17
    ds_read_b64_tr_b16 v[54:55], v11 offset:57344
    v_mfma_f32_16x16x32_bf16 v[168:171], v[60:63], v[32:35], v[168:171]
    ds_read_b128 v[16:19], v8 offset:49152
    v_mul_f32 v113, v245, v113
    v_mfma_f32_16x16x32_bf16 v[172:175], v[56:59], v[20:23], v[172:175]
    ds_read_b128 v[32:35], v9 offset:49152
    v_mfma_f32_16x16x32_bf16 v[172:175], v[60:63], v[36:39], v[172:175]
    ds_read_b128 v[20:23], v8 offset:51200
    v_mfma_f32_16x16x32_bf16 v[184:187], v[56:59], v[24:27], v[184:187]
    ds_read_b128 v[36:39], v9 offset:51200
    v_mfma_f32_16x16x32_bf16 v[184:187], v[60:63], v[40:43], v[184:187]
    ds_read_b128 v[24:27], v8 offset:53248
    v_mfma_f32_16x16x32_bf16 v[188:191], v[56:59], v[28:31], v[188:191]
    ds_read_b128 v[40:43], v9 offset:53248
    v_mfma_f32_16x16x32_bf16 v[188:191], v[60:63], v[44:47], v[188:191]
    ds_read_b128 v[28:31], v8 offset:55296
    s_waitcnt lgkmcnt(5)
    v_mfma_f32_16x16x32_bf16 v[128:131], v[48:51], v[16:19], v[128:131]
    ds_read_b128 v[44:47], v9 offset:55296
    v_fmac_f32 v114, v202, v216
    v_mfma_f32_16x16x32_bf16 v[128:131], v[52:55], v[32:35], v[128:131]
    ds_read_b64_tr_b16 v[56:57], v10 offset:50176
    s_waitcnt lgkmcnt(5)
    v_mfma_f32_16x16x32_bf16 v[132:135], v[48:51], v[20:23], v[132:135]
    ds_read_b64_tr_b16 v[58:59], v11 offset:50176
    v_fmac_f32 v115, v203, v216
    v_mfma_f32_16x16x32_bf16 v[132:135], v[52:55], v[36:39], v[132:135]
    ds_read_b64_tr_b16 v[60:61], v10 offset:58368
    s_waitcnt lgkmcnt(5)
    v_mfma_f32_16x16x32_bf16 v[144:147], v[48:51], v[24:27], v[144:147]
    ds_read_b64_tr_b16 v[62:63], v11 offset:58368
    v_mul_f32 v244, v114, v114
    v_mfma_f32_16x16x32_bf16 v[144:147], v[52:55], v[40:43], v[144:147]
    s_waitcnt lgkmcnt(4)
    v_mfma_f32_16x16x32_bf16 v[148:151], v[48:51], v[28:31], v[148:151]
    ds_read_b64_tr_b16 v[48:49], v10 offset:51200
    v_mul_f32 v245, v115, v115
    v_mfma_f32_16x16x32_bf16 v[148:151], v[52:55], v[44:47], v[148:151]
    ds_read_b64_tr_b16 v[50:51], v11 offset:51200
    s_waitcnt lgkmcnt(4)
    v_mfma_f32_16x16x32_bf16 v[156:159], v[56:59], v[28:31], v[156:159]
    ds_read_b64_tr_b16 v[52:53], v10 offset:59392
    s_waitcnt lgkmcnt(3)
    v_mfma_f32_16x16x32_bf16 v[156:159], v[60:63], v[44:47], v[156:159]
    ds_read_b64_tr_b16 v[54:55], v11 offset:59392
    v_fma_f32 v244, v244, v218, v217
    v_mfma_f32_16x16x32_bf16 v[152:155], v[56:59], v[24:27], v[152:155]
    v_fma_f32 v245, v245, v218, v217
    v_mfma_f32_16x16x32_bf16 v[152:155], v[60:63], v[40:43], v[152:155]
    v_mul_f32 v244, v244, v114
    v_mfma_f32_16x16x32_bf16 v[140:143], v[56:59], v[20:23], v[140:143]
    v_mul_f32 v245, v245, v115
    v_mfma_f32_16x16x32_bf16 v[140:143], v[60:63], v[36:39], v[140:143]
    v_exp_f32 v244, v244
    v_mfma_f32_16x16x32_bf16 v[136:139], v[56:59], v[16:19], v[136:139]
    ds_read_b64_tr_b16 v[56:57], v10 offset:52224
    v_mfma_f32_16x16x32_bf16 v[136:139], v[60:63], v[32:35], v[136:139]
    ds_read_b64_tr_b16 v[58:59], v11 offset:52224
    s_waitcnt lgkmcnt(2)
    v_mfma_f32_16x16x32_bf16 v[160:163], v[48:51], v[16:19], v[160:163]
    ds_read_b64_tr_b16 v[60:61], v10 offset:60416
    v_mfma_f32_16x16x32_bf16 v[160:163], v[52:55], v[32:35], v[160:163]
    ds_read_b64_tr_b16 v[62:63], v11 offset:60416
    v_mfma_f32_16x16x32_bf16 v[164:167], v[48:51], v[20:23], v[164:167]
    v_exp_f32 v245, v245
    v_mfma_f32_16x16x32_bf16 v[164:167], v[52:55], v[36:39], v[164:167]
    v_fma_f32 v244, v244, v219, v219
    v_fma_f32 v245, v245, v219, v219
    v_mfma_f32_16x16x32_bf16 v[176:179], v[48:51], v[24:27], v[176:179]
    v_rcp_f32 v244, v244
    v_mfma_f32_16x16x32_bf16 v[176:179], v[52:55], v[40:43], v[176:179]
    v_rcp_f32 v245, v245
    v_mfma_f32_16x16x32_bf16 v[180:183], v[48:51], v[28:31], v[180:183]
    v_mul_f32 v114, v244, v114
    v_mfma_f32_16x16x32_bf16 v[180:183], v[52:55], v[44:47], v[180:183]
    s_waitcnt lgkmcnt(0)
    s_barrier
    ds_read_b64_tr_b16 v[48:49], v10 offset:0
    ds_read_b64_tr_b16 v[50:51], v11 offset:0
    v_mfma_f32_16x16x32_bf16 v[168:171], v[56:59], v[16:19], v[168:171]
    ds_read_b64_tr_b16 v[52:53], v10 offset:8192
    ds_read_b64_tr_b16 v[54:55], v11 offset:8192
    v_mfma_f32_16x16x32_bf16 v[168:171], v[60:63], v[32:35], v[168:171]
    ds_read_b128 v[16:19], v8 offset:0
    v_mul_f32 v115, v245, v115
    v_mfma_f32_16x16x32_bf16 v[172:175], v[56:59], v[20:23], v[172:175]
    ds_read_b128 v[32:35], v9 offset:0
    v_mfma_f32_16x16x32_bf16 v[172:175], v[60:63], v[36:39], v[172:175]
    ds_read_b128 v[20:23], v8 offset:2048
    v_mfma_f32_16x16x32_bf16 v[184:187], v[56:59], v[24:27], v[184:187]
    ds_read_b128 v[36:39], v9 offset:2048
    v_mfma_f32_16x16x32_bf16 v[184:187], v[60:63], v[40:43], v[184:187]
    ds_read_b128 v[24:27], v8 offset:4096
    v_mfma_f32_16x16x32_bf16 v[188:191], v[56:59], v[28:31], v[188:191]
    ds_read_b128 v[40:43], v9 offset:4096
    v_mfma_f32_16x16x32_bf16 v[188:191], v[60:63], v[44:47], v[188:191]
    ds_read_b128 v[28:31], v8 offset:6144
    s_waitcnt lgkmcnt(5)
    v_mfma_f32_16x16x32_bf16 v[128:131], v[48:51], v[16:19], v[128:131]
    ds_read_b128 v[44:47], v9 offset:6144
    v_fmac_f32 v116, v200, v220
    v_mfma_f32_16x16x32_bf16 v[128:131], v[52:55], v[32:35], v[128:131]
    ds_read_b64_tr_b16 v[56:57], v10 offset:1024
    s_waitcnt lgkmcnt(5)
    v_mfma_f32_16x16x32_bf16 v[132:135], v[48:51], v[20:23], v[132:135]
    ds_read_b64_tr_b16 v[58:59], v11 offset:1024
    v_fmac_f32 v117, v201, v220
    v_mfma_f32_16x16x32_bf16 v[132:135], v[52:55], v[36:39], v[132:135]
    ds_read_b64_tr_b16 v[60:61], v10 offset:9216
    s_waitcnt lgkmcnt(5)
    v_mfma_f32_16x16x32_bf16 v[144:147], v[48:51], v[24:27], v[144:147]
    ds_read_b64_tr_b16 v[62:63], v11 offset:9216
    v_mul_f32 v244, v116, v116
    v_mfma_f32_16x16x32_bf16 v[144:147], v[52:55], v[40:43], v[144:147]
    s_waitcnt lgkmcnt(4)
    v_mfma_f32_16x16x32_bf16 v[148:151], v[48:51], v[28:31], v[148:151]
    ds_read_b64_tr_b16 v[48:49], v10 offset:2048
    v_mul_f32 v245, v117, v117
    v_mfma_f32_16x16x32_bf16 v[148:151], v[52:55], v[44:47], v[148:151]
    ds_read_b64_tr_b16 v[50:51], v11 offset:2048
    s_waitcnt lgkmcnt(4)
    v_mfma_f32_16x16x32_bf16 v[156:159], v[56:59], v[28:31], v[156:159]
    ds_read_b64_tr_b16 v[52:53], v10 offset:10240
    s_waitcnt lgkmcnt(3)
    v_mfma_f32_16x16x32_bf16 v[156:159], v[60:63], v[44:47], v[156:159]
    ds_read_b64_tr_b16 v[54:55], v11 offset:10240
    v_fma_f32 v244, v244, v222, v221
    v_mfma_f32_16x16x32_bf16 v[152:155], v[56:59], v[24:27], v[152:155]
    v_fma_f32 v245, v245, v222, v221
    v_mfma_f32_16x16x32_bf16 v[152:155], v[60:63], v[40:43], v[152:155]
    v_mul_f32 v244, v244, v116
    v_mfma_f32_16x16x32_bf16 v[140:143], v[56:59], v[20:23], v[140:143]
    v_mul_f32 v245, v245, v117
    v_mfma_f32_16x16x32_bf16 v[140:143], v[60:63], v[36:39], v[140:143]
    v_exp_f32 v244, v244
    v_mfma_f32_16x16x32_bf16 v[136:139], v[56:59], v[16:19], v[136:139]
    ds_read_b64_tr_b16 v[56:57], v10 offset:3072
    v_mfma_f32_16x16x32_bf16 v[136:139], v[60:63], v[32:35], v[136:139]
    ds_read_b64_tr_b16 v[58:59], v11 offset:3072
    s_waitcnt lgkmcnt(2)
    v_mfma_f32_16x16x32_bf16 v[160:163], v[48:51], v[16:19], v[160:163]
    ds_read_b64_tr_b16 v[60:61], v10 offset:11264
    v_mfma_f32_16x16x32_bf16 v[160:163], v[52:55], v[32:35], v[160:163]
    ds_read_b64_tr_b16 v[62:63], v11 offset:11264
    v_mfma_f32_16x16x32_bf16 v[164:167], v[48:51], v[20:23], v[164:167]
    v_exp_f32 v245, v245
    v_mfma_f32_16x16x32_bf16 v[164:167], v[52:55], v[36:39], v[164:167]
    v_fma_f32 v244, v244, v223, v223
    v_fma_f32 v245, v245, v223, v223
    v_mfma_f32_16x16x32_bf16 v[176:179], v[48:51], v[24:27], v[176:179]
    v_rcp_f32 v244, v244
    v_mfma_f32_16x16x32_bf16 v[176:179], v[52:55], v[40:43], v[176:179]
    v_rcp_f32 v245, v245
    v_mfma_f32_16x16x32_bf16 v[180:183], v[48:51], v[28:31], v[180:183]
    v_mul_f32 v116, v244, v116
    v_mfma_f32_16x16x32_bf16 v[180:183], v[52:55], v[44:47], v[180:183]
    s_waitcnt lgkmcnt(0)
    s_barrier
    ds_read_b64_tr_b16 v[48:49], v10 offset:16384
    ds_read_b64_tr_b16 v[50:51], v11 offset:16384
    v_mfma_f32_16x16x32_bf16 v[168:171], v[56:59], v[16:19], v[168:171]
    ds_read_b64_tr_b16 v[52:53], v10 offset:24576
    ds_read_b64_tr_b16 v[54:55], v11 offset:24576
    v_mfma_f32_16x16x32_bf16 v[168:171], v[60:63], v[32:35], v[168:171]
    ds_read_b128 v[16:19], v8 offset:16384
    v_mul_f32 v117, v245, v117
    v_mfma_f32_16x16x32_bf16 v[172:175], v[56:59], v[20:23], v[172:175]
    ds_read_b128 v[32:35], v9 offset:16384
    v_mfma_f32_16x16x32_bf16 v[172:175], v[60:63], v[36:39], v[172:175]
    ds_read_b128 v[20:23], v8 offset:18432
    v_mfma_f32_16x16x32_bf16 v[184:187], v[56:59], v[24:27], v[184:187]
    ds_read_b128 v[36:39], v9 offset:18432
    v_mfma_f32_16x16x32_bf16 v[184:187], v[60:63], v[40:43], v[184:187]
    ds_read_b128 v[24:27], v8 offset:20480
    v_mfma_f32_16x16x32_bf16 v[188:191], v[56:59], v[28:31], v[188:191]
    ds_read_b128 v[40:43], v9 offset:20480
    v_mfma_f32_16x16x32_bf16 v[188:191], v[60:63], v[44:47], v[188:191]
    ds_read_b128 v[28:31], v8 offset:22528
    s_waitcnt lgkmcnt(5)
    v_mfma_f32_16x16x32_bf16 v[128:131], v[48:51], v[16:19], v[128:131]
    ds_read_b128 v[44:47], v9 offset:22528
    v_fmac_f32 v118, v202, v220
    v_mfma_f32_16x16x32_bf16 v[128:131], v[52:55], v[32:35], v[128:131]
    ds_read_b64_tr_b16 v[56:57], v10 offset:17408
    s_waitcnt lgkmcnt(5)
    v_mfma_f32_16x16x32_bf16 v[132:135], v[48:51], v[20:23], v[132:135]
    ds_read_b64_tr_b16 v[58:59], v11 offset:17408
    v_fmac_f32 v119, v203, v220
    v_mfma_f32_16x16x32_bf16 v[132:135], v[52:55], v[36:39], v[132:135]
    ds_read_b64_tr_b16 v[60:61], v10 offset:25600
    s_waitcnt lgkmcnt(5)
    v_mfma_f32_16x16x32_bf16 v[144:147], v[48:51], v[24:27], v[144:147]
    ds_read_b64_tr_b16 v[62:63], v11 offset:25600
    v_mul_f32 v244, v118, v118
    v_mfma_f32_16x16x32_bf16 v[144:147], v[52:55], v[40:43], v[144:147]
    s_waitcnt lgkmcnt(4)
    v_mfma_f32_16x16x32_bf16 v[148:151], v[48:51], v[28:31], v[148:151]
    ds_read_b64_tr_b16 v[48:49], v10 offset:18432
    v_mul_f32 v245, v119, v119
    v_mfma_f32_16x16x32_bf16 v[148:151], v[52:55], v[44:47], v[148:151]
    ds_read_b64_tr_b16 v[50:51], v11 offset:18432
    s_waitcnt lgkmcnt(4)
    v_mfma_f32_16x16x32_bf16 v[156:159], v[56:59], v[28:31], v[156:159]
    ds_read_b64_tr_b16 v[52:53], v10 offset:26624
    s_waitcnt lgkmcnt(3)
    v_mfma_f32_16x16x32_bf16 v[156:159], v[60:63], v[44:47], v[156:159]
    ds_read_b64_tr_b16 v[54:55], v11 offset:26624
    v_fma_f32 v244, v244, v222, v221
    v_mfma_f32_16x16x32_bf16 v[152:155], v[56:59], v[24:27], v[152:155]
    v_fma_f32 v245, v245, v222, v221
    v_mfma_f32_16x16x32_bf16 v[152:155], v[60:63], v[40:43], v[152:155]
    v_mul_f32 v244, v244, v118
    v_mfma_f32_16x16x32_bf16 v[140:143], v[56:59], v[20:23], v[140:143]
    v_mul_f32 v245, v245, v119
    v_mfma_f32_16x16x32_bf16 v[140:143], v[60:63], v[36:39], v[140:143]
    v_exp_f32 v244, v244
    v_mfma_f32_16x16x32_bf16 v[136:139], v[56:59], v[16:19], v[136:139]
    ds_read_b64_tr_b16 v[56:57], v10 offset:19456
    v_mfma_f32_16x16x32_bf16 v[136:139], v[60:63], v[32:35], v[136:139]
    ds_read_b64_tr_b16 v[58:59], v11 offset:19456
    s_waitcnt lgkmcnt(2)
    v_mfma_f32_16x16x32_bf16 v[160:163], v[48:51], v[16:19], v[160:163]
    ds_read_b64_tr_b16 v[60:61], v10 offset:27648
    v_mfma_f32_16x16x32_bf16 v[160:163], v[52:55], v[32:35], v[160:163]
    ds_read_b64_tr_b16 v[62:63], v11 offset:27648
    v_mfma_f32_16x16x32_bf16 v[164:167], v[48:51], v[20:23], v[164:167]
    v_exp_f32 v245, v245
    v_mfma_f32_16x16x32_bf16 v[164:167], v[52:55], v[36:39], v[164:167]
    v_fma_f32 v244, v244, v223, v223
    v_fma_f32 v245, v245, v223, v223
    v_mfma_f32_16x16x32_bf16 v[176:179], v[48:51], v[24:27], v[176:179]
    v_rcp_f32 v244, v244
    v_mfma_f32_16x16x32_bf16 v[176:179], v[52:55], v[40:43], v[176:179]
    v_rcp_f32 v245, v245
    v_mfma_f32_16x16x32_bf16 v[180:183], v[48:51], v[28:31], v[180:183]
    v_mul_f32 v118, v244, v118
    v_mfma_f32_16x16x32_bf16 v[180:183], v[52:55], v[44:47], v[180:183]
    s_waitcnt lgkmcnt(0)
    s_barrier
    ds_read_b64_tr_b16 v[48:49], v10 offset:32768
    ds_read_b64_tr_b16 v[50:51], v11 offset:32768
    v_mfma_f32_16x16x32_bf16 v[168:171], v[56:59], v[16:19], v[168:171]
    ds_read_b64_tr_b16 v[52:53], v10 offset:40960
    ds_read_b64_tr_b16 v[54:55], v11 offset:40960
    v_mfma_f32_16x16x32_bf16 v[168:171], v[60:63], v[32:35], v[168:171]
    ds_read_b128 v[16:19], v8 offset:32768
    v_mul_f32 v119, v245, v119
    v_mfma_f32_16x16x32_bf16 v[172:175], v[56:59], v[20:23], v[172:175]
    ds_read_b128 v[32:35], v9 offset:32768
    v_mfma_f32_16x16x32_bf16 v[172:175], v[60:63], v[36:39], v[172:175]
    ds_read_b128 v[20:23], v8 offset:34816
    v_mfma_f32_16x16x32_bf16 v[184:187], v[56:59], v[24:27], v[184:187]
    ds_read_b128 v[36:39], v9 offset:34816
    v_mfma_f32_16x16x32_bf16 v[184:187], v[60:63], v[40:43], v[184:187]
    ds_read_b128 v[24:27], v8 offset:36864
    v_mfma_f32_16x16x32_bf16 v[188:191], v[56:59], v[28:31], v[188:191]
    ds_read_b128 v[40:43], v9 offset:36864
    v_mfma_f32_16x16x32_bf16 v[188:191], v[60:63], v[44:47], v[188:191]
    ds_read_b128 v[28:31], v8 offset:38912
    s_waitcnt lgkmcnt(5)
    v_mfma_f32_16x16x32_bf16 v[128:131], v[48:51], v[16:19], v[128:131]
    ds_read_b128 v[44:47], v9 offset:38912
    v_fmac_f32 v124, v204, v220
    v_mfma_f32_16x16x32_bf16 v[128:131], v[52:55], v[32:35], v[128:131]
    ds_read_b64_tr_b16 v[56:57], v10 offset:33792
    s_waitcnt lgkmcnt(5)
    v_mfma_f32_16x16x32_bf16 v[132:135], v[48:51], v[20:23], v[132:135]
    ds_read_b64_tr_b16 v[58:59], v11 offset:33792
    v_fmac_f32 v125, v205, v220
    v_mfma_f32_16x16x32_bf16 v[132:135], v[52:55], v[36:39], v[132:135]
    ds_read_b64_tr_b16 v[60:61], v10 offset:41984
    s_waitcnt lgkmcnt(5)
    v_mfma_f32_16x16x32_bf16 v[144:147], v[48:51], v[24:27], v[144:147]
    ds_read_b64_tr_b16 v[62:63], v11 offset:41984
    v_mul_f32 v244, v124, v124
    v_mfma_f32_16x16x32_bf16 v[144:147], v[52:55], v[40:43], v[144:147]
    s_waitcnt lgkmcnt(4)
    v_mfma_f32_16x16x32_bf16 v[148:151], v[48:51], v[28:31], v[148:151]
    ds_read_b64_tr_b16 v[48:49], v10 offset:34816
    v_mul_f32 v245, v125, v125
    v_mfma_f32_16x16x32_bf16 v[148:151], v[52:55], v[44:47], v[148:151]
    ds_read_b64_tr_b16 v[50:51], v11 offset:34816
    s_waitcnt lgkmcnt(4)
    v_mfma_f32_16x16x32_bf16 v[156:159], v[56:59], v[28:31], v[156:159]
    ds_read_b64_tr_b16 v[52:53], v10 offset:43008
    s_waitcnt lgkmcnt(3)
    v_mfma_f32_16x16x32_bf16 v[156:159], v[60:63], v[44:47], v[156:159]
    ds_read_b64_tr_b16 v[54:55], v11 offset:43008
    v_fma_f32 v244, v244, v222, v221
    v_mfma_f32_16x16x32_bf16 v[152:155], v[56:59], v[24:27], v[152:155]
    v_fma_f32 v245, v245, v222, v221
    v_mfma_f32_16x16x32_bf16 v[152:155], v[60:63], v[40:43], v[152:155]
    v_mul_f32 v244, v244, v124
    v_mfma_f32_16x16x32_bf16 v[140:143], v[56:59], v[20:23], v[140:143]
    v_mul_f32 v245, v245, v125
    v_mfma_f32_16x16x32_bf16 v[140:143], v[60:63], v[36:39], v[140:143]
    v_exp_f32 v244, v244
    v_mfma_f32_16x16x32_bf16 v[136:139], v[56:59], v[16:19], v[136:139]
    ds_read_b64_tr_b16 v[56:57], v10 offset:35840
    v_mfma_f32_16x16x32_bf16 v[136:139], v[60:63], v[32:35], v[136:139]
    ds_read_b64_tr_b16 v[58:59], v11 offset:35840
    s_waitcnt lgkmcnt(2)
    v_mfma_f32_16x16x32_bf16 v[160:163], v[48:51], v[16:19], v[160:163]
    ds_read_b64_tr_b16 v[60:61], v10 offset:44032
    v_mfma_f32_16x16x32_bf16 v[160:163], v[52:55], v[32:35], v[160:163]
    ds_read_b64_tr_b16 v[62:63], v11 offset:44032
    v_mfma_f32_16x16x32_bf16 v[164:167], v[48:51], v[20:23], v[164:167]
    v_exp_f32 v245, v245
    v_mfma_f32_16x16x32_bf16 v[164:167], v[52:55], v[36:39], v[164:167]
    v_fma_f32 v244, v244, v223, v223
    v_fma_f32 v245, v245, v223, v223
    v_mfma_f32_16x16x32_bf16 v[176:179], v[48:51], v[24:27], v[176:179]
    v_rcp_f32 v244, v244
    v_mfma_f32_16x16x32_bf16 v[176:179], v[52:55], v[40:43], v[176:179]
    v_rcp_f32 v245, v245
    v_mfma_f32_16x16x32_bf16 v[180:183], v[48:51], v[28:31], v[180:183]
    v_mul_f32 v124, v244, v124
    v_mfma_f32_16x16x32_bf16 v[180:183], v[52:55], v[44:47], v[180:183]
    s_waitcnt lgkmcnt(0)
    s_barrier
    ds_read_b64_tr_b16 v[48:49], v10 offset:49152
    ds_read_b64_tr_b16 v[50:51], v11 offset:49152
    v_mfma_f32_16x16x32_bf16 v[168:171], v[56:59], v[16:19], v[168:171]
    ds_read_b64_tr_b16 v[52:53], v10 offset:57344
    ds_read_b64_tr_b16 v[54:55], v11 offset:57344
    v_mfma_f32_16x16x32_bf16 v[168:171], v[60:63], v[32:35], v[168:171]
    ds_read_b128 v[16:19], v8 offset:49152
    v_mul_f32 v125, v245, v125
    v_mfma_f32_16x16x32_bf16 v[172:175], v[56:59], v[20:23], v[172:175]
    ds_read_b128 v[32:35], v9 offset:49152
    v_mfma_f32_16x16x32_bf16 v[172:175], v[60:63], v[36:39], v[172:175]
    ds_read_b128 v[20:23], v8 offset:51200
    v_mfma_f32_16x16x32_bf16 v[184:187], v[56:59], v[24:27], v[184:187]
    ds_read_b128 v[36:39], v9 offset:51200
    v_mfma_f32_16x16x32_bf16 v[184:187], v[60:63], v[40:43], v[184:187]
    ds_read_b128 v[24:27], v8 offset:53248
    v_mfma_f32_16x16x32_bf16 v[188:191], v[56:59], v[28:31], v[188:191]
    ds_read_b128 v[40:43], v9 offset:53248
    v_mfma_f32_16x16x32_bf16 v[188:191], v[60:63], v[44:47], v[188:191]
    ds_read_b128 v[28:31], v8 offset:55296
    s_waitcnt lgkmcnt(5)
    v_mfma_f32_16x16x32_bf16 v[128:131], v[48:51], v[16:19], v[128:131]
    ds_read_b128 v[44:47], v9 offset:55296
    v_fmac_f32 v126, v206, v220
    v_mfma_f32_16x16x32_bf16 v[128:131], v[52:55], v[32:35], v[128:131]
    ds_read_b64_tr_b16 v[56:57], v10 offset:50176
    s_waitcnt lgkmcnt(5)
    v_mfma_f32_16x16x32_bf16 v[132:135], v[48:51], v[20:23], v[132:135]
    ds_read_b64_tr_b16 v[58:59], v11 offset:50176
    v_fmac_f32 v127, v207, v220
    v_mfma_f32_16x16x32_bf16 v[132:135], v[52:55], v[36:39], v[132:135]
    ds_read_b64_tr_b16 v[60:61], v10 offset:58368
    s_waitcnt lgkmcnt(5)
    v_mfma_f32_16x16x32_bf16 v[144:147], v[48:51], v[24:27], v[144:147]
    ds_read_b64_tr_b16 v[62:63], v11 offset:58368
    v_mul_f32 v244, v126, v126
    v_mfma_f32_16x16x32_bf16 v[144:147], v[52:55], v[40:43], v[144:147]
    s_waitcnt lgkmcnt(4)
    v_mfma_f32_16x16x32_bf16 v[148:151], v[48:51], v[28:31], v[148:151]
    ds_read_b64_tr_b16 v[48:49], v10 offset:51200
    v_mul_f32 v245, v127, v127
    v_mfma_f32_16x16x32_bf16 v[148:151], v[52:55], v[44:47], v[148:151]
    ds_read_b64_tr_b16 v[50:51], v11 offset:51200
    s_waitcnt lgkmcnt(4)
    v_mfma_f32_16x16x32_bf16 v[156:159], v[56:59], v[28:31], v[156:159]
    ds_read_b64_tr_b16 v[52:53], v10 offset:59392
    s_waitcnt lgkmcnt(3)
    v_mfma_f32_16x16x32_bf16 v[156:159], v[60:63], v[44:47], v[156:159]
    ds_read_b64_tr_b16 v[54:55], v11 offset:59392
    v_fma_f32 v244, v244, v222, v221
    v_mfma_f32_16x16x32_bf16 v[152:155], v[56:59], v[24:27], v[152:155]
    v_fma_f32 v245, v245, v222, v221
    v_mfma_f32_16x16x32_bf16 v[152:155], v[60:63], v[40:43], v[152:155]
    v_mul_f32 v244, v244, v126
    v_mfma_f32_16x16x32_bf16 v[140:143], v[56:59], v[20:23], v[140:143]
    v_mul_f32 v245, v245, v127
    v_mfma_f32_16x16x32_bf16 v[140:143], v[60:63], v[36:39], v[140:143]
    v_exp_f32 v244, v244
    v_mfma_f32_16x16x32_bf16 v[136:139], v[56:59], v[16:19], v[136:139]
    ds_read_b64_tr_b16 v[56:57], v10 offset:52224
    v_mfma_f32_16x16x32_bf16 v[136:139], v[60:63], v[32:35], v[136:139]
    ds_read_b64_tr_b16 v[58:59], v11 offset:52224
    s_waitcnt lgkmcnt(2)
    v_mfma_f32_16x16x32_bf16 v[160:163], v[48:51], v[16:19], v[160:163]
    ds_read_b64_tr_b16 v[60:61], v10 offset:60416
    v_mfma_f32_16x16x32_bf16 v[160:163], v[52:55], v[32:35], v[160:163]
    ds_read_b64_tr_b16 v[62:63], v11 offset:60416
    v_mfma_f32_16x16x32_bf16 v[164:167], v[48:51], v[20:23], v[164:167]
    v_exp_f32 v245, v245
    v_mfma_f32_16x16x32_bf16 v[164:167], v[52:55], v[36:39], v[164:167]
    v_fma_f32 v244, v244, v223, v223
    v_fma_f32 v245, v245, v223, v223
    v_mfma_f32_16x16x32_bf16 v[176:179], v[48:51], v[24:27], v[176:179]
    v_rcp_f32 v244, v244
    v_mfma_f32_16x16x32_bf16 v[176:179], v[52:55], v[40:43], v[176:179]
    v_rcp_f32 v245, v245
    v_mfma_f32_16x16x32_bf16 v[180:183], v[48:51], v[28:31], v[180:183]
    v_mul_f32 v126, v244, v126
    v_mfma_f32_16x16x32_bf16 v[180:183], v[52:55], v[44:47], v[180:183]
    s_waitcnt lgkmcnt(0)
    s_barrier
    ds_read_b64_tr_b16 v[48:49], v10 offset:0
    ds_read_b64_tr_b16 v[50:51], v11 offset:0
    v_mfma_f32_16x16x32_bf16 v[168:171], v[56:59], v[16:19], v[168:171]
    ds_read_b64_tr_b16 v[52:53], v10 offset:8192
    ds_read_b64_tr_b16 v[54:55], v11 offset:8192
    v_mfma_f32_16x16x32_bf16 v[168:171], v[60:63], v[32:35], v[168:171]
    ds_read_b128 v[16:19], v8 offset:0
    v_mul_f32 v127, v245, v127
    v_mfma_f32_16x16x32_bf16 v[172:175], v[56:59], v[20:23], v[172:175]
    ds_read_b128 v[32:35], v9 offset:0
    v_mfma_f32_16x16x32_bf16 v[172:175], v[60:63], v[36:39], v[172:175]
    ds_read_b128 v[20:23], v8 offset:2048
    v_mfma_f32_16x16x32_bf16 v[184:187], v[56:59], v[24:27], v[184:187]
    ds_read_b128 v[36:39], v9 offset:2048
    v_mfma_f32_16x16x32_bf16 v[184:187], v[60:63], v[40:43], v[184:187]
    ds_read_b128 v[24:27], v8 offset:4096
    v_mfma_f32_16x16x32_bf16 v[188:191], v[56:59], v[28:31], v[188:191]
    ds_read_b128 v[40:43], v9 offset:4096
    v_mfma_f32_16x16x32_bf16 v[188:191], v[60:63], v[44:47], v[188:191]
    ds_read_b128 v[28:31], v8 offset:6144
    s_waitcnt lgkmcnt(5)
    v_mfma_f32_16x16x32_bf16 v[128:131], v[48:51], v[16:19], v[128:131]
    ds_read_b128 v[44:47], v9 offset:6144
    v_fmac_f32 v120, v204, v216
    v_mfma_f32_16x16x32_bf16 v[128:131], v[52:55], v[32:35], v[128:131]
    ds_read_b64_tr_b16 v[56:57], v10 offset:1024
    s_waitcnt lgkmcnt(5)
    v_mfma_f32_16x16x32_bf16 v[132:135], v[48:51], v[20:23], v[132:135]
    ds_read_b64_tr_b16 v[58:59], v11 offset:1024
    v_fmac_f32 v121, v205, v216
    v_mfma_f32_16x16x32_bf16 v[132:135], v[52:55], v[36:39], v[132:135]
    ds_read_b64_tr_b16 v[60:61], v10 offset:9216
    s_waitcnt lgkmcnt(5)
    v_mfma_f32_16x16x32_bf16 v[144:147], v[48:51], v[24:27], v[144:147]
    ds_read_b64_tr_b16 v[62:63], v11 offset:9216
    v_mul_f32 v244, v120, v120
    v_mfma_f32_16x16x32_bf16 v[144:147], v[52:55], v[40:43], v[144:147]
    s_waitcnt lgkmcnt(4)
    v_mfma_f32_16x16x32_bf16 v[148:151], v[48:51], v[28:31], v[148:151]
    ds_read_b64_tr_b16 v[48:49], v10 offset:2048
    v_mul_f32 v245, v121, v121
    v_mfma_f32_16x16x32_bf16 v[148:151], v[52:55], v[44:47], v[148:151]
    ds_read_b64_tr_b16 v[50:51], v11 offset:2048
    s_waitcnt lgkmcnt(4)
    v_mfma_f32_16x16x32_bf16 v[156:159], v[56:59], v[28:31], v[156:159]
    ds_read_b64_tr_b16 v[52:53], v10 offset:10240
    s_waitcnt lgkmcnt(3)
    v_mfma_f32_16x16x32_bf16 v[156:159], v[60:63], v[44:47], v[156:159]
    ds_read_b64_tr_b16 v[54:55], v11 offset:10240
    v_fma_f32 v244, v244, v218, v217
    v_mfma_f32_16x16x32_bf16 v[152:155], v[56:59], v[24:27], v[152:155]
    v_fma_f32 v245, v245, v218, v217
    v_mfma_f32_16x16x32_bf16 v[152:155], v[60:63], v[40:43], v[152:155]
    v_mul_f32 v244, v244, v120
    v_mfma_f32_16x16x32_bf16 v[140:143], v[56:59], v[20:23], v[140:143]
    v_mul_f32 v245, v245, v121
    v_mfma_f32_16x16x32_bf16 v[140:143], v[60:63], v[36:39], v[140:143]
    v_exp_f32 v244, v244
    v_mfma_f32_16x16x32_bf16 v[136:139], v[56:59], v[16:19], v[136:139]
    ds_read_b64_tr_b16 v[56:57], v10 offset:3072
    v_mfma_f32_16x16x32_bf16 v[136:139], v[60:63], v[32:35], v[136:139]
    ds_read_b64_tr_b16 v[58:59], v11 offset:3072
    s_waitcnt lgkmcnt(2)
    v_mfma_f32_16x16x32_bf16 v[160:163], v[48:51], v[16:19], v[160:163]
    ds_read_b64_tr_b16 v[60:61], v10 offset:11264
    v_mfma_f32_16x16x32_bf16 v[160:163], v[52:55], v[32:35], v[160:163]
    ds_read_b64_tr_b16 v[62:63], v11 offset:11264
    v_mfma_f32_16x16x32_bf16 v[164:167], v[48:51], v[20:23], v[164:167]
    v_exp_f32 v245, v245
    v_mfma_f32_16x16x32_bf16 v[164:167], v[52:55], v[36:39], v[164:167]
    v_fma_f32 v244, v244, v219, v219
    v_fma_f32 v245, v245, v219, v219
    v_mfma_f32_16x16x32_bf16 v[176:179], v[48:51], v[24:27], v[176:179]
    v_rcp_f32 v244, v244
    v_mfma_f32_16x16x32_bf16 v[176:179], v[52:55], v[40:43], v[176:179]
    v_rcp_f32 v245, v245
    v_mfma_f32_16x16x32_bf16 v[180:183], v[48:51], v[28:31], v[180:183]
    v_mul_f32 v120, v244, v120
    v_mfma_f32_16x16x32_bf16 v[180:183], v[52:55], v[44:47], v[180:183]
    s_waitcnt lgkmcnt(0)
    s_barrier
    ds_read_b64_tr_b16 v[48:49], v10 offset:16384
    ds_read_b64_tr_b16 v[50:51], v11 offset:16384
    v_mfma_f32_16x16x32_bf16 v[168:171], v[56:59], v[16:19], v[168:171]
    ds_read_b64_tr_b16 v[52:53], v10 offset:24576
    ds_read_b64_tr_b16 v[54:55], v11 offset:24576
    v_mfma_f32_16x16x32_bf16 v[168:171], v[60:63], v[32:35], v[168:171]
    ds_read_b128 v[16:19], v8 offset:16384
    v_mul_f32 v121, v245, v121
    v_mfma_f32_16x16x32_bf16 v[172:175], v[56:59], v[20:23], v[172:175]
    ds_read_b128 v[32:35], v9 offset:16384
    v_mfma_f32_16x16x32_bf16 v[172:175], v[60:63], v[36:39], v[172:175]
    ds_read_b128 v[20:23], v8 offset:18432
    v_mfma_f32_16x16x32_bf16 v[184:187], v[56:59], v[24:27], v[184:187]
    ds_read_b128 v[36:39], v9 offset:18432
    v_mfma_f32_16x16x32_bf16 v[184:187], v[60:63], v[40:43], v[184:187]
    ds_read_b128 v[24:27], v8 offset:20480
    v_mfma_f32_16x16x32_bf16 v[188:191], v[56:59], v[28:31], v[188:191]
    ds_read_b128 v[40:43], v9 offset:20480
    v_mfma_f32_16x16x32_bf16 v[188:191], v[60:63], v[44:47], v[188:191]
    ds_read_b128 v[28:31], v8 offset:22528
    s_waitcnt lgkmcnt(5)
    v_mfma_f32_16x16x32_bf16 v[128:131], v[48:51], v[16:19], v[128:131]
    ds_read_b128 v[44:47], v9 offset:22528
    v_fmac_f32 v122, v206, v216
    v_mfma_f32_16x16x32_bf16 v[128:131], v[52:55], v[32:35], v[128:131]
    ds_read_b64_tr_b16 v[56:57], v10 offset:17408
    s_waitcnt lgkmcnt(5)
    v_mfma_f32_16x16x32_bf16 v[132:135], v[48:51], v[20:23], v[132:135]
    ds_read_b64_tr_b16 v[58:59], v11 offset:17408
    v_fmac_f32 v123, v207, v216
    v_mfma_f32_16x16x32_bf16 v[132:135], v[52:55], v[36:39], v[132:135]
    ds_read_b64_tr_b16 v[60:61], v10 offset:25600
    s_waitcnt lgkmcnt(5)
    v_mfma_f32_16x16x32_bf16 v[144:147], v[48:51], v[24:27], v[144:147]
    ds_read_b64_tr_b16 v[62:63], v11 offset:25600
    v_mul_f32 v244, v122, v122
    v_mfma_f32_16x16x32_bf16 v[144:147], v[52:55], v[40:43], v[144:147]
    s_waitcnt lgkmcnt(4)
    v_mfma_f32_16x16x32_bf16 v[148:151], v[48:51], v[28:31], v[148:151]
    ds_read_b64_tr_b16 v[48:49], v10 offset:18432
    v_mul_f32 v245, v123, v123
    v_mfma_f32_16x16x32_bf16 v[148:151], v[52:55], v[44:47], v[148:151]
    ds_read_b64_tr_b16 v[50:51], v11 offset:18432
    s_waitcnt lgkmcnt(4)
    v_mfma_f32_16x16x32_bf16 v[156:159], v[56:59], v[28:31], v[156:159]
    ds_read_b64_tr_b16 v[52:53], v10 offset:26624
    s_waitcnt lgkmcnt(3)
    v_mfma_f32_16x16x32_bf16 v[156:159], v[60:63], v[44:47], v[156:159]
    ds_read_b64_tr_b16 v[54:55], v11 offset:26624
    v_fma_f32 v244, v244, v218, v217
    v_mfma_f32_16x16x32_bf16 v[152:155], v[56:59], v[24:27], v[152:155]
    v_fma_f32 v245, v245, v218, v217
    v_mfma_f32_16x16x32_bf16 v[152:155], v[60:63], v[40:43], v[152:155]
    v_mul_f32 v244, v244, v122
    v_mfma_f32_16x16x32_bf16 v[140:143], v[56:59], v[20:23], v[140:143]
    v_mul_f32 v245, v245, v123
    v_mfma_f32_16x16x32_bf16 v[140:143], v[60:63], v[36:39], v[140:143]
    v_exp_f32 v244, v244
    v_mfma_f32_16x16x32_bf16 v[136:139], v[56:59], v[16:19], v[136:139]
    ds_read_b64_tr_b16 v[56:57], v10 offset:19456
    v_mfma_f32_16x16x32_bf16 v[136:139], v[60:63], v[32:35], v[136:139]
    ds_read_b64_tr_b16 v[58:59], v11 offset:19456
    s_waitcnt lgkmcnt(2)
    v_mfma_f32_16x16x32_bf16 v[160:163], v[48:51], v[16:19], v[160:163]
    ds_read_b64_tr_b16 v[60:61], v10 offset:27648
    v_mfma_f32_16x16x32_bf16 v[160:163], v[52:55], v[32:35], v[160:163]
    ds_read_b64_tr_b16 v[62:63], v11 offset:27648
    v_mfma_f32_16x16x32_bf16 v[164:167], v[48:51], v[20:23], v[164:167]
    v_exp_f32 v245, v245
    v_mfma_f32_16x16x32_bf16 v[164:167], v[52:55], v[36:39], v[164:167]
    v_fma_f32 v244, v244, v219, v219
    v_fma_f32 v245, v245, v219, v219
    v_mfma_f32_16x16x32_bf16 v[176:179], v[48:51], v[24:27], v[176:179]
    v_rcp_f32 v244, v244
    v_mfma_f32_16x16x32_bf16 v[176:179], v[52:55], v[40:43], v[176:179]
    v_rcp_f32 v245, v245
    v_mfma_f32_16x16x32_bf16 v[180:183], v[48:51], v[28:31], v[180:183]
    v_mul_f32 v122, v244, v122
    v_mfma_f32_16x16x32_bf16 v[180:183], v[52:55], v[44:47], v[180:183]
    s_waitcnt lgkmcnt(0)
    s_barrier
    ds_read_b64_tr_b16 v[48:49], v10 offset:32768
    ds_read_b64_tr_b16 v[50:51], v11 offset:32768
    v_mfma_f32_16x16x32_bf16 v[168:171], v[56:59], v[16:19], v[168:171]
    ds_read_b64_tr_b16 v[52:53], v10 offset:40960
    ds_read_b64_tr_b16 v[54:55], v11 offset:40960
    v_mfma_f32_16x16x32_bf16 v[168:171], v[60:63], v[32:35], v[168:171]
    ds_read_b128 v[16:19], v8 offset:32768
    v_mul_f32 v123, v245, v123
    v_mfma_f32_16x16x32_bf16 v[172:175], v[56:59], v[20:23], v[172:175]
    ds_read_b128 v[32:35], v9 offset:32768
    v_mfma_f32_16x16x32_bf16 v[172:175], v[60:63], v[36:39], v[172:175]
    ds_read_b128 v[20:23], v8 offset:34816
    v_mfma_f32_16x16x32_bf16 v[184:187], v[56:59], v[24:27], v[184:187]
    ds_read_b128 v[36:39], v9 offset:34816
    v_mfma_f32_16x16x32_bf16 v[184:187], v[60:63], v[40:43], v[184:187]
    ds_read_b128 v[24:27], v8 offset:36864
    v_mfma_f32_16x16x32_bf16 v[188:191], v[56:59], v[28:31], v[188:191]
    ds_read_b128 v[40:43], v9 offset:36864
    v_mfma_f32_16x16x32_bf16 v[188:191], v[60:63], v[44:47], v[188:191]
    ds_read_b128 v[28:31], v8 offset:38912
    s_waitcnt lgkmcnt(5)
    v_mfma_f32_16x16x32_bf16 v[128:131], v[48:51], v[16:19], v[128:131]
    ds_read_b128 v[44:47], v9 offset:38912
L_pad18:
    s_cbranch_execz L_padr18
    v_fmac_f32 v108, v204, v212
    v_mfma_f32_16x16x32_bf16 v[128:131], v[52:55], v[32:35], v[128:131]
    ds_read_b64_tr_b16 v[56:57], v10 offset:33792
    s_waitcnt lgkmcnt(5)
    v_mfma_f32_16x16x32_bf16 v[132:135], v[48:51], v[20:23], v[132:135]
    ds_read_b64_tr_b16 v[58:59], v11 offset:33792
    v_fmac_f32 v109, v205, v212
    v_mfma_f32_16x16x32_bf16 v[132:135], v[52:55], v[36:39], v[132:135]
    ds_read_b64_tr_b16 v[60:61], v10 offset:41984
    s_waitcnt lgkmcnt(5)
    v_mfma_f32_16x16x32_bf16 v[144:147], v[48:51], v[24:27], v[144:147]
    ds_read_b64_tr_b16 v[62:63], v11 offset:41984
    v_mul_f32 v244, v108, v108
    v_mfma_f32_16x16x32_bf16 v[144:147], v[52:55], v[40:43], v[144:147]
    s_waitcnt lgkmcnt(4)
    v_mfma_f32_16x16x32_bf16 v[148:151], v[48:51], v[28:31], v[148:151]
    ds_read_b64_tr_b16 v[48:49], v10 offset:34816
    v_mul_f32 v245, v109, v109
    v_mfma_f32_16x16x32_bf16 v[148:151], v[52:55], v[44:47], v[148:151]
    ds_read_b64_tr_b16 v[50:51], v11 offset:34816
    s_waitcnt lgkmcnt(4)
    v_mfma_f32_16x16x32_bf16 v[156:159], v[56:59], v[28:31], v[156:159]
    ds_read_b64_tr_b16 v[52:53], v10 offset:43008
    s_waitcnt lgkmcnt(3)
    v_mfma_f32_16x16x32_bf16 v[156:159], v[60:63], v[44:47], v[156:159]
    ds_read_b64_tr_b16 v[54:55], v11 offset:43008
    v_fma_f32 v244, v244, v214, v213
    v_mfma_f32_16x16x32_bf16 v[152:155], v[56:59], v[24:27], v[152:155]
    v_fma_f32 v245, v245, v214, v213
    v_mfma_f32_16x16x32_bf16 v[152:155], v[60:63], v[40:43], v[152:155]
    v_mul_f32 v244, v244, v108
    v_mfma_f32_16x16x32_bf16 v[140:143], v[56:59], v[20:23], v[140:143]
    v_mul_f32 v245, v245, v109
    v_mfma_f32_16x16x32_bf16 v[140:143], v[60:63], v[36:39], v[140:143]
    v_exp_f32 v244, v244
    v_mfma_f32_16x16x32_bf16 v[136:139], v[56:59], v[16:19], v[136:139]
    ds_read_b64_tr_b16 v[56:57], v10 offset:35840
    v_mfma_f32_16x16x32_bf16 v[136:139], v[60:63], v[32:35], v[136:139]
    ds_read_b64_tr_b16 v[58:59], v11 offset:35840
    s_waitcnt lgkmcnt(2)
    v_mfma_f32_16x16x32_bf16 v[160:163], v[48:51], v[16:19], v[160:163]
    ds_read_b64_tr_b16 v[60:61], v10 offset:44032
    v_mfma_f32_16x16x32_bf16 v[160:163], v[52:55], v[32:35], v[160:163]
    ds_read_b64_tr_b16 v[62:63], v11 offset:44032
    v_mfma_f32_16x16x32_bf16 v[164:167], v[48:51], v[20:23], v[164:167]
    v_exp_f32 v245, v245
    v_mfma_f32_16x16x32_bf16 v[164:167], v[52:55], v[36:39], v[164:167]
    v_fma_f32 v244, v244, v215, v215
    v_fma_f32 v245, v245, v215, v215
    v_mfma_f32_16x16x32_bf16 v[176:179], v[48:51], v[24:27], v[176:179]
    v_rcp_f32 v244, v244
    v_mfma_f32_16x16x32_bf16 v[176:179], v[52:55], v[40:43], v[176:179]
    v_rcp_f32 v245, v245
    v_mfma_f32_16x16x32_bf16 v[180:183], v[48:51], v[28:31], v[180:183]
    v_mul_f32 v108, v244, v108
    v_mfma_f32_16x16x32_bf16 v[180:183], v[52:55], v[44:47], v[180:183]
    s_waitcnt lgkmcnt(0)
    s_barrier
    ds_read_b64_tr_b16 v[48:49], v10 offset:49152
    ds_read_b64_tr_b16 v[50:51], v11 offset:49152
    v_mfma_f32_16x16x32_bf16 v[168:171], v[56:59], v[16:19], v[168:171]
    ds_read_b64_tr_b16 v[52:53], v10 offset:57344
    ds_read_b64_tr_b16 v[54:55], v11 offset:57344
    v_mfma_f32_16x16x32_bf16 v[168:171], v[60:63], v[32:35], v[168:171]
    ds_read_b128 v[16:19], v8 offset:49152
    v_mul_f32 v109, v245, v109
    v_mfma_f32_16x16x32_bf16 v[172:175], v[56:59], v[20:23], v[172:175]
    ds_read_b128 v[32:35], v9 offset:49152
    v_mfma_f32_16x16x32_bf16 v[172:175], v[60:63], v[36:39], v[172:175]
    ds_read_b128 v[20:23], v8 offset:51200
    v_mfma_f32_16x16x32_bf16 v[184:187], v[56:59], v[24:27], v[184:187]
    ds_read_b128 v[36:39], v9 offset:51200
    v_mfma_f32_16x16x32_bf16 v[184:187], v[60:63], v[40:43], v[184:187]
    ds_read_b128 v[24:27], v8 offset:53248
    v_mfma_f32_16x16x32_bf16 v[188:191], v[56:59], v[28:31], v[188:191]
    ds_read_b128 v[40:43], v9 offset:53248
    v_mfma_f32_16x16x32_bf16 v[188:191], v[60:63], v[44:47], v[188:191]
    ds_read_b128 v[28:31], v8 offset:55296
    s_waitcnt lgkmcnt(5)
    v_mfma_f32_16x16x32_bf16 v[128:131], v[48:51], v[16:19], v[128:131]
    ds_read_b128 v[44:47], v9 offset:55296
    v_fmac_f32 v110, v206, v212
    v_mfma_f32_16x16x32_bf16 v[128:131], v[52:55], v[32:35], v[128:131]
    ds_read_b64_tr_b16 v[56:57], v10 offset:50176
    s_waitcnt lgkmcnt(5)
    v_mfma_f32_16x16x32_bf16 v[132:135], v[48:51], v[20:23], v[132:135]
    ds_read_b64_tr_b16 v[58:59], v11 offset:50176
    v_fmac_f32 v111, v207, v212
    v_mfma_f32_16x16x32_bf16 v[132:135], v[52:55], v[36:39], v[132:135]
    ds_read_b64_tr_b16 v[60:61], v10 offset:58368
    s_waitcnt lgkmcnt(5)
    v_mfma_f32_16x16x32_bf16 v[144:147], v[48:51], v[24:27], v[144:147]
    ds_read_b64_tr_b16 v[62:63], v11 offset:58368
    v_mul_f32 v244, v110, v110
    v_mfma_f32_16x16x32_bf16 v[144:147], v[52:55], v[40:43], v[144:147]
    s_waitcnt lgkmcnt(4)
    v_mfma_f32_16x16x32_bf16 v[148:151], v[48:51], v[28:31], v[148:151]
    ds_read_b64_tr_b16 v[48:49], v10 offset:51200
    v_mul_f32 v245, v111, v111
    v_mfma_f32_16x16x32_bf16 v[148:151], v[52:55], v[44:47], v[148:151]
    ds_read_b64_tr_b16 v[50:51], v11 offset:51200
    s_waitcnt lgkmcnt(4)
    v_mfma_f32_16x16x32_bf16 v[156:159], v[56:59], v[28:31], v[156:159]
    ds_read_b64_tr_b16 v[52:53], v10 offset:59392
    s_waitcnt lgkmcnt(3)
    v_mfma_f32_16x16x32_bf16 v[156:159], v[60:63], v[44:47], v[156:159]
    ds_read_b64_tr_b16 v[54:55], v11 offset:59392
    v_fma_f32 v244, v244, v214, v213
    v_mfma_f32_16x16x32_bf16 v[152:155], v[56:59], v[24:27], v[152:155]
    v_fma_f32 v245, v245, v214, v213
    v_mfma_f32_16x16x32_bf16 v[152:155], v[60:63], v[40:43], v[152:155]
    v_mul_f32 v244, v244, v110
    v_mfma_f32_16x16x32_bf16 v[140:143], v[56:59], v[20:23], v[140:143]
    v_mul_f32 v245, v245, v111
    v_mfma_f32_16x16x32_bf16 v[140:143], v[60:63], v[36:39], v[140:143]
    v_exp_f32 v244, v244
    v_mfma_f32_16x16x32_bf16 v[136:139], v[56:59], v[16:19], v[136:139]
    ds_read_b64_tr_b16 v[56:57], v10 offset:52224
    v_mfma_f32_16x16x32_bf16 v[136:139], v[60:63], v[32:35], v[136:139]
    ds_read_b64_tr_b16 v[58:59], v11 offset:52224
    s_waitcnt lgkmcnt(2)
    v_mfma_f32_16x16x32_bf16 v[160:163], v[48:51], v[16:19], v[160:163]
    ds_read_b64_tr_b16 v[60:61], v10 offset:60416
    v_mfma_f32_16x16x32_bf16 v[160:163], v[52:55], v[32:35], v[160:163]
    ds_read_b64_tr_b16 v[62:63], v11 offset:60416
    v_mfma_f32_16x16x32_bf16 v[164:167], v[48:51], v[20:23], v[164:167]
    v_exp_f32 v245, v245
    v_mfma_f32_16x16x32_bf16 v[164:167], v[52:55], v[36:39], v[164:167]
    v_fma_f32 v244, v244, v215, v215
    v_fma_f32 v245, v245, v215, v215
    v_mfma_f32_16x16x32_bf16 v[176:179], v[48:51], v[24:27], v[176:179]
    v_rcp_f32 v244, v244
    v_mfma_f32_16x16x32_bf16 v[176:179], v[52:55], v[40:43], v[176:179]
    v_rcp_f32 v245, v245
    v_mfma_f32_16x16x32_bf16 v[180:183], v[48:51], v[28:31], v[180:183]
    v_mul_f32 v110, v244, v110
    v_mfma_f32_16x16x32_bf16 v[180:183], v[52:55], v[44:47], v[180:183]
    s_waitcnt lgkmcnt(0)
    s_barrier
    ds_read_b64_tr_b16 v[48:49], v10 offset:0
    ds_read_b64_tr_b16 v[50:51], v11 offset:0
    v_mfma_f32_16x16x32_bf16 v[168:171], v[56:59], v[16:19], v[168:171]
    ds_read_b64_tr_b16 v[52:53], v10 offset:8192
    ds_read_b64_tr_b16 v[54:55], v11 offset:8192
    v_mfma_f32_16x16x32_bf16 v[168:171], v[60:63], v[32:35], v[168:171]
    ds_read_b128 v[16:19], v8 offset:0
    v_mul_f32 v111, v245, v111
    v_mfma_f32_16x16x32_bf16 v[172:175], v[56:59], v[20:23], v[172:175]
    ds_read_b128 v[32:35], v9 offset:0
    v_mfma_f32_16x16x32_bf16 v[172:175], v[60:63], v[36:39], v[172:175]
    ds_read_b128 v[20:23], v8 offset:2048
    v_mfma_f32_16x16x32_bf16 v[184:187], v[56:59], v[24:27], v[184:187]
    ds_read_b128 v[36:39], v9 offset:2048
    v_mfma_f32_16x16x32_bf16 v[184:187], v[60:63], v[40:43], v[184:187]
    ds_read_b128 v[24:27], v8 offset:4096
    v_mfma_f32_16x16x32_bf16 v[188:191], v[56:59], v[28:31], v[188:191]
    ds_read_b128 v[40:43], v9 offset:4096
    v_mfma_f32_16x16x32_bf16 v[188:191], v[60:63], v[44:47], v[188:191]
    ds_read_b128 v[28:31], v8 offset:6144
    s_waitcnt lgkmcnt(5)
    v_mfma_f32_16x16x32_bf16 v[128:131], v[48:51], v[16:19], v[128:131]
    ds_read_b128 v[44:47], v9 offset:6144
    v_fmac_f32 v104, v204, v208
    v_mfma_f32_16x16x32_bf16 v[128:131], v[52:55], v[32:35], v[128:131]
    ds_read_b64_tr_b16 v[56:57], v10 offset:1024
    s_waitcnt lgkmcnt(5)
    v_mfma_f32_16x16x32_bf16 v[132:135], v[48:51], v[20:23], v[132:135]
    ds_read_b64_tr_b16 v[58:59], v11 offset:1024
    v_fmac_f32 v105, v205, v208
    v_mfma_f32_16x16x32_bf16 v[132:135], v[52:55], v[36:39], v[132:135]
    ds_read_b64_tr_b16 v[60:61], v10 offset:9216
    s_waitcnt lgkmcnt(5)
    v_mfma_f32_16x16x32_bf16 v[144:147], v[48:51], v[24:27], v[144:147]
    ds_read_b64_tr_b16 v[62:63], v11 offset:9216
    v_mul_f32 v244, v104, v104
    v_mfma_f32_16x16x32_bf16 v[144:147], v[52:55], v[40:43], v[144:147]
    s_waitcnt lgkmcnt(4)
    v_mfma_f32_16x16x32_bf16 v[148:151], v[48:51], v[28:31], v[148:151]
    ds_read_b64_tr_b16 v[48:49], v10 offset:2048
    v_mul_f32 v245, v105, v105
    v_mfma_f32_16x16x32_bf16 v[148:151], v[52:55], v[44:47], v[148:151]
    ds_read_b64_tr_b16 v[50:51], v11 offset:2048
    s_waitcnt lgkmcnt(4)
    v_mfma_f32_16x16x32_bf16 v[156:159], v[56:59], v[28:31], v[156:159]
    ds_read_b64_tr_b16 v[52:53], v10 offset:10240
    s_waitcnt lgkmcnt(3)
    v_mfma_f32_16x16x32_bf16 v[156:159], v[60:63], v[44:47], v[156:159]
    ds_read_b64_tr_b16 v[54:55], v11 offset:10240
    v_fma_f32 v244, v244, v210, v209
    v_mfma_f32_16x16x32_bf16 v[152:155], v[56:59], v[24:27], v[152:155]
    v_fma_f32 v245, v245, v210, v209
    v_mfma_f32_16x16x32_bf16 v[152:155], v[60:63], v[40:43], v[152:155]
    v_mul_f32 v244, v244, v104
    v_mfma_f32_16x16x32_bf16 v[140:143], v[56:59], v[20:23], v[140:143]
    v_mul_f32 v245, v245, v105
    v_mfma_f32_16x16x32_bf16 v[140:143], v[60:63], v[36:39], v[140:143]
    v_exp_f32 v244, v244
    v_mfma_f32_16x16x32_bf16 v[136:139], v[56:59], v[16:19], v[136:139]
    ds_read_b64_tr_b16 v[56:57], v10 offset:3072
    v_mfma_f32_16x16x32_bf16 v[136:139], v[60:63], v[32:35], v[136:139]
    ds_read_b64_tr_b16 v[58:59], v11 offset:3072
    s_waitcnt lgkmcnt(2)
    v_mfma_f32_16x16x32_bf16 v[160:163], v[48:51], v[16:19], v[160:163]
    ds_read_b64_tr_b16 v[60:61], v10 offset:11264
    v_mfma_f32_16x16x32_bf16 v[160:163], v[52:55], v[32:35], v[160:163]
    ds_read_b64_tr_b16 v[62:63], v11 offset:11264
    v_mfma_f32_16x16x32_bf16 v[164:167], v[48:51], v[20:23], v[164:167]
    v_exp_f32 v245, v245
    v_mfma_f32_16x16x32_bf16 v[164:167], v[52:55], v[36:39], v[164:167]
    v_fma_f32 v244, v244, v211, v211
    v_fma_f32 v245, v245, v211, v211
    v_mfma_f32_16x16x32_bf16 v[176:179], v[48:51], v[24:27], v[176:179]
    v_rcp_f32 v244, v244
    v_mfma_f32_16x16x32_bf16 v[176:179], v[52:55], v[40:43], v[176:179]
    v_rcp_f32 v245, v245
    v_mfma_f32_16x16x32_bf16 v[180:183], v[48:51], v[28:31], v[180:183]
    v_mul_f32 v104, v244, v104
    v_mfma_f32_16x16x32_bf16 v[180:183], v[52:55], v[44:47], v[180:183]
    s_waitcnt lgkmcnt(0)
    s_barrier
    ds_read_b64_tr_b16 v[48:49], v10 offset:16384
    ds_read_b64_tr_b16 v[50:51], v11 offset:16384
    v_mfma_f32_16x16x32_bf16 v[168:171], v[56:59], v[16:19], v[168:171]
    ds_read_b64_tr_b16 v[52:53], v10 offset:24576
    ds_read_b64_tr_b16 v[54:55], v11 offset:24576
    v_mfma_f32_16x16x32_bf16 v[168:171], v[60:63], v[32:35], v[168:171]
    ds_read_b128 v[16:19], v8 offset:16384
    v_mul_f32 v105, v245, v105
    v_mfma_f32_16x16x32_bf16 v[172:175], v[56:59], v[20:23], v[172:175]
    ds_read_b128 v[32:35], v9 offset:16384
    v_mfma_f32_16x16x32_bf16 v[172:175], v[60:63], v[36:39], v[172:175]
    ds_read_b128 v[20:23], v8 offset:18432
    v_mfma_f32_16x16x32_bf16 v[184:187], v[56:59], v[24:27], v[184:187]
    ds_read_b128 v[36:39], v9 offset:18432
    v_mfma_f32_16x16x32_bf16 v[184:187], v[60:63], v[40:43], v[184:187]
    ds_read_b128 v[24:27], v8 offset:20480
    v_mfma_f32_16x16x32_bf16 v[188:191], v[56:59], v[28:31], v[188:191]
    ds_read_b128 v[40:43], v9 offset:20480
    v_mfma_f32_16x16x32_bf16 v[188:191], v[60:63], v[44:47], v[188:191]
    ds_read_b128 v[28:31], v8 offset:22528
    s_waitcnt lgkmcnt(5)
    v_mfma_f32_16x16x32_bf16 v[128:131], v[48:51], v[16:19], v[128:131]
    ds_read_b128 v[44:47], v9 offset:22528
    v_fmac_f32 v106, v206, v208
    v_mfma_f32_16x16x32_bf16 v[128:131], v[52:55], v[32:35], v[128:131]
    ds_read_b64_tr_b16 v[56:57], v10 offset:17408
    s_waitcnt lgkmcnt(5)
    v_mfma_f32_16x16x32_bf16 v[132:135], v[48:51], v[20:23], v[132:135]
    ds_read_b64_tr_b16 v[58:59], v11 offset:17408
    v_fmac_f32 v107, v207, v208
    v_mfma_f32_16x16x32_bf16 v[132:135], v[52:55], v[36:39], v[132:135]
    ds_read_b64_tr_b16 v[60:61], v10 offset:25600
    s_waitcnt lgkmcnt(5)
    v_mfma_f32_16x16x32_bf16 v[144:147], v[48:51], v[24:27], v[144:147]
    ds_read_b64_tr_b16 v[62:63], v11 offset:25600
    v_mfma_f32_16x16x32_bf16 v[144:147], v[52:55], v[40:43], v[144:147]
    s_waitcnt lgkmcnt(4)
    v_mul_f32 v244, v106, v106
    v_mfma_f32_16x16x32_bf16 v[148:151], v[48:51], v[28:31], v[148:151]
    ds_read_b64_tr_b16 v[48:49], v10 offset:18432
    v_mfma_f32_16x16x32_bf16 v[148:151], v[52:55], v[44:47], v[148:151]
    ds_read_b64_tr_b16 v[50:51], v11 offset:18432
    s_waitcnt lgkmcnt(4)
    v_mfma_f32_16x16x32_bf16 v[156:159], v[56:59], v[28:31], v[156:159]
    ds_read_b64_tr_b16 v[52:53], v10 offset:26624
    s_waitcnt lgkmcnt(3)
    v_mfma_f32_16x16x32_bf16 v[156:159], v[60:63], v[44:47], v[156:159]
    ds_read_b64_tr_b16 v[54:55], v11 offset:26624
    v_mul_f32 v245, v107, v107
    v_mfma_f32_16x16x32_bf16 v[152:155], v[56:59], v[24:27], v[152:155]
    v_fma_f32 v244, v244, v210, v209
    v_mfma_f32_16x16x32_bf16 v[152:155], v[60:63], v[40:43], v[152:155]
    v_fma_f32 v245, v245, v210, v209
    v_mfma_f32_16x16x32_bf16 v[140:143], v[56:59], v[20:23], v[140:143]
    v_mul_f32 v244, v244, v106
    v_mfma_f32_16x16x32_bf16 v[140:143], v[60:63], v[36:39], v[140:143]
    v_mul_f32 v245, v245, v107
    v_mfma_f32_16x16x32_bf16 v[136:139], v[56:59], v[16:19], v[136:139]
    ds_read_b64_tr_b16 v[56:57], v10 offset:19456
    v_mfma_f32_16x16x32_bf16 v[136:139], v[60:63], v[32:35], v[136:139]
    ds_read_b64_tr_b16 v[58:59], v11 offset:19456
    s_waitcnt lgkmcnt(2)
    v_mfma_f32_16x16x32_bf16 v[160:163], v[48:51], v[16:19], v[160:163]
    ds_read_b64_tr_b16 v[60:61], v10 offset:27648
    v_mfma_f32_16x16x32_bf16 v[160:163], v[52:55], v[32:35], v[160:163]
    ds_read_b64_tr_b16 v[62:63], v11 offset:27648
    v_mfma_f32_16x16x32_bf16 v[164:167], v[48:51], v[20:23], v[164:167]
    v_exp_f32 v244, v244
    v_mfma_f32_16x16x32_bf16 v[164:167], v[52:55], v[36:39], v[164:167]
    v_exp_f32 v245, v245
    v_mfma_f32_16x16x32_bf16 v[176:179], v[48:51], v[24:27], v[176:179]
    v_fma_f32 v244, v244, v211, v211
    v_mfma_f32_16x16x32_bf16 v[176:179], v[52:55], v[40:43], v[176:179]
    v_fma_f32 v245, v245, v211, v211
    v_mfma_f32_16x16x32_bf16 v[180:183], v[48:51], v[28:31], v[180:183]
    v_rcp_f32 v244, v244
    v_mfma_f32_16x16x32_bf16 v[180:183], v[52:55], v[44:47], v[180:183]
    s_waitcnt lgkmcnt(0)
    s_barrier
    v_mfma_f32_16x16x32_bf16 v[168:171], v[56:59], v[16:19], v[168:171]
    v_rcp_f32 v245, v245
    v_mfma_f32_16x16x32_bf16 v[168:171], v[60:63], v[32:35], v[168:171]
    v_mfma_f32_16x16x32_bf16 v[172:175], v[56:59], v[20:23], v[172:175]
    v_mul_f32 v106, v244, v106
    v_mfma_f32_16x16x32_bf16 v[172:175], v[60:63], v[36:39], v[172:175]
    v_mul_f32 v107, v245, v107
    v_mfma_f32_16x16x32_bf16 v[184:187], v[56:59], v[24:27], v[184:187]
    v_mfma_f32_16x16x32_bf16 v[184:187], v[60:63], v[40:43], v[184:187]
    v_mfma_f32_16x16x32_bf16 v[188:191], v[56:59], v[28:31], v[188:191]
    v_mfma_f32_16x16x32_bf16 v[188:191], v[60:63], v[44:47], v[188:191]
    v_pk_mul_f32 v[128:129], v[128:129], v[64:65]
    v_pk_mul_f32 v[130:131], v[130:131], v[66:67]
    v_pk_mul_f32 v[132:133], v[132:133], v[68:69]
    v_pk_mul_f32 v[134:135], v[134:135], v[70:71]
    v_cvt_pk_bf16_f32 v64, v128, v129
    v_cvt_pk_bf16_f32 v65, v130, v131
    v_cvt_pk_bf16_f32 v66, v132, v133
    v_cvt_pk_bf16_f32 v67, v134, v135
    v_pk_mul_f32 v[144:145], v[144:145], v[80:81]
    v_pk_mul_f32 v[146:147], v[146:147], v[82:83]
    v_pk_mul_f32 v[148:149], v[148:149], v[84:85]
    v_pk_mul_f32 v[150:151], v[150:151], v[86:87]
    v_permlane16_swap_b32 v64, v66
    v_permlane16_swap_b32 v65, v67
    buffer_store_dwordx4 v[64:67], v15, s[24:27], s70 offen offset:0 sc1
    v_cvt_pk_bf16_f32 v80, v144, v145
    v_cvt_pk_bf16_f32 v81, v146, v147
    v_cvt_pk_bf16_f32 v82, v148, v149
    v_cvt_pk_bf16_f32 v83, v150, v151
    v_pk_mul_f32 v[136:137], v[136:137], v[72:73]
    v_pk_mul_f32 v[138:139], v[138:139], v[74:75]
    v_pk_mul_f32 v[140:141], v[140:141], v[76:77]
    v_pk_mul_f32 v[142:143], v[142:143], v[78:79]
    v_permlane16_swap_b32 v80, v82
    v_permlane16_swap_b32 v81, v83
    buffer_store_dwordx4 v[80:83], v15, s[24:27], s71 offen offset:0 sc1
    v_cvt_pk_bf16_f32 v72, v136, v137
    v_cvt_pk_bf16_f32 v73, v138, v139
    v_cvt_pk_bf16_f32 v74, v140, v141
    v_cvt_pk_bf16_f32 v75, v142, v143
    v_pk_mul_f32 v[152:153], v[152:153], v[88:89]
    v_pk_mul_f32 v[154:155], v[154:155], v[90:91]
    v_pk_mul_f32 v[156:157], v[156:157], v[92:93]
    v_pk_mul_f32 v[158:159], v[158:159], v[94:95]
    v_permlane16_swap_b32 v72, v74
    v_permlane16_swap_b32 v73, v75
    buffer_store_dwordx4 v[72:75], v15, s[24:27], s70 offen offset:1024 sc1
    v_cvt_pk_bf16_f32 v88, v152, v153
    v_cvt_pk_bf16_f32 v89, v154, v155
    v_cvt_pk_bf16_f32 v90, v156, v157
    v_cvt_pk_bf16_f32 v91, v158, v159
    v_pk_mul_f32 v[160:161], v[160:161], v[96:97]
    v_pk_mul_f32 v[162:163], v[162:163], v[98:99]
    v_pk_mul_f32 v[164:165], v[164:165], v[100:101]
    v_pk_mul_f32 v[166:167], v[166:167], v[102:103]
    v_permlane16_swap_b32 v88, v90
    v_permlane16_swap_b32 v89, v91
    buffer_store_dwordx4 v[88:91], v15, s[24:27], s71 offen offset:1024 sc1
    v_cvt_pk_bf16_f32 v96, v160, v161
    v_cvt_pk_bf16_f32 v97, v162, v163
    v_cvt_pk_bf16_f32 v98, v164, v165
    v_cvt_pk_bf16_f32 v99, v166, v167
    v_pk_mul_f32 v[176:177], v[176:177], v[112:113]
    v_pk_mul_f32 v[178:179], v[178:179], v[114:115]
    v_pk_mul_f32 v[180:181], v[180:181], v[116:117]
    v_pk_mul_f32 v[182:183], v[182:183], v[118:119]
    v_permlane16_swap_b32 v96, v98
    v_permlane16_swap_b32 v97, v99
    buffer_store_dwordx4 v[96:99], v15, s[24:27], s70 offen offset:2048 sc1
    v_cvt_pk_bf16_f32 v112, v176, v177
    v_cvt_pk_bf16_f32 v113, v178, v179
    v_cvt_pk_bf16_f32 v114, v180, v181
    v_cvt_pk_bf16_f32 v115, v182, v183
    v_pk_mul_f32 v[168:169], v[168:169], v[104:105]
    v_pk_mul_f32 v[170:171], v[170:171], v[106:107]
    v_pk_mul_f32 v[172:173], v[172:173], v[108:109]
    v_pk_mul_f32 v[174:175], v[174:175], v[110:111]
    v_permlane16_swap_b32 v112, v114
    v_permlane16_swap_b32 v113, v115
    buffer_store_dwordx4 v[112:115], v15, s[24:27], s71 offen offset:2048 sc1
    v_cvt_pk_bf16_f32 v104, v168, v169
    v_cvt_pk_bf16_f32 v105, v170, v171
    v_cvt_pk_bf16_f32 v106, v172, v173
    v_cvt_pk_bf16_f32 v107, v174, v175
    v_pk_mul_f32 v[184:185], v[184:185], v[120:121]
    v_pk_mul_f32 v[186:187], v[186:187], v[122:123]
    v_pk_mul_f32 v[188:189], v[188:189], v[124:125]
    v_pk_mul_f32 v[190:191], v[190:191], v[126:127]
    v_permlane16_swap_b32 v104, v106
    v_permlane16_swap_b32 v105, v107
    buffer_store_dwordx4 v[104:107], v15, s[24:27], s70 offen offset:3072 sc1
    v_cvt_pk_bf16_f32 v120, v184, v185
    v_cvt_pk_bf16_f32 v121, v186, v187
    v_cvt_pk_bf16_f32 v122, v188, v189
    v_cvt_pk_bf16_f32 v123, v190, v191
    s_nop 0
    v_permlane16_swap_b32 v120, v122
    v_permlane16_swap_b32 v121, v123
    buffer_store_dwordx4 v[120:123], v15, s[24:27], s71 offen offset:3072 sc1
L_c_p5:
    s_bitcmp1_b32 s2, 0
    s_cbranch_scc1 L_p_par_146
    s_waitcnt vmcnt(0)
L_p_par_146:
    s_barrier
    s_and_b32 s56, s2, 7
    s_lshr_b32 s57, s2, 3
    s_and_b32 s58, s57, 3
    s_lshr_b32 s59, s57, 2
    s_lshr_b32 s4, s56, 1
    s_mul_i32 s4, s4, 4
    s_add_u32 s4, s4, s58
    s_and_b32 s5, s56, 1
    s_mul_i32 s5, s5, 8
    s_add_u32 s5, s5, s59
    s_add_u32 s6, s58, s59
    s_lshl_b32 s56, s4, 2
    s_add_u32 s56, s56, s3
    s_lshl_b32 s57, s56, 16
    s_lshl_b32 s58, s5, 7
    s_add_u32 s58, s58, s57
    v_and_b32 v4, 31, v1
    v_lshlrev_b32 v14, 11, v4
    v_lshrrev_b32 v5, 5, v1
    v_lshl_add_u32 v14, v5, 4, v14
    v_add_u32 v14, s58, v14
    s_mov_b32 s81, 0
    s_mov_b32 s84, -49152
    s_mov_b32 s85, -49152
    s_add_u32 s81, s81, 1
    s_and_b32 s81, s81, 3
    s_cselect_b32 s82, 16384, s84
    s_lshr_b32 s72, s3, 0
    s_and_b32 s73, s3, 0
    s_mul_i32 s62, s72, 4096
    s_add_u32 s62, s62, 0
    v_and_b32 v48, 15, v1
    v_lshrrev_b32 v49, 4, v1
    v_lshlrev_b32 v50, 4, v48
    v_lshl_add_u32 v50, v49, 9, v50
    v_add_u32 v8, s62, v50
    v_bfe_u32 v50, v1, 2, 2
    v_lshlrev_b32 v10, 7, v50
    v_lshl_add_u32 v10, v49, 10, v10
    v_bfe_u32 v50, v1, 3, 1
    v_lshl_add_u32 v10, v50, 6, v10
    v_bfe_u32 v50, v1, 4, 1
    v_lshl_add_u32 v10, v50, 5, v10
    s_mov_b32 s62, 98304
    v_add_u32 v10, s62, v10
    v_and_b32 v50, 3, v1
    v_lshl_add_u32 v10, v50, 3, v10
    v_xor_b32 v11, 32, v10
    v_xor_b32 v12, 64, v10
    v_xor_b32 v13, 96, v10
    v_permlane16_swap_b32 v224, v226
    v_permlane16_swap_b32 v225, v227
    v_permlane16_swap_b32 v228, v230
    v_permlane16_swap_b32 v229, v231
    v_permlane16_swap_b32 v232, v234
    v_permlane16_swap_b32 v233, v235
    v_permlane16_swap_b32 v236, v238
    v_permlane16_swap_b32 v237, v239
    v_lshlrev_b32 v128, 16, v224
    v_and_b32 v129, 0xffff0000, v224
    v_lshlrev_b32 v130, 16, v225
    v_and_b32 v131, 0xffff0000, v225
    v_lshlrev_b32 v132, 16, v226
    v_and_b32 v133, 0xffff0000, v226
    v_lshlrev_b32 v134, 16, v227
    v_and_b32 v135, 0xffff0000, v227
    v_lshlrev_b32 v136, 16, v228
    v_and_b32 v137, 0xffff0000, v228
    v_lshlrev_b32 v138, 16, v229
    v_and_b32 v139, 0xffff0000, v229
    v_lshlrev_b32 v140, 16, v230
    v_and_b32 v141, 0xffff0000, v230
    v_lshlrev_b32 v142, 16, v231
    v_and_b32 v143, 0xffff0000, v231
    v_lshlrev_b32 v144, 16, v232
    v_and_b32 v145, 0xffff0000, v232
    v_lshlrev_b32 v146, 16, v233
    v_and_b32 v147, 0xffff0000, v233
    v_lshlrev_b32 v148, 16, v234
    v_and_b32 v149, 0xffff0000, v234
    v_lshlrev_b32 v150, 16, v235
    v_and_b32 v151, 0xffff0000, v235
    v_lshlrev_b32 v152, 16, v236
    v_and_b32 v153, 0xffff0000, v236
    v_lshlrev_b32 v154, 16, v237
    v_and_b32 v155, 0xffff0000, v237
    v_lshlrev_b32 v156, 16, v238
    v_and_b32 v157, 0xffff0000, v238
    v_lshlrev_b32 v158, 16, v239
    v_and_b32 v159, 0xffff0000, v239
    v_mov_b64 v[96:97], 0
    v_mov_b64 v[98:99], 0
    v_mov_b64 v[100:101], 0
    v_mov_b64 v[102:103], 0
    v_mov_b64 v[104:105], 0
    v_mov_b64 v[106:107], 0
    v_mov_b64 v[108:109], 0
    v_mov_b64 v[110:111], 0
    v_mov_b64 v[112:113], 0
    v_mov_b64 v[114:115], 0
    v_mov_b64 v[116:117], 0
    v_mov_b64 v[118:119], 0
    v_mov_b64 v[120:121], 0
    v_mov_b64 v[122:123], 0
    v_mov_b64 v[124:125], 0
    v_mov_b64 v[126:127], 0
    s_lshl_b32 s68, s2, 2
    s_add_u32 s68, s68, s3
    s_lshl_b32 s68, s68, 12
    s_xor_b32 s69, s68, 16384
    s_add_u32 s68, s68, 12582912
    s_add_u32 s69, s69, 12582912
    s_mov_b32 s20, s50
    s_mov_b32 s21, s51
    s_mov_b32 s22, 4194304
    s_mov_b32 s23, 0x20000
    s_mul_i32 s56, s3, 4608
    s_add_u32 s56, s56, 65536
    v_and_b32 v2, 15, v1
    v_mul_u32_u24 v5, 144, v2
    v_lshrrev_b32 v2, 4, v1
    v_lshl_add_u32 v5, v2, 3, v5
    v_add_u32 v5, s56, v5
    v_lshrrev_b32 v2, 3, v1
    v_and_b32 v3, 7, v1
    v_mul_u32_u24 v6, 144, v2
    v_lshl_add_u32 v6, v3, 4, v6
    v_add_u32 v6, s56, v6
    v_lshlrev_b32 v7, 11, v2
    v_lshl_add_u32 v7, v3, 4, v7
    s_mov_b32 s70, s58
    s_waitcnt vmcnt(0)
    s_barrier
    s_barrier
    ds_read_b64_tr_b16 v[32:33], v10 offset:32768
    ds_read_b64_tr_b16 v[34:35], v10 offset:33280
    ds_read_b64_tr_b16 v[36:37], v10 offset:36864
    ds_read_b64_tr_b16 v[38:39], v10 offset:37376
    ds_read_b128 v[16:19], v8 offset:32768
    ds_read_b128 v[24:27], v8 offset:34816
    ds_read_b128 v[20:23], v8 offset:33024
    ds_read_b128 v[28:31], v8 offset:35072
    ds_read_b64_tr_b16 v[40:41], v11 offset:32768
    ds_read_b64_tr_b16 v[42:43], v11 offset:33280
    ds_read_b64_tr_b16 v[44:45], v11 offset:36864
    ds_read_b64_tr_b16 v[46:47], v11 offset:37376
    ds_read_b64_tr_b16 v[48:49], v12 offset:32768
    ds_read_b64_tr_b16 v[50:51], v12 offset:33280
    s_mov_b32 s80, 3
    .p2align 6
L_p_c4_147:
    s_waitcnt lgkmcnt(9)
    ds_read_b64_tr_b16 v[52:53], v12 offset:36864
    ds_read_b64_tr_b16 v[54:55], v12 offset:37376
    v_mfma_f32_16x16x32_bf16 v[96:99], v[32:35], v[16:19], v[96:99]
    ds_read_b64_tr_b16 v[56:57], v13 offset:32768
    ds_read_b64_tr_b16 v[58:59], v13 offset:33280
    s_waitcnt lgkmcnt(12)
    v_mfma_f32_16x16x32_bf16 v[96:99], v[36:39], v[24:27], v[96:99]
    ds_read_b64_tr_b16 v[60:61], v13 offset:36864
    s_waitcnt lgkmcnt(12)
    v_mfma_f32_16x16x32_bf16 v[100:103], v[32:35], v[20:23], v[100:103]
    ds_read_b64_tr_b16 v[62:63], v13 offset:37376
    s_waitcnt lgkmcnt(12)
    v_mfma_f32_16x16x32_bf16 v[100:103], v[36:39], v[28:31], v[100:103]
    ds_read_b64_tr_b16 v[64:65], v10 offset:40960
    s_waitcnt lgkmcnt(11)
    v_mfma_f32_16x16x32_bf16 v[108:111], v[40:43], v[20:23], v[108:111]
    ds_read_b64_tr_b16 v[66:67], v10 offset:41472
    s_waitcnt lgkmcnt(10)
    v_mfma_f32_16x16x32_bf16 v[108:111], v[44:47], v[28:31], v[108:111]
    ds_read_b64_tr_b16 v[68:69], v10 offset:45056
    v_mfma_f32_16x16x32_bf16 v[104:107], v[40:43], v[16:19], v[104:107]
    ds_read_b64_tr_b16 v[70:71], v10 offset:45568
    v_mfma_f32_16x16x32_bf16 v[104:107], v[44:47], v[24:27], v[104:107]
    ds_read_b64_tr_b16 v[72:73], v11 offset:40960
    s_waitcnt lgkmcnt(7)
    v_mfma_f32_16x16x32_bf16 v[112:115], v[48:51], v[16:19], v[112:115]
    ds_read_b64_tr_b16 v[74:75], v11 offset:41472
    v_mfma_f32_16x16x32_bf16 v[112:115], v[52:55], v[24:27], v[112:115]
    ds_read_b64_tr_b16 v[76:77], v11 offset:45056
    v_mfma_f32_16x16x32_bf16 v[116:119], v[48:51], v[20:23], v[116:119]
    ds_read_b64_tr_b16 v[78:79], v11 offset:45568
    v_mfma_f32_16x16x32_bf16 v[116:119], v[52:55], v[28:31], v[116:119]
    ds_read_b64_tr_b16 v[80:81], v12 offset:40960
    v_mfma_f32_16x16x32_bf16 v[124:127], v[56:59], v[20:23], v[124:127]
    ds_read_b64_tr_b16 v[82:83], v12 offset:41472
    s_waitcnt lgkmcnt(8)
    v_mfma_f32_16x16x32_bf16 v[124:127], v[60:63], v[28:31], v[124:127]
    ds_read_b64_tr_b16 v[84:85], v12 offset:45056
    v_mfma_f32_16x16x32_bf16 v[120:123], v[56:59], v[16:19], v[120:123]
    ds_read_b64_tr_b16 v[86:87], v12 offset:45568
    v_mfma_f32_16x16x32_bf16 v[120:123], v[60:63], v[24:27], v[120:123]
    ds_read_b64_tr_b16 v[88:89], v13 offset:40960
    v_mfma_f32_16x16x32_bf16 v[128:131], v[64:67], v[16:19], v[128:131]
    ds_read_b64_tr_b16 v[90:91], v13 offset:41472
    s_waitcnt lgkmcnt(8)
    v_mfma_f32_16x16x32_bf16 v[128:131], v[68:71], v[24:27], v[128:131]
    ds_read_b64_tr_b16 v[92:93], v13 offset:45056
    v_mfma_f32_16x16x32_bf16 v[132:135], v[64:67], v[20:23], v[132:135]
    ds_read_b64_tr_b16 v[94:95], v13 offset:45568
    v_mfma_f32_16x16x32_bf16 v[132:135], v[68:71], v[28:31], v[132:135]
    v_mfma_f32_16x16x32_bf16 v[140:143], v[72:75], v[20:23], v[140:143]
    s_waitcnt lgkmcnt(6)
    v_mfma_f32_16x16x32_bf16 v[140:143], v[76:79], v[28:31], v[140:143]
    v_mfma_f32_16x16x32_bf16 v[136:139], v[72:75], v[16:19], v[136:139]
    v_mfma_f32_16x16x32_bf16 v[136:139], v[76:79], v[24:27], v[136:139]
    v_mfma_f32_16x16x32_bf16 v[144:147], v[80:83], v[16:19], v[144:147]
    s_waitcnt lgkmcnt(0)
    s_barrier
    ds_read_b64_tr_b16 v[32:33], v10 offset:49152
    ds_read_b64_tr_b16 v[34:35], v10 offset:49664
    v_mfma_f32_16x16x32_bf16 v[144:147], v[84:87], v[24:27], v[144:147]
L_pad19:
    s_cbranch_execz L_padr19
    ds_read_b64_tr_b16 v[36:37], v10 offset:53248
    ds_read_b64_tr_b16 v[38:39], v10 offset:53760
    v_mfma_f32_16x16x32_bf16 v[148:151], v[80:83], v[20:23], v[148:151]
    ds_read_b128 v[192:195], v8 offset:49152
    ds_read_b128 v[200:203], v8 offset:51200
    v_mfma_f32_16x16x32_bf16 v[148:151], v[84:87], v[28:31], v[148:151]
    ds_read_b128 v[196:199], v8 offset:49408
    ds_read_b128 v[204:207], v8 offset:51456
    v_mfma_f32_16x16x32_bf16 v[156:159], v[88:91], v[20:23], v[156:159]
    ds_read_b64_tr_b16 v[40:41], v11 offset:49152
    ds_read_b64_tr_b16 v[42:43], v11 offset:49664
    v_mfma_f32_16x16x32_bf16 v[156:159], v[92:95], v[28:31], v[156:159]
    ds_read_b64_tr_b16 v[44:45], v11 offset:53248
    ds_read_b64_tr_b16 v[46:47], v11 offset:53760
    v_mfma_f32_16x16x32_bf16 v[152:155], v[88:91], v[16:19], v[152:155]
    ds_read_b64_tr_b16 v[48:49], v12 offset:49152
    ds_read_b64_tr_b16 v[50:51], v12 offset:49664
    v_mfma_f32_16x16x32_bf16 v[152:155], v[92:95], v[24:27], v[152:155]
    s_waitcnt lgkmcnt(9)
    ds_read_b64_tr_b16 v[52:53], v12 offset:53248
    ds_read_b64_tr_b16 v[54:55], v12 offset:53760
    v_mfma_f32_16x16x32_bf16 v[96:99], v[32:35], v[192:195], v[96:99]
    ds_read_b64_tr_b16 v[56:57], v13 offset:49152
    ds_read_b64_tr_b16 v[58:59], v13 offset:49664
    s_waitcnt lgkmcnt(12)
    v_mfma_f32_16x16x32_bf16 v[96:99], v[36:39], v[200:203], v[96:99]
    ds_read_b64_tr_b16 v[60:61], v13 offset:53248
    s_waitcnt lgkmcnt(12)
    v_mfma_f32_16x16x32_bf16 v[100:103], v[32:35], v[196:199], v[100:103]
    ds_read_b64_tr_b16 v[62:63], v13 offset:53760
    s_waitcnt lgkmcnt(12)
    v_mfma_f32_16x16x32_bf16 v[100:103], v[36:39], v[204:207], v[100:103]
    ds_read_b64_tr_b16 v[64:65], v10 offset:57344
    s_waitcnt lgkmcnt(11)
    v_mfma_f32_16x16x32_bf16 v[108:111], v[40:43], v[196:199], v[108:111]
    ds_read_b64_tr_b16 v[66:67], v10 offset:57856
    s_waitcnt lgkmcnt(10)
    v_mfma_f32_16x16x32_bf16 v[108:111], v[44:47], v[204:207], v[108:111]
    ds_read_b64_tr_b16 v[68:69], v10 offset:61440
    v_mfma_f32_16x16x32_bf16 v[104:107], v[40:43], v[192:195], v[104:107]
    ds_read_b64_tr_b16 v[70:71], v10 offset:61952
    v_mfma_f32_16x16x32_bf16 v[104:107], v[44:47], v[200:203], v[104:107]
    ds_read_b64_tr_b16 v[72:73], v11 offset:57344
    s_waitcnt lgkmcnt(7)
    v_mfma_f32_16x16x32_bf16 v[112:115], v[48:51], v[192:195], v[112:115]
    ds_read_b64_tr_b16 v[74:75], v11 offset:57856
    v_mfma_f32_16x16x32_bf16 v[112:115], v[52:55], v[200:203], v[112:115]
    ds_read_b64_tr_b16 v[76:77], v11 offset:61440
    v_mfma_f32_16x16x32_bf16 v[116:119], v[48:51], v[196:199], v[116:119]
    ds_read_b64_tr_b16 v[78:79], v11 offset:61952
    v_mfma_f32_16x16x32_bf16 v[116:119], v[52:55], v[204:207], v[116:119]
    ds_read_b64_tr_b16 v[80:81], v12 offset:57344
    v_mfma_f32_16x16x32_bf16 v[124:127], v[56:59], v[196:199], v[124:127]
    ds_read_b64_tr_b16 v[82:83], v12 offset:57856
    s_waitcnt lgkmcnt(8)
    v_mfma_f32_16x16x32_bf16 v[124:127], v[60:63], v[204:207], v[124:127]
    ds_read_b64_tr_b16 v[84:85], v12 offset:61440
    v_mfma_f32_16x16x32_bf16 v[120:123], v[56:59], v[192:195], v[120:123]
    ds_read_b64_tr_b16 v[86:87], v12 offset:61952
    v_mfma_f32_16x16x32_bf16 v[120:123], v[60:63], v[200:203], v[120:123]
    ds_read_b64_tr_b16 v[88:89], v13 offset:57344
    v_mfma_f32_16x16x32_bf16 v[128:131], v[64:67], v[192:195], v[128:131]
    ds_read_b64_tr_b16 v[90:91], v13 offset:57856
    s_waitcnt lgkmcnt(8)
    v_mfma_f32_16x16x32_bf16 v[128:131], v[68:71], v[200:203], v[128:131]
    ds_read_b64_tr_b16 v[92:93], v13 offset:61440
    v_mfma_f32_16x16x32_bf16 v[132:135], v[64:67], v[196:199], v[132:135]
    ds_read_b64_tr_b16 v[94:95], v13 offset:61952
    v_mfma_f32_16x16x32_bf16 v[132:135], v[68:71], v[204:207], v[132:135]
    v_mfma_f32_16x16x32_bf16 v[140:143], v[72:75], v[196:199], v[140:143]
    s_waitcnt lgkmcnt(6)
    v_mfma_f32_16x16x32_bf16 v[140:143], v[76:79], v[204:207], v[140:143]
    v_mfma_f32_16x16x32_bf16 v[136:139], v[72:75], v[192:195], v[136:139]
    v_mfma_f32_16x16x32_bf16 v[136:139], v[76:79], v[200:203], v[136:139]
    v_mfma_f32_16x16x32_bf16 v[144:147], v[80:83], v[192:195], v[144:147]
    s_waitcnt lgkmcnt(0)
    s_barrier
    ds_read_b64_tr_b16 v[32:33], v10 offset:0
    ds_read_b64_tr_b16 v[34:35], v10 offset:512
    v_mfma_f32_16x16x32_bf16 v[144:147], v[84:87], v[200:203], v[144:147]
    ds_read_b64_tr_b16 v[36:37], v10 offset:4096
    ds_read_b64_tr_b16 v[38:39], v10 offset:4608
    v_mfma_f32_16x16x32_bf16 v[148:151], v[80:83], v[196:199], v[148:151]
    ds_read_b128 v[16:19], v8 offset:0
    ds_read_b128 v[24:27], v8 offset:2048
    v_mfma_f32_16x16x32_bf16 v[148:151], v[84:87], v[204:207], v[148:151]
    ds_read_b128 v[20:23], v8 offset:256
    ds_read_b128 v[28:31], v8 offset:2304
    v_mfma_f32_16x16x32_bf16 v[156:159], v[88:91], v[196:199], v[156:159]
    ds_read_b64_tr_b16 v[40:41], v11 offset:0
    ds_read_b64_tr_b16 v[42:43], v11 offset:512
    v_mfma_f32_16x16x32_bf16 v[156:159], v[92:95], v[204:207], v[156:159]
    ds_read_b64_tr_b16 v[44:45], v11 offset:4096
    ds_read_b64_tr_b16 v[46:47], v11 offset:4608
    v_mfma_f32_16x16x32_bf16 v[152:155], v[88:91], v[192:195], v[152:155]
    ds_read_b64_tr_b16 v[48:49], v12 offset:0
    ds_read_b64_tr_b16 v[50:51], v12 offset:512
    v_mfma_f32_16x16x32_bf16 v[152:155], v[92:95], v[200:203], v[152:155]
    s_waitcnt lgkmcnt(9)
    ds_read_b64_tr_b16 v[52:53], v12 offset:4096
    ds_read_b64_tr_b16 v[54:55], v12 offset:4608
    v_mfma_f32_16x16x32_bf16 v[96:99], v[32:35], v[16:19], v[96:99]
    ds_read_b64_tr_b16 v[56:57], v13 offset:0
    ds_read_b64_tr_b16 v[58:59], v13 offset:512
    s_waitcnt lgkmcnt(12)
    v_mfma_f32_16x16x32_bf16 v[96:99], v[36:39], v[24:27], v[96:99]
    ds_read_b64_tr_b16 v[60:61], v13 offset:4096
    s_waitcnt lgkmcnt(12)
    v_mfma_f32_16x16x32_bf16 v[100:103], v[32:35], v[20:23], v[100:103]
    ds_read_b64_tr_b16 v[62:63], v13 offset:4608
    s_waitcnt lgkmcnt(12)
    v_mfma_f32_16x16x32_bf16 v[100:103], v[36:39], v[28:31], v[100:103]
    ds_read_b64_tr_b16 v[64:65], v10 offset:8192
    s_waitcnt lgkmcnt(11)
    v_mfma_f32_16x16x32_bf16 v[108:111], v[40:43], v[20:23], v[108:111]
    ds_read_b64_tr_b16 v[66:67], v10 offset:8704
    s_waitcnt lgkmcnt(10)
    v_mfma_f32_16x16x32_bf16 v[108:111], v[44:47], v[28:31], v[108:111]
    ds_read_b64_tr_b16 v[68:69], v10 offset:12288
    v_mfma_f32_16x16x32_bf16 v[104:107], v[40:43], v[16:19], v[104:107]
    ds_read_b64_tr_b16 v[70:71], v10 offset:12800
    v_mfma_f32_16x16x32_bf16 v[104:107], v[44:47], v[24:27], v[104:107]
    ds_read_b64_tr_b16 v[72:73], v11 offset:8192
    s_waitcnt lgkmcnt(7)
    v_mfma_f32_16x16x32_bf16 v[112:115], v[48:51], v[16:19], v[112:115]
    ds_read_b64_tr_b16 v[74:75], v11 offset:8704
    v_mfma_f32_16x16x32_bf16 v[112:115], v[52:55], v[24:27], v[112:115]
    ds_read_b64_tr_b16 v[76:77], v11 offset:12288
    v_mfma_f32_16x16x32_bf16 v[116:119], v[48:51], v[20:23], v[116:119]
    ds_read_b64_tr_b16 v[78:79], v11 offset:12800
    v_mfma_f32_16x16x32_bf16 v[116:119], v[52:55], v[28:31], v[116:119]
    ds_read_b64_tr_b16 v[80:81], v12 offset:8192
    v_mfma_f32_16x16x32_bf16 v[124:127], v[56:59], v[20:23], v[124:127]
    ds_read_b64_tr_b16 v[82:83], v12 offset:8704
    s_waitcnt lgkmcnt(8)
    v_mfma_f32_16x16x32_bf16 v[124:127], v[60:63], v[28:31], v[124:127]
    ds_read_b64_tr_b16 v[84:85], v12 offset:12288
    v_mfma_f32_16x16x32_bf16 v[120:123], v[56:59], v[16:19], v[120:123]
    ds_read_b64_tr_b16 v[86:87], v12 offset:12800
    v_mfma_f32_16x16x32_bf16 v[120:123], v[60:63], v[24:27], v[120:123]
    ds_read_b64_tr_b16 v[88:89], v13 offset:8192
    v_mfma_f32_16x16x32_bf16 v[128:131], v[64:67], v[16:19], v[128:131]
    ds_read_b64_tr_b16 v[90:91], v13 offset:8704
    s_waitcnt lgkmcnt(8)
    v_mfma_f32_16x16x32_bf16 v[128:131], v[68:71], v[24:27], v[128:131]
    ds_read_b64_tr_b16 v[92:93], v13 offset:12288
    v_mfma_f32_16x16x32_bf16 v[132:135], v[64:67], v[20:23], v[132:135]
    ds_read_b64_tr_b16 v[94:95], v13 offset:12800
    v_mfma_f32_16x16x32_bf16 v[132:135], v[68:71], v[28:31], v[132:135]
    v_mfma_f32_16x16x32_bf16 v[140:143], v[72:75], v[20:23], v[140:143]
    s_waitcnt lgkmcnt(6)
    v_mfma_f32_16x16x32_bf16 v[140:143], v[76:79], v[28:31], v[140:143]
    v_mfma_f32_16x16x32_bf16 v[136:139], v[72:75], v[16:19], v[136:139]
    v_mfma_f32_16x16x32_bf16 v[136:139], v[76:79], v[24:27], v[136:139]
    v_mfma_f32_16x16x32_bf16 v[144:147], v[80:83], v[16:19], v[144:147]
    s_waitcnt lgkmcnt(0)
    s_barrier
    ds_read_b64_tr_b16 v[32:33], v10 offset:16384
    ds_read_b64_tr_b16 v[34:35], v10 offset:16896
    v_mfma_f32_16x16x32_bf16 v[144:147], v[84:87], v[24:27], v[144:147]
    ds_read_b64_tr_b16 v[36:37], v10 offset:20480
    ds_read_b64_tr_b16 v[38:39], v10 offset:20992
    v_mfma_f32_16x16x32_bf16 v[148:151], v[80:83], v[20:23], v[148:151]
    ds_read_b128 v[192:195], v8 offset:16384
    ds_read_b128 v[200:203], v8 offset:18432
    v_mfma_f32_16x16x32_bf16 v[148:151], v[84:87], v[28:31], v[148:151]
    ds_read_b128 v[196:199], v8 offset:16640
    ds_read_b128 v[204:207], v8 offset:18688
    v_mfma_f32_16x16x32_bf16 v[156:159], v[88:91], v[20:23], v[156:159]
    ds_read_b64_tr_b16 v[40:41], v11 offset:16384
    ds_read_b64_tr_b16 v[42:43], v11 offset:16896
    v_mfma_f32_16x16x32_bf16 v[156:159], v[92:95], v[28:31], v[156:159]
    ds_read_b64_tr_b16 v[44:45], v11 offset:20480
    ds_read_b64_tr_b16 v[46:47], v11 offset:20992
    v_mfma_f32_16x16x32_bf16 v[152:155], v[88:91], v[16:19], v[152:155]
    ds_read_b64_tr_b16 v[48:49], v12 offset:16384
    ds_read_b64_tr_b16 v[50:51], v12 offset:16896
    v_mfma_f32_16x16x32_bf16 v[152:155], v[92:95], v[24:27], v[152:155]
    s_waitcnt lgkmcnt(9)
    ds_read_b64_tr_b16 v[52:53], v12 offset:20480
    ds_read_b64_tr_b16 v[54:55], v12 offset:20992
    v_mfma_f32_16x16x32_bf16 v[96:99], v[32:35], v[192:195], v[96:99]
    ds_read_b64_tr_b16 v[56:57], v13 offset:16384
    ds_read_b64_tr_b16 v[58:59], v13 offset:16896
    s_waitcnt lgkmcnt(12)
    v_mfma_f32_16x16x32_bf16 v[96:99], v[36:39], v[200:203], v[96:99]
    ds_read_b64_tr_b16 v[60:61], v13 offset:20480
    s_waitcnt lgkmcnt(12)
    v_mfma_f32_16x16x32_bf16 v[100:103], v[32:35], v[196:199], v[100:103]
    ds_read_b64_tr_b16 v[62:63], v13 offset:20992
    s_waitcnt lgkmcnt(12)
    v_mfma_f32_16x16x32_bf16 v[100:103], v[36:39], v[204:207], v[100:103]
    ds_read_b64_tr_b16 v[64:65], v10 offset:24576
    s_waitcnt lgkmcnt(11)
    v_mfma_f32_16x16x32_bf16 v[108:111], v[40:43], v[196:199], v[108:111]
    ds_read_b64_tr_b16 v[66:67], v10 offset:25088
    s_waitcnt lgkmcnt(10)
    v_mfma_f32_16x16x32_bf16 v[108:111], v[44:47], v[204:207], v[108:111]
    ds_read_b64_tr_b16 v[68:69], v10 offset:28672
    s_sub_u32 s80, s80, 1
    v_mfma_f32_16x16x32_bf16 v[104:107], v[40:43], v[192:195], v[104:107]
    ds_read_b64_tr_b16 v[70:71], v10 offset:29184
    v_mfma_f32_16x16x32_bf16 v[104:107], v[44:47], v[200:203], v[104:107]
    ds_read_b64_tr_b16 v[72:73], v11 offset:24576
    s_waitcnt lgkmcnt(7)
    v_mfma_f32_16x16x32_bf16 v[112:115], v[48:51], v[192:195], v[112:115]
    ds_read_b64_tr_b16 v[74:75], v11 offset:25088
    v_mfma_f32_16x16x32_bf16 v[112:115], v[52:55], v[200:203], v[112:115]
    ds_read_b64_tr_b16 v[76:77], v11 offset:28672
    v_mfma_f32_16x16x32_bf16 v[116:119], v[48:51], v[196:199], v[116:119]
    ds_read_b64_tr_b16 v[78:79], v11 offset:29184
    v_mfma_f32_16x16x32_bf16 v[116:119], v[52:55], v[204:207], v[116:119]
    ds_read_b64_tr_b16 v[80:81], v12 offset:24576
    v_mfma_f32_16x16x32_bf16 v[124:127], v[56:59], v[196:199], v[124:127]
    ds_read_b64_tr_b16 v[82:83], v12 offset:25088
    s_waitcnt lgkmcnt(8)
    v_mfma_f32_16x16x32_bf16 v[124:127], v[60:63], v[204:207], v[124:127]
    ds_read_b64_tr_b16 v[84:85], v12 offset:28672
    v_mfma_f32_16x16x32_bf16 v[120:123], v[56:59], v[192:195], v[120:123]
    ds_read_b64_tr_b16 v[86:87], v12 offset:29184
    v_mfma_f32_16x16x32_bf16 v[120:123], v[60:63], v[200:203], v[120:123]
    ds_read_b64_tr_b16 v[88:89], v13 offset:24576
    v_mfma_f32_16x16x32_bf16 v[128:131], v[64:67], v[192:195], v[128:131]
    ds_read_b64_tr_b16 v[90:91], v13 offset:25088
    s_waitcnt lgkmcnt(8)
    v_mfma_f32_16x16x32_bf16 v[128:131], v[68:71], v[200:203], v[128:131]
    ds_read_b64_tr_b16 v[92:93], v13 offset:28672
    v_mfma_f32_16x16x32_bf16 v[132:135], v[64:67], v[196:199], v[132:135]
    ds_read_b64_tr_b16 v[94:95], v13 offset:29184
    v_mfma_f32_16x16x32_bf16 v[132:135], v[68:71], v[204:207], v[132:135]
    s_cmp_lg_u32 s80, 0
    v_mfma_f32_16x16x32_bf16 v[140:143], v[72:75], v[196:199], v[140:143]
    s_waitcnt lgkmcnt(6)
    v_mfma_f32_16x16x32_bf16 v[140:143], v[76:79], v[204:207], v[140:143]
    v_mfma_f32_16x16x32_bf16 v[136:139], v[72:75], v[192:195], v[136:139]
    v_mfma_f32_16x16x32_bf16 v[136:139], v[76:79], v[200:203], v[136:139]
    v_mfma_f32_16x16x32_bf16 v[144:147], v[80:83], v[192:195], v[144:147]
    s_waitcnt lgkmcnt(0)
    s_barrier
    ds_read_b64_tr_b16 v[32:33], v10 offset:32768
    ds_read_b64_tr_b16 v[34:35], v10 offset:33280
    v_mfma_f32_16x16x32_bf16 v[144:147], v[84:87], v[200:203], v[144:147]
    ds_read_b64_tr_b16 v[36:37], v10 offset:36864
    ds_read_b64_tr_b16 v[38:39], v10 offset:37376
    v_mfma_f32_16x16x32_bf16 v[148:151], v[80:83], v[196:199], v[148:151]
    ds_read_b128 v[16:19], v8 offset:32768
    ds_read_b128 v[24:27], v8 offset:34816
    v_mfma_f32_16x16x32_bf16 v[148:151], v[84:87], v[204:207], v[148:151]
    ds_read_b128 v[20:23], v8 offset:33024
    ds_read_b128 v[28:31], v8 offset:35072
    v_mfma_f32_16x16x32_bf16 v[156:159], v[88:91], v[196:199], v[156:159]
    ds_read_b64_tr_b16 v[40:41], v11 offset:32768
    ds_read_b64_tr_b16 v[42:43], v11 offset:33280
    v_mfma_f32_16x16x32_bf16 v[156:159], v[92:95], v[204:207], v[156:159]
    ds_read_b64_tr_b16 v[44:45], v11 offset:36864
    ds_read_b64_tr_b16 v[46:47], v11 offset:37376
    v_mfma_f32_16x16x32_bf16 v[152:155], v[88:91], v[192:195], v[152:155]
    ds_read_b64_tr_b16 v[48:49], v12 offset:32768
    ds_read_b64_tr_b16 v[50:51], v12 offset:33280
    v_mfma_f32_16x16x32_bf16 v[152:155], v[92:95], v[200:203], v[152:155]
    s_cbranch_scc1 L_p_c4_147
    s_waitcnt lgkmcnt(9)
    ds_read_b64_tr_b16 v[52:53], v12 offset:36864
    ds_read_b64_tr_b16 v[54:55], v12 offset:37376
    v_mfma_f32_16x16x32_bf16 v[96:99], v[32:35], v[16:19], v[96:99]
    ds_read_b64_tr_b16 v[56:57], v13 offset:32768
    ds_read_b64_tr_b16 v[58:59], v13 offset:33280
    s_waitcnt lgkmcnt(12)
    v_mfma_f32_16x16x32_bf16 v[96:99], v[36:39], v[24:27], v[96:99]
    ds_read_b64_tr_b16 v[60:61], v13 offset:36864
    s_waitcnt lgkmcnt(12)
    v_mfma_f32_16x16x32_bf16 v[100:103], v[32:35], v[20:23], v[100:103]
    ds_read_b64_tr_b16 v[62:63], v13 offset:37376
    s_waitcnt lgkmcnt(12)
    v_mfma_f32_16x16x32_bf16 v[100:103], v[36:39], v[28:31], v[100:103]
    ds_read_b64_tr_b16 v[64:65], v10 offset:40960
    s_waitcnt lgkmcnt(11)
    v_mfma_f32_16x16x32_bf16 v[108:111], v[40:43], v[20:23], v[108:111]
    ds_read_b64_tr_b16 v[66:67], v10 offset:41472
    s_waitcnt lgkmcnt(10)
    v_mfma_f32_16x16x32_bf16 v[108:111], v[44:47], v[28:31], v[108:111]
    ds_read_b64_tr_b16 v[68:69], v10 offset:45056
    v_mfma_f32_16x16x32_bf16 v[104:107], v[40:43], v[16:19], v[104:107]
    ds_read_b64_tr_b16 v[70:71], v10 offset:45568
    v_mfma_f32_16x16x32_bf16 v[104:107], v[44:47], v[24:27], v[104:107]
    ds_read_b64_tr_b16 v[72:73], v11 offset:40960
    s_waitcnt lgkmcnt(7)
    v_mfma_f32_16x16x32_bf16 v[112:115], v[48:51], v[16:19], v[112:115]
    ds_read_b64_tr_b16 v[74:75], v11 offset:41472
    v_mfma_f32_16x16x32_bf16 v[112:115], v[52:55], v[24:27], v[112:115]
    ds_read_b64_tr_b16 v[76:77], v11 offset:45056
    v_mfma_f32_16x16x32_bf16 v[116:119], v[48:51], v[20:23], v[116:119]
    ds_read_b64_tr_b16 v[78:79], v11 offset:45568
    v_mfma_f32_16x16x32_bf16 v[116:119], v[52:55], v[28:31], v[116:119]
    ds_read_b64_tr_b16 v[80:81], v12 offset:40960
    v_mfma_f32_16x16x32_bf16 v[124:127], v[56:59], v[20:23], v[124:127]
    ds_read_b64_tr_b16 v[82:83], v12 offset:41472
    s_waitcnt lgkmcnt(8)
    v_mfma_f32_16x16x32_bf16 v[124:127], v[60:63], v[28:31], v[124:127]
    ds_read_b64_tr_b16 v[84:85], v12 offset:45056
    v_mfma_f32_16x16x32_bf16 v[120:123], v[56:59], v[16:19], v[120:123]
    ds_read_b64_tr_b16 v[86:87], v12 offset:45568
    v_mfma_f32_16x16x32_bf16 v[120:123], v[60:63], v[24:27], v[120:123]
    ds_read_b64_tr_b16 v[88:89], v13 offset:40960
    v_mfma_f32_16x16x32_bf16 v[128:131], v[64:67], v[16:19], v[128:131]
    ds_read_b64_tr_b16 v[90:91], v13 offset:41472
    s_waitcnt lgkmcnt(8)
    v_mfma_f32_16x16x32_bf16 v[128:131], v[68:71], v[24:27], v[128:131]
    ds_read_b64_tr_b16 v[92:93], v13 offset:45056
    v_mfma_f32_16x16x32_bf16 v[132:135], v[64:67], v[20:23], v[132:135]
    ds_read_b64_tr_b16 v[94:95], v13 offset:45568
    v_mfma_f32_16x16x32_bf16 v[132:135], v[68:71], v[28:31], v[132:135]
    v_mfma_f32_16x16x32_bf16 v[140:143], v[72:75], v[20:23], v[140:143]
    s_waitcnt lgkmcnt(6)
    v_mfma_f32_16x16x32_bf16 v[140:143], v[76:79], v[28:31], v[140:143]
    v_mfma_f32_16x16x32_bf16 v[136:139], v[72:75], v[16:19], v[136:139]
    v_mfma_f32_16x16x32_bf16 v[136:139], v[76:79], v[24:27], v[136:139]
    v_mfma_f32_16x16x32_bf16 v[144:147], v[80:83], v[16:19], v[144:147]
    s_waitcnt lgkmcnt(0)
    s_barrier
    ds_read_b64_tr_b16 v[32:33], v10 offset:49152
    ds_read_b64_tr_b16 v[34:35], v10 offset:49664
    v_mfma_f32_16x16x32_bf16 v[144:147], v[84:87], v[24:27], v[144:147]
    ds_read_b64_tr_b16 v[36:37], v10 offset:53248
    ds_read_b64_tr_b16 v[38:39], v10 offset:53760
    v_mfma_f32_16x16x32_bf16 v[148:151], v[80:83], v[20:23], v[148:151]
    ds_read_b128 v[192:195], v8 offset:49152
    ds_read_b128 v[200:203], v8 offset:51200
    v_mfma_f32_16x16x32_bf16 v[148:151], v[84:87], v[28:31], v[148:151]
    ds_read_b128 v[196:199], v8 offset:49408
    ds_read_b128 v[204:207], v8 offset:51456
    v_mfma_f32_16x16x32_bf16 v[156:159], v[88:91], v[20:23], v[156:159]
    ds_read_b64_tr_b16 v[40:41], v11 offset:49152
    ds_read_b64_tr_b16 v[42:43], v11 offset:49664
    v_mfma_f32_16x16x32_bf16 v[156:159], v[92:95], v[28:31], v[156:159]
    ds_read_b64_tr_b16 v[44:45], v11 offset:53248
    ds_read_b64_tr_b16 v[46:47], v11 offset:53760
    v_mfma_f32_16x16x32_bf16 v[152:155], v[88:91], v[16:19], v[152:155]
    ds_read_b64_tr_b16 v[48:49], v12 offset:49152
    ds_read_b64_tr_b16 v[50:51], v12 offset:49664
    v_mfma_f32_16x16x32_bf16 v[152:155], v[92:95], v[24:27], v[152:155]
    s_waitcnt lgkmcnt(9)
    ds_read_b64_tr_b16 v[52:53], v12 offset:53248
    ds_read_b64_tr_b16 v[54:55], v12 offset:53760
    v_mfma_f32_16x16x32_bf16 v[96:99], v[32:35], v[192:195], v[96:99]
    ds_read_b64_tr_b16 v[56:57], v13 offset:49152
    ds_read_b64_tr_b16 v[58:59], v13 offset:49664
    s_waitcnt lgkmcnt(12)
    v_mfma_f32_16x16x32_bf16 v[96:99], v[36:39], v[200:203], v[96:99]
    ds_read_b64_tr_b16 v[60:61], v13 offset:53248
    s_waitcnt lgkmcnt(12)
    v_mfma_f32_16x16x32_bf16 v[100:103], v[32:35], v[196:199], v[100:103]
    ds_read_b64_tr_b16 v[62:63], v13 offset:53760
    s_waitcnt lgkmcnt(12)
    v_mfma_f32_16x16x32_bf16 v[100:103], v[36:39], v[204:207], v[100:103]
    ds_read_b64_tr_b16 v[64:65], v10 offset:57344
    s_waitcnt lgkmcnt(11)
    v_mfma_f32_16x16x32_bf16 v[108:111], v[40:43], v[196:199], v[108:111]
    ds_read_b64_tr_b16 v[66:67], v10 offset:57856
    s_waitcnt lgkmcnt(10)
    v_mfma_f32_16x16x32_bf16 v[108:111], v[44:47], v[204:207], v[108:111]
    ds_read_b64_tr_b16 v[68:69], v10 offset:61440
    v_mfma_f32_16x16x32_bf16 v[104:107], v[40:43], v[192:195], v[104:107]
    ds_read_b64_tr_b16 v[70:71], v10 offset:61952
    v_mfma_f32_16x16x32_bf16 v[104:107], v[44:47], v[200:203], v[104:107]
    ds_read_b64_tr_b16 v[72:73], v11 offset:57344
    s_waitcnt lgkmcnt(7)
    v_mfma_f32_16x16x32_bf16 v[112:115], v[48:51], v[192:195], v[112:115]
    ds_read_b64_tr_b16 v[74:75], v11 offset:57856
    v_mfma_f32_16x16x32_bf16 v[112:115], v[52:55], v[200:203], v[112:115]
    ds_read_b64_tr_b16 v[76:77], v11 offset:61440
    v_mfma_f32_16x16x32_bf16 v[116:119], v[48:51], v[196:199], v[116:119]
    ds_read_b64_tr_b16 v[78:79], v11 offset:61952
    v_cvt_pk_bf16_f32 v176, v96, v97
    v_cvt_pk_bf16_f32 v177, v98, v99
    v_mfma_f32_16x16x32_bf16 v[116:119], v[52:55], v[204:207], v[116:119]
    ds_read_b64_tr_b16 v[80:81], v12 offset:57344
    v_cvt_pk_bf16_f32 v178, v100, v101
    v_cvt_pk_bf16_f32 v179, v102, v103
    v_mfma_f32_16x16x32_bf16 v[124:127], v[56:59], v[196:199], v[124:127]
    ds_read_b64_tr_b16 v[82:83], v12 offset:57856
    s_waitcnt lgkmcnt(8)
    v_mfma_f32_16x16x32_bf16 v[124:127], v[60:63], v[204:207], v[124:127]
    ds_read_b64_tr_b16 v[84:85], v12 offset:61440
    buffer_store_dwordx4 v[176:179], v15, s[24:27], s68 offen offset:0 sc1
    v_mfma_f32_16x16x32_bf16 v[120:123], v[56:59], v[192:195], v[120:123]
    ds_read_b64_tr_b16 v[86:87], v12 offset:61952
    v_cvt_pk_bf16_f32 v180, v104, v105
    v_cvt_pk_bf16_f32 v181, v106, v107
    v_mfma_f32_16x16x32_bf16 v[120:123], v[60:63], v[200:203], v[120:123]
    ds_read_b64_tr_b16 v[88:89], v13 offset:57344
    v_cvt_pk_bf16_f32 v182, v108, v109
    v_mfma_f32_16x16x32_bf16 v[128:131], v[64:67], v[192:195], v[128:131]
    ds_read_b64_tr_b16 v[90:91], v13 offset:57856
    s_waitcnt lgkmcnt(8)
    v_cvt_pk_bf16_f32 v183, v110, v111
    v_mfma_f32_16x16x32_bf16 v[128:131], v[68:71], v[200:203], v[128:131]
    ds_read_b64_tr_b16 v[92:93], v13 offset:61440
    buffer_store_dwordx4 v[180:183], v15, s[24:27], s68 offen offset:1024 sc1
    v_mfma_f32_16x16x32_bf16 v[132:135], v[64:67], v[196:199], v[132:135]
    ds_read_b64_tr_b16 v[94:95], v13 offset:61952
    v_cvt_pk_bf16_f32 v184, v112, v113
    v_cvt_pk_bf16_f32 v185, v114, v115
    v_mfma_f32_16x16x32_bf16 v[132:135], v[68:71], v[204:207], v[132:135]
    v_cvt_pk_bf16_f32 v186, v116, v117
    v_cvt_pk_bf16_f32 v187, v118, v119
    v_mfma_f32_16x16x32_bf16 v[140:143], v[72:75], v[196:199], v[140:143]
    s_waitcnt lgkmcnt(6)
    buffer_store_dwordx4 v[184:187], v15, s[24:27], s68 offen offset:2048 sc1
    v_mfma_f32_16x16x32_bf16 v[140:143], v[76:79], v[204:207], v[140:143]
    v_cvt_pk_bf16_f32 v188, v120, v121
    v_cvt_pk_bf16_f32 v189, v122, v123
    v_mfma_f32_16x16x32_bf16 v[136:139], v[72:75], v[192:195], v[136:139]
    v_cvt_pk_bf16_f32 v190, v124, v125
    v_cvt_pk_bf16_f32 v191, v126, v127
    v_mfma_f32_16x16x32_bf16 v[136:139], v[76:79], v[200:203], v[136:139]
    buffer_store_dwordx4 v[188:191], v15, s[24:27], s68 offen offset:3072 sc1
    v_mfma_f32_16x16x32_bf16 v[144:147], v[80:83], v[192:195], v[144:147]
    s_waitcnt lgkmcnt(0)
    s_barrier
    v_mfma_f32_16x16x32_bf16 v[144:147], v[84:87], v[200:203], v[144:147]
    v_mfma_f32_16x16x32_bf16 v[148:151], v[80:83], v[196:199], v[148:151]
    v_mfma_f32_16x16x32_bf16 v[148:151], v[84:87], v[204:207], v[148:151]
    v_mfma_f32_16x16x32_bf16 v[156:159], v[88:91], v[196:199], v[156:159]
    v_mfma_f32_16x16x32_bf16 v[156:159], v[92:95], v[204:207], v[156:159]
    v_mfma_f32_16x16x32_bf16 v[152:155], v[88:91], v[192:195], v[152:155]
    v_mfma_f32_16x16x32_bf16 v[152:155], v[92:95], v[200:203], v[152:155]
    s_sleep 3
    s_mov_b32 s66, 0x40000
L_p_vsp_154:
    buffer_load_dwordx4 v[80:83], v15, s[24:27], s69 offen offset:0 sc1
    buffer_load_dwordx4 v[84:87], v15, s[24:27], s69 offen offset:1024 sc1
    buffer_load_dwordx4 v[88:91], v15, s[24:27], s69 offen offset:2048 sc1
    buffer_load_dwordx4 v[92:95], v15, s[24:27], s69 offen offset:3072 sc1
    s_waitcnt vmcnt(0)
    v_max_u32 v2, v80, v81
    v_max3_u32 v2, v2, v82, v83
    v_max3_u32 v2, v2, v84, v85
    v_max3_u32 v2, v2, v86, v87
    v_max3_u32 v2, v2, v88, v89
    v_max3_u32 v2, v2, v90, v91
    v_max3_u32 v2, v2, v92, v93
    v_max3_u32 v2, v2, v94, v95
    v_cmp_eq_u32 vcc, -1, v2
    s_cmp_eq_u64 vcc, 0
    s_cbranch_scc1 L_p_vok_155
    s_sleep 2
    s_sub_u32 s66, s66, 1
    s_cmp_lg_u32 s66, 0
    s_cbranch_scc1 L_p_vsp_154
L_p_vok_155:
    v_lshlrev_b32 v16, 16, v80
    v_and_b32 v17, 0xffff0000, v80
    v_pk_add_f32 v[128:129], v[128:129], v[16:17]
    v_lshlrev_b32 v18, 16, v81
    v_and_b32 v19, 0xffff0000, v81
    v_pk_add_f32 v[130:131], v[130:131], v[18:19]
    v_lshlrev_b32 v16, 16, v82
    v_and_b32 v17, 0xffff0000, v82
    v_pk_add_f32 v[132:133], v[132:133], v[16:17]
    v_lshlrev_b32 v18, 16, v83
    v_and_b32 v19, 0xffff0000, v83
    v_pk_add_f32 v[134:135], v[134:135], v[18:19]
    v_cvt_pk_bf16_f32 v160, v128, v129
    v_cvt_pk_bf16_f32 v161, v130, v131
    v_cvt_pk_bf16_f32 v162, v132, v133
    v_cvt_pk_bf16_f32 v163, v134, v135
    ds_write_b64 v5, v[160:161] offset:0
    ds_write_b64 v5, v[162:163] offset:2304
    v_lshlrev_b32 v16, 16, v84
    v_and_b32 v17, 0xffff0000, v84
    v_pk_add_f32 v[136:137], v[136:137], v[16:17]
    v_lshlrev_b32 v18, 16, v85
    v_and_b32 v19, 0xffff0000, v85
    v_pk_add_f32 v[138:139], v[138:139], v[18:19]
    v_lshlrev_b32 v16, 16, v86
    v_and_b32 v17, 0xffff0000, v86
    v_pk_add_f32 v[140:141], v[140:141], v[16:17]
    v_lshlrev_b32 v18, 16, v87
    v_and_b32 v19, 0xffff0000, v87
    v_pk_add_f32 v[142:143], v[142:143], v[18:19]
    v_cvt_pk_bf16_f32 v164, v136, v137
    v_cvt_pk_bf16_f32 v165, v138, v139
    v_cvt_pk_bf16_f32 v166, v140, v141
    v_cvt_pk_bf16_f32 v167, v142, v143
    ds_write_b64 v5, v[164:165] offset:32
    ds_write_b64 v5, v[166:167] offset:2336
    v_lshlrev_b32 v16, 16, v88
    v_and_b32 v17, 0xffff0000, v88
    v_pk_add_f32 v[144:145], v[144:145], v[16:17]
    v_lshlrev_b32 v18, 16, v89
    v_and_b32 v19, 0xffff0000, v89
    v_pk_add_f32 v[146:147], v[146:147], v[18:19]
    v_lshlrev_b32 v16, 16, v90
    v_and_b32 v17, 0xffff0000, v90
    v_pk_add_f32 v[148:149], v[148:149], v[16:17]
    v_lshlrev_b32 v18, 16, v91
    v_and_b32 v19, 0xffff0000, v91
    v_pk_add_f32 v[150:151], v[150:151], v[18:19]
    v_cvt_pk_bf16_f32 v168, v144, v145
    v_cvt_pk_bf16_f32 v169, v146, v147
    v_cvt_pk_bf16_f32 v170, v148, v149
    v_cvt_pk_bf16_f32 v171, v150, v151
    ds_write_b64 v5, v[168:169] offset:64
    ds_write_b64 v5, v[170:171] offset:2368
    v_lshlrev_b32 v16, 16, v92
    v_and_b32 v17, 0xffff0000, v92
    v_pk_add_f32 v[152:153], v[152:153], v[16:17]
    v_lshlrev_b32 v18, 16, v93
    v_and_b32 v19, 0xffff0000, v93
    v_pk_add_f32 v[154:155], v[154:155], v[18:19]
    v_lshlrev_b32 v16, 16, v94
    v_and_b32 v17, 0xffff0000, v94
    v_pk_add_f32 v[156:157], v[156:157], v[16:17]
    v_lshlrev_b32 v18, 16, v95
    v_and_b32 v19, 0xffff0000, v95
    v_pk_add_f32 v[158:159], v[158:159], v[18:19]
    v_cvt_pk_bf16_f32 v172, v152, v153
    v_cvt_pk_bf16_f32 v173, v154, v155
    v_cvt_pk_bf16_f32 v174, v156, v157
    v_cvt_pk_bf16_f32 v175, v158, v159
    ds_write_b64 v5, v[172:173] offset:96
    ds_write_b64 v5, v[174:175] offset:2400
    s_waitcnt lgkmcnt(0)
    ds_read_b128 v[176:179], v6 offset:0
    ds_read_b128 v[180:183], v6 offset:1152
    ds_read_b128 v[184:187], v6 offset:2304
    ds_read_b128 v[188:191], v6 offset:3456
    s_waitcnt lgkmcnt(3)
    buffer_store_dwordx4 v[176:179], v7, s[20:23], s70 offen sc1
    s_add_u32 s70, s70, 16384
    s_waitcnt lgkmcnt(2)
    buffer_store_dwordx4 v[180:183], v7, s[20:23], s70 offen sc1
    s_add_u32 s70, s70, 16384
    s_waitcnt lgkmcnt(1)
    buffer_store_dwordx4 v[184:187], v7, s[20:23], s70 offen sc1
    s_add_u32 s70, s70, 16384
    s_waitcnt lgkmcnt(0)
    buffer_store_dwordx4 v[188:191], v7, s[20:23], s70 offen sc1
    s_add_u32 s70, s70, 16384
    s_branch L_fin
L_c_helper:
    s_waitcnt vmcnt(1)
    s_barrier
    s_barrier
    s_cmp_ge_u32 s3, 2
    s_cbranch_scc1 L_nopf
    s_mov_b32 s16, s48
    s_mov_b32 s17, s49
    s_mov_b32 s18, 3670016
    s_mov_b32 s19, 0x20000
    s_mov_b32 s20, s44
    s_mov_b32 s21, s45
    s_mov_b32 s22, 8388608
    s_mov_b32 s23, 0x20000
    s_sub_u32 s56, s2, 224
    s_mul_i32 s56, s56, 2
    s_add_u32 s56, s56, s3
    s_lshl_b32 s60, s56, 13
    v_lshlrev_b32 v2, 7, v1
    s_mov_b32 s80, 16
L_p_pf_156:
    buffer_load_dword v3, v2, s[20:23], s60 offen
    s_add_u32 s60, s60, 524288
    s_waitcnt vmcnt(1)
    s_sub_u32 s80, s80, 1
    s_cmp_lg_u32 s80, 0
    s_cbranch_scc1 L_p_pf_156
    s_lshl_b32 s60, s56, 13
    s_mov_b32 s80, 7
L_p_pf_157:
    buffer_load_dword v3, v2, s[16:19], s60 offen
    s_add_u32 s60, s60, 524288
    s_waitcnt vmcnt(1)
    s_sub_u32 s80, s80, 1
L_pad20:
    s_cbranch_execz L_padr20
    s_cmp_lg_u32 s80, 0
    s_cbranch_scc1 L_p_pf_157
    s_waitcnt vmcnt(0)
L_nopf:
    s_branch L_c_p5
L_fin:
L_end:
    s_endpgm

.section .rodata,"a"
.p2align 6
.amdhsa_kernel sequential_preLN__linear_kernel_hedgehog__mixer_gmlp__prompt_kernel
  .amdhsa_next_free_vgpr 256
  .amdhsa_next_free_sgpr 102
  .amdhsa_accum_offset 256
  .amdhsa_group_segment_fixed_size 0
  .amdhsa_kernarg_size 96
  .amdhsa_user_sgpr_count 2
  .amdhsa_user_sgpr_kernarg_segment_ptr 1
  .amdhsa_system_sgpr_workgroup_id_x 1
  .amdhsa_float_denorm_mode_32 3
.end_amdhsa_kernel
```
